```python
import torch

def _softmax(x, axis=-1):
    return torch.softmax(x, dim=axis)
def _gelu(x):
    return torch.nn.functional.gelu(x, approximate="tanh")
def _silu(x):
    return torch.nn.functional.silu(x)
def _sigmoid(x):
    return torch.sigmoid(x)
def _layernorm(x, axis=-1, eps=1e-5):
    m = x.mean(dim=axis, keepdim=True)
    v = x.var(dim=axis, keepdim=True, unbiased=False)
    return (x - m) / torch.sqrt(v + eps)
def _scatter_add(tgt, idx, src, axis=0):
    return tgt.clone().index_add_(axis, idx, src)
def _segment_sum(src, seg, n):
    out = torch.zeros((n,) + src.shape[1:], dtype=src.dtype)
    return out.index_add_(0, seg, src)
def _pad(x, pw):
    flat = tuple(v for pair in reversed(pw) for v in pair)
    return torch.nn.functional.pad(x, flat)

kernel_name = 'gated_mix__softmax_full_mha__geglu_ffn__prompt'

def setup_inputs():

    _w = (lambda a: (lambda t: t.to(torch.bfloat16) if t.is_floating_point() else t)(torch.as_tensor(a)))
    def _A_setup():
        B, S, D = 1, 2048, 576
        return {
            "x": _w((lambda *s: torch.randn(*s, dtype=torch.bfloat16) * 0.05)(B, S, D)),
            "wqkv": _w((lambda *s: torch.randn(*s, dtype=torch.bfloat16) * 0.8)(D, 3 * D)),
            "wo": _w((lambda *s: torch.randn(*s, dtype=torch.bfloat16) * 0.05)(D, D)),
        }
    _A_in = _A_setup()

    def _B_setup():
        B, S, D, F = 1, 2048, 576, 4608
        return {
            "x": _w((lambda *s: torch.randn(*s, dtype=torch.bfloat16) * 0.05)(B, S, D)),
            "w_gate": _w((lambda *s: torch.randn(*s, dtype=torch.bfloat16) * 0.1)(D, F)),
            "w_up": _w((lambda *s: torch.randn(*s, dtype=torch.bfloat16) * 0.1)(D, F)),
            "w_down": _w((lambda *s: torch.randn(*s, dtype=torch.bfloat16) * 0.1)(F, D)),
        }
    _B_in = _B_setup()

    return {
        "A_x": _A_in["x"],
        "A_wqkv": _A_in["wqkv"],
        "A_wo": _A_in["wo"],
        "B_x": _B_in["x"],
        "B_w_gate": _B_in["w_gate"],
        "B_w_up": _B_in["w_up"],
        "B_w_down": _B_in["w_down"],
        "gate_w": _w((lambda *s: torch.randn(*s, dtype=torch.bfloat16) * 0.05)(576) * 16.0),
    }

def reference(A_x, A_wqkv, A_wo, B_x, B_w_gate, B_w_up, B_w_down, gate_w):
    def _A_ref(x, wqkv, wo):
        B, S, D = x.shape
        H = 32; Dh = D // H
        qkv = (lambda x, *d: x.permute(*d))((x @ wqkv).reshape(B, S, 3, H, Dh), 2, 0, 3, 1, 4)
        q, k, v = qkv[0], qkv[1], qkv[2]
        scale = Dh ** -0.5
        scores = torch.einsum("bhqd,bhkd->bhqk", q, k) * scale
        p = _softmax(scores, axis=-1)
        o = torch.einsum("bhqk,bhkd->bhqd", p, v)
        return (lambda x, *d: x.permute(*d))(o, 0, 2, 1, 3).reshape(B, S, D) @ wo

    def _B_ref(x, w_gate, w_up, w_down):
        return (_gelu(x @ w_gate) * (x @ w_up)) @ w_down

    x = A_x
    g = _sigmoid((x * gate_w).sum(-1, keepdims=True))
    a = _A_ref(x, A_wqkv, A_wo)
    b = _B_ref(x, B_w_gate, B_w_up, B_w_down)
    return g * a + (1 - g) * b
```

```asm
; @launch kernel=l1_kernel grid=(256,1,1) block=(512,1,1) lds=163840
; @launch kernel=l2_kernel grid=(512,1,1) block=(256,1,1) lds=73728
; @launch kernel=l3_kernel grid=(192,1,1) block=(384,1,1) lds=98304
.amdgcn_target "amdgcn-amd-amdhsa--gfx950"
.text
.globl l1_kernel
.p2align 8
.type l1_kernel,@function
l1_kernel:
    s_load_dwordx4 s[48:51], s[0:1], 0
    s_load_dwordx4 s[52:55], s[0:1], 32
    s_load_dwordx2 s[56:57], s[0:1], 80
    s_load_dwordx2 s[58:59], s[0:1], 56
    s_cmp_ge_u32 s2, 256
    s_cbranch_scc1 L1_END
    v_lshrrev_b32 v16, 6, v0
    v_and_b32 v0, 63, v0
    v_readfirstlane_b32 s20, v16
    s_and_b32 s30, s2, 7
    s_lshr_b32 s31, s2, 3
    s_and_b32 s32, s30, 1
    s_lshl_b32 s32, s32, 2
    s_and_b32 s33, s31, 3
    s_add_u32 s21, s32, s33
    s_lshr_b32 s35, s30, 1
    s_lshr_b32 s22, s31, 2
    s_add_u32 s34, s33, s22
    s_and_b32 s34, s34, 3
    s_lshl_b32 s34, s34, 1
    v_lshrrev_b32 v17, 3, v0
    v_and_b32 v18, 7, v0
    v_lshrrev_b32 v19, 4, v0
    v_xor_b32 v19, v19, v18
    v_lshlrev_b32 v19, 4, v19
    v_mul_u32_u24 v20, 1152, v17
    v_add_u32 v3, v20, v19
    v_xor_b32 v19, 64, v19
    v_add_u32 v15, v20, v19
    v_lshlrev_b32 v20, 1, v17
    v_and_b32 v20, 4, v20
    v_xor_b32 v20, v20, v18
    v_lshlrev_b32 v20, 4, v20
    s_lshl_b32 s24, s20, 10
    s_lshl_b32 s23, s21, 3
    s_add_u32 s23, s23, s20
    s_mul_i32 s29, s23, 36864
    s_lshl_b32 s88, s34, 7
    s_add_u32 s88, s88, s29
    s_mov_b32 s6, 2359296
    s_mov_b32 s7, 0x00020000
    s_mov_b32 s11, 0x00020000
    s_cmp_lg_u32 s20, 7
    s_cbranch_scc1 L1_NOPF
    s_getpc_b64 s[98:99]
    s_and_b32 s98, s98, 0xffffff00
    s_mul_i32 s33, s31, 2432
    v_lshlrev_b32 v30, 7, v0
    v_add_u32 v30, s33, v30
    v_mov_b32 v31, s99
    v_add_co_u32 v30, vcc, s98, v30
    s_nop 1
    v_addc_co_u32 v31, vcc, 0, v31, vcc
    v_cmp_gt_u32 vcc, 19, v0
    s_nop 0
    s_and_saveexec_b64 s[96:97], vcc
    global_load_dword v32, v[30:31], off
    s_mov_b64 exec, -1
L1_NOPF:
    s_cmp_ge_u32 s22, 6
    s_cbranch_scc1 L1_QKV
    v_and_b32 v20, 2, v17
    s_and_b32 s33, s20, 1
    s_lshl_b32 s33, s33, 2
    v_or_b32 v20, s33, v20
    v_xor_b32 v20, v20, v18
    v_lshlrev_b32 v20, 4, v20
    v_mul_u32_u24 v2, 9216, v17
    v_add_u32 v2, v2, v20
    s_mul_i32 s35, s35, 6
    s_add_u32 s46, s35, s22
    s_mul_i32 s35, s46, 384
    s_mov_b32 s10, 5308416
    s_mul_i32 s47, s20, 73728
    s_add_u32 s47, s47, s35
    s_mul_i32 s36, s34, 589824
    s_add_u32 s36, s36, s47
    s_waitcnt lgkmcnt(0)
    s_mov_b32 s4, s48
    s_mov_b32 s5, s49
    s_mov_b32 s8, s52
    s_mov_b32 s9, s53
    s_cmp_ge_u32 s20, 4
    s_cbranch_scc1 L1_FF
    s_setprio 1
    s_add_u32 m0, s24, 0
    s_add_u32 s30, s36, 0
    buffer_load_dwordx4 v2, s[8:11], s30 offen lds
    s_add_u32 m0, m0, 4096
    s_add_u32 s30, s30, 294912
    buffer_load_dwordx4 v2, s[8:11], s30 offen lds
    s_add_u32 m0, s24, 98304
    s_add_u32 s30, s88, 0
    buffer_load_dwordx4 v3, s[4:7], s30 offen lds
    s_add_u32 m0, s24, 106496
    s_add_u32 s30, s88, 9216
    buffer_load_dwordx4 v15, s[4:7], s30 offen lds
    s_add_u32 m0, s24, 114688
    s_add_u32 s30, s88, 18432
    buffer_load_dwordx4 v3, s[4:7], s30 offen lds
    s_add_u32 m0, s24, 122880
    s_add_u32 s30, s88, 27648
    buffer_load_dwordx4 v15, s[4:7], s30 offen lds
    s_mov_b32 s12, s54
    s_mov_b32 s13, s55
    s_mov_b32 s14, 5308416
    s_mov_b32 s15, 0x00020000
    s_add_u32 s33, s47, 5308416
    s_add_u32 s35, s29, 1152
    s_add_u32 s37, s36, 589824
    s_cmp_eq_u32 s37, s33
    s_cselect_b32 s37, s47, s37
    s_add_u32 s89, s88, 128
    s_cmp_eq_u32 s89, s35
    s_cselect_b32 s89, s29, s89
    s_add_u32 s38, s37, 589824
    s_cmp_eq_u32 s38, s33
    s_cselect_b32 s38, s47, s38
    s_add_u32 s90, s89, 128
    s_cmp_eq_u32 s90, s35
    s_cselect_b32 s90, s29, s90
    s_add_u32 s39, s38, 589824
    s_cmp_eq_u32 s39, s33
    s_cselect_b32 s39, s47, s39
    s_add_u32 s91, s90, 128
    s_cmp_eq_u32 s91, s35
    s_cselect_b32 s91, s29, s91
    s_add_u32 s40, s39, 589824
    s_cmp_eq_u32 s40, s33
    s_cselect_b32 s40, s47, s40
    s_add_u32 s92, s91, 128
    s_cmp_eq_u32 s92, s35
    s_cselect_b32 s92, s29, s92
    s_add_u32 s41, s40, 589824
    s_cmp_eq_u32 s41, s33
    s_cselect_b32 s41, s47, s41
    s_add_u32 s93, s92, 128
    s_cmp_eq_u32 s93, s35
    s_cselect_b32 s93, s29, s93
    s_add_u32 s42, s41, 589824
    s_cmp_eq_u32 s42, s33
    s_cselect_b32 s42, s47, s42
    s_add_u32 s94, s93, 128
    s_cmp_eq_u32 s94, s35
    s_cselect_b32 s94, s29, s94
    s_add_u32 s43, s42, 589824
    s_cmp_eq_u32 s43, s33
    s_cselect_b32 s43, s47, s43
    s_add_u32 s95, s94, 128
    s_cmp_eq_u32 s95, s35
    s_cselect_b32 s95, s29, s95
    s_add_u32 s44, s43, 589824
    s_cmp_eq_u32 s44, s33
    s_cselect_b32 s44, s47, s44
    s_add_u32 s96, s95, 128
    s_cmp_eq_u32 s96, s35
    s_cselect_b32 s96, s29, s96
    s_barrier
    s_add_u32 m0, s24, 8192
    s_add_u32 s30, s36, 0
    buffer_load_dwordx4 v2, s[12:15], s30 offen lds
    s_add_u32 m0, m0, 4096
    s_add_u32 s30, s30, 294912
    buffer_load_dwordx4 v2, s[12:15], s30 offen lds
    s_add_u32 m0, s24, 16384
    s_add_u32 s30, s37, 0
    buffer_load_dwordx4 v2, s[8:11], s30 offen lds
    s_add_u32 m0, m0, 4096
    s_add_u32 s30, s30, 294912
    buffer_load_dwordx4 v2, s[8:11], s30 offen lds
    s_add_u32 m0, s24, 24576
    s_add_u32 s30, s38, 0
    buffer_load_dwordx4 v2, s[8:11], s30 offen lds
    s_add_u32 m0, m0, 4096
    s_add_u32 s30, s30, 294912
    buffer_load_dwordx4 v2, s[8:11], s30 offen lds
    s_add_u32 m0, s24, 32768
    s_add_u32 s30, s37, 0
    buffer_load_dwordx4 v2, s[12:15], s30 offen lds
    s_add_u32 m0, m0, 4096
    s_add_u32 s30, s30, 294912
    buffer_load_dwordx4 v2, s[12:15], s30 offen lds
    s_mov_b32 s16, s56
    s_mov_b32 s17, s57
    s_mov_b32 s18, 268435456
    s_mov_b32 s19, 0x00020000
    v_and_b32 v21, 15, v0
    v_lshrrev_b32 v22, 2, v21
    v_and_b32 v25, 3, v21
    v_lshrrev_b32 v23, 4, v0
    v_lshl_add_u32 v24, v23, 3, v22
    v_lshlrev_b32 v24, 7, v24
    v_lshl_add_u32 v24, v25, 3, v24
    v_lshrrev_b32 v22, 1, v22
    v_and_b32 v25, 1, v23
    v_lshl_add_u32 v22, v25, 1, v22
    v_lshl_add_u32 v4, v22, 5, v24
    v_xor_b32 v5, 32, v4
    v_xor_b32 v6, 64, v4
    v_xor_b32 v7, 96, v4
    v_lshrrev_b32 v22, 1, v21
    v_xor_b32 v22, v22, v23
    v_lshlrev_b32 v22, 4, v22
    v_and_b32 v24, 7, v21
    v_lshl_add_u32 v22, v24, 7, v22
    v_lshrrev_b32 v24, 3, v21
    v_lshl_add_u32 v22, v24, 13, v22
    s_add_u32 s33, s24, 0x18000
    v_add_u32 v11, s33, v22
    v_xor_b32 v12, 64, v11
    v_lshlrev_b32 v13, 9, v23
    v_lshl_add_u32 v13, v21, 4, v13
    v_add_u32 v8, 0x10000, v4
    v_add_u32 v9, 0x10000, v5
    v_add_u32 v1, 0x10000, v6
    v_add_u32 v0, 0x10000, v7
    v_mov_b32 v10, 0xc0135761
    s_mov_b32 s26, 0xbdd2d3e8
    s_mul_i32 s25, s23, 294912
    s_mul_i32 s33, s46, 12288
    s_add_u32 s25, s25, s33
    s_waitcnt vmcnt(8)
    ds_read_b128 v[112:115], v11 offset:0
    ds_read_b128 v[116:119], v11 offset:16384
    ds_read_b128 v[120:123], v12 offset:0
    ds_read_b128 v[124:127], v12 offset:16384
    s_add_u32 m0, s24, 40960
    s_add_u32 s30, s39, 0
    buffer_load_dwordx4 v2, s[8:11], s30 offen lds
    s_add_u32 m0, m0, 4096
    s_add_u32 s30, s30, 294912
    buffer_load_dwordx4 v2, s[8:11], s30 offen lds
    s_add_u32 m0, s24, 131072
    s_add_u32 s30, s89, 0
    buffer_load_dwordx4 v3, s[4:7], s30 offen lds
    s_add_u32 m0, s24, 139264
    s_add_u32 s30, s89, 9216
    buffer_load_dwordx4 v15, s[4:7], s30 offen lds
    s_add_u32 m0, s24, 147456
    s_add_u32 s30, s89, 18432
    buffer_load_dwordx4 v3, s[4:7], s30 offen lds
    s_barrier
    ds_read_b64_tr_b16 v[16:17], v4 offset:0
    ds_read_b64_tr_b16 v[18:19], v4 offset:512
    ds_read_b64_tr_b16 v[20:21], v5 offset:0
    ds_read_b64_tr_b16 v[22:23], v5 offset:512
    ds_read_b64_tr_b16 v[24:25], v6 offset:0
    ds_read_b64_tr_b16 v[26:27], v6 offset:512
    ds_read_b64_tr_b16 v[28:29], v7 offset:0
    ds_read_b64_tr_b16 v[30:31], v7 offset:512
    ds_read_b64_tr_b16 v[32:33], v4 offset:4096
    ds_read_b64_tr_b16 v[34:35], v4 offset:4608
    ds_read_b64_tr_b16 v[36:37], v5 offset:4096
    ds_read_b64_tr_b16 v[38:39], v5 offset:4608
    ds_read_b64_tr_b16 v[40:41], v6 offset:4096
    ds_read_b64_tr_b16 v[42:43], v6 offset:4608
    s_waitcnt lgkmcnt(10)
    v_mfma_f32_16x16x32_bf16 v[48:51], v[16:19], v[112:115], 0
    ds_read_b64_tr_b16 v[44:45], v7 offset:4096
    ds_read_b64_tr_b16 v[46:47], v7 offset:4608
    v_mfma_f32_16x16x32_bf16 v[64:67], v[16:19], v[116:119], 0
    s_add_u32 m0, s24, 155648
    s_add_u32 s30, s89, 27648
    buffer_load_dwordx4 v15, s[4:7], s30 offen lds
    s_add_u32 m0, s24, 49152
    s_add_u32 s30, s40, 0
    buffer_load_dwordx4 v2, s[8:11], s30 offen lds
    s_add_u32 m0, m0, 4096
    s_add_u32 s30, s30, 294912
    buffer_load_dwordx4 v2, s[8:11], s30 offen lds
    v_mfma_f32_16x16x32_bf16 v[52:55], v[20:23], v[112:115], 0
    v_mfma_f32_16x16x32_bf16 v[68:71], v[20:23], v[116:119], 0
    s_waitcnt vmcnt(14)
    s_barrier
    ds_read_b64_tr_b16 v[16:17], v4 offset:8192
    ds_read_b64_tr_b16 v[18:19], v4 offset:8704
    s_add_u32 m0, s24, 98304
    s_add_u32 s30, s90, 0
    buffer_load_dwordx4 v3, s[4:7], s30 offen lds
    s_add_u32 m0, s24, 106496
    s_add_u32 s30, s90, 9216
    buffer_load_dwordx4 v15, s[4:7], s30 offen lds
    s_waitcnt lgkmcnt(10)
    v_mfma_f32_16x16x32_bf16 v[56:59], v[24:27], v[112:115], 0
    ds_read_b64_tr_b16 v[20:21], v5 offset:8192
    ds_read_b64_tr_b16 v[22:23], v5 offset:8704
    v_mfma_f32_16x16x32_bf16 v[72:75], v[24:27], v[116:119], 0
    s_add_u32 m0, s24, 114688
    s_add_u32 s30, s90, 18432
    buffer_load_dwordx4 v3, s[4:7], s30 offen lds
    s_add_u32 m0, s24, 122880
    s_add_u32 s30, s90, 27648
    buffer_load_dwordx4 v15, s[4:7], s30 offen lds
    v_mfma_f32_16x16x32_bf16 v[60:63], v[28:31], v[112:115], 0
    ds_read_b64_tr_b16 v[24:25], v6 offset:8192
    ds_read_b64_tr_b16 v[26:27], v6 offset:8704
    v_mfma_f32_16x16x32_bf16 v[76:79], v[28:31], v[116:119], 0
    s_add_u32 m0, s24, 57344
    s_add_u32 s30, s38, 0
    buffer_load_dwordx4 v2, s[12:15], s30 offen lds
    s_add_u32 m0, m0, 4096
    s_add_u32 s30, s30, 294912
    buffer_load_dwordx4 v2, s[12:15], s30 offen lds
    s_waitcnt lgkmcnt(10)
    v_mfma_f32_16x16x32_bf16 v[48:51], v[32:35], v[120:123], v[48:51]
    ds_read_b64_tr_b16 v[28:29], v7 offset:8192
    ds_read_b64_tr_b16 v[30:31], v7 offset:8704
    v_mfma_f32_16x16x32_bf16 v[64:67], v[32:35], v[124:127], v[64:67]
    v_mfma_f32_16x16x32_bf16 v[52:55], v[36:39], v[120:123], v[52:55]
    ds_read_b64_tr_b16 v[32:33], v4 offset:12288
    ds_read_b64_tr_b16 v[34:35], v4 offset:12800
    v_mfma_f32_16x16x32_bf16 v[68:71], v[36:39], v[124:127], v[68:71]
    s_waitcnt lgkmcnt(10)
    v_mfma_f32_16x16x32_bf16 v[56:59], v[40:43], v[120:123], v[56:59]
    ds_read_b64_tr_b16 v[36:37], v5 offset:12288
    ds_read_b64_tr_b16 v[38:39], v5 offset:12800
    v_mfma_f32_16x16x32_bf16 v[72:75], v[40:43], v[124:127], v[72:75]
    v_mfma_f32_16x16x32_bf16 v[60:63], v[44:47], v[120:123], v[60:63]
    ds_read_b64_tr_b16 v[40:41], v6 offset:12288
    ds_read_b64_tr_b16 v[42:43], v6 offset:12800
    v_mfma_f32_16x16x32_bf16 v[76:79], v[44:47], v[124:127], v[76:79]
    s_waitcnt lgkmcnt(10)
    v_mfma_f32_16x16x32_bf16 v[80:83], v[16:19], v[112:115], 0
    ds_read_b64_tr_b16 v[44:45], v7 offset:12288
    ds_read_b64_tr_b16 v[46:47], v7 offset:12800
    v_mfma_f32_16x16x32_bf16 v[96:99], v[16:19], v[116:119], 0
    v_mfma_f32_16x16x32_bf16 v[84:87], v[20:23], v[112:115], 0
    v_mfma_f32_16x16x32_bf16 v[100:103], v[20:23], v[116:119], 0
    s_waitcnt vmcnt(18)
    s_barrier
    ds_read_b64_tr_b16 v[16:17], v4 offset:16384
    ds_read_b64_tr_b16 v[18:19], v4 offset:16896
    s_add_u32 m0, s24, 65536
    s_add_u32 s30, s41, 0
    buffer_load_dwordx4 v2, s[8:11], s30 offen lds
    s_add_u32 m0, m0, 4096
    s_add_u32 s30, s30, 294912
    buffer_load_dwordx4 v2, s[8:11], s30 offen lds
    s_waitcnt lgkmcnt(10)
    v_mfma_f32_16x16x32_bf16 v[88:91], v[24:27], v[112:115], 0
    ds_read_b64_tr_b16 v[20:21], v5 offset:16384
    ds_read_b64_tr_b16 v[22:23], v5 offset:16896
    v_mfma_f32_16x16x32_bf16 v[104:107], v[24:27], v[116:119], 0
    v_mfma_f32_16x16x32_bf16 v[92:95], v[28:31], v[112:115], 0
    ds_read_b64_tr_b16 v[24:25], v6 offset:16384
    ds_read_b64_tr_b16 v[26:27], v6 offset:16896
    v_mfma_f32_16x16x32_bf16 v[108:111], v[28:31], v[116:119], 0
    s_waitcnt lgkmcnt(10)
    v_mfma_f32_16x16x32_bf16 v[80:83], v[32:35], v[120:123], v[80:83]
    ds_read_b64_tr_b16 v[28:29], v7 offset:16384
    ds_read_b64_tr_b16 v[30:31], v7 offset:16896
    v_mfma_f32_16x16x32_bf16 v[96:99], v[32:35], v[124:127], v[96:99]
    s_waitcnt vmcnt(10)
    ds_read_b128 v[128:131], v11 offset:32768
    ds_read_b128 v[132:135], v11 offset:49152
    ds_read_b128 v[136:139], v12 offset:32768
    ds_read_b128 v[140:143], v12 offset:49152
    v_mfma_f32_16x16x32_bf16 v[84:87], v[36:39], v[120:123], v[84:87]
    ds_read_b64_tr_b16 v[32:33], v4 offset:20480
    ds_read_b64_tr_b16 v[34:35], v4 offset:20992
    v_mfma_f32_16x16x32_bf16 v[100:103], v[36:39], v[124:127], v[100:103]
    s_waitcnt lgkmcnt(14)
    v_mfma_f32_16x16x32_bf16 v[88:91], v[40:43], v[120:123], v[88:91]
    ds_read_b64_tr_b16 v[36:37], v5 offset:20480
    ds_read_b64_tr_b16 v[38:39], v5 offset:20992
    v_mfma_f32_16x16x32_bf16 v[104:107], v[40:43], v[124:127], v[104:107]
    v_mfma_f32_16x16x32_bf16 v[92:95], v[44:47], v[120:123], v[92:95]
    ds_read_b64_tr_b16 v[40:41], v6 offset:20480
    ds_read_b64_tr_b16 v[42:43], v6 offset:20992
    v_mfma_f32_16x16x32_bf16 v[108:111], v[44:47], v[124:127], v[108:111]
    s_waitcnt lgkmcnt(14)
    s_waitcnt lgkmcnt(6)
    v_mfma_f32_16x16x32_bf16 v[48:51], v[16:19], v[128:131], v[48:51]
    ds_read_b64_tr_b16 v[44:45], v7 offset:20480
    ds_read_b64_tr_b16 v[46:47], v7 offset:20992
    v_mfma_f32_16x16x32_bf16 v[64:67], v[16:19], v[132:135], v[64:67]
    s_add_u32 m0, s24, 131072
    s_add_u32 s30, s91, 0
    buffer_load_dwordx4 v3, s[4:7], s30 offen lds
    s_add_u32 m0, s24, 139264
    s_add_u32 s30, s91, 9216
    buffer_load_dwordx4 v15, s[4:7], s30 offen lds
    v_mfma_f32_16x16x32_bf16 v[52:55], v[20:23], v[128:131], v[52:55]
    v_mfma_f32_16x16x32_bf16 v[68:71], v[20:23], v[132:135], v[68:71]
    s_barrier
    ds_read_b64_tr_b16 v[16:17], v4 offset:24576
    ds_read_b64_tr_b16 v[18:19], v4 offset:25088
    s_add_u32 m0, s24, 147456
    s_add_u32 s30, s91, 18432
    buffer_load_dwordx4 v3, s[4:7], s30 offen lds
    s_add_u32 m0, s24, 155648
    s_add_u32 s30, s91, 27648
    buffer_load_dwordx4 v15, s[4:7], s30 offen lds
    v_mfma_f32_16x16x32_bf16 v[56:59], v[24:27], v[128:131], v[56:59]
    ds_read_b64_tr_b16 v[20:21], v5 offset:24576
    ds_read_b64_tr_b16 v[22:23], v5 offset:25088
    v_mfma_f32_16x16x32_bf16 v[72:75], v[24:27], v[132:135], v[72:75]
    s_add_u32 m0, s24, 73728
    s_add_u32 s30, s42, 0
    buffer_load_dwordx4 v2, s[8:11], s30 offen lds
    s_add_u32 m0, m0, 4096
    s_add_u32 s30, s30, 294912
    buffer_load_dwordx4 v2, s[8:11], s30 offen lds
    v_mfma_f32_16x16x32_bf16 v[60:63], v[28:31], v[128:131], v[60:63]
    ds_read_b64_tr_b16 v[24:25], v6 offset:24576
    ds_read_b64_tr_b16 v[26:27], v6 offset:25088
    v_mfma_f32_16x16x32_bf16 v[76:79], v[28:31], v[132:135], v[76:79]
    s_waitcnt lgkmcnt(10)
    v_mfma_f32_16x16x32_bf16 v[48:51], v[32:35], v[136:139], v[48:51]
    ds_read_b64_tr_b16 v[28:29], v7 offset:24576
    ds_read_b64_tr_b16 v[30:31], v7 offset:25088
    v_mfma_f32_16x16x32_bf16 v[64:67], v[32:35], v[140:143], v[64:67]
    s_waitcnt vmcnt(10)
    ds_read_b128 v[144:147], v11 offset:0
    ds_read_b128 v[148:151], v11 offset:16384
    ds_read_b128 v[152:155], v12 offset:0
    ds_read_b128 v[156:159], v12 offset:16384
    v_mfma_f32_16x16x32_bf16 v[52:55], v[36:39], v[136:139], v[52:55]
    ds_read_b64_tr_b16 v[32:33], v4 offset:28672
    ds_read_b64_tr_b16 v[34:35], v4 offset:29184
    v_mfma_f32_16x16x32_bf16 v[68:71], v[36:39], v[140:143], v[68:71]
    s_waitcnt lgkmcnt(14)
    v_mfma_f32_16x16x32_bf16 v[56:59], v[40:43], v[136:139], v[56:59]
    ds_read_b64_tr_b16 v[36:37], v5 offset:28672
    ds_read_b64_tr_b16 v[38:39], v5 offset:29184
    v_mfma_f32_16x16x32_bf16 v[72:75], v[40:43], v[140:143], v[72:75]
    v_mfma_f32_16x16x32_bf16 v[60:63], v[44:47], v[136:139], v[60:63]
    ds_read_b64_tr_b16 v[40:41], v6 offset:28672
    ds_read_b64_tr_b16 v[42:43], v6 offset:29184
    v_mfma_f32_16x16x32_bf16 v[76:79], v[44:47], v[140:143], v[76:79]
    s_waitcnt lgkmcnt(14)
    s_waitcnt lgkmcnt(6)
    v_mfma_f32_16x16x32_bf16 v[48:51], v[16:19], v[144:147], v[48:51]
    ds_read_b64_tr_b16 v[44:45], v7 offset:28672
    ds_read_b64_tr_b16 v[46:47], v7 offset:29184
    v_mfma_f32_16x16x32_bf16 v[64:67], v[16:19], v[148:151], v[64:67]
    s_add_u32 m0, s24, 98304
    s_add_u32 s30, s92, 0
    buffer_load_dwordx4 v3, s[4:7], s30 offen lds
    s_add_u32 m0, s24, 106496
    s_add_u32 s30, s92, 9216
    buffer_load_dwordx4 v15, s[4:7], s30 offen lds
    v_mfma_f32_16x16x32_bf16 v[52:55], v[20:23], v[144:147], v[52:55]
    ds_read_b64_tr_b16 v[16:17], v4 offset:32768
    ds_read_b64_tr_b16 v[18:19], v4 offset:33280
    v_mfma_f32_16x16x32_bf16 v[68:71], v[20:23], v[148:151], v[68:71]
    s_add_u32 m0, s24, 114688
    s_add_u32 s30, s92, 18432
    buffer_load_dwordx4 v3, s[4:7], s30 offen lds
    s_add_u32 m0, s24, 122880
    s_add_u32 s30, s92, 27648
    buffer_load_dwordx4 v15, s[4:7], s30 offen lds
    v_mfma_f32_16x16x32_bf16 v[56:59], v[24:27], v[144:147], v[56:59]
    ds_read_b64_tr_b16 v[20:21], v5 offset:32768
    ds_read_b64_tr_b16 v[22:23], v5 offset:33280
    v_mfma_f32_16x16x32_bf16 v[72:75], v[24:27], v[148:151], v[72:75]
    s_add_u32 m0, s24, 81920
    s_add_u32 s30, s39, 0
    buffer_load_dwordx4 v2, s[12:15], s30 offen lds
    s_add_u32 m0, m0, 4096
    s_add_u32 s30, s30, 294912
    buffer_load_dwordx4 v2, s[12:15], s30 offen lds
    s_add_u32 m0, s24, 90112
    s_add_u32 s30, s43, 0
    buffer_load_dwordx4 v2, s[8:11], s30 offen lds
    s_add_u32 m0, m0, 4096
    s_add_u32 s30, s30, 294912
    buffer_load_dwordx4 v2, s[8:11], s30 offen lds
    v_mfma_f32_16x16x32_bf16 v[60:63], v[28:31], v[144:147], v[60:63]
    ds_read_b64_tr_b16 v[24:25], v6 offset:32768
    ds_read_b64_tr_b16 v[26:27], v6 offset:33280
    v_mfma_f32_16x16x32_bf16 v[76:79], v[28:31], v[148:151], v[76:79]
    s_waitcnt lgkmcnt(10)
    v_mfma_f32_16x16x32_bf16 v[48:51], v[32:35], v[152:155], v[48:51]
    ds_read_b64_tr_b16 v[28:29], v7 offset:32768
    ds_read_b64_tr_b16 v[30:31], v7 offset:33280
    v_mfma_f32_16x16x32_bf16 v[64:67], v[32:35], v[156:159], v[64:67]
    v_mfma_f32_16x16x32_bf16 v[52:55], v[36:39], v[152:155], v[52:55]
    ds_read_b64_tr_b16 v[32:33], v4 offset:36864
    ds_read_b64_tr_b16 v[34:35], v4 offset:37376
    v_mfma_f32_16x16x32_bf16 v[68:71], v[36:39], v[156:159], v[68:71]
    s_waitcnt lgkmcnt(10)
    v_mfma_f32_16x16x32_bf16 v[56:59], v[40:43], v[152:155], v[56:59]
    ds_read_b64_tr_b16 v[36:37], v5 offset:36864
    ds_read_b64_tr_b16 v[38:39], v5 offset:37376
    v_mfma_f32_16x16x32_bf16 v[72:75], v[40:43], v[156:159], v[72:75]
    v_mfma_f32_16x16x32_bf16 v[60:63], v[44:47], v[152:155], v[60:63]
    ds_read_b64_tr_b16 v[40:41], v6 offset:36864
    ds_read_b64_tr_b16 v[42:43], v6 offset:37376
    v_mfma_f32_16x16x32_bf16 v[76:79], v[44:47], v[156:159], v[76:79]
    s_waitcnt lgkmcnt(10)
    v_mfma_f32_16x16x32_bf16 v[80:83], v[16:19], v[128:131], v[80:83]
    ds_read_b64_tr_b16 v[44:45], v7 offset:36864
    ds_read_b64_tr_b16 v[46:47], v7 offset:37376
    v_mfma_f32_16x16x32_bf16 v[96:99], v[16:19], v[132:135], v[96:99]
    v_mfma_f32_16x16x32_bf16 v[84:87], v[20:23], v[128:131], v[84:87]
    ds_read_b64_tr_b16 v[16:17], v4 offset:40960
    ds_read_b64_tr_b16 v[18:19], v4 offset:41472
    v_mfma_f32_16x16x32_bf16 v[100:103], v[20:23], v[132:135], v[100:103]
    s_waitcnt lgkmcnt(10)
    v_mfma_f32_16x16x32_bf16 v[88:91], v[24:27], v[128:131], v[88:91]
    ds_read_b64_tr_b16 v[20:21], v5 offset:40960
    ds_read_b64_tr_b16 v[22:23], v5 offset:41472
    v_mfma_f32_16x16x32_bf16 v[104:107], v[24:27], v[132:135], v[104:107]
    v_mfma_f32_16x16x32_bf16 v[92:95], v[28:31], v[128:131], v[92:95]
    ds_read_b64_tr_b16 v[24:25], v6 offset:40960
    ds_read_b64_tr_b16 v[26:27], v6 offset:41472
    v_mfma_f32_16x16x32_bf16 v[108:111], v[28:31], v[132:135], v[108:111]
    s_waitcnt lgkmcnt(10)
    v_mfma_f32_16x16x32_bf16 v[80:83], v[32:35], v[136:139], v[80:83]
    ds_read_b64_tr_b16 v[28:29], v7 offset:40960
    ds_read_b64_tr_b16 v[30:31], v7 offset:41472
    v_mfma_f32_16x16x32_bf16 v[96:99], v[32:35], v[140:143], v[96:99]
    s_waitcnt vmcnt(10)
    ds_read_b128 v[160:163], v11 offset:32768
    ds_read_b128 v[164:167], v11 offset:49152
    ds_read_b128 v[168:171], v12 offset:32768
    ds_read_b128 v[172:175], v12 offset:49152
    v_mfma_f32_16x16x32_bf16 v[84:87], v[36:39], v[136:139], v[84:87]
    ds_read_b64_tr_b16 v[32:33], v4 offset:45056
    ds_read_b64_tr_b16 v[34:35], v4 offset:45568
    v_mfma_f32_16x16x32_bf16 v[100:103], v[36:39], v[140:143], v[100:103]
    s_waitcnt lgkmcnt(14)
    v_mfma_f32_16x16x32_bf16 v[88:91], v[40:43], v[136:139], v[88:91]
    ds_read_b64_tr_b16 v[36:37], v5 offset:45056
    ds_read_b64_tr_b16 v[38:39], v5 offset:45568
    v_mfma_f32_16x16x32_bf16 v[104:107], v[40:43], v[140:143], v[104:107]
    v_mfma_f32_16x16x32_bf16 v[92:95], v[44:47], v[136:139], v[92:95]
    ds_read_b64_tr_b16 v[40:41], v6 offset:45056
    ds_read_b64_tr_b16 v[42:43], v6 offset:45568
    v_mfma_f32_16x16x32_bf16 v[108:111], v[44:47], v[140:143], v[108:111]
    s_waitcnt lgkmcnt(14)
    s_waitcnt lgkmcnt(6)
    v_mfma_f32_16x16x32_bf16 v[48:51], v[16:19], v[160:163], v[48:51]
    ds_read_b64_tr_b16 v[44:45], v7 offset:45056
    ds_read_b64_tr_b16 v[46:47], v7 offset:45568
    v_mfma_f32_16x16x32_bf16 v[64:67], v[16:19], v[164:167], v[64:67]
    s_add_u32 m0, s24, 131072
    s_add_u32 s30, s93, 0
    buffer_load_dwordx4 v3, s[4:7], s30 offen lds
    s_add_u32 m0, s24, 139264
    s_add_u32 s30, s93, 9216
    buffer_load_dwordx4 v15, s[4:7], s30 offen lds
    v_mfma_f32_16x16x32_bf16 v[52:55], v[20:23], v[160:163], v[52:55]
    v_mfma_f32_16x16x32_bf16 v[68:71], v[20:23], v[164:167], v[68:71]
    s_barrier
    ds_read_b64_tr_b16 v[16:17], v4 offset:49152
    ds_read_b64_tr_b16 v[18:19], v4 offset:49664
    s_add_u32 m0, s24, 147456
    s_add_u32 s30, s93, 18432
    buffer_load_dwordx4 v3, s[4:7], s30 offen lds
    s_add_u32 m0, s24, 155648
    s_add_u32 s30, s93, 27648
    buffer_load_dwordx4 v15, s[4:7], s30 offen lds
    v_mfma_f32_16x16x32_bf16 v[56:59], v[24:27], v[160:163], v[56:59]
    ds_read_b64_tr_b16 v[20:21], v5 offset:49152
    ds_read_b64_tr_b16 v[22:23], v5 offset:49664
    v_mfma_f32_16x16x32_bf16 v[72:75], v[24:27], v[164:167], v[72:75]
    s_add_u32 m0, s24, 0
    s_add_u32 s30, s44, 0
    buffer_load_dwordx4 v2, s[8:11], s30 offen lds
    s_add_u32 m0, m0, 4096
    s_add_u32 s30, s30, 294912
    buffer_load_dwordx4 v2, s[8:11], s30 offen lds
    v_mfma_f32_16x16x32_bf16 v[60:63], v[28:31], v[160:163], v[60:63]
    ds_read_b64_tr_b16 v[24:25], v6 offset:49152
    ds_read_b64_tr_b16 v[26:27], v6 offset:49664
    v_mfma_f32_16x16x32_bf16 v[76:79], v[28:31], v[164:167], v[76:79]
    s_waitcnt lgkmcnt(10)
    v_mfma_f32_16x16x32_bf16 v[48:51], v[32:35], v[168:171], v[48:51]
    ds_read_b64_tr_b16 v[28:29], v7 offset:49152
    ds_read_b64_tr_b16 v[30:31], v7 offset:49664
    v_mfma_f32_16x16x32_bf16 v[64:67], v[32:35], v[172:175], v[64:67]
    s_waitcnt vmcnt(10)
    ds_read_b128 v[176:179], v11 offset:0
    ds_read_b128 v[180:183], v11 offset:16384
    ds_read_b128 v[184:187], v12 offset:0
    ds_read_b128 v[188:191], v12 offset:16384
    v_mfma_f32_16x16x32_bf16 v[52:55], v[36:39], v[168:171], v[52:55]
    ds_read_b64_tr_b16 v[32:33], v4 offset:53248
    ds_read_b64_tr_b16 v[34:35], v4 offset:53760
    v_mfma_f32_16x16x32_bf16 v[68:71], v[36:39], v[172:175], v[68:71]
    s_waitcnt lgkmcnt(14)
    v_mfma_f32_16x16x32_bf16 v[56:59], v[40:43], v[168:171], v[56:59]
    ds_read_b64_tr_b16 v[36:37], v5 offset:53248
    ds_read_b64_tr_b16 v[38:39], v5 offset:53760
    v_mfma_f32_16x16x32_bf16 v[72:75], v[40:43], v[172:175], v[72:75]
    v_mfma_f32_16x16x32_bf16 v[60:63], v[44:47], v[168:171], v[60:63]
    ds_read_b64_tr_b16 v[40:41], v6 offset:53248
    ds_read_b64_tr_b16 v[42:43], v6 offset:53760
    v_mfma_f32_16x16x32_bf16 v[76:79], v[44:47], v[172:175], v[76:79]
    s_waitcnt lgkmcnt(14)
    s_waitcnt lgkmcnt(6)
    v_mfma_f32_16x16x32_bf16 v[48:51], v[16:19], v[176:179], v[48:51]
    ds_read_b64_tr_b16 v[44:45], v7 offset:53248
    ds_read_b64_tr_b16 v[46:47], v7 offset:53760
    v_mfma_f32_16x16x32_bf16 v[64:67], v[16:19], v[180:183], v[64:67]
    s_add_u32 m0, s24, 98304
    s_add_u32 s30, s94, 0
    buffer_load_dwordx4 v3, s[4:7], s30 offen lds
    s_add_u32 m0, s24, 106496
    s_add_u32 s30, s94, 9216
    buffer_load_dwordx4 v15, s[4:7], s30 offen lds
    v_mfma_f32_16x16x32_bf16 v[52:55], v[20:23], v[176:179], v[52:55]
    ds_read_b64_tr_b16 v[16:17], v4 offset:57344
    ds_read_b64_tr_b16 v[18:19], v4 offset:57856
    v_mfma_f32_16x16x32_bf16 v[68:71], v[20:23], v[180:183], v[68:71]
    s_add_u32 m0, s24, 114688
    s_add_u32 s30, s94, 18432
    buffer_load_dwordx4 v3, s[4:7], s30 offen lds
    s_add_u32 m0, s24, 122880
    s_add_u32 s30, s94, 27648
    buffer_load_dwordx4 v15, s[4:7], s30 offen lds
    v_mfma_f32_16x16x32_bf16 v[56:59], v[24:27], v[176:179], v[56:59]
    ds_read_b64_tr_b16 v[20:21], v5 offset:57344
    ds_read_b64_tr_b16 v[22:23], v5 offset:57856
    v_mfma_f32_16x16x32_bf16 v[72:75], v[24:27], v[180:183], v[72:75]
    s_add_u32 m0, s24, 8192
    s_add_u32 s30, s40, 0
    buffer_load_dwordx4 v2, s[12:15], s30 offen lds
    s_add_u32 m0, m0, 4096
    s_add_u32 s30, s30, 294912
    buffer_load_dwordx4 v2, s[12:15], s30 offen lds
    s_add_u32 m0, s24, 16384
    s_add_u32 s30, s41, 0
    buffer_load_dwordx4 v2, s[12:15], s30 offen lds
    s_add_u32 m0, m0, 4096
    s_add_u32 s30, s30, 294912
    buffer_load_dwordx4 v2, s[12:15], s30 offen lds
    v_mfma_f32_16x16x32_bf16 v[60:63], v[28:31], v[176:179], v[60:63]
    ds_read_b64_tr_b16 v[24:25], v6 offset:57344
    ds_read_b64_tr_b16 v[26:27], v6 offset:57856
    v_mfma_f32_16x16x32_bf16 v[76:79], v[28:31], v[180:183], v[76:79]
    s_waitcnt lgkmcnt(10)
    v_mfma_f32_16x16x32_bf16 v[48:51], v[32:35], v[184:187], v[48:51]
    ds_read_b64_tr_b16 v[28:29], v7 offset:57344
    ds_read_b64_tr_b16 v[30:31], v7 offset:57856
    v_mfma_f32_16x16x32_bf16 v[64:67], v[32:35], v[188:191], v[64:67]
    v_mfma_f32_16x16x32_bf16 v[52:55], v[36:39], v[184:187], v[52:55]
    ds_read_b64_tr_b16 v[32:33], v4 offset:61440
    ds_read_b64_tr_b16 v[34:35], v4 offset:61952
    v_mfma_f32_16x16x32_bf16 v[68:71], v[36:39], v[188:191], v[68:71]
    s_waitcnt lgkmcnt(10)
    v_mfma_f32_16x16x32_bf16 v[56:59], v[40:43], v[184:187], v[56:59]
    ds_read_b64_tr_b16 v[36:37], v5 offset:61440
    ds_read_b64_tr_b16 v[38:39], v5 offset:61952
    v_mfma_f32_16x16x32_bf16 v[72:75], v[40:43], v[188:191], v[72:75]
    v_mfma_f32_16x16x32_bf16 v[60:63], v[44:47], v[184:187], v[60:63]
    ds_read_b64_tr_b16 v[40:41], v6 offset:61440
    ds_read_b64_tr_b16 v[42:43], v6 offset:61952
    v_mfma_f32_16x16x32_bf16 v[76:79], v[44:47], v[188:191], v[76:79]
    s_waitcnt lgkmcnt(10)
    v_mfma_f32_16x16x32_bf16 v[80:83], v[16:19], v[144:147], v[80:83]
    ds_read_b64_tr_b16 v[44:45], v7 offset:61440
    ds_read_b64_tr_b16 v[46:47], v7 offset:61952
    v_mfma_f32_16x16x32_bf16 v[96:99], v[16:19], v[148:151], v[96:99]
    v_mfma_f32_16x16x32_bf16 v[84:87], v[20:23], v[144:147], v[84:87]
    ds_read_b64_tr_b16 v[16:17], v8 offset:0
    ds_read_b64_tr_b16 v[18:19], v8 offset:512
    v_mfma_f32_16x16x32_bf16 v[100:103], v[20:23], v[148:151], v[100:103]
    s_waitcnt lgkmcnt(10)
    v_mfma_f32_16x16x32_bf16 v[88:91], v[24:27], v[144:147], v[88:91]
    ds_read_b64_tr_b16 v[20:21], v9 offset:0
    ds_read_b64_tr_b16 v[22:23], v9 offset:512
    v_mfma_f32_16x16x32_bf16 v[104:107], v[24:27], v[148:151], v[104:107]
    v_mfma_f32_16x16x32_bf16 v[92:95], v[28:31], v[144:147], v[92:95]
    ds_read_b64_tr_b16 v[24:25], v1 offset:0
    ds_read_b64_tr_b16 v[26:27], v1 offset:512
    v_mfma_f32_16x16x32_bf16 v[108:111], v[28:31], v[148:151], v[108:111]
    s_waitcnt lgkmcnt(10)
    v_mfma_f32_16x16x32_bf16 v[80:83], v[32:35], v[152:155], v[80:83]
    ds_read_b64_tr_b16 v[28:29], v0 offset:0
    ds_read_b64_tr_b16 v[30:31], v0 offset:512
    v_mfma_f32_16x16x32_bf16 v[96:99], v[32:35], v[156:159], v[96:99]
    s_waitcnt vmcnt(10)
    ds_read_b128 v[192:195], v11 offset:32768
    ds_read_b128 v[196:199], v11 offset:49152
    ds_read_b128 v[200:203], v12 offset:32768
    ds_read_b128 v[204:207], v12 offset:49152
    v_mfma_f32_16x16x32_bf16 v[84:87], v[36:39], v[152:155], v[84:87]
    ds_read_b64_tr_b16 v[32:33], v8 offset:4096
    ds_read_b64_tr_b16 v[34:35], v8 offset:4608
    v_mfma_f32_16x16x32_bf16 v[100:103], v[36:39], v[156:159], v[100:103]
    s_waitcnt lgkmcnt(14)
    v_mfma_f32_16x16x32_bf16 v[88:91], v[40:43], v[152:155], v[88:91]
    ds_read_b64_tr_b16 v[36:37], v9 offset:4096
    ds_read_b64_tr_b16 v[38:39], v9 offset:4608
    v_mfma_f32_16x16x32_bf16 v[104:107], v[40:43], v[156:159], v[104:107]
    v_mfma_f32_16x16x32_bf16 v[92:95], v[44:47], v[152:155], v[92:95]
    ds_read_b64_tr_b16 v[40:41], v1 offset:4096
    ds_read_b64_tr_b16 v[42:43], v1 offset:4608
    v_mfma_f32_16x16x32_bf16 v[108:111], v[44:47], v[156:159], v[108:111]
    s_waitcnt lgkmcnt(14)
    s_waitcnt lgkmcnt(6)
    v_mfma_f32_16x16x32_bf16 v[48:51], v[16:19], v[192:195], v[48:51]
    ds_read_b64_tr_b16 v[44:45], v0 offset:4096
    ds_read_b64_tr_b16 v[46:47], v0 offset:4608
    v_mfma_f32_16x16x32_bf16 v[64:67], v[16:19], v[196:199], v[64:67]
    s_add_u32 m0, s24, 131072
    s_add_u32 s30, s95, 0
    buffer_load_dwordx4 v3, s[4:7], s30 offen lds
    s_add_u32 m0, s24, 139264
    s_add_u32 s30, s95, 9216
    buffer_load_dwordx4 v15, s[4:7], s30 offen lds
    v_mfma_f32_16x16x32_bf16 v[52:55], v[20:23], v[192:195], v[52:55]
    v_mfma_f32_16x16x32_bf16 v[68:71], v[20:23], v[196:199], v[68:71]
    s_barrier
    ds_read_b64_tr_b16 v[16:17], v8 offset:8192
    ds_read_b64_tr_b16 v[18:19], v8 offset:8704
    s_add_u32 m0, s24, 147456
    s_add_u32 s30, s95, 18432
    buffer_load_dwordx4 v3, s[4:7], s30 offen lds
    s_add_u32 m0, s24, 155648
    s_add_u32 s30, s95, 27648
    buffer_load_dwordx4 v15, s[4:7], s30 offen lds
    v_mfma_f32_16x16x32_bf16 v[56:59], v[24:27], v[192:195], v[56:59]
    ds_read_b64_tr_b16 v[20:21], v9 offset:8192
    ds_read_b64_tr_b16 v[22:23], v9 offset:8704
    v_mfma_f32_16x16x32_bf16 v[72:75], v[24:27], v[196:199], v[72:75]
    s_add_u32 m0, s24, 24576
    s_add_u32 s30, s42, 0
    buffer_load_dwordx4 v2, s[12:15], s30 offen lds
    s_add_u32 m0, m0, 4096
    s_add_u32 s30, s30, 294912
    buffer_load_dwordx4 v2, s[12:15], s30 offen lds
    v_mfma_f32_16x16x32_bf16 v[60:63], v[28:31], v[192:195], v[60:63]
    ds_read_b64_tr_b16 v[24:25], v1 offset:8192
    ds_read_b64_tr_b16 v[26:27], v1 offset:8704
    v_mfma_f32_16x16x32_bf16 v[76:79], v[28:31], v[196:199], v[76:79]
    s_waitcnt lgkmcnt(10)
    v_mfma_f32_16x16x32_bf16 v[48:51], v[32:35], v[200:203], v[48:51]
    ds_read_b64_tr_b16 v[28:29], v0 offset:8192
    ds_read_b64_tr_b16 v[30:31], v0 offset:8704
    v_mfma_f32_16x16x32_bf16 v[64:67], v[32:35], v[204:207], v[64:67]
    s_waitcnt vmcnt(10)
    ds_read_b128 v[208:211], v11 offset:0
    ds_read_b128 v[212:215], v11 offset:16384
    ds_read_b128 v[216:219], v12 offset:0
    ds_read_b128 v[220:223], v12 offset:16384
    v_mfma_f32_16x16x32_bf16 v[52:55], v[36:39], v[200:203], v[52:55]
    ds_read_b64_tr_b16 v[32:33], v8 offset:12288
    ds_read_b64_tr_b16 v[34:35], v8 offset:12800
    v_mfma_f32_16x16x32_bf16 v[68:71], v[36:39], v[204:207], v[68:71]
    s_waitcnt lgkmcnt(14)
    v_mfma_f32_16x16x32_bf16 v[56:59], v[40:43], v[200:203], v[56:59]
    ds_read_b64_tr_b16 v[36:37], v9 offset:12288
    ds_read_b64_tr_b16 v[38:39], v9 offset:12800
    v_mfma_f32_16x16x32_bf16 v[72:75], v[40:43], v[204:207], v[72:75]
    v_mfma_f32_16x16x32_bf16 v[60:63], v[44:47], v[200:203], v[60:63]
    ds_read_b64_tr_b16 v[40:41], v1 offset:12288
    ds_read_b64_tr_b16 v[42:43], v1 offset:12800
    v_mfma_f32_16x16x32_bf16 v[76:79], v[44:47], v[204:207], v[76:79]
    s_waitcnt lgkmcnt(14)
    s_waitcnt lgkmcnt(6)
    v_mfma_f32_16x16x32_bf16 v[48:51], v[16:19], v[208:211], v[48:51]
    ds_read_b64_tr_b16 v[44:45], v0 offset:12288
    ds_read_b64_tr_b16 v[46:47], v0 offset:12800
    v_mfma_f32_16x16x32_bf16 v[64:67], v[16:19], v[212:215], v[64:67]
    s_add_u32 m0, s24, 98304
    s_add_u32 s30, s96, 0
    buffer_load_dwordx4 v3, s[4:7], s30 offen lds
    s_add_u32 m0, s24, 106496
    s_add_u32 s30, s96, 9216
    buffer_load_dwordx4 v15, s[4:7], s30 offen lds
    v_mfma_f32_16x16x32_bf16 v[52:55], v[20:23], v[208:211], v[52:55]
    ds_read_b64_tr_b16 v[16:17], v8 offset:16384
    ds_read_b64_tr_b16 v[18:19], v8 offset:16896
    v_mfma_f32_16x16x32_bf16 v[68:71], v[20:23], v[212:215], v[68:71]
    s_add_u32 m0, s24, 114688
    s_add_u32 s30, s96, 18432
    buffer_load_dwordx4 v3, s[4:7], s30 offen lds
    s_add_u32 m0, s24, 122880
    s_add_u32 s30, s96, 27648
    buffer_load_dwordx4 v15, s[4:7], s30 offen lds
    v_mfma_f32_16x16x32_bf16 v[56:59], v[24:27], v[208:211], v[56:59]
    ds_read_b64_tr_b16 v[20:21], v9 offset:16384
    ds_read_b64_tr_b16 v[22:23], v9 offset:16896
    v_mfma_f32_16x16x32_bf16 v[72:75], v[24:27], v[212:215], v[72:75]
    s_add_u32 m0, s24, 32768
    s_add_u32 s30, s43, 0
    buffer_load_dwordx4 v2, s[12:15], s30 offen lds
    s_add_u32 m0, m0, 4096
    s_add_u32 s30, s30, 294912
    buffer_load_dwordx4 v2, s[12:15], s30 offen lds
    s_add_u32 m0, s24, 40960
    s_add_u32 s30, s44, 0
    buffer_load_dwordx4 v2, s[12:15], s30 offen lds
    s_add_u32 m0, m0, 4096
    s_add_u32 s30, s30, 294912
    buffer_load_dwordx4 v2, s[12:15], s30 offen lds
    v_mfma_f32_16x16x32_bf16 v[60:63], v[28:31], v[208:211], v[60:63]
    ds_read_b64_tr_b16 v[24:25], v1 offset:16384
    ds_read_b64_tr_b16 v[26:27], v1 offset:16896
    v_mfma_f32_16x16x32_bf16 v[76:79], v[28:31], v[212:215], v[76:79]
    s_add_u32 m0, s24, 49152
    s_add_u32 s30, s36, 128
    buffer_load_dwordx4 v2, s[8:11], s30 offen lds
    s_add_u32 m0, m0, 4096
    s_add_u32 s30, s30, 294912
    buffer_load_dwordx4 v2, s[8:11], s30 offen lds
    s_waitcnt lgkmcnt(10)
    v_mfma_f32_16x16x32_bf16 v[48:51], v[32:35], v[216:219], v[48:51]
    ds_read_b64_tr_b16 v[28:29], v0 offset:16384
    ds_read_b64_tr_b16 v[30:31], v0 offset:16896
    v_mfma_f32_16x16x32_bf16 v[64:67], v[32:35], v[220:223], v[64:67]
    v_mfma_f32_16x16x32_bf16 v[52:55], v[36:39], v[216:219], v[52:55]
    ds_read_b64_tr_b16 v[32:33], v8 offset:20480
    ds_read_b64_tr_b16 v[34:35], v8 offset:20992
    v_mfma_f32_16x16x32_bf16 v[68:71], v[36:39], v[220:223], v[68:71]
    s_waitcnt lgkmcnt(10)
    v_mfma_f32_16x16x32_bf16 v[56:59], v[40:43], v[216:219], v[56:59]
    ds_read_b64_tr_b16 v[36:37], v9 offset:20480
    ds_read_b64_tr_b16 v[38:39], v9 offset:20992
    v_mfma_f32_16x16x32_bf16 v[72:75], v[40:43], v[220:223], v[72:75]
    v_mfma_f32_16x16x32_bf16 v[60:63], v[44:47], v[216:219], v[60:63]
    ds_read_b64_tr_b16 v[40:41], v1 offset:20480
    ds_read_b64_tr_b16 v[42:43], v1 offset:20992
    v_mfma_f32_16x16x32_bf16 v[76:79], v[44:47], v[220:223], v[76:79]
    s_waitcnt lgkmcnt(10)
    v_mfma_f32_16x16x32_bf16 v[80:83], v[16:19], v[160:163], v[80:83]
    ds_read_b64_tr_b16 v[44:45], v0 offset:20480
    ds_read_b64_tr_b16 v[46:47], v0 offset:20992
    v_mfma_f32_16x16x32_bf16 v[96:99], v[16:19], v[164:167], v[96:99]
    v_mfma_f32_16x16x32_bf16 v[84:87], v[20:23], v[160:163], v[84:87]
    ds_read_b64_tr_b16 v[16:17], v8 offset:24576
    ds_read_b64_tr_b16 v[18:19], v8 offset:25088
    v_mfma_f32_16x16x32_bf16 v[100:103], v[20:23], v[164:167], v[100:103]
    s_waitcnt lgkmcnt(10)
    v_mfma_f32_16x16x32_bf16 v[88:91], v[24:27], v[160:163], v[88:91]
    ds_read_b64_tr_b16 v[20:21], v9 offset:24576
    ds_read_b64_tr_b16 v[22:23], v9 offset:25088
    v_mfma_f32_16x16x32_bf16 v[104:107], v[24:27], v[164:167], v[104:107]
    v_mfma_f32_16x16x32_bf16 v[92:95], v[28:31], v[160:163], v[92:95]
    ds_read_b64_tr_b16 v[24:25], v1 offset:24576
    ds_read_b64_tr_b16 v[26:27], v1 offset:25088
    v_mfma_f32_16x16x32_bf16 v[108:111], v[28:31], v[164:167], v[108:111]
    s_waitcnt lgkmcnt(10)
    v_mfma_f32_16x16x32_bf16 v[80:83], v[32:35], v[168:171], v[80:83]
    ds_read_b64_tr_b16 v[28:29], v0 offset:24576
    ds_read_b64_tr_b16 v[30:31], v0 offset:25088
    v_mfma_f32_16x16x32_bf16 v[96:99], v[32:35], v[172:175], v[96:99]
    s_waitcnt vmcnt(12)
    ds_read_b128 v[224:227], v11 offset:32768
    ds_read_b128 v[228:231], v11 offset:49152
    ds_read_b128 v[232:235], v12 offset:32768
    ds_read_b128 v[236:239], v12 offset:49152
    s_add_u32 m0, s24, 57344
    s_add_u32 s30, s37, 128
    buffer_load_dwordx4 v2, s[8:11], s30 offen lds
    s_add_u32 m0, m0, 4096
    s_add_u32 s30, s30, 294912
    buffer_load_dwordx4 v2, s[8:11], s30 offen lds
    v_mfma_f32_16x16x32_bf16 v[84:87], v[36:39], v[168:171], v[84:87]
    ds_read_b64_tr_b16 v[32:33], v8 offset:28672
    ds_read_b64_tr_b16 v[34:35], v8 offset:29184
    v_mfma_f32_16x16x32_bf16 v[100:103], v[36:39], v[172:175], v[100:103]
    s_waitcnt lgkmcnt(14)
    v_mfma_f32_16x16x32_bf16 v[88:91], v[40:43], v[168:171], v[88:91]
    ds_read_b64_tr_b16 v[36:37], v9 offset:28672
    ds_read_b64_tr_b16 v[38:39], v9 offset:29184
    v_mfma_f32_16x16x32_bf16 v[104:107], v[40:43], v[172:175], v[104:107]
    v_mfma_f32_16x16x32_bf16 v[92:95], v[44:47], v[168:171], v[92:95]
    ds_read_b64_tr_b16 v[40:41], v1 offset:28672
    ds_read_b64_tr_b16 v[42:43], v1 offset:29184
    v_mfma_f32_16x16x32_bf16 v[108:111], v[44:47], v[172:175], v[108:111]
    s_waitcnt lgkmcnt(14)
    s_waitcnt lgkmcnt(6)
    v_mfma_f32_16x16x32_bf16 v[48:51], v[16:19], v[224:227], v[48:51]
    ds_read_b64_tr_b16 v[44:45], v0 offset:28672
    ds_read_b64_tr_b16 v[46:47], v0 offset:29184
    v_mfma_f32_16x16x32_bf16 v[64:67], v[16:19], v[228:231], v[64:67]
    v_mfma_f32_16x16x32_bf16 v[52:55], v[20:23], v[224:227], v[52:55]
    v_mfma_f32_16x16x32_bf16 v[68:71], v[20:23], v[228:231], v[68:71]
    s_barrier
    ds_read_b64_tr_b16 v[16:17], v4 offset:0
    ds_read_b64_tr_b16 v[18:19], v4 offset:512
    s_add_u32 m0, s24, 65536
    s_add_u32 s30, s38, 128
    buffer_load_dwordx4 v2, s[8:11], s30 offen lds
    s_add_u32 m0, m0, 4096
    s_add_u32 s30, s30, 294912
    buffer_load_dwordx4 v2, s[8:11], s30 offen lds
    s_add_u32 m0, s24, 73728
    s_add_u32 s30, s39, 128
    buffer_load_dwordx4 v2, s[8:11], s30 offen lds
    s_add_u32 m0, m0, 4096
    s_add_u32 s30, s30, 294912
    buffer_load_dwordx4 v2, s[8:11], s30 offen lds
    v_mfma_f32_16x16x32_bf16 v[56:59], v[24:27], v[224:227], v[56:59]
    ds_read_b64_tr_b16 v[20:21], v5 offset:0
    ds_read_b64_tr_b16 v[22:23], v5 offset:512
    v_mfma_f32_16x16x32_bf16 v[72:75], v[24:27], v[228:231], v[72:75]
    s_add_u32 m0, s24, 81920
    s_add_u32 s30, s40, 128
    buffer_load_dwordx4 v2, s[8:11], s30 offen lds
    s_add_u32 m0, m0, 4096
    s_add_u32 s30, s30, 294912
    buffer_load_dwordx4 v2, s[8:11], s30 offen lds
    v_mfma_f32_16x16x32_bf16 v[60:63], v[28:31], v[224:227], v[60:63]
    ds_read_b64_tr_b16 v[24:25], v6 offset:0
    ds_read_b64_tr_b16 v[26:27], v6 offset:512
    v_mfma_f32_16x16x32_bf16 v[76:79], v[28:31], v[228:231], v[76:79]
    s_waitcnt lgkmcnt(10)
    v_mfma_f32_16x16x32_bf16 v[48:51], v[32:35], v[232:235], v[48:51]
    ds_read_b64_tr_b16 v[28:29], v7 offset:0
    ds_read_b64_tr_b16 v[30:31], v7 offset:512
    v_mfma_f32_16x16x32_bf16 v[64:67], v[32:35], v[236:239], v[64:67]
    s_waitcnt vmcnt(14)
    ds_read_b128 v[240:243], v11 offset:0
    ds_read_b128 v[244:247], v11 offset:16384
    ds_read_b128 v[248:251], v12 offset:0
    ds_read_b128 v[252:255], v12 offset:16384
    v_mfma_f32_16x16x32_bf16 v[52:55], v[36:39], v[232:235], v[52:55]
    ds_read_b64_tr_b16 v[32:33], v4 offset:4096
    ds_read_b64_tr_b16 v[34:35], v4 offset:4608
    v_mfma_f32_16x16x32_bf16 v[68:71], v[36:39], v[236:239], v[68:71]
    s_waitcnt lgkmcnt(14)
    v_mfma_f32_16x16x32_bf16 v[56:59], v[40:43], v[232:235], v[56:59]
    ds_read_b64_tr_b16 v[36:37], v5 offset:4096
    ds_read_b64_tr_b16 v[38:39], v5 offset:4608
    v_mfma_f32_16x16x32_bf16 v[72:75], v[40:43], v[236:239], v[72:75]
    v_mfma_f32_16x16x32_bf16 v[60:63], v[44:47], v[232:235], v[60:63]
    ds_read_b64_tr_b16 v[40:41], v6 offset:4096
    ds_read_b64_tr_b16 v[42:43], v6 offset:4608
    v_mfma_f32_16x16x32_bf16 v[76:79], v[44:47], v[236:239], v[76:79]
    s_waitcnt lgkmcnt(14)
    s_waitcnt lgkmcnt(6)
    v_mfma_f32_16x16x32_bf16 v[48:51], v[16:19], v[240:243], v[48:51]
    ds_read_b64_tr_b16 v[44:45], v7 offset:4096
    ds_read_b64_tr_b16 v[46:47], v7 offset:4608
    v_mfma_f32_16x16x32_bf16 v[64:67], v[16:19], v[244:247], v[64:67]
    v_mfma_f32_16x16x32_bf16 v[52:55], v[20:23], v[240:243], v[52:55]
    ds_read_b64_tr_b16 v[16:17], v4 offset:8192
    ds_read_b64_tr_b16 v[18:19], v4 offset:8704
    v_mfma_f32_16x16x32_bf16 v[68:71], v[20:23], v[244:247], v[68:71]
    v_mfma_f32_16x16x32_bf16 v[56:59], v[24:27], v[240:243], v[56:59]
    ds_read_b64_tr_b16 v[20:21], v5 offset:8192
    ds_read_b64_tr_b16 v[22:23], v5 offset:8704
    v_mfma_f32_16x16x32_bf16 v[72:75], v[24:27], v[244:247], v[72:75]
    v_mfma_f32_16x16x32_bf16 v[60:63], v[28:31], v[240:243], v[60:63]
    ds_read_b64_tr_b16 v[24:25], v6 offset:8192
    ds_read_b64_tr_b16 v[26:27], v6 offset:8704
    v_mfma_f32_16x16x32_bf16 v[76:79], v[28:31], v[244:247], v[76:79]
    s_waitcnt lgkmcnt(10)
    v_mfma_f32_16x16x32_bf16 v[48:51], v[32:35], v[248:251], v[48:51]
    ds_read_b64_tr_b16 v[28:29], v7 offset:8192
    ds_read_b64_tr_b16 v[30:31], v7 offset:8704
    v_mfma_f32_16x16x32_bf16 v[64:67], v[32:35], v[252:255], v[64:67]
    v_mfma_f32_16x16x32_bf16 v[52:55], v[36:39], v[248:251], v[52:55]
    ds_read_b64_tr_b16 v[32:33], v4 offset:12288
    ds_read_b64_tr_b16 v[34:35], v4 offset:12800
    v_mfma_f32_16x16x32_bf16 v[68:71], v[36:39], v[252:255], v[68:71]
    s_waitcnt lgkmcnt(10)
    v_mfma_f32_16x16x32_bf16 v[56:59], v[40:43], v[248:251], v[56:59]
    ds_read_b64_tr_b16 v[36:37], v5 offset:12288
    ds_read_b64_tr_b16 v[38:39], v5 offset:12800
    v_mfma_f32_16x16x32_bf16 v[72:75], v[40:43], v[252:255], v[72:75]
    v_mfma_f32_16x16x32_bf16 v[60:63], v[44:47], v[248:251], v[60:63]
    ds_read_b64_tr_b16 v[40:41], v6 offset:12288
    ds_read_b64_tr_b16 v[42:43], v6 offset:12800
    v_mfma_f32_16x16x32_bf16 v[76:79], v[44:47], v[252:255], v[76:79]
    v_mov_b32 v15, v13
    s_waitcnt lgkmcnt(10)
    v_mfma_f32_16x16x32_bf16 v[80:83], v[16:19], v[176:179], v[80:83]
    ds_read_b64_tr_b16 v[44:45], v7 offset:12288
    ds_read_b64_tr_b16 v[46:47], v7 offset:12800
    v_mfma_f32_16x16x32_bf16 v[96:99], v[16:19], v[180:183], v[96:99]
    v_mfma_f32_16x16x32_bf16 v[84:87], v[20:23], v[176:179], v[84:87]
    ds_read_b64_tr_b16 v[16:17], v4 offset:16384
    ds_read_b64_tr_b16 v[18:19], v4 offset:16896
    v_mfma_f32_16x16x32_bf16 v[100:103], v[20:23], v[180:183], v[100:103]
    s_waitcnt lgkmcnt(10)
    v_mfma_f32_16x16x32_bf16 v[88:91], v[24:27], v[176:179], v[88:91]
    ds_read_b64_tr_b16 v[20:21], v5 offset:16384
    ds_read_b64_tr_b16 v[22:23], v5 offset:16896
    v_mfma_f32_16x16x32_bf16 v[104:107], v[24:27], v[180:183], v[104:107]
    v_mfma_f32_16x16x32_bf16 v[92:95], v[28:31], v[176:179], v[92:95]
    ds_read_b64_tr_b16 v[24:25], v6 offset:16384
    ds_read_b64_tr_b16 v[26:27], v6 offset:16896
    v_mfma_f32_16x16x32_bf16 v[108:111], v[28:31], v[180:183], v[108:111]
    v_mul_f32 v11, v48, v48
    v_mul_f32 v12, v49, v49
    v_mul_f32 v13, v50, v50
    v_mul_f32 v14, v51, v51
    v_fma_f32 v11, v11, s26, v10
    v_fma_f32 v12, v12, s26, v10
    v_fma_f32 v13, v13, s26, v10
    s_waitcnt lgkmcnt(10)
    v_mfma_f32_16x16x32_bf16 v[80:83], v[32:35], v[184:187], v[80:83]
    ds_read_b64_tr_b16 v[28:29], v7 offset:16384
    ds_read_b64_tr_b16 v[30:31], v7 offset:16896
    v_mfma_f32_16x16x32_bf16 v[96:99], v[32:35], v[188:191], v[96:99]
    v_fma_f32 v14, v14, s26, v10
    v_mul_f32 v11, v11, v48
    v_mul_f32 v12, v12, v49
    v_mul_f32 v13, v13, v50
    v_mul_f32 v14, v14, v51
    v_exp_f32 v11, v11
    v_mfma_f32_16x16x32_bf16 v[84:87], v[36:39], v[184:187], v[84:87]
    ds_read_b64_tr_b16 v[32:33], v4 offset:20480
    ds_read_b64_tr_b16 v[34:35], v4 offset:20992
    v_mfma_f32_16x16x32_bf16 v[100:103], v[36:39], v[188:191], v[100:103]
    v_exp_f32 v12, v12
    v_exp_f32 v13, v13
    v_exp_f32 v14, v14
    v_add_f32 v11, 1.0, v11
    v_add_f32 v12, 1.0, v12
    v_add_f32 v13, 1.0, v13
    s_waitcnt lgkmcnt(10)
    v_mfma_f32_16x16x32_bf16 v[88:91], v[40:43], v[184:187], v[88:91]
    ds_read_b64_tr_b16 v[36:37], v5 offset:20480
    ds_read_b64_tr_b16 v[38:39], v5 offset:20992
    v_mfma_f32_16x16x32_bf16 v[104:107], v[40:43], v[188:191], v[104:107]
    v_add_f32 v14, 1.0, v14
    v_rcp_f32 v11, v11
    v_rcp_f32 v12, v12
    v_rcp_f32 v13, v13
    v_rcp_f32 v14, v14
    v_mul_f32 v48, v11, v48
    v_mfma_f32_16x16x32_bf16 v[92:95], v[44:47], v[184:187], v[92:95]
    ds_read_b64_tr_b16 v[40:41], v6 offset:20480
    ds_read_b64_tr_b16 v[42:43], v6 offset:20992
    v_mfma_f32_16x16x32_bf16 v[108:111], v[44:47], v[188:191], v[108:111]
    v_mul_f32 v49, v12, v49
    v_mul_f32 v50, v13, v50
    v_mul_f32 v51, v14, v51
    v_mul_f32 v11, v52, v52
    v_mul_f32 v12, v53, v53
    v_mul_f32 v13, v54, v54
    v_mul_f32 v14, v55, v55
    s_waitcnt lgkmcnt(10)
    v_mfma_f32_16x16x32_bf16 v[80:83], v[16:19], v[192:195], v[80:83]
    ds_read_b64_tr_b16 v[44:45], v7 offset:20480
    ds_read_b64_tr_b16 v[46:47], v7 offset:20992
    v_mfma_f32_16x16x32_bf16 v[96:99], v[16:19], v[196:199], v[96:99]
    v_fma_f32 v11, v11, s26, v10
    v_fma_f32 v12, v12, s26, v10
    v_fma_f32 v13, v13, s26, v10
    v_fma_f32 v14, v14, s26, v10
    v_mul_f32 v11, v11, v52
    v_mul_f32 v12, v12, v53
    v_mfma_f32_16x16x32_bf16 v[84:87], v[20:23], v[192:195], v[84:87]
    v_mfma_f32_16x16x32_bf16 v[100:103], v[20:23], v[196:199], v[100:103]
    s_waitcnt vmcnt(4)
    s_barrier
    ds_read_b64_tr_b16 v[16:17], v4 offset:24576
    ds_read_b64_tr_b16 v[18:19], v4 offset:25088
    s_add_u32 m0, s24, 90112
    s_add_u32 s30, s41, 128
    buffer_load_dwordx4 v2, s[8:11], s30 offen lds
    s_add_u32 m0, m0, 4096
    s_add_u32 s30, s30, 294912
    buffer_load_dwordx4 v2, s[8:11], s30 offen lds
    s_add_u32 m0, s24, 0
    s_add_u32 s30, s42, 128
    buffer_load_dwordx4 v2, s[8:11], s30 offen lds
    s_add_u32 m0, m0, 4096
    s_add_u32 s30, s30, 294912
    buffer_load_dwordx4 v2, s[8:11], s30 offen lds
    v_mul_f32 v13, v13, v54
    v_mul_f32 v14, v14, v55
    v_exp_f32 v11, v11
    v_exp_f32 v12, v12
    v_exp_f32 v13, v13
    v_exp_f32 v14, v14
    s_waitcnt lgkmcnt(10)
    v_mfma_f32_16x16x32_bf16 v[88:91], v[24:27], v[192:195], v[88:91]
    ds_read_b64_tr_b16 v[20:21], v5 offset:24576
    ds_read_b64_tr_b16 v[22:23], v5 offset:25088
    v_mfma_f32_16x16x32_bf16 v[104:107], v[24:27], v[196:199], v[104:107]
    s_add_u32 m0, s24, 8192
    s_add_u32 s30, s43, 128
    buffer_load_dwordx4 v2, s[8:11], s30 offen lds
    s_add_u32 m0, m0, 4096
    s_add_u32 s30, s30, 294912
    buffer_load_dwordx4 v2, s[8:11], s30 offen lds
    s_add_u32 m0, s24, 98304
    s_add_u32 s30, s44, 128
    buffer_load_dwordx4 v2, s[8:11], s30 offen lds
    s_add_u32 m0, m0, 4096
    s_add_u32 s30, s30, 294912
    buffer_load_dwordx4 v2, s[8:11], s30 offen lds
    v_add_f32 v11, 1.0, v11
    v_add_f32 v12, 1.0, v12
    v_add_f32 v13, 1.0, v13
    v_add_f32 v14, 1.0, v14
    v_rcp_f32 v11, v11
    v_rcp_f32 v12, v12
    v_mfma_f32_16x16x32_bf16 v[92:95], v[28:31], v[192:195], v[92:95]
    ds_read_b64_tr_b16 v[24:25], v6 offset:24576
    ds_read_b64_tr_b16 v[26:27], v6 offset:25088
    v_mfma_f32_16x16x32_bf16 v[108:111], v[28:31], v[196:199], v[108:111]
    s_add_u32 m0, s24, 106496
    s_add_u32 s30, s36, 128
    buffer_load_dwordx4 v2, s[12:15], s30 offen lds
    s_add_u32 m0, m0, 4096
    s_add_u32 s30, s30, 294912
    buffer_load_dwordx4 v2, s[12:15], s30 offen lds
    s_add_u32 m0, s24, 114688
    s_add_u32 s30, s37, 128
    buffer_load_dwordx4 v2, s[12:15], s30 offen lds
    s_add_u32 m0, m0, 4096
    s_add_u32 s30, s30, 294912
    buffer_load_dwordx4 v2, s[12:15], s30 offen lds
    v_rcp_f32 v13, v13
    v_rcp_f32 v14, v14
    v_mul_f32 v52, v11, v52
    v_mul_f32 v53, v12, v53
    v_mul_f32 v54, v13, v54
    v_mul_f32 v55, v14, v55
    s_waitcnt lgkmcnt(10)
    v_mfma_f32_16x16x32_bf16 v[80:83], v[32:35], v[200:203], v[80:83]
    ds_read_b64_tr_b16 v[28:29], v7 offset:24576
    ds_read_b64_tr_b16 v[30:31], v7 offset:25088
    v_mfma_f32_16x16x32_bf16 v[96:99], v[32:35], v[204:207], v[96:99]
    s_add_u32 m0, s24, 122880
    s_add_u32 s30, s38, 128
    buffer_load_dwordx4 v2, s[12:15], s30 offen lds
    s_add_u32 m0, m0, 4096
    s_add_u32 s30, s30, 294912
    buffer_load_dwordx4 v2, s[12:15], s30 offen lds
    v_mul_f32 v11, v56, v56
    v_mul_f32 v12, v57, v57
    v_mul_f32 v13, v58, v58
    v_mul_f32 v14, v59, v59
    v_fma_f32 v11, v11, s26, v10
    v_fma_f32 v12, v12, s26, v10
    v_fma_f32 v13, v13, s26, v10
    v_mfma_f32_16x16x32_bf16 v[84:87], v[36:39], v[200:203], v[84:87]
    ds_read_b64_tr_b16 v[32:33], v4 offset:28672
    ds_read_b64_tr_b16 v[34:35], v4 offset:29184
    v_mfma_f32_16x16x32_bf16 v[100:103], v[36:39], v[204:207], v[100:103]
    v_fma_f32 v14, v14, s26, v10
    v_mul_f32 v11, v11, v56
    v_mul_f32 v12, v12, v57
    v_mul_f32 v13, v13, v58
    v_mul_f32 v14, v14, v59
    v_exp_f32 v11, v11
    s_waitcnt lgkmcnt(10)
    v_mfma_f32_16x16x32_bf16 v[88:91], v[40:43], v[200:203], v[88:91]
    ds_read_b64_tr_b16 v[36:37], v5 offset:28672
    ds_read_b64_tr_b16 v[38:39], v5 offset:29184
    v_mfma_f32_16x16x32_bf16 v[104:107], v[40:43], v[204:207], v[104:107]
    v_exp_f32 v12, v12
    v_exp_f32 v13, v13
    v_exp_f32 v14, v14
    v_add_f32 v11, 1.0, v11
    v_add_f32 v12, 1.0, v12
    v_add_f32 v13, 1.0, v13
    v_mfma_f32_16x16x32_bf16 v[92:95], v[44:47], v[200:203], v[92:95]
    ds_read_b64_tr_b16 v[40:41], v6 offset:28672
    ds_read_b64_tr_b16 v[42:43], v6 offset:29184
    v_mfma_f32_16x16x32_bf16 v[108:111], v[44:47], v[204:207], v[108:111]
    v_add_f32 v14, 1.0, v14
    v_rcp_f32 v11, v11
    v_rcp_f32 v12, v12
    v_rcp_f32 v13, v13
    v_rcp_f32 v14, v14
    v_mul_f32 v56, v11, v56
    s_waitcnt lgkmcnt(10)
    v_mfma_f32_16x16x32_bf16 v[80:83], v[16:19], v[208:211], v[80:83]
    ds_read_b64_tr_b16 v[44:45], v7 offset:28672
    ds_read_b64_tr_b16 v[46:47], v7 offset:29184
    v_mfma_f32_16x16x32_bf16 v[96:99], v[16:19], v[212:215], v[96:99]
    v_mul_f32 v57, v12, v57
    v_mul_f32 v58, v13, v58
    v_mul_f32 v59, v14, v59
    v_mul_f32 v11, v60, v60
    v_mul_f32 v12, v61, v61
    v_mul_f32 v13, v62, v62
    v_mul_f32 v14, v63, v63
    v_mfma_f32_16x16x32_bf16 v[84:87], v[20:23], v[208:211], v[84:87]
    ds_read_b64_tr_b16 v[16:17], v4 offset:32768
    ds_read_b64_tr_b16 v[18:19], v4 offset:33280
    v_mfma_f32_16x16x32_bf16 v[100:103], v[20:23], v[212:215], v[100:103]
    v_fma_f32 v11, v11, s26, v10
    v_fma_f32 v12, v12, s26, v10
    v_fma_f32 v13, v13, s26, v10
    v_fma_f32 v14, v14, s26, v10
    v_mul_f32 v11, v11, v60
    v_mul_f32 v12, v12, v61
    s_waitcnt lgkmcnt(10)
    v_mfma_f32_16x16x32_bf16 v[88:91], v[24:27], v[208:211], v[88:91]
    ds_read_b64_tr_b16 v[20:21], v5 offset:32768
    ds_read_b64_tr_b16 v[22:23], v5 offset:33280
    v_mfma_f32_16x16x32_bf16 v[104:107], v[24:27], v[212:215], v[104:107]
    v_mul_f32 v13, v13, v62
    v_mul_f32 v14, v14, v63
    v_exp_f32 v11, v11
    v_exp_f32 v12, v12
    v_exp_f32 v13, v13
    v_exp_f32 v14, v14
    v_mfma_f32_16x16x32_bf16 v[92:95], v[28:31], v[208:211], v[92:95]
    ds_read_b64_tr_b16 v[24:25], v6 offset:32768
    ds_read_b64_tr_b16 v[26:27], v6 offset:33280
    v_mfma_f32_16x16x32_bf16 v[108:111], v[28:31], v[212:215], v[108:111]
    v_add_f32 v11, 1.0, v11
    v_add_f32 v12, 1.0, v12
    v_add_f32 v13, 1.0, v13
    v_add_f32 v14, 1.0, v14
    v_rcp_f32 v11, v11
    v_rcp_f32 v12, v12
    s_waitcnt lgkmcnt(10)
    v_mfma_f32_16x16x32_bf16 v[80:83], v[32:35], v[216:219], v[80:83]
    ds_read_b64_tr_b16 v[28:29], v7 offset:32768
    ds_read_b64_tr_b16 v[30:31], v7 offset:33280
    v_mfma_f32_16x16x32_bf16 v[96:99], v[32:35], v[220:223], v[96:99]
    v_rcp_f32 v13, v13
    v_rcp_f32 v14, v14
    v_mul_f32 v60, v11, v60
    v_mul_f32 v61, v12, v61
    v_mul_f32 v62, v13, v62
    v_mul_f32 v63, v14, v63
    v_mfma_f32_16x16x32_bf16 v[84:87], v[36:39], v[216:219], v[84:87]
    ds_read_b64_tr_b16 v[32:33], v4 offset:36864
    ds_read_b64_tr_b16 v[34:35], v4 offset:37376
    v_mfma_f32_16x16x32_bf16 v[100:103], v[36:39], v[220:223], v[100:103]
    v_mul_f32 v11, v64, v64
    v_mul_f32 v12, v65, v65
    v_mul_f32 v13, v66, v66
    v_mul_f32 v14, v67, v67
    v_fma_f32 v11, v11, s26, v10
    v_fma_f32 v12, v12, s26, v10
    v_fma_f32 v13, v13, s26, v10
    s_waitcnt lgkmcnt(10)
    v_mfma_f32_16x16x32_bf16 v[88:91], v[40:43], v[216:219], v[88:91]
    ds_read_b64_tr_b16 v[36:37], v5 offset:36864
    ds_read_b64_tr_b16 v[38:39], v5 offset:37376
    v_mfma_f32_16x16x32_bf16 v[104:107], v[40:43], v[220:223], v[104:107]
    v_fma_f32 v14, v14, s26, v10
    v_mul_f32 v11, v11, v64
    v_mul_f32 v12, v12, v65
    v_mul_f32 v13, v13, v66
    v_mul_f32 v14, v14, v67
    v_exp_f32 v11, v11
    v_mfma_f32_16x16x32_bf16 v[92:95], v[44:47], v[216:219], v[92:95]
    ds_read_b64_tr_b16 v[40:41], v6 offset:36864
    ds_read_b64_tr_b16 v[42:43], v6 offset:37376
    v_mfma_f32_16x16x32_bf16 v[108:111], v[44:47], v[220:223], v[108:111]
    v_exp_f32 v12, v12
    v_exp_f32 v13, v13
    v_exp_f32 v14, v14
    v_add_f32 v11, 1.0, v11
    v_add_f32 v12, 1.0, v12
    v_add_f32 v13, 1.0, v13
    s_waitcnt lgkmcnt(10)
    v_mfma_f32_16x16x32_bf16 v[80:83], v[16:19], v[224:227], v[80:83]
    ds_read_b64_tr_b16 v[44:45], v7 offset:36864
    ds_read_b64_tr_b16 v[46:47], v7 offset:37376
    v_mfma_f32_16x16x32_bf16 v[96:99], v[16:19], v[228:231], v[96:99]
    v_add_f32 v14, 1.0, v14
    v_rcp_f32 v11, v11
    v_rcp_f32 v12, v12
    v_rcp_f32 v13, v13
    v_rcp_f32 v14, v14
    v_mul_f32 v64, v11, v64
    v_mfma_f32_16x16x32_bf16 v[84:87], v[20:23], v[224:227], v[84:87]
    ds_read_b64_tr_b16 v[16:17], v4 offset:40960
    ds_read_b64_tr_b16 v[18:19], v4 offset:41472
    v_mfma_f32_16x16x32_bf16 v[100:103], v[20:23], v[228:231], v[100:103]
    v_mul_f32 v65, v12, v65
    v_mul_f32 v66, v13, v66
    v_mul_f32 v67, v14, v67
    v_mul_f32 v11, v68, v68
    v_mul_f32 v12, v69, v69
    v_mul_f32 v13, v70, v70
    v_mul_f32 v14, v71, v71
    s_waitcnt lgkmcnt(10)
    v_mfma_f32_16x16x32_bf16 v[88:91], v[24:27], v[224:227], v[88:91]
    ds_read_b64_tr_b16 v[20:21], v5 offset:40960
    ds_read_b64_tr_b16 v[22:23], v5 offset:41472
    v_mfma_f32_16x16x32_bf16 v[104:107], v[24:27], v[228:231], v[104:107]
    v_fma_f32 v11, v11, s26, v10
    v_fma_f32 v12, v12, s26, v10
    v_fma_f32 v13, v13, s26, v10
    v_fma_f32 v14, v14, s26, v10
    v_mul_f32 v11, v11, v68
    v_mul_f32 v12, v12, v69
    v_mfma_f32_16x16x32_bf16 v[92:95], v[28:31], v[224:227], v[92:95]
    ds_read_b64_tr_b16 v[24:25], v6 offset:40960
    ds_read_b64_tr_b16 v[26:27], v6 offset:41472
    v_mfma_f32_16x16x32_bf16 v[108:111], v[28:31], v[228:231], v[108:111]
    v_mul_f32 v13, v13, v70
    v_mul_f32 v14, v14, v71
    v_exp_f32 v11, v11
    v_exp_f32 v12, v12
    v_exp_f32 v13, v13
    v_exp_f32 v14, v14
    s_waitcnt lgkmcnt(10)
    v_mfma_f32_16x16x32_bf16 v[80:83], v[32:35], v[232:235], v[80:83]
    ds_read_b64_tr_b16 v[28:29], v7 offset:40960
    ds_read_b64_tr_b16 v[30:31], v7 offset:41472
    v_mfma_f32_16x16x32_bf16 v[96:99], v[32:35], v[236:239], v[96:99]
    v_add_f32 v11, 1.0, v11
    v_add_f32 v12, 1.0, v12
    v_add_f32 v13, 1.0, v13
    v_add_f32 v14, 1.0, v14
    v_rcp_f32 v11, v11
    v_rcp_f32 v12, v12
    v_mfma_f32_16x16x32_bf16 v[84:87], v[36:39], v[232:235], v[84:87]
    ds_read_b64_tr_b16 v[32:33], v4 offset:45056
    ds_read_b64_tr_b16 v[34:35], v4 offset:45568
    v_mfma_f32_16x16x32_bf16 v[100:103], v[36:39], v[236:239], v[100:103]
    v_rcp_f32 v13, v13
    v_rcp_f32 v14, v14
    v_mul_f32 v68, v11, v68
    v_mul_f32 v69, v12, v69
    v_mul_f32 v70, v13, v70
    v_mul_f32 v71, v14, v71
    s_waitcnt lgkmcnt(10)
    v_mfma_f32_16x16x32_bf16 v[88:91], v[40:43], v[232:235], v[88:91]
    ds_read_b64_tr_b16 v[36:37], v5 offset:45056
    ds_read_b64_tr_b16 v[38:39], v5 offset:45568
    v_mfma_f32_16x16x32_bf16 v[104:107], v[40:43], v[236:239], v[104:107]
    v_mul_f32 v11, v72, v72
    v_mul_f32 v12, v73, v73
    v_mul_f32 v13, v74, v74
    v_mul_f32 v14, v75, v75
    v_fma_f32 v11, v11, s26, v10
    v_fma_f32 v12, v12, s26, v10
    v_fma_f32 v13, v13, s26, v10
    v_mfma_f32_16x16x32_bf16 v[92:95], v[44:47], v[232:235], v[92:95]
    ds_read_b64_tr_b16 v[40:41], v6 offset:45056
    ds_read_b64_tr_b16 v[42:43], v6 offset:45568
    v_mfma_f32_16x16x32_bf16 v[108:111], v[44:47], v[236:239], v[108:111]
    v_fma_f32 v14, v14, s26, v10
    v_mul_f32 v11, v11, v72
    v_mul_f32 v12, v12, v73
    v_mul_f32 v13, v13, v74
    v_mul_f32 v14, v14, v75
    v_exp_f32 v11, v11
    s_waitcnt lgkmcnt(10)
    v_mfma_f32_16x16x32_bf16 v[80:83], v[16:19], v[240:243], v[80:83]
    ds_read_b64_tr_b16 v[44:45], v7 offset:45056
    ds_read_b64_tr_b16 v[46:47], v7 offset:45568
    v_mfma_f32_16x16x32_bf16 v[96:99], v[16:19], v[244:247], v[96:99]
    v_exp_f32 v12, v12
    v_exp_f32 v13, v13
    v_exp_f32 v14, v14
    v_add_f32 v11, 1.0, v11
    v_add_f32 v12, 1.0, v12
    v_add_f32 v13, 1.0, v13
    v_mfma_f32_16x16x32_bf16 v[84:87], v[20:23], v[240:243], v[84:87]
    ds_read_b64_tr_b16 v[16:17], v4 offset:49152
    ds_read_b64_tr_b16 v[18:19], v4 offset:49664
    v_mfma_f32_16x16x32_bf16 v[100:103], v[20:23], v[244:247], v[100:103]
    v_add_f32 v14, 1.0, v14
    v_rcp_f32 v11, v11
    v_rcp_f32 v12, v12
    v_rcp_f32 v13, v13
    v_rcp_f32 v14, v14
    v_mul_f32 v72, v11, v72
    s_waitcnt lgkmcnt(10)
    v_mfma_f32_16x16x32_bf16 v[88:91], v[24:27], v[240:243], v[88:91]
    ds_read_b64_tr_b16 v[20:21], v5 offset:49152
    ds_read_b64_tr_b16 v[22:23], v5 offset:49664
    v_mfma_f32_16x16x32_bf16 v[104:107], v[24:27], v[244:247], v[104:107]
    v_mul_f32 v73, v12, v73
    v_mul_f32 v74, v13, v74
    v_mul_f32 v75, v14, v75
    v_mul_f32 v11, v76, v76
    v_mul_f32 v12, v77, v77
    v_mul_f32 v13, v78, v78
    v_mul_f32 v14, v79, v79
    v_mfma_f32_16x16x32_bf16 v[92:95], v[28:31], v[240:243], v[92:95]
    ds_read_b64_tr_b16 v[24:25], v6 offset:49152
    ds_read_b64_tr_b16 v[26:27], v6 offset:49664
    v_mfma_f32_16x16x32_bf16 v[108:111], v[28:31], v[244:247], v[108:111]
    v_fma_f32 v11, v11, s26, v10
    v_fma_f32 v12, v12, s26, v10
    v_fma_f32 v13, v13, s26, v10
    v_fma_f32 v14, v14, s26, v10
    v_mul_f32 v11, v11, v76
    v_mul_f32 v12, v12, v77
    s_waitcnt lgkmcnt(10)
    v_mfma_f32_16x16x32_bf16 v[80:83], v[32:35], v[248:251], v[80:83]
    ds_read_b64_tr_b16 v[28:29], v7 offset:49152
    ds_read_b64_tr_b16 v[30:31], v7 offset:49664
    v_mfma_f32_16x16x32_bf16 v[96:99], v[32:35], v[252:255], v[96:99]
    v_mul_f32 v13, v13, v78
    v_mul_f32 v14, v14, v79
    v_exp_f32 v11, v11
    v_exp_f32 v12, v12
    v_exp_f32 v13, v13
    v_exp_f32 v14, v14
    v_mfma_f32_16x16x32_bf16 v[84:87], v[36:39], v[248:251], v[84:87]
    ds_read_b64_tr_b16 v[32:33], v4 offset:53248
    ds_read_b64_tr_b16 v[34:35], v4 offset:53760
    v_mfma_f32_16x16x32_bf16 v[100:103], v[36:39], v[252:255], v[100:103]
    v_add_f32 v11, 1.0, v11
    v_add_f32 v12, 1.0, v12
    v_add_f32 v13, 1.0, v13
    v_add_f32 v14, 1.0, v14
    v_rcp_f32 v11, v11
    v_rcp_f32 v12, v12
    s_waitcnt lgkmcnt(10)
    v_mfma_f32_16x16x32_bf16 v[88:91], v[40:43], v[248:251], v[88:91]
    ds_read_b64_tr_b16 v[36:37], v5 offset:53248
    ds_read_b64_tr_b16 v[38:39], v5 offset:53760
    v_mfma_f32_16x16x32_bf16 v[104:107], v[40:43], v[252:255], v[104:107]
    v_rcp_f32 v13, v13
    v_rcp_f32 v14, v14
    v_mul_f32 v76, v11, v76
    v_mul_f32 v77, v12, v77
    v_mul_f32 v78, v13, v78
    v_mul_f32 v79, v14, v79
    v_mfma_f32_16x16x32_bf16 v[92:95], v[44:47], v[248:251], v[92:95]
    ds_read_b64_tr_b16 v[40:41], v6 offset:53248
    ds_read_b64_tr_b16 v[42:43], v6 offset:53760
    v_mfma_f32_16x16x32_bf16 v[108:111], v[44:47], v[252:255], v[108:111]
    v_mul_f32 v80, v48, v80
    v_mul_f32 v81, v49, v81
    v_mul_f32 v82, v50, v82
    v_mul_f32 v83, v51, v83
    v_mul_f32 v96, v64, v96
    v_mul_f32 v97, v65, v97
    v_mul_f32 v98, v66, v98
    v_mul_f32 v99, v67, v99
    s_waitcnt lgkmcnt(10)
    v_mfma_f32_16x16x32_bf16 v[48:51], v[16:19], v[112:115], 0
    ds_read_b64_tr_b16 v[44:45], v7 offset:53248
    ds_read_b64_tr_b16 v[46:47], v7 offset:53760
    v_mfma_f32_16x16x32_bf16 v[64:67], v[16:19], v[116:119], 0
    v_mul_f32 v84, v52, v84
    v_mul_f32 v85, v53, v85
    v_mul_f32 v86, v54, v86
    v_mul_f32 v87, v55, v87
    v_mul_f32 v100, v68, v100
    v_mul_f32 v101, v69, v101
    v_mul_f32 v102, v70, v102
    v_mul_f32 v103, v71, v103
    v_mfma_f32_16x16x32_bf16 v[52:55], v[20:23], v[112:115], 0
    ds_read_b64_tr_b16 v[16:17], v4 offset:57344
    ds_read_b64_tr_b16 v[18:19], v4 offset:57856
    v_mfma_f32_16x16x32_bf16 v[68:71], v[20:23], v[116:119], 0
    v_mul_f32 v88, v56, v88
    v_mul_f32 v89, v57, v89
    v_mul_f32 v90, v58, v90
    v_mul_f32 v91, v59, v91
    v_mul_f32 v104, v72, v104
    v_mul_f32 v105, v73, v105
    v_mul_f32 v106, v74, v106
    v_mul_f32 v107, v75, v107
    s_waitcnt lgkmcnt(10)
    v_mfma_f32_16x16x32_bf16 v[56:59], v[24:27], v[112:115], 0
    ds_read_b64_tr_b16 v[20:21], v5 offset:57344
    ds_read_b64_tr_b16 v[22:23], v5 offset:57856
    v_mfma_f32_16x16x32_bf16 v[72:75], v[24:27], v[116:119], 0
    v_mul_f32 v92, v60, v92
    v_mul_f32 v93, v61, v93
    v_mul_f32 v94, v62, v94
    v_mul_f32 v95, v63, v95
    v_mul_f32 v108, v76, v108
    v_mul_f32 v109, v77, v109
    v_mul_f32 v110, v78, v110
    v_mul_f32 v111, v79, v111
    v_mfma_f32_16x16x32_bf16 v[60:63], v[28:31], v[112:115], 0
    ds_read_b64_tr_b16 v[24:25], v6 offset:57344
    ds_read_b64_tr_b16 v[26:27], v6 offset:57856
    v_mfma_f32_16x16x32_bf16 v[76:79], v[28:31], v[116:119], 0
    s_waitcnt lgkmcnt(10)
    v_mfma_f32_16x16x32_bf16 v[48:51], v[32:35], v[120:123], v[48:51]
    ds_read_b64_tr_b16 v[28:29], v7 offset:57344
    ds_read_b64_tr_b16 v[30:31], v7 offset:57856
    v_mfma_f32_16x16x32_bf16 v[64:67], v[32:35], v[124:127], v[64:67]
    v_cvt_pk_bf16_f32 v80, v80, v81
    v_mfma_f32_16x16x32_bf16 v[52:55], v[36:39], v[120:123], v[52:55]
    ds_read_b64_tr_b16 v[32:33], v4 offset:61440
    ds_read_b64_tr_b16 v[34:35], v4 offset:61952
    v_mfma_f32_16x16x32_bf16 v[68:71], v[36:39], v[124:127], v[68:71]
    v_cvt_pk_bf16_f32 v81, v82, v83
    s_waitcnt lgkmcnt(10)
    v_mfma_f32_16x16x32_bf16 v[56:59], v[40:43], v[120:123], v[56:59]
    ds_read_b64_tr_b16 v[36:37], v5 offset:61440
    ds_read_b64_tr_b16 v[38:39], v5 offset:61952
    v_mfma_f32_16x16x32_bf16 v[72:75], v[40:43], v[124:127], v[72:75]
    v_mfma_f32_16x16x32_bf16 v[60:63], v[44:47], v[120:123], v[60:63]
    ds_read_b64_tr_b16 v[40:41], v6 offset:61440
    ds_read_b64_tr_b16 v[42:43], v6 offset:61952
    v_mfma_f32_16x16x32_bf16 v[76:79], v[44:47], v[124:127], v[76:79]
    v_cvt_pk_bf16_f32 v82, v84, v85
    s_waitcnt lgkmcnt(10)
    v_mfma_f32_16x16x32_bf16 v[48:51], v[16:19], v[128:131], v[48:51]
    ds_read_b64_tr_b16 v[44:45], v7 offset:61440
    ds_read_b64_tr_b16 v[46:47], v7 offset:61952
    v_mfma_f32_16x16x32_bf16 v[64:67], v[16:19], v[132:135], v[64:67]
    v_mfma_f32_16x16x32_bf16 v[52:55], v[20:23], v[128:131], v[52:55]
    ds_read_b64_tr_b16 v[16:17], v8 offset:0
    ds_read_b64_tr_b16 v[18:19], v8 offset:512
    v_mfma_f32_16x16x32_bf16 v[68:71], v[20:23], v[132:135], v[68:71]
    v_cvt_pk_bf16_f32 v83, v86, v87
    s_waitcnt lgkmcnt(10)
    v_mfma_f32_16x16x32_bf16 v[56:59], v[24:27], v[128:131], v[56:59]
    ds_read_b64_tr_b16 v[20:21], v9 offset:0
    ds_read_b64_tr_b16 v[22:23], v9 offset:512
    v_mfma_f32_16x16x32_bf16 v[72:75], v[24:27], v[132:135], v[72:75]
    buffer_store_dwordx4 v[80:83], v15, s[16:19], s25 offen offset:0 sc1
    v_mfma_f32_16x16x32_bf16 v[60:63], v[28:31], v[128:131], v[60:63]
    ds_read_b64_tr_b16 v[24:25], v1 offset:0
    ds_read_b64_tr_b16 v[26:27], v1 offset:512
    v_mfma_f32_16x16x32_bf16 v[76:79], v[28:31], v[132:135], v[76:79]
    s_waitcnt lgkmcnt(10)
    v_mfma_f32_16x16x32_bf16 v[48:51], v[32:35], v[136:139], v[48:51]
    ds_read_b64_tr_b16 v[28:29], v0 offset:0
    ds_read_b64_tr_b16 v[30:31], v0 offset:512
    v_mfma_f32_16x16x32_bf16 v[64:67], v[32:35], v[140:143], v[64:67]
    v_cvt_pk_bf16_f32 v84, v88, v89
    v_mfma_f32_16x16x32_bf16 v[52:55], v[36:39], v[136:139], v[52:55]
    ds_read_b64_tr_b16 v[32:33], v8 offset:4096
    ds_read_b64_tr_b16 v[34:35], v8 offset:4608
    v_mfma_f32_16x16x32_bf16 v[68:71], v[36:39], v[140:143], v[68:71]
    s_waitcnt lgkmcnt(10)
    v_mfma_f32_16x16x32_bf16 v[56:59], v[40:43], v[136:139], v[56:59]
    ds_read_b64_tr_b16 v[36:37], v9 offset:4096
    ds_read_b64_tr_b16 v[38:39], v9 offset:4608
    v_mfma_f32_16x16x32_bf16 v[72:75], v[40:43], v[140:143], v[72:75]
    v_cvt_pk_bf16_f32 v85, v90, v91
    v_mfma_f32_16x16x32_bf16 v[60:63], v[44:47], v[136:139], v[60:63]
    ds_read_b64_tr_b16 v[40:41], v1 offset:4096
    ds_read_b64_tr_b16 v[42:43], v1 offset:4608
    v_mfma_f32_16x16x32_bf16 v[76:79], v[44:47], v[140:143], v[76:79]
    s_waitcnt lgkmcnt(10)
    v_mfma_f32_16x16x32_bf16 v[48:51], v[16:19], v[144:147], v[48:51]
    ds_read_b64_tr_b16 v[44:45], v0 offset:4096
    ds_read_b64_tr_b16 v[46:47], v0 offset:4608
    v_mfma_f32_16x16x32_bf16 v[64:67], v[16:19], v[148:151], v[64:67]
    v_cvt_pk_bf16_f32 v86, v92, v93
    v_mfma_f32_16x16x32_bf16 v[52:55], v[20:23], v[144:147], v[52:55]
    v_mfma_f32_16x16x32_bf16 v[68:71], v[20:23], v[148:151], v[68:71]
    s_waitcnt vmcnt(7)
    s_barrier
    ds_read_b64_tr_b16 v[16:17], v8 offset:8192
    ds_read_b64_tr_b16 v[18:19], v8 offset:8704
    s_add_u32 m0, s24, 16384
    s_add_u32 s30, s39, 128
    buffer_load_dwordx4 v2, s[12:15], s30 offen lds
    s_add_u32 m0, m0, 4096
    s_add_u32 s30, s30, 294912
    buffer_load_dwordx4 v2, s[12:15], s30 offen lds
    s_add_u32 m0, s24, 24576
    s_add_u32 s30, s40, 128
    buffer_load_dwordx4 v2, s[12:15], s30 offen lds
    s_add_u32 m0, m0, 4096
    s_add_u32 s30, s30, 294912
    buffer_load_dwordx4 v2, s[12:15], s30 offen lds
    v_cvt_pk_bf16_f32 v87, v94, v95
    s_waitcnt lgkmcnt(10)
    v_mfma_f32_16x16x32_bf16 v[56:59], v[24:27], v[144:147], v[56:59]
    ds_read_b64_tr_b16 v[20:21], v9 offset:8192
    ds_read_b64_tr_b16 v[22:23], v9 offset:8704
    v_mfma_f32_16x16x32_bf16 v[72:75], v[24:27], v[148:151], v[72:75]
    s_add_u32 m0, s24, 32768
    s_add_u32 s30, s41, 128
    buffer_load_dwordx4 v2, s[12:15], s30 offen lds
    s_add_u32 m0, m0, 4096
    s_add_u32 s30, s30, 294912
    buffer_load_dwordx4 v2, s[12:15], s30 offen lds
    s_add_u32 m0, s24, 40960
    s_add_u32 s30, s42, 128
    buffer_load_dwordx4 v2, s[12:15], s30 offen lds
    s_add_u32 m0, m0, 4096
    s_add_u32 s30, s30, 294912
    buffer_load_dwordx4 v2, s[12:15], s30 offen lds
    v_mfma_f32_16x16x32_bf16 v[60:63], v[28:31], v[144:147], v[60:63]
    ds_read_b64_tr_b16 v[24:25], v1 offset:8192
    ds_read_b64_tr_b16 v[26:27], v1 offset:8704
    v_mfma_f32_16x16x32_bf16 v[76:79], v[28:31], v[148:151], v[76:79]
    s_add_u32 m0, s24, 49152
    s_add_u32 s30, s43, 128
    buffer_load_dwordx4 v2, s[12:15], s30 offen lds
    s_add_u32 m0, m0, 4096
    s_add_u32 s30, s30, 294912
    buffer_load_dwordx4 v2, s[12:15], s30 offen lds
    s_add_u32 m0, s24, 57344
    s_add_u32 s30, s44, 128
    buffer_load_dwordx4 v2, s[12:15], s30 offen lds
    s_add_u32 m0, m0, 4096
    s_add_u32 s30, s30, 294912
    buffer_load_dwordx4 v2, s[12:15], s30 offen lds
    buffer_store_dwordx4 v[84:87], v15, s[16:19], s25 offen offset:2048 sc1
    s_waitcnt lgkmcnt(10)
    v_mfma_f32_16x16x32_bf16 v[48:51], v[32:35], v[152:155], v[48:51]
    ds_read_b64_tr_b16 v[28:29], v0 offset:8192
    ds_read_b64_tr_b16 v[30:31], v0 offset:8704
    v_mfma_f32_16x16x32_bf16 v[64:67], v[32:35], v[156:159], v[64:67]
    v_mfma_f32_16x16x32_bf16 v[52:55], v[36:39], v[152:155], v[52:55]
    ds_read_b64_tr_b16 v[32:33], v8 offset:12288
    ds_read_b64_tr_b16 v[34:35], v8 offset:12800
    v_mfma_f32_16x16x32_bf16 v[68:71], v[36:39], v[156:159], v[68:71]
    v_cvt_pk_bf16_f32 v96, v96, v97
    s_waitcnt lgkmcnt(10)
    v_mfma_f32_16x16x32_bf16 v[56:59], v[40:43], v[152:155], v[56:59]
    ds_read_b64_tr_b16 v[36:37], v9 offset:12288
    ds_read_b64_tr_b16 v[38:39], v9 offset:12800
    v_mfma_f32_16x16x32_bf16 v[72:75], v[40:43], v[156:159], v[72:75]
    v_cvt_pk_bf16_f32 v97, v98, v99
    v_mfma_f32_16x16x32_bf16 v[60:63], v[44:47], v[152:155], v[60:63]
    ds_read_b64_tr_b16 v[40:41], v1 offset:12288
    ds_read_b64_tr_b16 v[42:43], v1 offset:12800
    v_mfma_f32_16x16x32_bf16 v[76:79], v[44:47], v[156:159], v[76:79]
    s_waitcnt lgkmcnt(10)
    v_mfma_f32_16x16x32_bf16 v[48:51], v[16:19], v[160:163], v[48:51]
    ds_read_b64_tr_b16 v[44:45], v0 offset:12288
    ds_read_b64_tr_b16 v[46:47], v0 offset:12800
    v_mfma_f32_16x16x32_bf16 v[64:67], v[16:19], v[164:167], v[64:67]
    v_cvt_pk_bf16_f32 v98, v100, v101
    v_mfma_f32_16x16x32_bf16 v[52:55], v[20:23], v[160:163], v[52:55]
    ds_read_b64_tr_b16 v[16:17], v8 offset:16384
    ds_read_b64_tr_b16 v[18:19], v8 offset:16896
    v_mfma_f32_16x16x32_bf16 v[68:71], v[20:23], v[164:167], v[68:71]
    s_waitcnt lgkmcnt(10)
    v_mfma_f32_16x16x32_bf16 v[56:59], v[24:27], v[160:163], v[56:59]
    ds_read_b64_tr_b16 v[20:21], v9 offset:16384
    ds_read_b64_tr_b16 v[22:23], v9 offset:16896
    v_mfma_f32_16x16x32_bf16 v[72:75], v[24:27], v[164:167], v[72:75]
    v_cvt_pk_bf16_f32 v99, v102, v103
    v_mfma_f32_16x16x32_bf16 v[60:63], v[28:31], v[160:163], v[60:63]
    ds_read_b64_tr_b16 v[24:25], v1 offset:16384
    ds_read_b64_tr_b16 v[26:27], v1 offset:16896
    v_mfma_f32_16x16x32_bf16 v[76:79], v[28:31], v[164:167], v[76:79]
    s_waitcnt lgkmcnt(10)
    v_mfma_f32_16x16x32_bf16 v[48:51], v[32:35], v[168:171], v[48:51]
    ds_read_b64_tr_b16 v[28:29], v0 offset:16384
    ds_read_b64_tr_b16 v[30:31], v0 offset:16896
    v_mfma_f32_16x16x32_bf16 v[64:67], v[32:35], v[172:175], v[64:67]
    buffer_store_dwordx4 v[96:99], v15, s[16:19], s25 offen offset:256 sc1
    v_mfma_f32_16x16x32_bf16 v[52:55], v[36:39], v[168:171], v[52:55]
    ds_read_b64_tr_b16 v[32:33], v8 offset:20480
    ds_read_b64_tr_b16 v[34:35], v8 offset:20992
    v_mfma_f32_16x16x32_bf16 v[68:71], v[36:39], v[172:175], v[68:71]
    v_cvt_pk_bf16_f32 v100, v104, v105
    s_waitcnt lgkmcnt(10)
    v_mfma_f32_16x16x32_bf16 v[56:59], v[40:43], v[168:171], v[56:59]
    ds_read_b64_tr_b16 v[36:37], v9 offset:20480
    ds_read_b64_tr_b16 v[38:39], v9 offset:20992
    v_mfma_f32_16x16x32_bf16 v[72:75], v[40:43], v[172:175], v[72:75]
    v_mfma_f32_16x16x32_bf16 v[60:63], v[44:47], v[168:171], v[60:63]
    ds_read_b64_tr_b16 v[40:41], v1 offset:20480
    ds_read_b64_tr_b16 v[42:43], v1 offset:20992
    v_mfma_f32_16x16x32_bf16 v[76:79], v[44:47], v[172:175], v[76:79]
    v_cvt_pk_bf16_f32 v101, v106, v107
    s_waitcnt lgkmcnt(10)
    v_mfma_f32_16x16x32_bf16 v[48:51], v[16:19], v[176:179], v[48:51]
    ds_read_b64_tr_b16 v[44:45], v0 offset:20480
    ds_read_b64_tr_b16 v[46:47], v0 offset:20992
    v_mfma_f32_16x16x32_bf16 v[64:67], v[16:19], v[180:183], v[64:67]
    v_mfma_f32_16x16x32_bf16 v[52:55], v[20:23], v[176:179], v[52:55]
    ds_read_b64_tr_b16 v[16:17], v8 offset:24576
    ds_read_b64_tr_b16 v[18:19], v8 offset:25088
    v_mfma_f32_16x16x32_bf16 v[68:71], v[20:23], v[180:183], v[68:71]
    v_cvt_pk_bf16_f32 v102, v108, v109
    s_waitcnt lgkmcnt(10)
    v_mfma_f32_16x16x32_bf16 v[56:59], v[24:27], v[176:179], v[56:59]
    ds_read_b64_tr_b16 v[20:21], v9 offset:24576
    ds_read_b64_tr_b16 v[22:23], v9 offset:25088
    v_mfma_f32_16x16x32_bf16 v[72:75], v[24:27], v[180:183], v[72:75]
    v_cvt_pk_bf16_f32 v103, v110, v111
    v_mfma_f32_16x16x32_bf16 v[60:63], v[28:31], v[176:179], v[60:63]
    ds_read_b64_tr_b16 v[24:25], v1 offset:24576
    ds_read_b64_tr_b16 v[26:27], v1 offset:25088
    v_mfma_f32_16x16x32_bf16 v[76:79], v[28:31], v[180:183], v[76:79]
    s_waitcnt lgkmcnt(10)
    v_mfma_f32_16x16x32_bf16 v[48:51], v[32:35], v[184:187], v[48:51]
    ds_read_b64_tr_b16 v[28:29], v0 offset:24576
    ds_read_b64_tr_b16 v[30:31], v0 offset:25088
    v_mfma_f32_16x16x32_bf16 v[64:67], v[32:35], v[188:191], v[64:67]
    buffer_store_dwordx4 v[100:103], v15, s[16:19], s25 offen offset:2304 sc1
    v_mfma_f32_16x16x32_bf16 v[52:55], v[36:39], v[184:187], v[52:55]
    ds_read_b64_tr_b16 v[32:33], v8 offset:28672
    ds_read_b64_tr_b16 v[34:35], v8 offset:29184
    v_mfma_f32_16x16x32_bf16 v[68:71], v[36:39], v[188:191], v[68:71]
    s_waitcnt lgkmcnt(10)
    v_mfma_f32_16x16x32_bf16 v[56:59], v[40:43], v[184:187], v[56:59]
    ds_read_b64_tr_b16 v[36:37], v9 offset:28672
    ds_read_b64_tr_b16 v[38:39], v9 offset:29184
    v_mfma_f32_16x16x32_bf16 v[72:75], v[40:43], v[188:191], v[72:75]
    s_add_u32 s25, s25, 4096
    v_mfma_f32_16x16x32_bf16 v[60:63], v[44:47], v[184:187], v[60:63]
    ds_read_b64_tr_b16 v[40:41], v1 offset:28672
    ds_read_b64_tr_b16 v[42:43], v1 offset:29184
    v_mfma_f32_16x16x32_bf16 v[76:79], v[44:47], v[188:191], v[76:79]
    s_waitcnt lgkmcnt(10)
    v_mfma_f32_16x16x32_bf16 v[48:51], v[16:19], v[192:195], v[48:51]
    ds_read_b64_tr_b16 v[44:45], v0 offset:28672
    ds_read_b64_tr_b16 v[46:47], v0 offset:29184
    v_mfma_f32_16x16x32_bf16 v[64:67], v[16:19], v[196:199], v[64:67]
    v_mfma_f32_16x16x32_bf16 v[52:55], v[20:23], v[192:195], v[52:55]
    ds_read_b64_tr_b16 v[16:17], v4 offset:0
    ds_read_b64_tr_b16 v[18:19], v4 offset:512
    v_mfma_f32_16x16x32_bf16 v[68:71], v[20:23], v[196:199], v[68:71]
    s_waitcnt lgkmcnt(10)
    v_mfma_f32_16x16x32_bf16 v[56:59], v[24:27], v[192:195], v[56:59]
    ds_read_b64_tr_b16 v[20:21], v5 offset:0
    ds_read_b64_tr_b16 v[22:23], v5 offset:512
    v_mfma_f32_16x16x32_bf16 v[72:75], v[24:27], v[196:199], v[72:75]
    v_mfma_f32_16x16x32_bf16 v[60:63], v[28:31], v[192:195], v[60:63]
    ds_read_b64_tr_b16 v[24:25], v6 offset:0
    ds_read_b64_tr_b16 v[26:27], v6 offset:512
    v_mfma_f32_16x16x32_bf16 v[76:79], v[28:31], v[196:199], v[76:79]
    s_waitcnt lgkmcnt(10)
    v_mfma_f32_16x16x32_bf16 v[48:51], v[32:35], v[200:203], v[48:51]
    ds_read_b64_tr_b16 v[28:29], v7 offset:0
    ds_read_b64_tr_b16 v[30:31], v7 offset:512
    v_mfma_f32_16x16x32_bf16 v[64:67], v[32:35], v[204:207], v[64:67]
    v_mfma_f32_16x16x32_bf16 v[52:55], v[36:39], v[200:203], v[52:55]
    ds_read_b64_tr_b16 v[32:33], v4 offset:4096
    ds_read_b64_tr_b16 v[34:35], v4 offset:4608
    v_mfma_f32_16x16x32_bf16 v[68:71], v[36:39], v[204:207], v[68:71]
    s_waitcnt lgkmcnt(10)
    v_mfma_f32_16x16x32_bf16 v[56:59], v[40:43], v[200:203], v[56:59]
    ds_read_b64_tr_b16 v[36:37], v5 offset:4096
    ds_read_b64_tr_b16 v[38:39], v5 offset:4608
    v_mfma_f32_16x16x32_bf16 v[72:75], v[40:43], v[204:207], v[72:75]
    v_mfma_f32_16x16x32_bf16 v[60:63], v[44:47], v[200:203], v[60:63]
    ds_read_b64_tr_b16 v[40:41], v6 offset:4096
    ds_read_b64_tr_b16 v[42:43], v6 offset:4608
    v_mfma_f32_16x16x32_bf16 v[76:79], v[44:47], v[204:207], v[76:79]
    s_waitcnt lgkmcnt(10)
    v_mfma_f32_16x16x32_bf16 v[48:51], v[16:19], v[208:211], v[48:51]
    ds_read_b64_tr_b16 v[44:45], v7 offset:4096
    ds_read_b64_tr_b16 v[46:47], v7 offset:4608
    v_mfma_f32_16x16x32_bf16 v[64:67], v[16:19], v[212:215], v[64:67]
    v_mfma_f32_16x16x32_bf16 v[52:55], v[20:23], v[208:211], v[52:55]
    ds_read_b64_tr_b16 v[16:17], v4 offset:8192
    ds_read_b64_tr_b16 v[18:19], v4 offset:8704
    v_mfma_f32_16x16x32_bf16 v[68:71], v[20:23], v[212:215], v[68:71]
    s_waitcnt lgkmcnt(10)
    v_mfma_f32_16x16x32_bf16 v[56:59], v[24:27], v[208:211], v[56:59]
    ds_read_b64_tr_b16 v[20:21], v5 offset:8192
    ds_read_b64_tr_b16 v[22:23], v5 offset:8704
    v_mfma_f32_16x16x32_bf16 v[72:75], v[24:27], v[212:215], v[72:75]
    v_mfma_f32_16x16x32_bf16 v[60:63], v[28:31], v[208:211], v[60:63]
    ds_read_b64_tr_b16 v[24:25], v6 offset:8192
    ds_read_b64_tr_b16 v[26:27], v6 offset:8704
    v_mfma_f32_16x16x32_bf16 v[76:79], v[28:31], v[212:215], v[76:79]
    s_waitcnt lgkmcnt(10)
    v_mfma_f32_16x16x32_bf16 v[48:51], v[32:35], v[216:219], v[48:51]
    ds_read_b64_tr_b16 v[28:29], v7 offset:8192
    ds_read_b64_tr_b16 v[30:31], v7 offset:8704
    v_mfma_f32_16x16x32_bf16 v[64:67], v[32:35], v[220:223], v[64:67]
    v_mfma_f32_16x16x32_bf16 v[52:55], v[36:39], v[216:219], v[52:55]
    ds_read_b64_tr_b16 v[32:33], v4 offset:12288
    ds_read_b64_tr_b16 v[34:35], v4 offset:12800
    v_mfma_f32_16x16x32_bf16 v[68:71], v[36:39], v[220:223], v[68:71]
    s_waitcnt lgkmcnt(10)
    v_mfma_f32_16x16x32_bf16 v[56:59], v[40:43], v[216:219], v[56:59]
    ds_read_b64_tr_b16 v[36:37], v5 offset:12288
    ds_read_b64_tr_b16 v[38:39], v5 offset:12800
    v_mfma_f32_16x16x32_bf16 v[72:75], v[40:43], v[220:223], v[72:75]
    v_mfma_f32_16x16x32_bf16 v[60:63], v[44:47], v[216:219], v[60:63]
    ds_read_b64_tr_b16 v[40:41], v6 offset:12288
    ds_read_b64_tr_b16 v[42:43], v6 offset:12800
    v_mfma_f32_16x16x32_bf16 v[76:79], v[44:47], v[220:223], v[76:79]
    s_waitcnt lgkmcnt(10)
    v_mfma_f32_16x16x32_bf16 v[48:51], v[16:19], v[224:227], v[48:51]
    ds_read_b64_tr_b16 v[44:45], v7 offset:12288
    ds_read_b64_tr_b16 v[46:47], v7 offset:12800
    v_mfma_f32_16x16x32_bf16 v[64:67], v[16:19], v[228:231], v[64:67]
    v_mfma_f32_16x16x32_bf16 v[52:55], v[20:23], v[224:227], v[52:55]
    ds_read_b64_tr_b16 v[16:17], v8 offset:32768
    ds_read_b64_tr_b16 v[18:19], v8 offset:33280
    v_mfma_f32_16x16x32_bf16 v[68:71], v[20:23], v[228:231], v[68:71]
    s_waitcnt lgkmcnt(10)
    v_mfma_f32_16x16x32_bf16 v[56:59], v[24:27], v[224:227], v[56:59]
    ds_read_b64_tr_b16 v[20:21], v9 offset:32768
    ds_read_b64_tr_b16 v[22:23], v9 offset:33280
    v_mfma_f32_16x16x32_bf16 v[72:75], v[24:27], v[228:231], v[72:75]
    v_mfma_f32_16x16x32_bf16 v[60:63], v[28:31], v[224:227], v[60:63]
    ds_read_b64_tr_b16 v[24:25], v1 offset:32768
    ds_read_b64_tr_b16 v[26:27], v1 offset:33280
    v_mfma_f32_16x16x32_bf16 v[76:79], v[28:31], v[228:231], v[76:79]
    s_waitcnt lgkmcnt(10)
    v_mfma_f32_16x16x32_bf16 v[48:51], v[32:35], v[232:235], v[48:51]
    ds_read_b64_tr_b16 v[28:29], v0 offset:32768
    ds_read_b64_tr_b16 v[30:31], v0 offset:33280
    v_mfma_f32_16x16x32_bf16 v[64:67], v[32:35], v[236:239], v[64:67]
    v_mfma_f32_16x16x32_bf16 v[52:55], v[36:39], v[232:235], v[52:55]
    ds_read_b64_tr_b16 v[32:33], v8 offset:36864
    ds_read_b64_tr_b16 v[34:35], v8 offset:37376
    v_mfma_f32_16x16x32_bf16 v[68:71], v[36:39], v[236:239], v[68:71]
    s_waitcnt lgkmcnt(10)
    v_mfma_f32_16x16x32_bf16 v[56:59], v[40:43], v[232:235], v[56:59]
    ds_read_b64_tr_b16 v[36:37], v9 offset:36864
    ds_read_b64_tr_b16 v[38:39], v9 offset:37376
    v_mfma_f32_16x16x32_bf16 v[72:75], v[40:43], v[236:239], v[72:75]
    v_mfma_f32_16x16x32_bf16 v[60:63], v[44:47], v[232:235], v[60:63]
    ds_read_b64_tr_b16 v[40:41], v1 offset:36864
    ds_read_b64_tr_b16 v[42:43], v1 offset:37376
    v_mfma_f32_16x16x32_bf16 v[76:79], v[44:47], v[236:239], v[76:79]
    s_waitcnt lgkmcnt(10)
    v_mfma_f32_16x16x32_bf16 v[48:51], v[16:19], v[240:243], v[48:51]
    ds_read_b64_tr_b16 v[44:45], v0 offset:36864
    ds_read_b64_tr_b16 v[46:47], v0 offset:37376
    v_mfma_f32_16x16x32_bf16 v[64:67], v[16:19], v[244:247], v[64:67]
    v_mfma_f32_16x16x32_bf16 v[52:55], v[20:23], v[240:243], v[52:55]
    v_mfma_f32_16x16x32_bf16 v[68:71], v[20:23], v[244:247], v[68:71]
    s_waitcnt vmcnt(9)
    s_barrier
    ds_read_b64_tr_b16 v[16:17], v8 offset:40960
    ds_read_b64_tr_b16 v[18:19], v8 offset:41472
    s_add_u32 m0, s24, 65536
    s_add_u32 s30, s36, 256
    buffer_load_dwordx4 v2, s[8:11], s30 offen lds
    s_add_u32 m0, m0, 4096
    s_add_u32 s30, s30, 294912
    buffer_load_dwordx4 v2, s[8:11], s30 offen lds
    s_add_u32 m0, s24, 73728
    s_add_u32 s30, s37, 256
    buffer_load_dwordx4 v2, s[8:11], s30 offen lds
    s_add_u32 m0, m0, 4096
    s_add_u32 s30, s30, 294912
    buffer_load_dwordx4 v2, s[8:11], s30 offen lds
    s_waitcnt lgkmcnt(10)
    v_mfma_f32_16x16x32_bf16 v[56:59], v[24:27], v[240:243], v[56:59]
    ds_read_b64_tr_b16 v[20:21], v9 offset:40960
    ds_read_b64_tr_b16 v[22:23], v9 offset:41472
    v_mfma_f32_16x16x32_bf16 v[72:75], v[24:27], v[244:247], v[72:75]
    s_add_u32 m0, s24, 81920
    s_add_u32 s30, s38, 256
    buffer_load_dwordx4 v2, s[8:11], s30 offen lds
    s_add_u32 m0, m0, 4096
    s_add_u32 s30, s30, 294912
    buffer_load_dwordx4 v2, s[8:11], s30 offen lds
    s_add_u32 m0, s24, 90112
    s_add_u32 s30, s39, 256
    buffer_load_dwordx4 v2, s[8:11], s30 offen lds
    s_add_u32 m0, m0, 4096
    s_add_u32 s30, s30, 294912
    buffer_load_dwordx4 v2, s[8:11], s30 offen lds
    v_mfma_f32_16x16x32_bf16 v[60:63], v[28:31], v[240:243], v[60:63]
    ds_read_b64_tr_b16 v[24:25], v1 offset:40960
    ds_read_b64_tr_b16 v[26:27], v1 offset:41472
    v_mfma_f32_16x16x32_bf16 v[76:79], v[28:31], v[244:247], v[76:79]
    s_add_u32 m0, s24, 0
    s_add_u32 s30, s40, 256
    buffer_load_dwordx4 v2, s[8:11], s30 offen lds
    s_add_u32 m0, m0, 4096
    s_add_u32 s30, s30, 294912
    buffer_load_dwordx4 v2, s[8:11], s30 offen lds
    s_add_u32 m0, s24, 8192
    s_add_u32 s30, s41, 256
    buffer_load_dwordx4 v2, s[8:11], s30 offen lds
    s_add_u32 m0, m0, 4096
    s_add_u32 s30, s30, 294912
    buffer_load_dwordx4 v2, s[8:11], s30 offen lds
    s_waitcnt lgkmcnt(10)
    v_mfma_f32_16x16x32_bf16 v[48:51], v[32:35], v[248:251], v[48:51]
    ds_read_b64_tr_b16 v[28:29], v0 offset:40960
    ds_read_b64_tr_b16 v[30:31], v0 offset:41472
    v_mfma_f32_16x16x32_bf16 v[64:67], v[32:35], v[252:255], v[64:67]
    v_mfma_f32_16x16x32_bf16 v[52:55], v[36:39], v[248:251], v[52:55]
    ds_read_b64_tr_b16 v[32:33], v8 offset:45056
    ds_read_b64_tr_b16 v[34:35], v8 offset:45568
    v_mfma_f32_16x16x32_bf16 v[68:71], v[36:39], v[252:255], v[68:71]
    s_waitcnt lgkmcnt(10)
    v_mfma_f32_16x16x32_bf16 v[56:59], v[40:43], v[248:251], v[56:59]
    ds_read_b64_tr_b16 v[36:37], v9 offset:45056
    ds_read_b64_tr_b16 v[38:39], v9 offset:45568
    v_mfma_f32_16x16x32_bf16 v[72:75], v[40:43], v[252:255], v[72:75]
    v_mfma_f32_16x16x32_bf16 v[60:63], v[44:47], v[248:251], v[60:63]
    ds_read_b64_tr_b16 v[40:41], v1 offset:45056
    ds_read_b64_tr_b16 v[42:43], v1 offset:45568
    v_mfma_f32_16x16x32_bf16 v[76:79], v[44:47], v[252:255], v[76:79]
    s_waitcnt lgkmcnt(10)
    v_mfma_f32_16x16x32_bf16 v[80:83], v[16:19], v[112:115], 0
    ds_read_b64_tr_b16 v[44:45], v0 offset:45056
    ds_read_b64_tr_b16 v[46:47], v0 offset:45568
    v_mfma_f32_16x16x32_bf16 v[96:99], v[16:19], v[116:119], 0
    v_mfma_f32_16x16x32_bf16 v[84:87], v[20:23], v[112:115], 0
    ds_read_b64_tr_b16 v[16:17], v8 offset:49152
    ds_read_b64_tr_b16 v[18:19], v8 offset:49664
    v_mfma_f32_16x16x32_bf16 v[100:103], v[20:23], v[116:119], 0
    s_waitcnt lgkmcnt(10)
    v_mfma_f32_16x16x32_bf16 v[88:91], v[24:27], v[112:115], 0
    ds_read_b64_tr_b16 v[20:21], v9 offset:49152
    ds_read_b64_tr_b16 v[22:23], v9 offset:49664
    v_mfma_f32_16x16x32_bf16 v[104:107], v[24:27], v[116:119], 0
    v_mfma_f32_16x16x32_bf16 v[92:95], v[28:31], v[112:115], 0
    ds_read_b64_tr_b16 v[24:25], v1 offset:49152
    ds_read_b64_tr_b16 v[26:27], v1 offset:49664
    v_mfma_f32_16x16x32_bf16 v[108:111], v[28:31], v[116:119], 0
    v_mul_f32 v11, v48, v48
    v_mul_f32 v12, v49, v49
    v_mul_f32 v13, v50, v50
    v_mul_f32 v14, v51, v51
    s_waitcnt lgkmcnt(10)
    v_mfma_f32_16x16x32_bf16 v[80:83], v[32:35], v[120:123], v[80:83]
    ds_read_b64_tr_b16 v[28:29], v0 offset:49152
    ds_read_b64_tr_b16 v[30:31], v0 offset:49664
    v_mfma_f32_16x16x32_bf16 v[96:99], v[32:35], v[124:127], v[96:99]
    v_fma_f32 v11, v11, s26, v10
    v_fma_f32 v12, v12, s26, v10
    v_fma_f32 v13, v13, s26, v10
    v_mfma_f32_16x16x32_bf16 v[84:87], v[36:39], v[120:123], v[84:87]
    ds_read_b64_tr_b16 v[32:33], v8 offset:53248
    ds_read_b64_tr_b16 v[34:35], v8 offset:53760
    v_mfma_f32_16x16x32_bf16 v[100:103], v[36:39], v[124:127], v[100:103]
    v_fma_f32 v14, v14, s26, v10
    v_mul_f32 v11, v11, v48
    v_mul_f32 v12, v12, v49
    v_mul_f32 v13, v13, v50
    s_waitcnt lgkmcnt(10)
    v_mfma_f32_16x16x32_bf16 v[88:91], v[40:43], v[120:123], v[88:91]
    ds_read_b64_tr_b16 v[36:37], v9 offset:53248
    ds_read_b64_tr_b16 v[38:39], v9 offset:53760
    v_mfma_f32_16x16x32_bf16 v[104:107], v[40:43], v[124:127], v[104:107]
    v_mul_f32 v14, v14, v51
    v_exp_f32 v11, v11
    v_exp_f32 v12, v12
    v_mfma_f32_16x16x32_bf16 v[92:95], v[44:47], v[120:123], v[92:95]
    ds_read_b64_tr_b16 v[40:41], v1 offset:53248
    ds_read_b64_tr_b16 v[42:43], v1 offset:53760
    v_mfma_f32_16x16x32_bf16 v[108:111], v[44:47], v[124:127], v[108:111]
    v_exp_f32 v13, v13
    v_exp_f32 v14, v14
    v_add_f32 v11, 1.0, v11
    s_waitcnt lgkmcnt(10)
    v_mfma_f32_16x16x32_bf16 v[80:83], v[16:19], v[128:131], v[80:83]
    ds_read_b64_tr_b16 v[44:45], v0 offset:53248
    ds_read_b64_tr_b16 v[46:47], v0 offset:53760
    v_mfma_f32_16x16x32_bf16 v[96:99], v[16:19], v[132:135], v[96:99]
    v_add_f32 v12, 1.0, v12
    v_add_f32 v13, 1.0, v13
    v_add_f32 v14, 1.0, v14
    v_rcp_f32 v11, v11
    v_mfma_f32_16x16x32_bf16 v[84:87], v[20:23], v[128:131], v[84:87]
    ds_read_b64_tr_b16 v[16:17], v8 offset:57344
    ds_read_b64_tr_b16 v[18:19], v8 offset:57856
    v_mfma_f32_16x16x32_bf16 v[100:103], v[20:23], v[132:135], v[100:103]
    v_rcp_f32 v12, v12
    v_rcp_f32 v13, v13
    v_rcp_f32 v14, v14
    s_waitcnt lgkmcnt(10)
    v_mfma_f32_16x16x32_bf16 v[88:91], v[24:27], v[128:131], v[88:91]
    ds_read_b64_tr_b16 v[20:21], v9 offset:57344
    ds_read_b64_tr_b16 v[22:23], v9 offset:57856
    v_mfma_f32_16x16x32_bf16 v[104:107], v[24:27], v[132:135], v[104:107]
    v_mul_f32 v48, v11, v48
    v_mul_f32 v49, v12, v49
    v_mul_f32 v50, v13, v50
    v_mfma_f32_16x16x32_bf16 v[92:95], v[28:31], v[128:131], v[92:95]
    ds_read_b64_tr_b16 v[24:25], v1 offset:57344
    ds_read_b64_tr_b16 v[26:27], v1 offset:57856
    v_mfma_f32_16x16x32_bf16 v[108:111], v[28:31], v[132:135], v[108:111]
    v_mul_f32 v51, v14, v51
    v_mul_f32 v11, v52, v52
    v_mul_f32 v12, v53, v53
    v_mul_f32 v13, v54, v54
    s_waitcnt lgkmcnt(10)
    v_mfma_f32_16x16x32_bf16 v[80:83], v[32:35], v[136:139], v[80:83]
    ds_read_b64_tr_b16 v[28:29], v0 offset:57344
    ds_read_b64_tr_b16 v[30:31], v0 offset:57856
    v_mfma_f32_16x16x32_bf16 v[96:99], v[32:35], v[140:143], v[96:99]
    v_mul_f32 v14, v55, v55
    v_fma_f32 v11, v11, s26, v10
    v_fma_f32 v12, v12, s26, v10
    v_mfma_f32_16x16x32_bf16 v[84:87], v[36:39], v[136:139], v[84:87]
    ds_read_b64_tr_b16 v[32:33], v8 offset:61440
    ds_read_b64_tr_b16 v[34:35], v8 offset:61952
    v_mfma_f32_16x16x32_bf16 v[100:103], v[36:39], v[140:143], v[100:103]
    v_fma_f32 v13, v13, s26, v10
    v_fma_f32 v14, v14, s26, v10
    v_mul_f32 v11, v11, v52
    s_waitcnt lgkmcnt(10)
    v_mfma_f32_16x16x32_bf16 v[88:91], v[40:43], v[136:139], v[88:91]
    ds_read_b64_tr_b16 v[36:37], v9 offset:61440
    ds_read_b64_tr_b16 v[38:39], v9 offset:61952
    v_mfma_f32_16x16x32_bf16 v[104:107], v[40:43], v[140:143], v[104:107]
    v_mul_f32 v12, v12, v53
    v_mul_f32 v13, v13, v54
    v_mul_f32 v14, v14, v55
    v_exp_f32 v11, v11
    v_mfma_f32_16x16x32_bf16 v[92:95], v[44:47], v[136:139], v[92:95]
    ds_read_b64_tr_b16 v[40:41], v1 offset:61440
    ds_read_b64_tr_b16 v[42:43], v1 offset:61952
    v_mfma_f32_16x16x32_bf16 v[108:111], v[44:47], v[140:143], v[108:111]
    v_exp_f32 v12, v12
    v_exp_f32 v13, v13
    v_exp_f32 v14, v14
    s_waitcnt lgkmcnt(10)
    v_mfma_f32_16x16x32_bf16 v[80:83], v[16:19], v[144:147], v[80:83]
    ds_read_b64_tr_b16 v[44:45], v0 offset:61440
    ds_read_b64_tr_b16 v[46:47], v0 offset:61952
    v_mfma_f32_16x16x32_bf16 v[96:99], v[16:19], v[148:151], v[96:99]
    v_add_f32 v11, 1.0, v11
    v_add_f32 v12, 1.0, v12
    v_add_f32 v13, 1.0, v13
    v_mfma_f32_16x16x32_bf16 v[84:87], v[20:23], v[144:147], v[84:87]
    ds_read_b64_tr_b16 v[16:17], v4 offset:16384
    ds_read_b64_tr_b16 v[18:19], v4 offset:16896
    v_mfma_f32_16x16x32_bf16 v[100:103], v[20:23], v[148:151], v[100:103]
    v_add_f32 v14, 1.0, v14
    v_rcp_f32 v11, v11
    v_rcp_f32 v12, v12
    v_rcp_f32 v13, v13
    s_waitcnt lgkmcnt(10)
    v_mfma_f32_16x16x32_bf16 v[88:91], v[24:27], v[144:147], v[88:91]
    ds_read_b64_tr_b16 v[20:21], v5 offset:16384
    ds_read_b64_tr_b16 v[22:23], v5 offset:16896
    v_mfma_f32_16x16x32_bf16 v[104:107], v[24:27], v[148:151], v[104:107]
    v_rcp_f32 v14, v14
    v_mul_f32 v52, v11, v52
    v_mul_f32 v53, v12, v53
    v_mfma_f32_16x16x32_bf16 v[92:95], v[28:31], v[144:147], v[92:95]
    ds_read_b64_tr_b16 v[24:25], v6 offset:16384
    ds_read_b64_tr_b16 v[26:27], v6 offset:16896
    v_mfma_f32_16x16x32_bf16 v[108:111], v[28:31], v[148:151], v[108:111]
    v_mul_f32 v54, v13, v54
    v_mul_f32 v55, v14, v55
    v_mul_f32 v11, v56, v56
    s_waitcnt lgkmcnt(10)
    v_mfma_f32_16x16x32_bf16 v[80:83], v[32:35], v[152:155], v[80:83]
    ds_read_b64_tr_b16 v[28:29], v7 offset:16384
    ds_read_b64_tr_b16 v[30:31], v7 offset:16896
    v_mfma_f32_16x16x32_bf16 v[96:99], v[32:35], v[156:159], v[96:99]
    v_mul_f32 v12, v57, v57
    v_mul_f32 v13, v58, v58
    v_mul_f32 v14, v59, v59
    v_fma_f32 v11, v11, s26, v10
    v_mfma_f32_16x16x32_bf16 v[84:87], v[36:39], v[152:155], v[84:87]
    ds_read_b64_tr_b16 v[32:33], v4 offset:20480
    ds_read_b64_tr_b16 v[34:35], v4 offset:20992
    v_mfma_f32_16x16x32_bf16 v[100:103], v[36:39], v[156:159], v[100:103]
    v_fma_f32 v12, v12, s26, v10
    v_fma_f32 v13, v13, s26, v10
    v_fma_f32 v14, v14, s26, v10
    s_waitcnt lgkmcnt(10)
    v_mfma_f32_16x16x32_bf16 v[88:91], v[40:43], v[152:155], v[88:91]
    ds_read_b64_tr_b16 v[36:37], v5 offset:20480
    ds_read_b64_tr_b16 v[38:39], v5 offset:20992
    v_mfma_f32_16x16x32_bf16 v[104:107], v[40:43], v[156:159], v[104:107]
    v_mul_f32 v11, v11, v56
    v_mul_f32 v12, v12, v57
    v_mul_f32 v13, v13, v58
    v_mfma_f32_16x16x32_bf16 v[92:95], v[44:47], v[152:155], v[92:95]
    ds_read_b64_tr_b16 v[40:41], v6 offset:20480
    ds_read_b64_tr_b16 v[42:43], v6 offset:20992
    v_mfma_f32_16x16x32_bf16 v[108:111], v[44:47], v[156:159], v[108:111]
    v_mul_f32 v14, v14, v59
    v_exp_f32 v11, v11
    v_exp_f32 v12, v12
    v_exp_f32 v13, v13
    s_waitcnt lgkmcnt(10)
    v_mfma_f32_16x16x32_bf16 v[80:83], v[16:19], v[160:163], v[80:83]
    ds_read_b64_tr_b16 v[44:45], v7 offset:20480
    ds_read_b64_tr_b16 v[46:47], v7 offset:20992
    v_mfma_f32_16x16x32_bf16 v[96:99], v[16:19], v[164:167], v[96:99]
    v_exp_f32 v14, v14
    v_add_f32 v11, 1.0, v11
    v_add_f32 v12, 1.0, v12
    v_mfma_f32_16x16x32_bf16 v[84:87], v[20:23], v[160:163], v[84:87]
    ds_read_b64_tr_b16 v[16:17], v4 offset:24576
    ds_read_b64_tr_b16 v[18:19], v4 offset:25088
    v_mfma_f32_16x16x32_bf16 v[100:103], v[20:23], v[164:167], v[100:103]
    v_add_f32 v13, 1.0, v13
    v_add_f32 v14, 1.0, v14
    v_rcp_f32 v11, v11
    s_waitcnt lgkmcnt(10)
    v_mfma_f32_16x16x32_bf16 v[88:91], v[24:27], v[160:163], v[88:91]
    ds_read_b64_tr_b16 v[20:21], v5 offset:24576
    ds_read_b64_tr_b16 v[22:23], v5 offset:25088
    v_mfma_f32_16x16x32_bf16 v[104:107], v[24:27], v[164:167], v[104:107]
    v_rcp_f32 v12, v12
    v_rcp_f32 v13, v13
    v_rcp_f32 v14, v14
    v_mul_f32 v56, v11, v56
    v_mfma_f32_16x16x32_bf16 v[92:95], v[28:31], v[160:163], v[92:95]
    ds_read_b64_tr_b16 v[24:25], v6 offset:24576
    ds_read_b64_tr_b16 v[26:27], v6 offset:25088
    v_mfma_f32_16x16x32_bf16 v[108:111], v[28:31], v[164:167], v[108:111]
    v_mul_f32 v57, v12, v57
    v_mul_f32 v58, v13, v58
    v_mul_f32 v59, v14, v59
    s_waitcnt lgkmcnt(10)
    v_mfma_f32_16x16x32_bf16 v[80:83], v[32:35], v[168:171], v[80:83]
    ds_read_b64_tr_b16 v[28:29], v7 offset:24576
    ds_read_b64_tr_b16 v[30:31], v7 offset:25088
    v_mfma_f32_16x16x32_bf16 v[96:99], v[32:35], v[172:175], v[96:99]
    v_mul_f32 v11, v60, v60
    v_mul_f32 v12, v61, v61
    v_mul_f32 v13, v62, v62
    v_mfma_f32_16x16x32_bf16 v[84:87], v[36:39], v[168:171], v[84:87]
    ds_read_b64_tr_b16 v[32:33], v4 offset:28672
    ds_read_b64_tr_b16 v[34:35], v4 offset:29184
    v_mfma_f32_16x16x32_bf16 v[100:103], v[36:39], v[172:175], v[100:103]
    v_mul_f32 v14, v63, v63
    v_fma_f32 v11, v11, s26, v10
    v_fma_f32 v12, v12, s26, v10
    v_fma_f32 v13, v13, s26, v10
    s_waitcnt lgkmcnt(10)
    v_mfma_f32_16x16x32_bf16 v[88:91], v[40:43], v[168:171], v[88:91]
    ds_read_b64_tr_b16 v[36:37], v5 offset:28672
    ds_read_b64_tr_b16 v[38:39], v5 offset:29184
    v_mfma_f32_16x16x32_bf16 v[104:107], v[40:43], v[172:175], v[104:107]
    v_fma_f32 v14, v14, s26, v10
    v_mul_f32 v11, v11, v60
    v_mul_f32 v12, v12, v61
    v_mfma_f32_16x16x32_bf16 v[92:95], v[44:47], v[168:171], v[92:95]
    ds_read_b64_tr_b16 v[40:41], v6 offset:28672
    ds_read_b64_tr_b16 v[42:43], v6 offset:29184
    v_mfma_f32_16x16x32_bf16 v[108:111], v[44:47], v[172:175], v[108:111]
    v_mul_f32 v13, v13, v62
    v_mul_f32 v14, v14, v63
    v_exp_f32 v11, v11
    s_waitcnt lgkmcnt(10)
    v_mfma_f32_16x16x32_bf16 v[80:83], v[16:19], v[176:179], v[80:83]
    ds_read_b64_tr_b16 v[44:45], v7 offset:28672
    ds_read_b64_tr_b16 v[46:47], v7 offset:29184
    v_mfma_f32_16x16x32_bf16 v[96:99], v[16:19], v[180:183], v[96:99]
    v_exp_f32 v12, v12
    v_exp_f32 v13, v13
    v_exp_f32 v14, v14
    v_add_f32 v11, 1.0, v11
    v_mfma_f32_16x16x32_bf16 v[84:87], v[20:23], v[176:179], v[84:87]
    ds_read_b64_tr_b16 v[16:17], v4 offset:32768
    ds_read_b64_tr_b16 v[18:19], v4 offset:33280
    v_mfma_f32_16x16x32_bf16 v[100:103], v[20:23], v[180:183], v[100:103]
    v_add_f32 v12, 1.0, v12
    v_add_f32 v13, 1.0, v13
    v_add_f32 v14, 1.0, v14
    s_waitcnt lgkmcnt(10)
    v_mfma_f32_16x16x32_bf16 v[88:91], v[24:27], v[176:179], v[88:91]
    ds_read_b64_tr_b16 v[20:21], v5 offset:32768
    ds_read_b64_tr_b16 v[22:23], v5 offset:33280
    v_mfma_f32_16x16x32_bf16 v[104:107], v[24:27], v[180:183], v[104:107]
    v_rcp_f32 v11, v11
    v_rcp_f32 v12, v12
    v_rcp_f32 v13, v13
    v_mfma_f32_16x16x32_bf16 v[92:95], v[28:31], v[176:179], v[92:95]
    ds_read_b64_tr_b16 v[24:25], v6 offset:32768
    ds_read_b64_tr_b16 v[26:27], v6 offset:33280
    v_mfma_f32_16x16x32_bf16 v[108:111], v[28:31], v[180:183], v[108:111]
    v_rcp_f32 v14, v14
    v_mul_f32 v60, v11, v60
    v_mul_f32 v61, v12, v61
    v_mul_f32 v62, v13, v62
    s_waitcnt lgkmcnt(10)
    v_mfma_f32_16x16x32_bf16 v[80:83], v[32:35], v[184:187], v[80:83]
    ds_read_b64_tr_b16 v[28:29], v7 offset:32768
    ds_read_b64_tr_b16 v[30:31], v7 offset:33280
    v_mfma_f32_16x16x32_bf16 v[96:99], v[32:35], v[188:191], v[96:99]
    v_mul_f32 v63, v14, v63
    v_mul_f32 v11, v64, v64
    v_mul_f32 v12, v65, v65
    v_mfma_f32_16x16x32_bf16 v[84:87], v[36:39], v[184:187], v[84:87]
    ds_read_b64_tr_b16 v[32:33], v4 offset:36864
    ds_read_b64_tr_b16 v[34:35], v4 offset:37376
    v_mfma_f32_16x16x32_bf16 v[100:103], v[36:39], v[188:191], v[100:103]
    v_mul_f32 v13, v66, v66
    v_mul_f32 v14, v67, v67
    v_fma_f32 v11, v11, s26, v10
    v_fma_f32 v12, v12, s26, v10
    s_waitcnt lgkmcnt(10)
    v_mfma_f32_16x16x32_bf16 v[88:91], v[40:43], v[184:187], v[88:91]
    ds_read_b64_tr_b16 v[36:37], v5 offset:36864
    ds_read_b64_tr_b16 v[38:39], v5 offset:37376
    v_mfma_f32_16x16x32_bf16 v[104:107], v[40:43], v[188:191], v[104:107]
    v_fma_f32 v13, v13, s26, v10
    v_fma_f32 v14, v14, s26, v10
    v_mul_f32 v11, v11, v64
    v_mfma_f32_16x16x32_bf16 v[92:95], v[44:47], v[184:187], v[92:95]
    ds_read_b64_tr_b16 v[40:41], v6 offset:36864
    ds_read_b64_tr_b16 v[42:43], v6 offset:37376
    v_mfma_f32_16x16x32_bf16 v[108:111], v[44:47], v[188:191], v[108:111]
    v_mul_f32 v12, v12, v65
    v_mul_f32 v13, v13, v66
    v_mul_f32 v14, v14, v67
    s_waitcnt lgkmcnt(10)
    v_mfma_f32_16x16x32_bf16 v[80:83], v[16:19], v[192:195], v[80:83]
    ds_read_b64_tr_b16 v[44:45], v7 offset:36864
    ds_read_b64_tr_b16 v[46:47], v7 offset:37376
    v_mfma_f32_16x16x32_bf16 v[96:99], v[16:19], v[196:199], v[96:99]
    v_exp_f32 v11, v11
    v_exp_f32 v12, v12
    v_exp_f32 v13, v13
    v_exp_f32 v14, v14
    v_mfma_f32_16x16x32_bf16 v[84:87], v[20:23], v[192:195], v[84:87]
    v_mfma_f32_16x16x32_bf16 v[100:103], v[20:23], v[196:199], v[100:103]
    s_waitcnt vmcnt(6)
    s_barrier
    ds_read_b64_tr_b16 v[16:17], v4 offset:40960
    ds_read_b64_tr_b16 v[18:19], v4 offset:41472
    s_add_u32 m0, s24, 98304
    s_add_u32 s30, s42, 256
    buffer_load_dwordx4 v2, s[8:11], s30 offen lds
    s_add_u32 m0, m0, 4096
    s_add_u32 s30, s30, 294912
    buffer_load_dwordx4 v2, s[8:11], s30 offen lds
    s_add_u32 m0, s24, 106496
    s_add_u32 s30, s43, 256
    buffer_load_dwordx4 v2, s[8:11], s30 offen lds
    s_add_u32 m0, m0, 4096
    s_add_u32 s30, s30, 294912
    buffer_load_dwordx4 v2, s[8:11], s30 offen lds
    v_add_f32 v11, 1.0, v11
    v_add_f32 v12, 1.0, v12
    v_add_f32 v13, 1.0, v13
    s_waitcnt lgkmcnt(10)
    v_mfma_f32_16x16x32_bf16 v[88:91], v[24:27], v[192:195], v[88:91]
    ds_read_b64_tr_b16 v[20:21], v5 offset:40960
    ds_read_b64_tr_b16 v[22:23], v5 offset:41472
    v_mfma_f32_16x16x32_bf16 v[104:107], v[24:27], v[196:199], v[104:107]
    s_add_u32 m0, s24, 114688
    s_add_u32 s30, s44, 256
    buffer_load_dwordx4 v2, s[8:11], s30 offen lds
    s_add_u32 m0, m0, 4096
    s_add_u32 s30, s30, 294912
    buffer_load_dwordx4 v2, s[8:11], s30 offen lds
    s_add_u32 m0, s24, 122880
    s_add_u32 s30, s36, 256
    buffer_load_dwordx4 v2, s[12:15], s30 offen lds
    s_add_u32 m0, m0, 4096
    s_add_u32 s30, s30, 294912
    buffer_load_dwordx4 v2, s[12:15], s30 offen lds
    v_add_f32 v14, 1.0, v14
    v_rcp_f32 v11, v11
    v_rcp_f32 v12, v12
    v_mfma_f32_16x16x32_bf16 v[92:95], v[28:31], v[192:195], v[92:95]
    ds_read_b64_tr_b16 v[24:25], v6 offset:40960
    ds_read_b64_tr_b16 v[26:27], v6 offset:41472
    v_mfma_f32_16x16x32_bf16 v[108:111], v[28:31], v[196:199], v[108:111]
    s_add_u32 m0, s24, 16384
    s_add_u32 s30, s37, 256
    buffer_load_dwordx4 v2, s[12:15], s30 offen lds
    s_add_u32 m0, m0, 4096
    s_add_u32 s30, s30, 294912
    buffer_load_dwordx4 v2, s[12:15], s30 offen lds
    s_add_u32 m0, s24, 24576
    s_add_u32 s30, s38, 256
    buffer_load_dwordx4 v2, s[12:15], s30 offen lds
    s_add_u32 m0, m0, 4096
    s_add_u32 s30, s30, 294912
    buffer_load_dwordx4 v2, s[12:15], s30 offen lds
    v_rcp_f32 v13, v13
    v_rcp_f32 v14, v14
    v_mul_f32 v64, v11, v64
    v_mul_f32 v65, v12, v65
    s_waitcnt lgkmcnt(10)
    v_mfma_f32_16x16x32_bf16 v[80:83], v[32:35], v[200:203], v[80:83]
    ds_read_b64_tr_b16 v[28:29], v7 offset:40960
    ds_read_b64_tr_b16 v[30:31], v7 offset:41472
    v_mfma_f32_16x16x32_bf16 v[96:99], v[32:35], v[204:207], v[96:99]
    v_mul_f32 v66, v13, v66
    v_mul_f32 v67, v14, v67
    v_mul_f32 v11, v68, v68
    v_mfma_f32_16x16x32_bf16 v[84:87], v[36:39], v[200:203], v[84:87]
    ds_read_b64_tr_b16 v[32:33], v4 offset:45056
    ds_read_b64_tr_b16 v[34:35], v4 offset:45568
    v_mfma_f32_16x16x32_bf16 v[100:103], v[36:39], v[204:207], v[100:103]
    v_mul_f32 v12, v69, v69
    v_mul_f32 v13, v70, v70
    v_mul_f32 v14, v71, v71
    s_waitcnt lgkmcnt(10)
    v_mfma_f32_16x16x32_bf16 v[88:91], v[40:43], v[200:203], v[88:91]
    ds_read_b64_tr_b16 v[36:37], v5 offset:45056
    ds_read_b64_tr_b16 v[38:39], v5 offset:45568
    v_mfma_f32_16x16x32_bf16 v[104:107], v[40:43], v[204:207], v[104:107]
    v_fma_f32 v11, v11, s26, v10
    v_fma_f32 v12, v12, s26, v10
    v_fma_f32 v13, v13, s26, v10
    v_fma_f32 v14, v14, s26, v10
    v_mfma_f32_16x16x32_bf16 v[92:95], v[44:47], v[200:203], v[92:95]
    ds_read_b64_tr_b16 v[40:41], v6 offset:45056
    ds_read_b64_tr_b16 v[42:43], v6 offset:45568
    v_mfma_f32_16x16x32_bf16 v[108:111], v[44:47], v[204:207], v[108:111]
    v_mul_f32 v11, v11, v68
    v_mul_f32 v12, v12, v69
    v_mul_f32 v13, v13, v70
    s_waitcnt lgkmcnt(10)
    v_mfma_f32_16x16x32_bf16 v[80:83], v[16:19], v[208:211], v[80:83]
    ds_read_b64_tr_b16 v[44:45], v7 offset:45056
    ds_read_b64_tr_b16 v[46:47], v7 offset:45568
    v_mfma_f32_16x16x32_bf16 v[96:99], v[16:19], v[212:215], v[96:99]
    v_mul_f32 v14, v14, v71
    v_exp_f32 v11, v11
    v_exp_f32 v12, v12
    v_mfma_f32_16x16x32_bf16 v[84:87], v[20:23], v[208:211], v[84:87]
    ds_read_b64_tr_b16 v[16:17], v4 offset:49152
    ds_read_b64_tr_b16 v[18:19], v4 offset:49664
    v_mfma_f32_16x16x32_bf16 v[100:103], v[20:23], v[212:215], v[100:103]
    v_exp_f32 v13, v13
    v_exp_f32 v14, v14
    v_add_f32 v11, 1.0, v11
    v_add_f32 v12, 1.0, v12
    s_waitcnt lgkmcnt(10)
    v_mfma_f32_16x16x32_bf16 v[88:91], v[24:27], v[208:211], v[88:91]
    ds_read_b64_tr_b16 v[20:21], v5 offset:49152
    ds_read_b64_tr_b16 v[22:23], v5 offset:49664
    v_mfma_f32_16x16x32_bf16 v[104:107], v[24:27], v[212:215], v[104:107]
    v_add_f32 v13, 1.0, v13
    v_add_f32 v14, 1.0, v14
    v_rcp_f32 v11, v11
    v_mfma_f32_16x16x32_bf16 v[92:95], v[28:31], v[208:211], v[92:95]
    ds_read_b64_tr_b16 v[24:25], v6 offset:49152
    ds_read_b64_tr_b16 v[26:27], v6 offset:49664
    v_mfma_f32_16x16x32_bf16 v[108:111], v[28:31], v[212:215], v[108:111]
    v_rcp_f32 v12, v12
    v_rcp_f32 v13, v13
    v_rcp_f32 v14, v14
    s_waitcnt lgkmcnt(10)
    v_mfma_f32_16x16x32_bf16 v[80:83], v[32:35], v[216:219], v[80:83]
    ds_read_b64_tr_b16 v[28:29], v7 offset:49152
    ds_read_b64_tr_b16 v[30:31], v7 offset:49664
    v_mfma_f32_16x16x32_bf16 v[96:99], v[32:35], v[220:223], v[96:99]
    v_mul_f32 v68, v11, v68
    v_mul_f32 v69, v12, v69
    v_mul_f32 v70, v13, v70
    v_mul_f32 v71, v14, v71
    v_mfma_f32_16x16x32_bf16 v[84:87], v[36:39], v[216:219], v[84:87]
    ds_read_b64_tr_b16 v[32:33], v4 offset:53248
    ds_read_b64_tr_b16 v[34:35], v4 offset:53760
    v_mfma_f32_16x16x32_bf16 v[100:103], v[36:39], v[220:223], v[100:103]
    v_mul_f32 v11, v72, v72
    v_mul_f32 v12, v73, v73
    v_mul_f32 v13, v74, v74
    s_waitcnt lgkmcnt(10)
    v_mfma_f32_16x16x32_bf16 v[88:91], v[40:43], v[216:219], v[88:91]
    ds_read_b64_tr_b16 v[36:37], v5 offset:53248
    ds_read_b64_tr_b16 v[38:39], v5 offset:53760
    v_mfma_f32_16x16x32_bf16 v[104:107], v[40:43], v[220:223], v[104:107]
    v_mul_f32 v14, v75, v75
    v_fma_f32 v11, v11, s26, v10
    v_fma_f32 v12, v12, s26, v10
    v_mfma_f32_16x16x32_bf16 v[92:95], v[44:47], v[216:219], v[92:95]
    ds_read_b64_tr_b16 v[40:41], v6 offset:53248
    ds_read_b64_tr_b16 v[42:43], v6 offset:53760
    v_mfma_f32_16x16x32_bf16 v[108:111], v[44:47], v[220:223], v[108:111]
    v_fma_f32 v13, v13, s26, v10
    v_fma_f32 v14, v14, s26, v10
    v_mul_f32 v11, v11, v72
    v_mul_f32 v12, v12, v73
    s_waitcnt lgkmcnt(10)
    v_mfma_f32_16x16x32_bf16 v[80:83], v[16:19], v[224:227], v[80:83]
    ds_read_b64_tr_b16 v[44:45], v7 offset:53248
    ds_read_b64_tr_b16 v[46:47], v7 offset:53760
    v_mfma_f32_16x16x32_bf16 v[96:99], v[16:19], v[228:231], v[96:99]
    v_mul_f32 v13, v13, v74
    v_mul_f32 v14, v14, v75
    v_exp_f32 v11, v11
    v_mfma_f32_16x16x32_bf16 v[84:87], v[20:23], v[224:227], v[84:87]
    ds_read_b64_tr_b16 v[16:17], v4 offset:57344
    ds_read_b64_tr_b16 v[18:19], v4 offset:57856
    v_mfma_f32_16x16x32_bf16 v[100:103], v[20:23], v[228:231], v[100:103]
    v_exp_f32 v12, v12
    v_exp_f32 v13, v13
    v_exp_f32 v14, v14
    s_waitcnt lgkmcnt(10)
    v_mfma_f32_16x16x32_bf16 v[88:91], v[24:27], v[224:227], v[88:91]
    ds_read_b64_tr_b16 v[20:21], v5 offset:57344
    ds_read_b64_tr_b16 v[22:23], v5 offset:57856
    v_mfma_f32_16x16x32_bf16 v[104:107], v[24:27], v[228:231], v[104:107]
    v_add_f32 v11, 1.0, v11
    v_add_f32 v12, 1.0, v12
    v_add_f32 v13, 1.0, v13
    v_add_f32 v14, 1.0, v14
    v_mfma_f32_16x16x32_bf16 v[92:95], v[28:31], v[224:227], v[92:95]
    ds_read_b64_tr_b16 v[24:25], v6 offset:57344
    ds_read_b64_tr_b16 v[26:27], v6 offset:57856
    v_mfma_f32_16x16x32_bf16 v[108:111], v[28:31], v[228:231], v[108:111]
    v_rcp_f32 v11, v11
    v_rcp_f32 v12, v12
    v_rcp_f32 v13, v13
    s_waitcnt lgkmcnt(10)
    v_mfma_f32_16x16x32_bf16 v[80:83], v[32:35], v[232:235], v[80:83]
    ds_read_b64_tr_b16 v[28:29], v7 offset:57344
    ds_read_b64_tr_b16 v[30:31], v7 offset:57856
    v_mfma_f32_16x16x32_bf16 v[96:99], v[32:35], v[236:239], v[96:99]
    v_rcp_f32 v14, v14
    v_mul_f32 v72, v11, v72
    v_mul_f32 v73, v12, v73
    v_mfma_f32_16x16x32_bf16 v[84:87], v[36:39], v[232:235], v[84:87]
    ds_read_b64_tr_b16 v[32:33], v4 offset:61440
    ds_read_b64_tr_b16 v[34:35], v4 offset:61952
    v_mfma_f32_16x16x32_bf16 v[100:103], v[36:39], v[236:239], v[100:103]
    v_mul_f32 v74, v13, v74
    v_mul_f32 v75, v14, v75
    v_mul_f32 v11, v76, v76
    v_mul_f32 v12, v77, v77
    s_waitcnt lgkmcnt(10)
    v_mfma_f32_16x16x32_bf16 v[88:91], v[40:43], v[232:235], v[88:91]
    ds_read_b64_tr_b16 v[36:37], v5 offset:61440
    ds_read_b64_tr_b16 v[38:39], v5 offset:61952
    v_mfma_f32_16x16x32_bf16 v[104:107], v[40:43], v[236:239], v[104:107]
    v_mul_f32 v13, v78, v78
    v_mul_f32 v14, v79, v79
    v_fma_f32 v11, v11, s26, v10
    v_mfma_f32_16x16x32_bf16 v[92:95], v[44:47], v[232:235], v[92:95]
    ds_read_b64_tr_b16 v[40:41], v6 offset:61440
    ds_read_b64_tr_b16 v[42:43], v6 offset:61952
    v_mfma_f32_16x16x32_bf16 v[108:111], v[44:47], v[236:239], v[108:111]
    v_fma_f32 v12, v12, s26, v10
    v_fma_f32 v13, v13, s26, v10
    v_fma_f32 v14, v14, s26, v10
    s_waitcnt lgkmcnt(10)
    v_mfma_f32_16x16x32_bf16 v[80:83], v[16:19], v[240:243], v[80:83]
    ds_read_b64_tr_b16 v[44:45], v7 offset:61440
    ds_read_b64_tr_b16 v[46:47], v7 offset:61952
    v_mfma_f32_16x16x32_bf16 v[96:99], v[16:19], v[244:247], v[96:99]
    v_mul_f32 v11, v11, v76
    v_mul_f32 v12, v12, v77
    v_mul_f32 v13, v13, v78
    v_mul_f32 v14, v14, v79
    v_mfma_f32_16x16x32_bf16 v[84:87], v[20:23], v[240:243], v[84:87]
    ds_read_b64_tr_b16 v[16:17], v8 offset:0
    ds_read_b64_tr_b16 v[18:19], v8 offset:512
    v_mfma_f32_16x16x32_bf16 v[100:103], v[20:23], v[244:247], v[100:103]
    v_exp_f32 v11, v11
    v_exp_f32 v12, v12
    v_exp_f32 v13, v13
    s_waitcnt lgkmcnt(10)
    v_mfma_f32_16x16x32_bf16 v[88:91], v[24:27], v[240:243], v[88:91]
    ds_read_b64_tr_b16 v[20:21], v9 offset:0
    ds_read_b64_tr_b16 v[22:23], v9 offset:512
    v_mfma_f32_16x16x32_bf16 v[104:107], v[24:27], v[244:247], v[104:107]
    v_exp_f32 v14, v14
    v_add_f32 v11, 1.0, v11
    v_add_f32 v12, 1.0, v12
    v_mfma_f32_16x16x32_bf16 v[92:95], v[28:31], v[240:243], v[92:95]
    ds_read_b64_tr_b16 v[24:25], v1 offset:0
    ds_read_b64_tr_b16 v[26:27], v1 offset:512
    v_mfma_f32_16x16x32_bf16 v[108:111], v[28:31], v[244:247], v[108:111]
    v_add_f32 v13, 1.0, v13
    v_add_f32 v14, 1.0, v14
    v_rcp_f32 v11, v11
    v_rcp_f32 v12, v12
    s_waitcnt lgkmcnt(10)
    v_mfma_f32_16x16x32_bf16 v[80:83], v[32:35], v[248:251], v[80:83]
    ds_read_b64_tr_b16 v[28:29], v0 offset:0
    ds_read_b64_tr_b16 v[30:31], v0 offset:512
    v_mfma_f32_16x16x32_bf16 v[96:99], v[32:35], v[252:255], v[96:99]
    v_rcp_f32 v13, v13
    v_rcp_f32 v14, v14
    v_mul_f32 v76, v11, v76
    v_mfma_f32_16x16x32_bf16 v[84:87], v[36:39], v[248:251], v[84:87]
    ds_read_b64_tr_b16 v[32:33], v8 offset:4096
    ds_read_b64_tr_b16 v[34:35], v8 offset:4608
    v_mfma_f32_16x16x32_bf16 v[100:103], v[36:39], v[252:255], v[100:103]
    v_mul_f32 v77, v12, v77
    v_mul_f32 v78, v13, v78
    v_mul_f32 v79, v14, v79
    s_waitcnt lgkmcnt(10)
    v_mfma_f32_16x16x32_bf16 v[88:91], v[40:43], v[248:251], v[88:91]
    ds_read_b64_tr_b16 v[36:37], v9 offset:4096
    ds_read_b64_tr_b16 v[38:39], v9 offset:4608
    v_mfma_f32_16x16x32_bf16 v[104:107], v[40:43], v[252:255], v[104:107]
    v_mfma_f32_16x16x32_bf16 v[92:95], v[44:47], v[248:251], v[92:95]
    ds_read_b64_tr_b16 v[40:41], v1 offset:4096
    ds_read_b64_tr_b16 v[42:43], v1 offset:4608
    v_mfma_f32_16x16x32_bf16 v[108:111], v[44:47], v[252:255], v[108:111]
    v_mul_f32 v80, v48, v80
    v_mul_f32 v81, v49, v81
    v_mul_f32 v82, v50, v82
    v_mul_f32 v83, v51, v83
    v_mul_f32 v96, v64, v96
    v_mul_f32 v97, v65, v97
    v_mul_f32 v98, v66, v98
    v_mul_f32 v99, v67, v99
    s_waitcnt lgkmcnt(10)
    v_mfma_f32_16x16x32_bf16 v[48:51], v[16:19], v[112:115], 0
    ds_read_b64_tr_b16 v[44:45], v0 offset:4096
    ds_read_b64_tr_b16 v[46:47], v0 offset:4608
    v_mfma_f32_16x16x32_bf16 v[64:67], v[16:19], v[116:119], 0
    v_mul_f32 v84, v52, v84
    v_mul_f32 v85, v53, v85
    v_mul_f32 v86, v54, v86
    v_mul_f32 v87, v55, v87
    v_mul_f32 v100, v68, v100
    v_mul_f32 v101, v69, v101
    v_mul_f32 v102, v70, v102
    v_mul_f32 v103, v71, v103
    v_mfma_f32_16x16x32_bf16 v[52:55], v[20:23], v[112:115], 0
    ds_read_b64_tr_b16 v[16:17], v8 offset:8192
    ds_read_b64_tr_b16 v[18:19], v8 offset:8704
    v_mfma_f32_16x16x32_bf16 v[68:71], v[20:23], v[116:119], 0
    v_mul_f32 v88, v56, v88
    v_mul_f32 v89, v57, v89
    v_mul_f32 v90, v58, v90
    v_mul_f32 v91, v59, v91
    v_mul_f32 v104, v72, v104
    v_mul_f32 v105, v73, v105
    v_mul_f32 v106, v74, v106
    v_mul_f32 v107, v75, v107
    s_waitcnt lgkmcnt(10)
    v_mfma_f32_16x16x32_bf16 v[56:59], v[24:27], v[112:115], 0
    ds_read_b64_tr_b16 v[20:21], v9 offset:8192
    ds_read_b64_tr_b16 v[22:23], v9 offset:8704
    v_mfma_f32_16x16x32_bf16 v[72:75], v[24:27], v[116:119], 0
    v_mul_f32 v92, v60, v92
    v_mul_f32 v93, v61, v93
    v_mul_f32 v94, v62, v94
    v_mul_f32 v95, v63, v95
    v_mul_f32 v108, v76, v108
    v_mul_f32 v109, v77, v109
    v_mul_f32 v110, v78, v110
    v_mul_f32 v111, v79, v111
    v_mfma_f32_16x16x32_bf16 v[60:63], v[28:31], v[112:115], 0
    ds_read_b64_tr_b16 v[24:25], v1 offset:8192
    ds_read_b64_tr_b16 v[26:27], v1 offset:8704
    v_mfma_f32_16x16x32_bf16 v[76:79], v[28:31], v[116:119], 0
    s_waitcnt lgkmcnt(10)
    v_mfma_f32_16x16x32_bf16 v[48:51], v[32:35], v[120:123], v[48:51]
    ds_read_b64_tr_b16 v[28:29], v0 offset:8192
    ds_read_b64_tr_b16 v[30:31], v0 offset:8704
    v_mfma_f32_16x16x32_bf16 v[64:67], v[32:35], v[124:127], v[64:67]
    v_cvt_pk_bf16_f32 v80, v80, v81
    v_mfma_f32_16x16x32_bf16 v[52:55], v[36:39], v[120:123], v[52:55]
    ds_read_b64_tr_b16 v[32:33], v8 offset:12288
    ds_read_b64_tr_b16 v[34:35], v8 offset:12800
    v_mfma_f32_16x16x32_bf16 v[68:71], v[36:39], v[124:127], v[68:71]
    v_cvt_pk_bf16_f32 v81, v82, v83
    s_waitcnt lgkmcnt(10)
    v_mfma_f32_16x16x32_bf16 v[56:59], v[40:43], v[120:123], v[56:59]
    ds_read_b64_tr_b16 v[36:37], v9 offset:12288
    ds_read_b64_tr_b16 v[38:39], v9 offset:12800
    v_mfma_f32_16x16x32_bf16 v[72:75], v[40:43], v[124:127], v[72:75]
    v_mfma_f32_16x16x32_bf16 v[60:63], v[44:47], v[120:123], v[60:63]
    ds_read_b64_tr_b16 v[40:41], v1 offset:12288
    ds_read_b64_tr_b16 v[42:43], v1 offset:12800
    v_mfma_f32_16x16x32_bf16 v[76:79], v[44:47], v[124:127], v[76:79]
    v_cvt_pk_bf16_f32 v82, v84, v85
    s_waitcnt lgkmcnt(10)
    v_mfma_f32_16x16x32_bf16 v[48:51], v[16:19], v[128:131], v[48:51]
    ds_read_b64_tr_b16 v[44:45], v0 offset:12288
    ds_read_b64_tr_b16 v[46:47], v0 offset:12800
    v_mfma_f32_16x16x32_bf16 v[64:67], v[16:19], v[132:135], v[64:67]
    v_mfma_f32_16x16x32_bf16 v[52:55], v[20:23], v[128:131], v[52:55]
    ds_read_b64_tr_b16 v[16:17], v8 offset:16384
    ds_read_b64_tr_b16 v[18:19], v8 offset:16896
    v_mfma_f32_16x16x32_bf16 v[68:71], v[20:23], v[132:135], v[68:71]
    v_cvt_pk_bf16_f32 v83, v86, v87
    s_waitcnt lgkmcnt(10)
    v_mfma_f32_16x16x32_bf16 v[56:59], v[24:27], v[128:131], v[56:59]
    ds_read_b64_tr_b16 v[20:21], v9 offset:16384
    ds_read_b64_tr_b16 v[22:23], v9 offset:16896
    v_mfma_f32_16x16x32_bf16 v[72:75], v[24:27], v[132:135], v[72:75]
    buffer_store_dwordx4 v[80:83], v15, s[16:19], s25 offen offset:0 sc1
    v_mfma_f32_16x16x32_bf16 v[60:63], v[28:31], v[128:131], v[60:63]
    ds_read_b64_tr_b16 v[24:25], v1 offset:16384
    ds_read_b64_tr_b16 v[26:27], v1 offset:16896
    v_mfma_f32_16x16x32_bf16 v[76:79], v[28:31], v[132:135], v[76:79]
    s_waitcnt lgkmcnt(10)
    v_mfma_f32_16x16x32_bf16 v[48:51], v[32:35], v[136:139], v[48:51]
    ds_read_b64_tr_b16 v[28:29], v0 offset:16384
    ds_read_b64_tr_b16 v[30:31], v0 offset:16896
    v_mfma_f32_16x16x32_bf16 v[64:67], v[32:35], v[140:143], v[64:67]
    v_cvt_pk_bf16_f32 v84, v88, v89
    v_mfma_f32_16x16x32_bf16 v[52:55], v[36:39], v[136:139], v[52:55]
    ds_read_b64_tr_b16 v[32:33], v8 offset:20480
    ds_read_b64_tr_b16 v[34:35], v8 offset:20992
    v_mfma_f32_16x16x32_bf16 v[68:71], v[36:39], v[140:143], v[68:71]
    s_waitcnt lgkmcnt(10)
    v_mfma_f32_16x16x32_bf16 v[56:59], v[40:43], v[136:139], v[56:59]
    ds_read_b64_tr_b16 v[36:37], v9 offset:20480
    ds_read_b64_tr_b16 v[38:39], v9 offset:20992
    v_mfma_f32_16x16x32_bf16 v[72:75], v[40:43], v[140:143], v[72:75]
    v_cvt_pk_bf16_f32 v85, v90, v91
    v_mfma_f32_16x16x32_bf16 v[60:63], v[44:47], v[136:139], v[60:63]
    ds_read_b64_tr_b16 v[40:41], v1 offset:20480
    ds_read_b64_tr_b16 v[42:43], v1 offset:20992
    v_mfma_f32_16x16x32_bf16 v[76:79], v[44:47], v[140:143], v[76:79]
    s_waitcnt lgkmcnt(10)
    v_mfma_f32_16x16x32_bf16 v[48:51], v[16:19], v[144:147], v[48:51]
    ds_read_b64_tr_b16 v[44:45], v0 offset:20480
    ds_read_b64_tr_b16 v[46:47], v0 offset:20992
    v_mfma_f32_16x16x32_bf16 v[64:67], v[16:19], v[148:151], v[64:67]
    v_cvt_pk_bf16_f32 v86, v92, v93
    v_mfma_f32_16x16x32_bf16 v[52:55], v[20:23], v[144:147], v[52:55]
    v_mfma_f32_16x16x32_bf16 v[68:71], v[20:23], v[148:151], v[68:71]
    s_waitcnt vmcnt(7)
    s_barrier
    ds_read_b64_tr_b16 v[16:17], v8 offset:24576
    ds_read_b64_tr_b16 v[18:19], v8 offset:25088
    s_add_u32 m0, s24, 32768
    s_add_u32 s30, s39, 256
    buffer_load_dwordx4 v2, s[12:15], s30 offen lds
    s_add_u32 m0, m0, 4096
    s_add_u32 s30, s30, 294912
    buffer_load_dwordx4 v2, s[12:15], s30 offen lds
    s_add_u32 m0, s24, 40960
    s_add_u32 s30, s40, 256
    buffer_load_dwordx4 v2, s[12:15], s30 offen lds
    s_add_u32 m0, m0, 4096
    s_add_u32 s30, s30, 294912
    buffer_load_dwordx4 v2, s[12:15], s30 offen lds
    v_cvt_pk_bf16_f32 v87, v94, v95
    s_waitcnt lgkmcnt(10)
    v_mfma_f32_16x16x32_bf16 v[56:59], v[24:27], v[144:147], v[56:59]
    ds_read_b64_tr_b16 v[20:21], v9 offset:24576
    ds_read_b64_tr_b16 v[22:23], v9 offset:25088
    v_mfma_f32_16x16x32_bf16 v[72:75], v[24:27], v[148:151], v[72:75]
    s_add_u32 m0, s24, 49152
    s_add_u32 s30, s41, 256
    buffer_load_dwordx4 v2, s[12:15], s30 offen lds
    s_add_u32 m0, m0, 4096
    s_add_u32 s30, s30, 294912
    buffer_load_dwordx4 v2, s[12:15], s30 offen lds
    s_add_u32 m0, s24, 57344
    s_add_u32 s30, s42, 256
    buffer_load_dwordx4 v2, s[12:15], s30 offen lds
    s_add_u32 m0, m0, 4096
    s_add_u32 s30, s30, 294912
    buffer_load_dwordx4 v2, s[12:15], s30 offen lds
    v_mfma_f32_16x16x32_bf16 v[60:63], v[28:31], v[144:147], v[60:63]
    ds_read_b64_tr_b16 v[24:25], v1 offset:24576
    ds_read_b64_tr_b16 v[26:27], v1 offset:25088
    v_mfma_f32_16x16x32_bf16 v[76:79], v[28:31], v[148:151], v[76:79]
    s_add_u32 m0, s24, 65536
    s_add_u32 s30, s43, 256
    buffer_load_dwordx4 v2, s[12:15], s30 offen lds
    s_add_u32 m0, m0, 4096
    s_add_u32 s30, s30, 294912
    buffer_load_dwordx4 v2, s[12:15], s30 offen lds
    s_add_u32 m0, s24, 73728
    s_add_u32 s30, s44, 256
    buffer_load_dwordx4 v2, s[12:15], s30 offen lds
    s_add_u32 m0, m0, 4096
    s_add_u32 s30, s30, 294912
    buffer_load_dwordx4 v2, s[12:15], s30 offen lds
    buffer_store_dwordx4 v[84:87], v15, s[16:19], s25 offen offset:2048 sc1
    s_waitcnt lgkmcnt(10)
    v_mfma_f32_16x16x32_bf16 v[48:51], v[32:35], v[152:155], v[48:51]
    ds_read_b64_tr_b16 v[28:29], v0 offset:24576
    ds_read_b64_tr_b16 v[30:31], v0 offset:25088
    v_mfma_f32_16x16x32_bf16 v[64:67], v[32:35], v[156:159], v[64:67]
    v_mfma_f32_16x16x32_bf16 v[52:55], v[36:39], v[152:155], v[52:55]
    ds_read_b64_tr_b16 v[32:33], v8 offset:28672
    ds_read_b64_tr_b16 v[34:35], v8 offset:29184
    v_mfma_f32_16x16x32_bf16 v[68:71], v[36:39], v[156:159], v[68:71]
    v_cvt_pk_bf16_f32 v96, v96, v97
    s_waitcnt lgkmcnt(10)
    v_mfma_f32_16x16x32_bf16 v[56:59], v[40:43], v[152:155], v[56:59]
    ds_read_b64_tr_b16 v[36:37], v9 offset:28672
    ds_read_b64_tr_b16 v[38:39], v9 offset:29184
    v_mfma_f32_16x16x32_bf16 v[72:75], v[40:43], v[156:159], v[72:75]
    v_cvt_pk_bf16_f32 v97, v98, v99
    v_mfma_f32_16x16x32_bf16 v[60:63], v[44:47], v[152:155], v[60:63]
    ds_read_b64_tr_b16 v[40:41], v1 offset:28672
    ds_read_b64_tr_b16 v[42:43], v1 offset:29184
    v_mfma_f32_16x16x32_bf16 v[76:79], v[44:47], v[156:159], v[76:79]
    s_waitcnt lgkmcnt(10)
    v_mfma_f32_16x16x32_bf16 v[48:51], v[16:19], v[160:163], v[48:51]
    ds_read_b64_tr_b16 v[44:45], v0 offset:28672
    ds_read_b64_tr_b16 v[46:47], v0 offset:29184
    v_mfma_f32_16x16x32_bf16 v[64:67], v[16:19], v[164:167], v[64:67]
    v_cvt_pk_bf16_f32 v98, v100, v101
    v_mfma_f32_16x16x32_bf16 v[52:55], v[20:23], v[160:163], v[52:55]
    ds_read_b64_tr_b16 v[16:17], v4 offset:0
    ds_read_b64_tr_b16 v[18:19], v4 offset:512
    v_mfma_f32_16x16x32_bf16 v[68:71], v[20:23], v[164:167], v[68:71]
    s_waitcnt lgkmcnt(10)
    v_mfma_f32_16x16x32_bf16 v[56:59], v[24:27], v[160:163], v[56:59]
    ds_read_b64_tr_b16 v[20:21], v5 offset:0
    ds_read_b64_tr_b16 v[22:23], v5 offset:512
    v_mfma_f32_16x16x32_bf16 v[72:75], v[24:27], v[164:167], v[72:75]
    v_cvt_pk_bf16_f32 v99, v102, v103
    v_mfma_f32_16x16x32_bf16 v[60:63], v[28:31], v[160:163], v[60:63]
    ds_read_b64_tr_b16 v[24:25], v6 offset:0
    ds_read_b64_tr_b16 v[26:27], v6 offset:512
    v_mfma_f32_16x16x32_bf16 v[76:79], v[28:31], v[164:167], v[76:79]
    s_waitcnt lgkmcnt(10)
    v_mfma_f32_16x16x32_bf16 v[48:51], v[32:35], v[168:171], v[48:51]
    ds_read_b64_tr_b16 v[28:29], v7 offset:0
    ds_read_b64_tr_b16 v[30:31], v7 offset:512
    v_mfma_f32_16x16x32_bf16 v[64:67], v[32:35], v[172:175], v[64:67]
    buffer_store_dwordx4 v[96:99], v15, s[16:19], s25 offen offset:256 sc1
    v_mfma_f32_16x16x32_bf16 v[52:55], v[36:39], v[168:171], v[52:55]
    ds_read_b64_tr_b16 v[32:33], v4 offset:4096
    ds_read_b64_tr_b16 v[34:35], v4 offset:4608
    v_mfma_f32_16x16x32_bf16 v[68:71], v[36:39], v[172:175], v[68:71]
    v_cvt_pk_bf16_f32 v100, v104, v105
    s_waitcnt lgkmcnt(10)
    v_mfma_f32_16x16x32_bf16 v[56:59], v[40:43], v[168:171], v[56:59]
    ds_read_b64_tr_b16 v[36:37], v5 offset:4096
    ds_read_b64_tr_b16 v[38:39], v5 offset:4608
    v_mfma_f32_16x16x32_bf16 v[72:75], v[40:43], v[172:175], v[72:75]
    v_mfma_f32_16x16x32_bf16 v[60:63], v[44:47], v[168:171], v[60:63]
    ds_read_b64_tr_b16 v[40:41], v6 offset:4096
    ds_read_b64_tr_b16 v[42:43], v6 offset:4608
    v_mfma_f32_16x16x32_bf16 v[76:79], v[44:47], v[172:175], v[76:79]
    v_cvt_pk_bf16_f32 v101, v106, v107
    s_waitcnt lgkmcnt(10)
    v_mfma_f32_16x16x32_bf16 v[48:51], v[16:19], v[176:179], v[48:51]
    ds_read_b64_tr_b16 v[44:45], v7 offset:4096
    ds_read_b64_tr_b16 v[46:47], v7 offset:4608
    v_mfma_f32_16x16x32_bf16 v[64:67], v[16:19], v[180:183], v[64:67]
    v_mfma_f32_16x16x32_bf16 v[52:55], v[20:23], v[176:179], v[52:55]
    ds_read_b64_tr_b16 v[16:17], v4 offset:8192
    ds_read_b64_tr_b16 v[18:19], v4 offset:8704
    v_mfma_f32_16x16x32_bf16 v[68:71], v[20:23], v[180:183], v[68:71]
    v_cvt_pk_bf16_f32 v102, v108, v109
    s_waitcnt lgkmcnt(10)
    v_mfma_f32_16x16x32_bf16 v[56:59], v[24:27], v[176:179], v[56:59]
    ds_read_b64_tr_b16 v[20:21], v5 offset:8192
    ds_read_b64_tr_b16 v[22:23], v5 offset:8704
    v_mfma_f32_16x16x32_bf16 v[72:75], v[24:27], v[180:183], v[72:75]
    v_cvt_pk_bf16_f32 v103, v110, v111
    v_mfma_f32_16x16x32_bf16 v[60:63], v[28:31], v[176:179], v[60:63]
    ds_read_b64_tr_b16 v[24:25], v6 offset:8192
    ds_read_b64_tr_b16 v[26:27], v6 offset:8704
    v_mfma_f32_16x16x32_bf16 v[76:79], v[28:31], v[180:183], v[76:79]
    s_waitcnt lgkmcnt(10)
    v_mfma_f32_16x16x32_bf16 v[48:51], v[32:35], v[184:187], v[48:51]
    ds_read_b64_tr_b16 v[28:29], v7 offset:8192
    ds_read_b64_tr_b16 v[30:31], v7 offset:8704
    v_mfma_f32_16x16x32_bf16 v[64:67], v[32:35], v[188:191], v[64:67]
    buffer_store_dwordx4 v[100:103], v15, s[16:19], s25 offen offset:2304 sc1
    v_mfma_f32_16x16x32_bf16 v[52:55], v[36:39], v[184:187], v[52:55]
    ds_read_b64_tr_b16 v[32:33], v4 offset:12288
    ds_read_b64_tr_b16 v[34:35], v4 offset:12800
    v_mfma_f32_16x16x32_bf16 v[68:71], v[36:39], v[188:191], v[68:71]
    s_waitcnt lgkmcnt(10)
    v_mfma_f32_16x16x32_bf16 v[56:59], v[40:43], v[184:187], v[56:59]
    ds_read_b64_tr_b16 v[36:37], v5 offset:12288
    ds_read_b64_tr_b16 v[38:39], v5 offset:12800
    v_mfma_f32_16x16x32_bf16 v[72:75], v[40:43], v[188:191], v[72:75]
    s_add_u32 s25, s25, 4096
    v_mfma_f32_16x16x32_bf16 v[60:63], v[44:47], v[184:187], v[60:63]
    ds_read_b64_tr_b16 v[40:41], v6 offset:12288
    ds_read_b64_tr_b16 v[42:43], v6 offset:12800
    v_mfma_f32_16x16x32_bf16 v[76:79], v[44:47], v[188:191], v[76:79]
    s_waitcnt lgkmcnt(10)
    v_mfma_f32_16x16x32_bf16 v[48:51], v[16:19], v[192:195], v[48:51]
    ds_read_b64_tr_b16 v[44:45], v7 offset:12288
    ds_read_b64_tr_b16 v[46:47], v7 offset:12800
    v_mfma_f32_16x16x32_bf16 v[64:67], v[16:19], v[196:199], v[64:67]
    v_mfma_f32_16x16x32_bf16 v[52:55], v[20:23], v[192:195], v[52:55]
    ds_read_b64_tr_b16 v[16:17], v8 offset:32768
    ds_read_b64_tr_b16 v[18:19], v8 offset:33280
    v_mfma_f32_16x16x32_bf16 v[68:71], v[20:23], v[196:199], v[68:71]
    s_waitcnt lgkmcnt(10)
    v_mfma_f32_16x16x32_bf16 v[56:59], v[24:27], v[192:195], v[56:59]
    ds_read_b64_tr_b16 v[20:21], v9 offset:32768
    ds_read_b64_tr_b16 v[22:23], v9 offset:33280
    v_mfma_f32_16x16x32_bf16 v[72:75], v[24:27], v[196:199], v[72:75]
    v_mfma_f32_16x16x32_bf16 v[60:63], v[28:31], v[192:195], v[60:63]
    ds_read_b64_tr_b16 v[24:25], v1 offset:32768
    ds_read_b64_tr_b16 v[26:27], v1 offset:33280
    v_mfma_f32_16x16x32_bf16 v[76:79], v[28:31], v[196:199], v[76:79]
    s_waitcnt lgkmcnt(10)
    v_mfma_f32_16x16x32_bf16 v[48:51], v[32:35], v[200:203], v[48:51]
    ds_read_b64_tr_b16 v[28:29], v0 offset:32768
    ds_read_b64_tr_b16 v[30:31], v0 offset:33280
    v_mfma_f32_16x16x32_bf16 v[64:67], v[32:35], v[204:207], v[64:67]
    v_mfma_f32_16x16x32_bf16 v[52:55], v[36:39], v[200:203], v[52:55]
    ds_read_b64_tr_b16 v[32:33], v8 offset:36864
    ds_read_b64_tr_b16 v[34:35], v8 offset:37376
    v_mfma_f32_16x16x32_bf16 v[68:71], v[36:39], v[204:207], v[68:71]
    s_waitcnt lgkmcnt(10)
    v_mfma_f32_16x16x32_bf16 v[56:59], v[40:43], v[200:203], v[56:59]
    ds_read_b64_tr_b16 v[36:37], v9 offset:36864
    ds_read_b64_tr_b16 v[38:39], v9 offset:37376
    v_mfma_f32_16x16x32_bf16 v[72:75], v[40:43], v[204:207], v[72:75]
    v_mfma_f32_16x16x32_bf16 v[60:63], v[44:47], v[200:203], v[60:63]
    ds_read_b64_tr_b16 v[40:41], v1 offset:36864
    ds_read_b64_tr_b16 v[42:43], v1 offset:37376
    v_mfma_f32_16x16x32_bf16 v[76:79], v[44:47], v[204:207], v[76:79]
    s_waitcnt lgkmcnt(10)
    v_mfma_f32_16x16x32_bf16 v[48:51], v[16:19], v[208:211], v[48:51]
    ds_read_b64_tr_b16 v[44:45], v0 offset:36864
    ds_read_b64_tr_b16 v[46:47], v0 offset:37376
    v_mfma_f32_16x16x32_bf16 v[64:67], v[16:19], v[212:215], v[64:67]
    v_mfma_f32_16x16x32_bf16 v[52:55], v[20:23], v[208:211], v[52:55]
    ds_read_b64_tr_b16 v[16:17], v8 offset:40960
    ds_read_b64_tr_b16 v[18:19], v8 offset:41472
    v_mfma_f32_16x16x32_bf16 v[68:71], v[20:23], v[212:215], v[68:71]
    s_waitcnt lgkmcnt(10)
    v_mfma_f32_16x16x32_bf16 v[56:59], v[24:27], v[208:211], v[56:59]
    ds_read_b64_tr_b16 v[20:21], v9 offset:40960
    ds_read_b64_tr_b16 v[22:23], v9 offset:41472
    v_mfma_f32_16x16x32_bf16 v[72:75], v[24:27], v[212:215], v[72:75]
    v_mfma_f32_16x16x32_bf16 v[60:63], v[28:31], v[208:211], v[60:63]
    ds_read_b64_tr_b16 v[24:25], v1 offset:40960
    ds_read_b64_tr_b16 v[26:27], v1 offset:41472
    v_mfma_f32_16x16x32_bf16 v[76:79], v[28:31], v[212:215], v[76:79]
    s_waitcnt lgkmcnt(10)
    v_mfma_f32_16x16x32_bf16 v[48:51], v[32:35], v[216:219], v[48:51]
    ds_read_b64_tr_b16 v[28:29], v0 offset:40960
    ds_read_b64_tr_b16 v[30:31], v0 offset:41472
    v_mfma_f32_16x16x32_bf16 v[64:67], v[32:35], v[220:223], v[64:67]
    v_mfma_f32_16x16x32_bf16 v[52:55], v[36:39], v[216:219], v[52:55]
    ds_read_b64_tr_b16 v[32:33], v8 offset:45056
    ds_read_b64_tr_b16 v[34:35], v8 offset:45568
    v_mfma_f32_16x16x32_bf16 v[68:71], v[36:39], v[220:223], v[68:71]
    s_waitcnt lgkmcnt(10)
    v_mfma_f32_16x16x32_bf16 v[56:59], v[40:43], v[216:219], v[56:59]
    ds_read_b64_tr_b16 v[36:37], v9 offset:45056
    ds_read_b64_tr_b16 v[38:39], v9 offset:45568
    v_mfma_f32_16x16x32_bf16 v[72:75], v[40:43], v[220:223], v[72:75]
    v_mfma_f32_16x16x32_bf16 v[60:63], v[44:47], v[216:219], v[60:63]
    ds_read_b64_tr_b16 v[40:41], v1 offset:45056
    ds_read_b64_tr_b16 v[42:43], v1 offset:45568
    v_mfma_f32_16x16x32_bf16 v[76:79], v[44:47], v[220:223], v[76:79]
    s_waitcnt lgkmcnt(10)
    v_mfma_f32_16x16x32_bf16 v[48:51], v[16:19], v[224:227], v[48:51]
    ds_read_b64_tr_b16 v[44:45], v0 offset:45056
    ds_read_b64_tr_b16 v[46:47], v0 offset:45568
    v_mfma_f32_16x16x32_bf16 v[64:67], v[16:19], v[228:231], v[64:67]
    v_mfma_f32_16x16x32_bf16 v[52:55], v[20:23], v[224:227], v[52:55]
    ds_read_b64_tr_b16 v[16:17], v8 offset:49152
    ds_read_b64_tr_b16 v[18:19], v8 offset:49664
    v_mfma_f32_16x16x32_bf16 v[68:71], v[20:23], v[228:231], v[68:71]
    s_waitcnt lgkmcnt(10)
    v_mfma_f32_16x16x32_bf16 v[56:59], v[24:27], v[224:227], v[56:59]
    ds_read_b64_tr_b16 v[20:21], v9 offset:49152
    ds_read_b64_tr_b16 v[22:23], v9 offset:49664
    v_mfma_f32_16x16x32_bf16 v[72:75], v[24:27], v[228:231], v[72:75]
    v_mfma_f32_16x16x32_bf16 v[60:63], v[28:31], v[224:227], v[60:63]
    ds_read_b64_tr_b16 v[24:25], v1 offset:49152
    ds_read_b64_tr_b16 v[26:27], v1 offset:49664
    v_mfma_f32_16x16x32_bf16 v[76:79], v[28:31], v[228:231], v[76:79]
    s_waitcnt lgkmcnt(10)
    v_mfma_f32_16x16x32_bf16 v[48:51], v[32:35], v[232:235], v[48:51]
    ds_read_b64_tr_b16 v[28:29], v0 offset:49152
    ds_read_b64_tr_b16 v[30:31], v0 offset:49664
    v_mfma_f32_16x16x32_bf16 v[64:67], v[32:35], v[236:239], v[64:67]
    v_mfma_f32_16x16x32_bf16 v[52:55], v[36:39], v[232:235], v[52:55]
    ds_read_b64_tr_b16 v[32:33], v8 offset:53248
    ds_read_b64_tr_b16 v[34:35], v8 offset:53760
    v_mfma_f32_16x16x32_bf16 v[68:71], v[36:39], v[236:239], v[68:71]
    s_waitcnt lgkmcnt(10)
    v_mfma_f32_16x16x32_bf16 v[56:59], v[40:43], v[232:235], v[56:59]
    ds_read_b64_tr_b16 v[36:37], v9 offset:53248
    ds_read_b64_tr_b16 v[38:39], v9 offset:53760
    v_mfma_f32_16x16x32_bf16 v[72:75], v[40:43], v[236:239], v[72:75]
    v_mfma_f32_16x16x32_bf16 v[60:63], v[44:47], v[232:235], v[60:63]
    ds_read_b64_tr_b16 v[40:41], v1 offset:53248
    ds_read_b64_tr_b16 v[42:43], v1 offset:53760
    v_mfma_f32_16x16x32_bf16 v[76:79], v[44:47], v[236:239], v[76:79]
    s_waitcnt lgkmcnt(10)
    v_mfma_f32_16x16x32_bf16 v[48:51], v[16:19], v[240:243], v[48:51]
    ds_read_b64_tr_b16 v[44:45], v0 offset:53248
    ds_read_b64_tr_b16 v[46:47], v0 offset:53760
    v_mfma_f32_16x16x32_bf16 v[64:67], v[16:19], v[244:247], v[64:67]
    v_mfma_f32_16x16x32_bf16 v[52:55], v[20:23], v[240:243], v[52:55]
    v_mfma_f32_16x16x32_bf16 v[68:71], v[20:23], v[244:247], v[68:71]
    s_waitcnt vmcnt(9)
    s_barrier
    ds_read_b64_tr_b16 v[16:17], v8 offset:57344
    ds_read_b64_tr_b16 v[18:19], v8 offset:57856
    s_waitcnt lgkmcnt(10)
    v_mfma_f32_16x16x32_bf16 v[56:59], v[24:27], v[240:243], v[56:59]
    ds_read_b64_tr_b16 v[20:21], v9 offset:57344
    ds_read_b64_tr_b16 v[22:23], v9 offset:57856
    v_mfma_f32_16x16x32_bf16 v[72:75], v[24:27], v[244:247], v[72:75]
    v_mfma_f32_16x16x32_bf16 v[60:63], v[28:31], v[240:243], v[60:63]
    ds_read_b64_tr_b16 v[24:25], v1 offset:57344
    ds_read_b64_tr_b16 v[26:27], v1 offset:57856
    v_mfma_f32_16x16x32_bf16 v[76:79], v[28:31], v[244:247], v[76:79]
    s_waitcnt lgkmcnt(10)
    v_mfma_f32_16x16x32_bf16 v[48:51], v[32:35], v[248:251], v[48:51]
    ds_read_b64_tr_b16 v[28:29], v0 offset:57344
    ds_read_b64_tr_b16 v[30:31], v0 offset:57856
    v_mfma_f32_16x16x32_bf16 v[64:67], v[32:35], v[252:255], v[64:67]
    v_mfma_f32_16x16x32_bf16 v[52:55], v[36:39], v[248:251], v[52:55]
    ds_read_b64_tr_b16 v[32:33], v8 offset:61440
    ds_read_b64_tr_b16 v[34:35], v8 offset:61952
    v_mfma_f32_16x16x32_bf16 v[68:71], v[36:39], v[252:255], v[68:71]
    s_waitcnt lgkmcnt(10)
    v_mfma_f32_16x16x32_bf16 v[56:59], v[40:43], v[248:251], v[56:59]
    ds_read_b64_tr_b16 v[36:37], v9 offset:61440
    ds_read_b64_tr_b16 v[38:39], v9 offset:61952
    v_mfma_f32_16x16x32_bf16 v[72:75], v[40:43], v[252:255], v[72:75]
    v_mfma_f32_16x16x32_bf16 v[60:63], v[44:47], v[248:251], v[60:63]
    ds_read_b64_tr_b16 v[40:41], v1 offset:61440
    ds_read_b64_tr_b16 v[42:43], v1 offset:61952
    v_mfma_f32_16x16x32_bf16 v[76:79], v[44:47], v[252:255], v[76:79]
    s_waitcnt lgkmcnt(10)
    v_mfma_f32_16x16x32_bf16 v[80:83], v[16:19], v[112:115], 0
    ds_read_b64_tr_b16 v[44:45], v0 offset:61440
    ds_read_b64_tr_b16 v[46:47], v0 offset:61952
    v_mfma_f32_16x16x32_bf16 v[96:99], v[16:19], v[116:119], 0
    v_mfma_f32_16x16x32_bf16 v[84:87], v[20:23], v[112:115], 0
    ds_read_b64_tr_b16 v[16:17], v4 offset:16384
    ds_read_b64_tr_b16 v[18:19], v4 offset:16896
    v_mfma_f32_16x16x32_bf16 v[100:103], v[20:23], v[116:119], 0
    s_waitcnt lgkmcnt(10)
    v_mfma_f32_16x16x32_bf16 v[88:91], v[24:27], v[112:115], 0
    ds_read_b64_tr_b16 v[20:21], v5 offset:16384
    ds_read_b64_tr_b16 v[22:23], v5 offset:16896
    v_mfma_f32_16x16x32_bf16 v[104:107], v[24:27], v[116:119], 0
    v_mfma_f32_16x16x32_bf16 v[92:95], v[28:31], v[112:115], 0
    ds_read_b64_tr_b16 v[24:25], v6 offset:16384
    ds_read_b64_tr_b16 v[26:27], v6 offset:16896
    v_mfma_f32_16x16x32_bf16 v[108:111], v[28:31], v[116:119], 0
    v_mul_f32 v11, v48, v48
    v_mul_f32 v12, v49, v49
    v_mul_f32 v13, v50, v50
    v_mul_f32 v14, v51, v51
    s_waitcnt lgkmcnt(10)
    v_mfma_f32_16x16x32_bf16 v[80:83], v[32:35], v[120:123], v[80:83]
    ds_read_b64_tr_b16 v[28:29], v7 offset:16384
    ds_read_b64_tr_b16 v[30:31], v7 offset:16896
    v_mfma_f32_16x16x32_bf16 v[96:99], v[32:35], v[124:127], v[96:99]
    v_fma_f32 v11, v11, s26, v10
    v_fma_f32 v12, v12, s26, v10
    v_fma_f32 v13, v13, s26, v10
    v_mfma_f32_16x16x32_bf16 v[84:87], v[36:39], v[120:123], v[84:87]
    ds_read_b64_tr_b16 v[32:33], v4 offset:20480
    ds_read_b64_tr_b16 v[34:35], v4 offset:20992
    v_mfma_f32_16x16x32_bf16 v[100:103], v[36:39], v[124:127], v[100:103]
    v_fma_f32 v14, v14, s26, v10
    v_mul_f32 v11, v11, v48
    v_mul_f32 v12, v12, v49
    v_mul_f32 v13, v13, v50
    s_waitcnt lgkmcnt(10)
    v_mfma_f32_16x16x32_bf16 v[88:91], v[40:43], v[120:123], v[88:91]
    ds_read_b64_tr_b16 v[36:37], v5 offset:20480
    ds_read_b64_tr_b16 v[38:39], v5 offset:20992
    v_mfma_f32_16x16x32_bf16 v[104:107], v[40:43], v[124:127], v[104:107]
    v_mul_f32 v14, v14, v51
    v_exp_f32 v11, v11
    v_exp_f32 v12, v12
    v_mfma_f32_16x16x32_bf16 v[92:95], v[44:47], v[120:123], v[92:95]
    ds_read_b64_tr_b16 v[40:41], v6 offset:20480
    ds_read_b64_tr_b16 v[42:43], v6 offset:20992
    v_mfma_f32_16x16x32_bf16 v[108:111], v[44:47], v[124:127], v[108:111]
    v_exp_f32 v13, v13
    v_exp_f32 v14, v14
    v_add_f32 v11, 1.0, v11
    s_waitcnt lgkmcnt(10)
    v_mfma_f32_16x16x32_bf16 v[80:83], v[16:19], v[128:131], v[80:83]
    ds_read_b64_tr_b16 v[44:45], v7 offset:20480
    ds_read_b64_tr_b16 v[46:47], v7 offset:20992
    v_mfma_f32_16x16x32_bf16 v[96:99], v[16:19], v[132:135], v[96:99]
    v_add_f32 v12, 1.0, v12
    v_add_f32 v13, 1.0, v13
    v_add_f32 v14, 1.0, v14
    v_rcp_f32 v11, v11
    v_mfma_f32_16x16x32_bf16 v[84:87], v[20:23], v[128:131], v[84:87]
    ds_read_b64_tr_b16 v[16:17], v4 offset:24576
    ds_read_b64_tr_b16 v[18:19], v4 offset:25088
    v_mfma_f32_16x16x32_bf16 v[100:103], v[20:23], v[132:135], v[100:103]
    v_rcp_f32 v12, v12
    v_rcp_f32 v13, v13
    v_rcp_f32 v14, v14
    s_waitcnt lgkmcnt(10)
    v_mfma_f32_16x16x32_bf16 v[88:91], v[24:27], v[128:131], v[88:91]
    ds_read_b64_tr_b16 v[20:21], v5 offset:24576
    ds_read_b64_tr_b16 v[22:23], v5 offset:25088
    v_mfma_f32_16x16x32_bf16 v[104:107], v[24:27], v[132:135], v[104:107]
    v_mul_f32 v48, v11, v48
    v_mul_f32 v49, v12, v49
    v_mul_f32 v50, v13, v50
    v_mfma_f32_16x16x32_bf16 v[92:95], v[28:31], v[128:131], v[92:95]
    ds_read_b64_tr_b16 v[24:25], v6 offset:24576
    ds_read_b64_tr_b16 v[26:27], v6 offset:25088
    v_mfma_f32_16x16x32_bf16 v[108:111], v[28:31], v[132:135], v[108:111]
    v_mul_f32 v51, v14, v51
    v_mul_f32 v11, v52, v52
    v_mul_f32 v12, v53, v53
    v_mul_f32 v13, v54, v54
    s_waitcnt lgkmcnt(10)
    v_mfma_f32_16x16x32_bf16 v[80:83], v[32:35], v[136:139], v[80:83]
    ds_read_b64_tr_b16 v[28:29], v7 offset:24576
    ds_read_b64_tr_b16 v[30:31], v7 offset:25088
    v_mfma_f32_16x16x32_bf16 v[96:99], v[32:35], v[140:143], v[96:99]
    v_mul_f32 v14, v55, v55
    v_fma_f32 v11, v11, s26, v10
    v_fma_f32 v12, v12, s26, v10
    v_mfma_f32_16x16x32_bf16 v[84:87], v[36:39], v[136:139], v[84:87]
    ds_read_b64_tr_b16 v[32:33], v4 offset:28672
    ds_read_b64_tr_b16 v[34:35], v4 offset:29184
    v_mfma_f32_16x16x32_bf16 v[100:103], v[36:39], v[140:143], v[100:103]
    v_fma_f32 v13, v13, s26, v10
    v_fma_f32 v14, v14, s26, v10
    v_mul_f32 v11, v11, v52
    s_waitcnt lgkmcnt(10)
    v_mfma_f32_16x16x32_bf16 v[88:91], v[40:43], v[136:139], v[88:91]
    ds_read_b64_tr_b16 v[36:37], v5 offset:28672
    ds_read_b64_tr_b16 v[38:39], v5 offset:29184
    v_mfma_f32_16x16x32_bf16 v[104:107], v[40:43], v[140:143], v[104:107]
    v_mul_f32 v12, v12, v53
    v_mul_f32 v13, v13, v54
    v_mul_f32 v14, v14, v55
    v_exp_f32 v11, v11
    v_mfma_f32_16x16x32_bf16 v[92:95], v[44:47], v[136:139], v[92:95]
    ds_read_b64_tr_b16 v[40:41], v6 offset:28672
    ds_read_b64_tr_b16 v[42:43], v6 offset:29184
    v_mfma_f32_16x16x32_bf16 v[108:111], v[44:47], v[140:143], v[108:111]
    v_exp_f32 v12, v12
    v_exp_f32 v13, v13
    v_exp_f32 v14, v14
    s_waitcnt lgkmcnt(10)
    v_mfma_f32_16x16x32_bf16 v[80:83], v[16:19], v[144:147], v[80:83]
    ds_read_b64_tr_b16 v[44:45], v7 offset:28672
    ds_read_b64_tr_b16 v[46:47], v7 offset:29184
    v_mfma_f32_16x16x32_bf16 v[96:99], v[16:19], v[148:151], v[96:99]
    v_add_f32 v11, 1.0, v11
    v_add_f32 v12, 1.0, v12
    v_add_f32 v13, 1.0, v13
    v_mfma_f32_16x16x32_bf16 v[84:87], v[20:23], v[144:147], v[84:87]
    ds_read_b64_tr_b16 v[16:17], v4 offset:32768
    ds_read_b64_tr_b16 v[18:19], v4 offset:33280
    v_mfma_f32_16x16x32_bf16 v[100:103], v[20:23], v[148:151], v[100:103]
    v_add_f32 v14, 1.0, v14
    v_rcp_f32 v11, v11
    v_rcp_f32 v12, v12
    v_rcp_f32 v13, v13
    s_waitcnt lgkmcnt(10)
    v_mfma_f32_16x16x32_bf16 v[88:91], v[24:27], v[144:147], v[88:91]
    ds_read_b64_tr_b16 v[20:21], v5 offset:32768
    ds_read_b64_tr_b16 v[22:23], v5 offset:33280
    v_mfma_f32_16x16x32_bf16 v[104:107], v[24:27], v[148:151], v[104:107]
    v_rcp_f32 v14, v14
    v_mul_f32 v52, v11, v52
    v_mul_f32 v53, v12, v53
    v_mfma_f32_16x16x32_bf16 v[92:95], v[28:31], v[144:147], v[92:95]
    ds_read_b64_tr_b16 v[24:25], v6 offset:32768
    ds_read_b64_tr_b16 v[26:27], v6 offset:33280
    v_mfma_f32_16x16x32_bf16 v[108:111], v[28:31], v[148:151], v[108:111]
    v_mul_f32 v54, v13, v54
    v_mul_f32 v55, v14, v55
    v_mul_f32 v11, v56, v56
    s_waitcnt lgkmcnt(10)
    v_mfma_f32_16x16x32_bf16 v[80:83], v[32:35], v[152:155], v[80:83]
    ds_read_b64_tr_b16 v[28:29], v7 offset:32768
    ds_read_b64_tr_b16 v[30:31], v7 offset:33280
    v_mfma_f32_16x16x32_bf16 v[96:99], v[32:35], v[156:159], v[96:99]
    v_mul_f32 v12, v57, v57
    v_mul_f32 v13, v58, v58
    v_mul_f32 v14, v59, v59
    v_fma_f32 v11, v11, s26, v10
    v_mfma_f32_16x16x32_bf16 v[84:87], v[36:39], v[152:155], v[84:87]
    ds_read_b64_tr_b16 v[32:33], v4 offset:36864
    ds_read_b64_tr_b16 v[34:35], v4 offset:37376
    v_mfma_f32_16x16x32_bf16 v[100:103], v[36:39], v[156:159], v[100:103]
    v_fma_f32 v12, v12, s26, v10
    v_fma_f32 v13, v13, s26, v10
    v_fma_f32 v14, v14, s26, v10
    s_waitcnt lgkmcnt(10)
    v_mfma_f32_16x16x32_bf16 v[88:91], v[40:43], v[152:155], v[88:91]
    ds_read_b64_tr_b16 v[36:37], v5 offset:36864
    ds_read_b64_tr_b16 v[38:39], v5 offset:37376
    v_mfma_f32_16x16x32_bf16 v[104:107], v[40:43], v[156:159], v[104:107]
    v_mul_f32 v11, v11, v56
    v_mul_f32 v12, v12, v57
    v_mul_f32 v13, v13, v58
    v_mfma_f32_16x16x32_bf16 v[92:95], v[44:47], v[152:155], v[92:95]
    ds_read_b64_tr_b16 v[40:41], v6 offset:36864
    ds_read_b64_tr_b16 v[42:43], v6 offset:37376
    v_mfma_f32_16x16x32_bf16 v[108:111], v[44:47], v[156:159], v[108:111]
    v_mul_f32 v14, v14, v59
    v_exp_f32 v11, v11
    v_exp_f32 v12, v12
    v_exp_f32 v13, v13
    s_waitcnt lgkmcnt(10)
    v_mfma_f32_16x16x32_bf16 v[80:83], v[16:19], v[160:163], v[80:83]
    ds_read_b64_tr_b16 v[44:45], v7 offset:36864
    ds_read_b64_tr_b16 v[46:47], v7 offset:37376
    v_mfma_f32_16x16x32_bf16 v[96:99], v[16:19], v[164:167], v[96:99]
    v_exp_f32 v14, v14
    v_add_f32 v11, 1.0, v11
    v_add_f32 v12, 1.0, v12
    v_mfma_f32_16x16x32_bf16 v[84:87], v[20:23], v[160:163], v[84:87]
    ds_read_b64_tr_b16 v[16:17], v4 offset:40960
    ds_read_b64_tr_b16 v[18:19], v4 offset:41472
    v_mfma_f32_16x16x32_bf16 v[100:103], v[20:23], v[164:167], v[100:103]
    v_add_f32 v13, 1.0, v13
    v_add_f32 v14, 1.0, v14
    v_rcp_f32 v11, v11
    s_waitcnt lgkmcnt(10)
    v_mfma_f32_16x16x32_bf16 v[88:91], v[24:27], v[160:163], v[88:91]
    ds_read_b64_tr_b16 v[20:21], v5 offset:40960
    ds_read_b64_tr_b16 v[22:23], v5 offset:41472
    v_mfma_f32_16x16x32_bf16 v[104:107], v[24:27], v[164:167], v[104:107]
    v_rcp_f32 v12, v12
    v_rcp_f32 v13, v13
    v_rcp_f32 v14, v14
    v_mul_f32 v56, v11, v56
    v_mfma_f32_16x16x32_bf16 v[92:95], v[28:31], v[160:163], v[92:95]
    ds_read_b64_tr_b16 v[24:25], v6 offset:40960
    ds_read_b64_tr_b16 v[26:27], v6 offset:41472
    v_mfma_f32_16x16x32_bf16 v[108:111], v[28:31], v[164:167], v[108:111]
    v_mul_f32 v57, v12, v57
    v_mul_f32 v58, v13, v58
    v_mul_f32 v59, v14, v59
    s_waitcnt lgkmcnt(10)
    v_mfma_f32_16x16x32_bf16 v[80:83], v[32:35], v[168:171], v[80:83]
    ds_read_b64_tr_b16 v[28:29], v7 offset:40960
    ds_read_b64_tr_b16 v[30:31], v7 offset:41472
    v_mfma_f32_16x16x32_bf16 v[96:99], v[32:35], v[172:175], v[96:99]
    v_mul_f32 v11, v60, v60
    v_mul_f32 v12, v61, v61
    v_mul_f32 v13, v62, v62
    v_mfma_f32_16x16x32_bf16 v[84:87], v[36:39], v[168:171], v[84:87]
    ds_read_b64_tr_b16 v[32:33], v4 offset:45056
    ds_read_b64_tr_b16 v[34:35], v4 offset:45568
    v_mfma_f32_16x16x32_bf16 v[100:103], v[36:39], v[172:175], v[100:103]
    v_mul_f32 v14, v63, v63
    v_fma_f32 v11, v11, s26, v10
    v_fma_f32 v12, v12, s26, v10
    v_fma_f32 v13, v13, s26, v10
    s_waitcnt lgkmcnt(10)
    v_mfma_f32_16x16x32_bf16 v[88:91], v[40:43], v[168:171], v[88:91]
    ds_read_b64_tr_b16 v[36:37], v5 offset:45056
    ds_read_b64_tr_b16 v[38:39], v5 offset:45568
    v_mfma_f32_16x16x32_bf16 v[104:107], v[40:43], v[172:175], v[104:107]
    v_fma_f32 v14, v14, s26, v10
    v_mul_f32 v11, v11, v60
    v_mul_f32 v12, v12, v61
    v_mfma_f32_16x16x32_bf16 v[92:95], v[44:47], v[168:171], v[92:95]
    ds_read_b64_tr_b16 v[40:41], v6 offset:45056
    ds_read_b64_tr_b16 v[42:43], v6 offset:45568
    v_mfma_f32_16x16x32_bf16 v[108:111], v[44:47], v[172:175], v[108:111]
    v_mul_f32 v13, v13, v62
    v_mul_f32 v14, v14, v63
    v_exp_f32 v11, v11
    s_waitcnt lgkmcnt(10)
    v_mfma_f32_16x16x32_bf16 v[80:83], v[16:19], v[176:179], v[80:83]
    ds_read_b64_tr_b16 v[44:45], v7 offset:45056
    ds_read_b64_tr_b16 v[46:47], v7 offset:45568
    v_mfma_f32_16x16x32_bf16 v[96:99], v[16:19], v[180:183], v[96:99]
    v_exp_f32 v12, v12
    v_exp_f32 v13, v13
    v_exp_f32 v14, v14
    v_add_f32 v11, 1.0, v11
    v_mfma_f32_16x16x32_bf16 v[84:87], v[20:23], v[176:179], v[84:87]
    ds_read_b64_tr_b16 v[16:17], v4 offset:49152
    ds_read_b64_tr_b16 v[18:19], v4 offset:49664
    v_mfma_f32_16x16x32_bf16 v[100:103], v[20:23], v[180:183], v[100:103]
    v_add_f32 v12, 1.0, v12
    v_add_f32 v13, 1.0, v13
    v_add_f32 v14, 1.0, v14
    s_waitcnt lgkmcnt(10)
    v_mfma_f32_16x16x32_bf16 v[88:91], v[24:27], v[176:179], v[88:91]
    ds_read_b64_tr_b16 v[20:21], v5 offset:49152
    ds_read_b64_tr_b16 v[22:23], v5 offset:49664
    v_mfma_f32_16x16x32_bf16 v[104:107], v[24:27], v[180:183], v[104:107]
    v_rcp_f32 v11, v11
    v_rcp_f32 v12, v12
    v_rcp_f32 v13, v13
    v_mfma_f32_16x16x32_bf16 v[92:95], v[28:31], v[176:179], v[92:95]
    ds_read_b64_tr_b16 v[24:25], v6 offset:49152
    ds_read_b64_tr_b16 v[26:27], v6 offset:49664
    v_mfma_f32_16x16x32_bf16 v[108:111], v[28:31], v[180:183], v[108:111]
    v_rcp_f32 v14, v14
    v_mul_f32 v60, v11, v60
    v_mul_f32 v61, v12, v61
    v_mul_f32 v62, v13, v62
    s_waitcnt lgkmcnt(10)
    v_mfma_f32_16x16x32_bf16 v[80:83], v[32:35], v[184:187], v[80:83]
    ds_read_b64_tr_b16 v[28:29], v7 offset:49152
    ds_read_b64_tr_b16 v[30:31], v7 offset:49664
    v_mfma_f32_16x16x32_bf16 v[96:99], v[32:35], v[188:191], v[96:99]
    v_mul_f32 v63, v14, v63
    v_mul_f32 v11, v64, v64
    v_mul_f32 v12, v65, v65
    v_mfma_f32_16x16x32_bf16 v[84:87], v[36:39], v[184:187], v[84:87]
    ds_read_b64_tr_b16 v[32:33], v4 offset:53248
    ds_read_b64_tr_b16 v[34:35], v4 offset:53760
    v_mfma_f32_16x16x32_bf16 v[100:103], v[36:39], v[188:191], v[100:103]
    v_mul_f32 v13, v66, v66
    v_mul_f32 v14, v67, v67
    v_fma_f32 v11, v11, s26, v10
    v_fma_f32 v12, v12, s26, v10
    s_waitcnt lgkmcnt(10)
    v_mfma_f32_16x16x32_bf16 v[88:91], v[40:43], v[184:187], v[88:91]
    ds_read_b64_tr_b16 v[36:37], v5 offset:53248
    ds_read_b64_tr_b16 v[38:39], v5 offset:53760
    v_mfma_f32_16x16x32_bf16 v[104:107], v[40:43], v[188:191], v[104:107]
    v_fma_f32 v13, v13, s26, v10
    v_fma_f32 v14, v14, s26, v10
    v_mul_f32 v11, v11, v64
    v_mfma_f32_16x16x32_bf16 v[92:95], v[44:47], v[184:187], v[92:95]
    ds_read_b64_tr_b16 v[40:41], v6 offset:53248
    ds_read_b64_tr_b16 v[42:43], v6 offset:53760
    v_mfma_f32_16x16x32_bf16 v[108:111], v[44:47], v[188:191], v[108:111]
    v_mul_f32 v12, v12, v65
    v_mul_f32 v13, v13, v66
    v_mul_f32 v14, v14, v67
    s_waitcnt lgkmcnt(10)
    v_mfma_f32_16x16x32_bf16 v[80:83], v[16:19], v[192:195], v[80:83]
    ds_read_b64_tr_b16 v[44:45], v7 offset:53248
    ds_read_b64_tr_b16 v[46:47], v7 offset:53760
    v_mfma_f32_16x16x32_bf16 v[96:99], v[16:19], v[196:199], v[96:99]
    v_exp_f32 v11, v11
    v_exp_f32 v12, v12
    v_exp_f32 v13, v13
    v_exp_f32 v14, v14
    v_mfma_f32_16x16x32_bf16 v[84:87], v[20:23], v[192:195], v[84:87]
    v_mfma_f32_16x16x32_bf16 v[100:103], v[20:23], v[196:199], v[100:103]
    s_waitcnt vmcnt(3)
    s_barrier
    ds_read_b64_tr_b16 v[16:17], v4 offset:57344
    ds_read_b64_tr_b16 v[18:19], v4 offset:57856
    v_add_f32 v11, 1.0, v11
    v_add_f32 v12, 1.0, v12
    v_add_f32 v13, 1.0, v13
    s_waitcnt lgkmcnt(10)
    v_mfma_f32_16x16x32_bf16 v[88:91], v[24:27], v[192:195], v[88:91]
    ds_read_b64_tr_b16 v[20:21], v5 offset:57344
    ds_read_b64_tr_b16 v[22:23], v5 offset:57856
    v_mfma_f32_16x16x32_bf16 v[104:107], v[24:27], v[196:199], v[104:107]
    v_add_f32 v14, 1.0, v14
    v_rcp_f32 v11, v11
    v_rcp_f32 v12, v12
    v_mfma_f32_16x16x32_bf16 v[92:95], v[28:31], v[192:195], v[92:95]
    ds_read_b64_tr_b16 v[24:25], v6 offset:57344
    ds_read_b64_tr_b16 v[26:27], v6 offset:57856
    v_mfma_f32_16x16x32_bf16 v[108:111], v[28:31], v[196:199], v[108:111]
    v_rcp_f32 v13, v13
    v_rcp_f32 v14, v14
    v_mul_f32 v64, v11, v64
    v_mul_f32 v65, v12, v65
    s_waitcnt lgkmcnt(10)
    v_mfma_f32_16x16x32_bf16 v[80:83], v[32:35], v[200:203], v[80:83]
    ds_read_b64_tr_b16 v[28:29], v7 offset:57344
    ds_read_b64_tr_b16 v[30:31], v7 offset:57856
    v_mfma_f32_16x16x32_bf16 v[96:99], v[32:35], v[204:207], v[96:99]
    v_mul_f32 v66, v13, v66
    v_mul_f32 v67, v14, v67
    v_mul_f32 v11, v68, v68
    v_mfma_f32_16x16x32_bf16 v[84:87], v[36:39], v[200:203], v[84:87]
    ds_read_b64_tr_b16 v[32:33], v4 offset:61440
    ds_read_b64_tr_b16 v[34:35], v4 offset:61952
    v_mfma_f32_16x16x32_bf16 v[100:103], v[36:39], v[204:207], v[100:103]
    v_mul_f32 v12, v69, v69
    v_mul_f32 v13, v70, v70
    v_mul_f32 v14, v71, v71
    s_waitcnt lgkmcnt(10)
    v_mfma_f32_16x16x32_bf16 v[88:91], v[40:43], v[200:203], v[88:91]
    ds_read_b64_tr_b16 v[36:37], v5 offset:61440
    ds_read_b64_tr_b16 v[38:39], v5 offset:61952
    v_mfma_f32_16x16x32_bf16 v[104:107], v[40:43], v[204:207], v[104:107]
    v_fma_f32 v11, v11, s26, v10
    v_fma_f32 v12, v12, s26, v10
    v_fma_f32 v13, v13, s26, v10
    v_fma_f32 v14, v14, s26, v10
    v_mfma_f32_16x16x32_bf16 v[92:95], v[44:47], v[200:203], v[92:95]
    ds_read_b64_tr_b16 v[40:41], v6 offset:61440
    ds_read_b64_tr_b16 v[42:43], v6 offset:61952
    v_mfma_f32_16x16x32_bf16 v[108:111], v[44:47], v[204:207], v[108:111]
    v_mul_f32 v11, v11, v68
    v_mul_f32 v12, v12, v69
    v_mul_f32 v13, v13, v70
    s_waitcnt lgkmcnt(10)
    v_mfma_f32_16x16x32_bf16 v[80:83], v[16:19], v[208:211], v[80:83]
    ds_read_b64_tr_b16 v[44:45], v7 offset:61440
    ds_read_b64_tr_b16 v[46:47], v7 offset:61952
    v_mfma_f32_16x16x32_bf16 v[96:99], v[16:19], v[212:215], v[96:99]
    v_mul_f32 v14, v14, v71
    v_exp_f32 v11, v11
    v_exp_f32 v12, v12
    v_mfma_f32_16x16x32_bf16 v[84:87], v[20:23], v[208:211], v[84:87]
    ds_read_b64_tr_b16 v[16:17], v8 offset:0
    ds_read_b64_tr_b16 v[18:19], v8 offset:512
    v_mfma_f32_16x16x32_bf16 v[100:103], v[20:23], v[212:215], v[100:103]
    v_exp_f32 v13, v13
    v_exp_f32 v14, v14
    v_add_f32 v11, 1.0, v11
    v_add_f32 v12, 1.0, v12
    s_waitcnt lgkmcnt(10)
    v_mfma_f32_16x16x32_bf16 v[88:91], v[24:27], v[208:211], v[88:91]
    ds_read_b64_tr_b16 v[20:21], v9 offset:0
    ds_read_b64_tr_b16 v[22:23], v9 offset:512
    v_mfma_f32_16x16x32_bf16 v[104:107], v[24:27], v[212:215], v[104:107]
    v_add_f32 v13, 1.0, v13
    v_add_f32 v14, 1.0, v14
    v_rcp_f32 v11, v11
    v_mfma_f32_16x16x32_bf16 v[92:95], v[28:31], v[208:211], v[92:95]
    ds_read_b64_tr_b16 v[24:25], v1 offset:0
    ds_read_b64_tr_b16 v[26:27], v1 offset:512
    v_mfma_f32_16x16x32_bf16 v[108:111], v[28:31], v[212:215], v[108:111]
    v_rcp_f32 v12, v12
    v_rcp_f32 v13, v13
    v_rcp_f32 v14, v14
    s_waitcnt lgkmcnt(10)
    v_mfma_f32_16x16x32_bf16 v[80:83], v[32:35], v[216:219], v[80:83]
    ds_read_b64_tr_b16 v[28:29], v0 offset:0
    ds_read_b64_tr_b16 v[30:31], v0 offset:512
    v_mfma_f32_16x16x32_bf16 v[96:99], v[32:35], v[220:223], v[96:99]
    v_mul_f32 v68, v11, v68
    v_mul_f32 v69, v12, v69
    v_mul_f32 v70, v13, v70
    v_mul_f32 v71, v14, v71
    v_mfma_f32_16x16x32_bf16 v[84:87], v[36:39], v[216:219], v[84:87]
    ds_read_b64_tr_b16 v[32:33], v8 offset:4096
    ds_read_b64_tr_b16 v[34:35], v8 offset:4608
    v_mfma_f32_16x16x32_bf16 v[100:103], v[36:39], v[220:223], v[100:103]
    v_mul_f32 v11, v72, v72
    v_mul_f32 v12, v73, v73
    v_mul_f32 v13, v74, v74
    s_waitcnt lgkmcnt(10)
    v_mfma_f32_16x16x32_bf16 v[88:91], v[40:43], v[216:219], v[88:91]
    ds_read_b64_tr_b16 v[36:37], v9 offset:4096
    ds_read_b64_tr_b16 v[38:39], v9 offset:4608
    v_mfma_f32_16x16x32_bf16 v[104:107], v[40:43], v[220:223], v[104:107]
    v_mul_f32 v14, v75, v75
    v_fma_f32 v11, v11, s26, v10
    v_fma_f32 v12, v12, s26, v10
    v_mfma_f32_16x16x32_bf16 v[92:95], v[44:47], v[216:219], v[92:95]
    ds_read_b64_tr_b16 v[40:41], v1 offset:4096
    ds_read_b64_tr_b16 v[42:43], v1 offset:4608
    v_mfma_f32_16x16x32_bf16 v[108:111], v[44:47], v[220:223], v[108:111]
    v_fma_f32 v13, v13, s26, v10
    v_fma_f32 v14, v14, s26, v10
    v_mul_f32 v11, v11, v72
    v_mul_f32 v12, v12, v73
    s_waitcnt lgkmcnt(10)
    v_mfma_f32_16x16x32_bf16 v[80:83], v[16:19], v[224:227], v[80:83]
    ds_read_b64_tr_b16 v[44:45], v0 offset:4096
    ds_read_b64_tr_b16 v[46:47], v0 offset:4608
    v_mfma_f32_16x16x32_bf16 v[96:99], v[16:19], v[228:231], v[96:99]
    v_mul_f32 v13, v13, v74
    v_mul_f32 v14, v14, v75
    v_exp_f32 v11, v11
    v_mfma_f32_16x16x32_bf16 v[84:87], v[20:23], v[224:227], v[84:87]
    ds_read_b64_tr_b16 v[16:17], v8 offset:8192
    ds_read_b64_tr_b16 v[18:19], v8 offset:8704
    v_mfma_f32_16x16x32_bf16 v[100:103], v[20:23], v[228:231], v[100:103]
    v_exp_f32 v12, v12
    v_exp_f32 v13, v13
    v_exp_f32 v14, v14
    s_waitcnt lgkmcnt(10)
    v_mfma_f32_16x16x32_bf16 v[88:91], v[24:27], v[224:227], v[88:91]
    ds_read_b64_tr_b16 v[20:21], v9 offset:8192
    ds_read_b64_tr_b16 v[22:23], v9 offset:8704
    v_mfma_f32_16x16x32_bf16 v[104:107], v[24:27], v[228:231], v[104:107]
    v_add_f32 v11, 1.0, v11
    v_add_f32 v12, 1.0, v12
    v_add_f32 v13, 1.0, v13
    v_add_f32 v14, 1.0, v14
    v_mfma_f32_16x16x32_bf16 v[92:95], v[28:31], v[224:227], v[92:95]
    ds_read_b64_tr_b16 v[24:25], v1 offset:8192
    ds_read_b64_tr_b16 v[26:27], v1 offset:8704
    v_mfma_f32_16x16x32_bf16 v[108:111], v[28:31], v[228:231], v[108:111]
    v_rcp_f32 v11, v11
    v_rcp_f32 v12, v12
    v_rcp_f32 v13, v13
    s_waitcnt lgkmcnt(10)
    v_mfma_f32_16x16x32_bf16 v[80:83], v[32:35], v[232:235], v[80:83]
    ds_read_b64_tr_b16 v[28:29], v0 offset:8192
    ds_read_b64_tr_b16 v[30:31], v0 offset:8704
    v_mfma_f32_16x16x32_bf16 v[96:99], v[32:35], v[236:239], v[96:99]
    v_rcp_f32 v14, v14
    v_mul_f32 v72, v11, v72
    v_mul_f32 v73, v12, v73
    v_mfma_f32_16x16x32_bf16 v[84:87], v[36:39], v[232:235], v[84:87]
    ds_read_b64_tr_b16 v[32:33], v8 offset:12288
    ds_read_b64_tr_b16 v[34:35], v8 offset:12800
    v_mfma_f32_16x16x32_bf16 v[100:103], v[36:39], v[236:239], v[100:103]
    v_mul_f32 v74, v13, v74
    v_mul_f32 v75, v14, v75
    v_mul_f32 v11, v76, v76
    v_mul_f32 v12, v77, v77
    s_waitcnt lgkmcnt(10)
    v_mfma_f32_16x16x32_bf16 v[88:91], v[40:43], v[232:235], v[88:91]
    ds_read_b64_tr_b16 v[36:37], v9 offset:12288
    ds_read_b64_tr_b16 v[38:39], v9 offset:12800
    v_mfma_f32_16x16x32_bf16 v[104:107], v[40:43], v[236:239], v[104:107]
    v_mul_f32 v13, v78, v78
    v_mul_f32 v14, v79, v79
    v_fma_f32 v11, v11, s26, v10
    v_mfma_f32_16x16x32_bf16 v[92:95], v[44:47], v[232:235], v[92:95]
    ds_read_b64_tr_b16 v[40:41], v1 offset:12288
    ds_read_b64_tr_b16 v[42:43], v1 offset:12800
    v_mfma_f32_16x16x32_bf16 v[108:111], v[44:47], v[236:239], v[108:111]
    v_fma_f32 v12, v12, s26, v10
    v_fma_f32 v13, v13, s26, v10
    v_fma_f32 v14, v14, s26, v10
    s_waitcnt lgkmcnt(10)
    v_mfma_f32_16x16x32_bf16 v[80:83], v[16:19], v[240:243], v[80:83]
    ds_read_b64_tr_b16 v[44:45], v0 offset:12288
    ds_read_b64_tr_b16 v[46:47], v0 offset:12800
    v_mfma_f32_16x16x32_bf16 v[96:99], v[16:19], v[244:247], v[96:99]
    v_mul_f32 v11, v11, v76
    v_mul_f32 v12, v12, v77
    v_mul_f32 v13, v13, v78
    v_mul_f32 v14, v14, v79
    v_mfma_f32_16x16x32_bf16 v[84:87], v[20:23], v[240:243], v[84:87]
    v_mfma_f32_16x16x32_bf16 v[100:103], v[20:23], v[244:247], v[100:103]
    v_exp_f32 v11, v11
    v_exp_f32 v12, v12
    v_exp_f32 v13, v13
    s_waitcnt lgkmcnt(8)
    v_mfma_f32_16x16x32_bf16 v[88:91], v[24:27], v[240:243], v[88:91]
    v_mfma_f32_16x16x32_bf16 v[104:107], v[24:27], v[244:247], v[104:107]
    v_exp_f32 v14, v14
    v_add_f32 v11, 1.0, v11
    v_add_f32 v12, 1.0, v12
    v_mfma_f32_16x16x32_bf16 v[92:95], v[28:31], v[240:243], v[92:95]
    v_mfma_f32_16x16x32_bf16 v[108:111], v[28:31], v[244:247], v[108:111]
    v_add_f32 v13, 1.0, v13
    v_add_f32 v14, 1.0, v14
    v_rcp_f32 v11, v11
    v_rcp_f32 v12, v12
    s_waitcnt lgkmcnt(4)
    v_mfma_f32_16x16x32_bf16 v[80:83], v[32:35], v[248:251], v[80:83]
    v_mfma_f32_16x16x32_bf16 v[96:99], v[32:35], v[252:255], v[96:99]
    v_rcp_f32 v13, v13
    v_rcp_f32 v14, v14
    v_mul_f32 v76, v11, v76
    v_mfma_f32_16x16x32_bf16 v[84:87], v[36:39], v[248:251], v[84:87]
    v_mfma_f32_16x16x32_bf16 v[100:103], v[36:39], v[252:255], v[100:103]
    v_mul_f32 v77, v12, v77
    v_mul_f32 v78, v13, v78
    v_mul_f32 v79, v14, v79
    s_waitcnt lgkmcnt(0)
    v_mfma_f32_16x16x32_bf16 v[88:91], v[40:43], v[248:251], v[88:91]
    v_mfma_f32_16x16x32_bf16 v[104:107], v[40:43], v[252:255], v[104:107]
    v_mfma_f32_16x16x32_bf16 v[92:95], v[44:47], v[248:251], v[92:95]
    v_mfma_f32_16x16x32_bf16 v[108:111], v[44:47], v[252:255], v[108:111]
    v_mul_f32 v80, v48, v80
    v_mul_f32 v81, v49, v81
    v_mul_f32 v82, v50, v82
    v_mul_f32 v83, v51, v83
    v_mul_f32 v84, v52, v84
    v_mul_f32 v85, v53, v85
    v_mul_f32 v86, v54, v86
    v_mul_f32 v87, v55, v87
    v_mul_f32 v88, v56, v88
    v_mul_f32 v89, v57, v89
    v_mul_f32 v90, v58, v90
    v_mul_f32 v91, v59, v91
    v_mul_f32 v92, v60, v92
    v_mul_f32 v93, v61, v93
    v_mul_f32 v94, v62, v94
    v_mul_f32 v95, v63, v95
    v_mul_f32 v96, v64, v96
    v_mul_f32 v97, v65, v97
    v_mul_f32 v98, v66, v98
    v_mul_f32 v99, v67, v99
    v_mul_f32 v100, v68, v100
    v_mul_f32 v101, v69, v101
    v_mul_f32 v102, v70, v102
    v_mul_f32 v103, v71, v103
    v_mul_f32 v104, v72, v104
    v_mul_f32 v105, v73, v105
    v_mul_f32 v106, v74, v106
    v_mul_f32 v107, v75, v107
    v_mul_f32 v108, v76, v108
    v_mul_f32 v109, v77, v109
    v_mul_f32 v110, v78, v110
    v_mul_f32 v111, v79, v111
    v_cvt_pk_bf16_f32 v80, v80, v81
    v_cvt_pk_bf16_f32 v81, v82, v83
    v_cvt_pk_bf16_f32 v82, v84, v85
    v_cvt_pk_bf16_f32 v83, v86, v87
    buffer_store_dwordx4 v[80:83], v15, s[16:19], s25 offen offset:0 sc1
    v_cvt_pk_bf16_f32 v84, v88, v89
    v_cvt_pk_bf16_f32 v85, v90, v91
    v_cvt_pk_bf16_f32 v86, v92, v93
    v_cvt_pk_bf16_f32 v87, v94, v95
    buffer_store_dwordx4 v[84:87], v15, s[16:19], s25 offen offset:2048 sc1
    v_cvt_pk_bf16_f32 v96, v96, v97
    v_cvt_pk_bf16_f32 v97, v98, v99
    v_cvt_pk_bf16_f32 v98, v100, v101
    v_cvt_pk_bf16_f32 v99, v102, v103
    buffer_store_dwordx4 v[96:99], v15, s[16:19], s25 offen offset:256 sc1
    v_cvt_pk_bf16_f32 v100, v104, v105
    v_cvt_pk_bf16_f32 v101, v106, v107
    v_cvt_pk_bf16_f32 v102, v108, v109
    v_cvt_pk_bf16_f32 v103, v110, v111
    buffer_store_dwordx4 v[100:103], v15, s[16:19], s25 offen offset:2304 sc1
    s_add_u32 s25, s25, 4096
    s_endpgm
L1_FF:
    s_add_u32 m0, s24, 98304
    s_add_u32 s30, s88, 0
    buffer_load_dwordx4 v3, s[4:7], s30 offen lds
    s_add_u32 m0, s24, 106496
    s_add_u32 s30, s88, 9216
    buffer_load_dwordx4 v15, s[4:7], s30 offen lds
    s_add_u32 m0, s24, 114688
    s_add_u32 s30, s88, 18432
    buffer_load_dwordx4 v3, s[4:7], s30 offen lds
    s_add_u32 m0, s24, 122880
    s_add_u32 s30, s88, 27648
    buffer_load_dwordx4 v15, s[4:7], s30 offen lds
    s_mov_b32 s12, s54
    s_mov_b32 s13, s55
    s_mov_b32 s14, 5308416
    s_mov_b32 s15, 0x00020000
    s_add_u32 s33, s47, 5308416
    s_add_u32 s35, s29, 1152
    s_add_u32 s37, s36, 589824
    s_cmp_eq_u32 s37, s33
    s_cselect_b32 s37, s47, s37
    s_add_u32 s89, s88, 128
    s_cmp_eq_u32 s89, s35
    s_cselect_b32 s89, s29, s89
    s_add_u32 s38, s37, 589824
    s_cmp_eq_u32 s38, s33
    s_cselect_b32 s38, s47, s38
    s_add_u32 s90, s89, 128
    s_cmp_eq_u32 s90, s35
    s_cselect_b32 s90, s29, s90
    s_add_u32 s39, s38, 589824
    s_cmp_eq_u32 s39, s33
    s_cselect_b32 s39, s47, s39
    s_add_u32 s91, s90, 128
    s_cmp_eq_u32 s91, s35
    s_cselect_b32 s91, s29, s91
    s_add_u32 s40, s39, 589824
    s_cmp_eq_u32 s40, s33
    s_cselect_b32 s40, s47, s40
    s_add_u32 s92, s91, 128
    s_cmp_eq_u32 s92, s35
    s_cselect_b32 s92, s29, s92
    s_add_u32 s41, s40, 589824
    s_cmp_eq_u32 s41, s33
    s_cselect_b32 s41, s47, s41
    s_add_u32 s93, s92, 128
    s_cmp_eq_u32 s93, s35
    s_cselect_b32 s93, s29, s93
    s_add_u32 s42, s41, 589824
    s_cmp_eq_u32 s42, s33
    s_cselect_b32 s42, s47, s42
    s_add_u32 s94, s93, 128
    s_cmp_eq_u32 s94, s35
    s_cselect_b32 s94, s29, s94
    s_add_u32 s43, s42, 589824
    s_cmp_eq_u32 s43, s33
    s_cselect_b32 s43, s47, s43
    s_add_u32 s95, s94, 128
    s_cmp_eq_u32 s95, s35
    s_cselect_b32 s95, s29, s95
    s_add_u32 s44, s43, 589824
    s_cmp_eq_u32 s44, s33
    s_cselect_b32 s44, s47, s44
    s_add_u32 s96, s95, 128
    s_cmp_eq_u32 s96, s35
    s_cselect_b32 s96, s29, s96
    s_barrier
    s_mov_b32 s16, s56
    s_mov_b32 s17, s57
    s_mov_b32 s18, 268435456
    s_mov_b32 s19, 0x00020000
    v_and_b32 v21, 15, v0
    v_lshrrev_b32 v22, 2, v21
    v_and_b32 v25, 3, v21
    v_lshrrev_b32 v23, 4, v0
    v_lshl_add_u32 v24, v23, 3, v22
    v_lshlrev_b32 v24, 7, v24
    v_lshl_add_u32 v24, v25, 3, v24
    v_lshrrev_b32 v22, 1, v22
    v_and_b32 v25, 1, v23
    v_lshl_add_u32 v22, v25, 1, v22
    v_lshl_add_u32 v4, v22, 5, v24
    v_xor_b32 v5, 32, v4
    v_xor_b32 v6, 64, v4
    v_xor_b32 v7, 96, v4
    v_lshrrev_b32 v22, 1, v21
    v_xor_b32 v22, v22, v23
    v_lshlrev_b32 v22, 4, v22
    v_and_b32 v24, 7, v21
    v_lshl_add_u32 v22, v24, 7, v22
    v_lshrrev_b32 v24, 3, v21
    v_lshl_add_u32 v22, v24, 13, v22
    s_add_u32 s33, s24, 0x18000
    v_add_u32 v11, s33, v22
    v_xor_b32 v12, 64, v11
    v_lshlrev_b32 v13, 9, v23
    v_lshl_add_u32 v13, v21, 4, v13
    v_add_u32 v8, 0x10000, v4
    v_add_u32 v9, 0x10000, v5
    v_add_u32 v1, 0x10000, v6
    v_add_u32 v0, 0x10000, v7
    v_mov_b32 v10, 0xc0135761
    s_mov_b32 s26, 0xbdd2d3e8
    s_mul_i32 s25, s23, 294912
    s_mul_i32 s33, s46, 12288
    s_add_u32 s25, s25, s33
    s_waitcnt vmcnt(0)
    ds_read_b128 v[112:115], v11 offset:0
    ds_read_b128 v[116:119], v11 offset:16384
    ds_read_b128 v[120:123], v12 offset:0
    ds_read_b128 v[124:127], v12 offset:16384
    s_add_u32 m0, s24, 131072
    s_add_u32 s30, s89, 0
    buffer_load_dwordx4 v3, s[4:7], s30 offen lds
    s_add_u32 m0, s24, 139264
    s_add_u32 s30, s89, 9216
    buffer_load_dwordx4 v15, s[4:7], s30 offen lds
    s_add_u32 m0, s24, 147456
    s_add_u32 s30, s89, 18432
    buffer_load_dwordx4 v3, s[4:7], s30 offen lds
    s_add_u32 m0, s24, 155648
    s_add_u32 s30, s89, 27648
    buffer_load_dwordx4 v15, s[4:7], s30 offen lds
    s_barrier
    ds_read_b64_tr_b16 v[16:17], v4 offset:0
    ds_read_b64_tr_b16 v[18:19], v4 offset:512
    ds_read_b64_tr_b16 v[20:21], v5 offset:0
    ds_read_b64_tr_b16 v[22:23], v5 offset:512
    ds_read_b64_tr_b16 v[24:25], v6 offset:0
    ds_read_b64_tr_b16 v[26:27], v6 offset:512
    ds_read_b64_tr_b16 v[28:29], v7 offset:0
    ds_read_b64_tr_b16 v[30:31], v7 offset:512
    ds_read_b64_tr_b16 v[32:33], v4 offset:4096
    ds_read_b64_tr_b16 v[34:35], v4 offset:4608
    ds_read_b64_tr_b16 v[36:37], v5 offset:4096
    ds_read_b64_tr_b16 v[38:39], v5 offset:4608
    ds_read_b64_tr_b16 v[40:41], v6 offset:4096
    ds_read_b64_tr_b16 v[42:43], v6 offset:4608
    s_waitcnt lgkmcnt(10)
    v_mfma_f32_16x16x32_bf16 v[48:51], v[16:19], v[112:115], 0
    ds_read_b64_tr_b16 v[44:45], v7 offset:4096
    ds_read_b64_tr_b16 v[46:47], v7 offset:4608
    v_mfma_f32_16x16x32_bf16 v[64:67], v[16:19], v[116:119], 0
    s_add_u32 m0, s24, 98304
    s_add_u32 s30, s90, 0
    buffer_load_dwordx4 v3, s[4:7], s30 offen lds
    s_add_u32 m0, s24, 106496
    s_add_u32 s30, s90, 9216
    buffer_load_dwordx4 v15, s[4:7], s30 offen lds
    v_mfma_f32_16x16x32_bf16 v[52:55], v[20:23], v[112:115], 0
    v_mfma_f32_16x16x32_bf16 v[68:71], v[20:23], v[116:119], 0
    s_barrier
    ds_read_b64_tr_b16 v[16:17], v4 offset:8192
    ds_read_b64_tr_b16 v[18:19], v4 offset:8704
    s_add_u32 m0, s24, 114688
    s_add_u32 s30, s90, 18432
    buffer_load_dwordx4 v3, s[4:7], s30 offen lds
    s_add_u32 m0, s24, 122880
    s_add_u32 s30, s90, 27648
    buffer_load_dwordx4 v15, s[4:7], s30 offen lds
    s_waitcnt lgkmcnt(10)
    v_mfma_f32_16x16x32_bf16 v[56:59], v[24:27], v[112:115], 0
    ds_read_b64_tr_b16 v[20:21], v5 offset:8192
    ds_read_b64_tr_b16 v[22:23], v5 offset:8704
    v_mfma_f32_16x16x32_bf16 v[72:75], v[24:27], v[116:119], 0
    v_mfma_f32_16x16x32_bf16 v[60:63], v[28:31], v[112:115], 0
    ds_read_b64_tr_b16 v[24:25], v6 offset:8192
    ds_read_b64_tr_b16 v[26:27], v6 offset:8704
    v_mfma_f32_16x16x32_bf16 v[76:79], v[28:31], v[116:119], 0
    s_waitcnt lgkmcnt(10)
    v_mfma_f32_16x16x32_bf16 v[48:51], v[32:35], v[120:123], v[48:51]
    ds_read_b64_tr_b16 v[28:29], v7 offset:8192
    ds_read_b64_tr_b16 v[30:31], v7 offset:8704
    v_mfma_f32_16x16x32_bf16 v[64:67], v[32:35], v[124:127], v[64:67]
    v_mfma_f32_16x16x32_bf16 v[52:55], v[36:39], v[120:123], v[52:55]
    ds_read_b64_tr_b16 v[32:33], v4 offset:12288
    ds_read_b64_tr_b16 v[34:35], v4 offset:12800
    v_mfma_f32_16x16x32_bf16 v[68:71], v[36:39], v[124:127], v[68:71]
    s_waitcnt lgkmcnt(10)
    v_mfma_f32_16x16x32_bf16 v[56:59], v[40:43], v[120:123], v[56:59]
    ds_read_b64_tr_b16 v[36:37], v5 offset:12288
    ds_read_b64_tr_b16 v[38:39], v5 offset:12800
    v_mfma_f32_16x16x32_bf16 v[72:75], v[40:43], v[124:127], v[72:75]
    v_mfma_f32_16x16x32_bf16 v[60:63], v[44:47], v[120:123], v[60:63]
    ds_read_b64_tr_b16 v[40:41], v6 offset:12288
    ds_read_b64_tr_b16 v[42:43], v6 offset:12800
    v_mfma_f32_16x16x32_bf16 v[76:79], v[44:47], v[124:127], v[76:79]
    s_waitcnt lgkmcnt(10)
    v_mfma_f32_16x16x32_bf16 v[80:83], v[16:19], v[112:115], 0
    ds_read_b64_tr_b16 v[44:45], v7 offset:12288
    ds_read_b64_tr_b16 v[46:47], v7 offset:12800
    v_mfma_f32_16x16x32_bf16 v[96:99], v[16:19], v[116:119], 0
    v_mfma_f32_16x16x32_bf16 v[84:87], v[20:23], v[112:115], 0
    v_mfma_f32_16x16x32_bf16 v[100:103], v[20:23], v[116:119], 0
    s_barrier
    ds_read_b64_tr_b16 v[16:17], v4 offset:16384
    ds_read_b64_tr_b16 v[18:19], v4 offset:16896
    s_waitcnt lgkmcnt(10)
    v_mfma_f32_16x16x32_bf16 v[88:91], v[24:27], v[112:115], 0
    ds_read_b64_tr_b16 v[20:21], v5 offset:16384
    ds_read_b64_tr_b16 v[22:23], v5 offset:16896
    v_mfma_f32_16x16x32_bf16 v[104:107], v[24:27], v[116:119], 0
    v_mfma_f32_16x16x32_bf16 v[92:95], v[28:31], v[112:115], 0
    ds_read_b64_tr_b16 v[24:25], v6 offset:16384
    ds_read_b64_tr_b16 v[26:27], v6 offset:16896
    v_mfma_f32_16x16x32_bf16 v[108:111], v[28:31], v[116:119], 0
    s_waitcnt lgkmcnt(10)
    v_mfma_f32_16x16x32_bf16 v[80:83], v[32:35], v[120:123], v[80:83]
    ds_read_b64_tr_b16 v[28:29], v7 offset:16384
    ds_read_b64_tr_b16 v[30:31], v7 offset:16896
    v_mfma_f32_16x16x32_bf16 v[96:99], v[32:35], v[124:127], v[96:99]
    s_waitcnt vmcnt(4)
    ds_read_b128 v[128:131], v11 offset:32768
    ds_read_b128 v[132:135], v11 offset:49152
    ds_read_b128 v[136:139], v12 offset:32768
    ds_read_b128 v[140:143], v12 offset:49152
    v_mfma_f32_16x16x32_bf16 v[84:87], v[36:39], v[120:123], v[84:87]
    ds_read_b64_tr_b16 v[32:33], v4 offset:20480
    ds_read_b64_tr_b16 v[34:35], v4 offset:20992
    v_mfma_f32_16x16x32_bf16 v[100:103], v[36:39], v[124:127], v[100:103]
    s_waitcnt lgkmcnt(14)
    v_mfma_f32_16x16x32_bf16 v[88:91], v[40:43], v[120:123], v[88:91]
    ds_read_b64_tr_b16 v[36:37], v5 offset:20480
    ds_read_b64_tr_b16 v[38:39], v5 offset:20992
    v_mfma_f32_16x16x32_bf16 v[104:107], v[40:43], v[124:127], v[104:107]
    v_mfma_f32_16x16x32_bf16 v[92:95], v[44:47], v[120:123], v[92:95]
    ds_read_b64_tr_b16 v[40:41], v6 offset:20480
    ds_read_b64_tr_b16 v[42:43], v6 offset:20992
    v_mfma_f32_16x16x32_bf16 v[108:111], v[44:47], v[124:127], v[108:111]
    s_waitcnt lgkmcnt(14)
    s_waitcnt lgkmcnt(6)
    v_mfma_f32_16x16x32_bf16 v[48:51], v[16:19], v[128:131], v[48:51]
    ds_read_b64_tr_b16 v[44:45], v7 offset:20480
    ds_read_b64_tr_b16 v[46:47], v7 offset:20992
    v_mfma_f32_16x16x32_bf16 v[64:67], v[16:19], v[132:135], v[64:67]
    s_add_u32 m0, s24, 131072
    s_add_u32 s30, s91, 0
    buffer_load_dwordx4 v3, s[4:7], s30 offen lds
    s_add_u32 m0, s24, 139264
    s_add_u32 s30, s91, 9216
    buffer_load_dwordx4 v15, s[4:7], s30 offen lds
    v_mfma_f32_16x16x32_bf16 v[52:55], v[20:23], v[128:131], v[52:55]
    v_mfma_f32_16x16x32_bf16 v[68:71], v[20:23], v[132:135], v[68:71]
    s_barrier
    ds_read_b64_tr_b16 v[16:17], v4 offset:24576
    ds_read_b64_tr_b16 v[18:19], v4 offset:25088
    s_add_u32 m0, s24, 147456
    s_add_u32 s30, s91, 18432
    buffer_load_dwordx4 v3, s[4:7], s30 offen lds
    s_add_u32 m0, s24, 155648
    s_add_u32 s30, s91, 27648
    buffer_load_dwordx4 v15, s[4:7], s30 offen lds
    v_mfma_f32_16x16x32_bf16 v[56:59], v[24:27], v[128:131], v[56:59]
    ds_read_b64_tr_b16 v[20:21], v5 offset:24576
    ds_read_b64_tr_b16 v[22:23], v5 offset:25088
    v_mfma_f32_16x16x32_bf16 v[72:75], v[24:27], v[132:135], v[72:75]
    v_mfma_f32_16x16x32_bf16 v[60:63], v[28:31], v[128:131], v[60:63]
    ds_read_b64_tr_b16 v[24:25], v6 offset:24576
    ds_read_b64_tr_b16 v[26:27], v6 offset:25088
    v_mfma_f32_16x16x32_bf16 v[76:79], v[28:31], v[132:135], v[76:79]
    s_waitcnt lgkmcnt(10)
    v_mfma_f32_16x16x32_bf16 v[48:51], v[32:35], v[136:139], v[48:51]
    ds_read_b64_tr_b16 v[28:29], v7 offset:24576
    ds_read_b64_tr_b16 v[30:31], v7 offset:25088
    v_mfma_f32_16x16x32_bf16 v[64:67], v[32:35], v[140:143], v[64:67]
    s_waitcnt vmcnt(4)
    ds_read_b128 v[144:147], v11 offset:0
    ds_read_b128 v[148:151], v11 offset:16384
    ds_read_b128 v[152:155], v12 offset:0
    ds_read_b128 v[156:159], v12 offset:16384
    v_mfma_f32_16x16x32_bf16 v[52:55], v[36:39], v[136:139], v[52:55]
    ds_read_b64_tr_b16 v[32:33], v4 offset:28672
    ds_read_b64_tr_b16 v[34:35], v4 offset:29184
    v_mfma_f32_16x16x32_bf16 v[68:71], v[36:39], v[140:143], v[68:71]
    s_waitcnt lgkmcnt(14)
    v_mfma_f32_16x16x32_bf16 v[56:59], v[40:43], v[136:139], v[56:59]
    ds_read_b64_tr_b16 v[36:37], v5 offset:28672
    ds_read_b64_tr_b16 v[38:39], v5 offset:29184
    v_mfma_f32_16x16x32_bf16 v[72:75], v[40:43], v[140:143], v[72:75]
    v_mfma_f32_16x16x32_bf16 v[60:63], v[44:47], v[136:139], v[60:63]
    ds_read_b64_tr_b16 v[40:41], v6 offset:28672
    ds_read_b64_tr_b16 v[42:43], v6 offset:29184
    v_mfma_f32_16x16x32_bf16 v[76:79], v[44:47], v[140:143], v[76:79]
    s_waitcnt lgkmcnt(14)
    s_waitcnt lgkmcnt(6)
    v_mfma_f32_16x16x32_bf16 v[48:51], v[16:19], v[144:147], v[48:51]
    ds_read_b64_tr_b16 v[44:45], v7 offset:28672
    ds_read_b64_tr_b16 v[46:47], v7 offset:29184
    v_mfma_f32_16x16x32_bf16 v[64:67], v[16:19], v[148:151], v[64:67]
    s_add_u32 m0, s24, 98304
    s_add_u32 s30, s92, 0
    buffer_load_dwordx4 v3, s[4:7], s30 offen lds
    s_add_u32 m0, s24, 106496
    s_add_u32 s30, s92, 9216
    buffer_load_dwordx4 v15, s[4:7], s30 offen lds
    v_mfma_f32_16x16x32_bf16 v[52:55], v[20:23], v[144:147], v[52:55]
    ds_read_b64_tr_b16 v[16:17], v4 offset:32768
    ds_read_b64_tr_b16 v[18:19], v4 offset:33280
    v_mfma_f32_16x16x32_bf16 v[68:71], v[20:23], v[148:151], v[68:71]
    s_add_u32 m0, s24, 114688
    s_add_u32 s30, s92, 18432
    buffer_load_dwordx4 v3, s[4:7], s30 offen lds
    s_add_u32 m0, s24, 122880
    s_add_u32 s30, s92, 27648
    buffer_load_dwordx4 v15, s[4:7], s30 offen lds
    v_mfma_f32_16x16x32_bf16 v[56:59], v[24:27], v[144:147], v[56:59]
    ds_read_b64_tr_b16 v[20:21], v5 offset:32768
    ds_read_b64_tr_b16 v[22:23], v5 offset:33280
    v_mfma_f32_16x16x32_bf16 v[72:75], v[24:27], v[148:151], v[72:75]
    v_mfma_f32_16x16x32_bf16 v[60:63], v[28:31], v[144:147], v[60:63]
    ds_read_b64_tr_b16 v[24:25], v6 offset:32768
    ds_read_b64_tr_b16 v[26:27], v6 offset:33280
    v_mfma_f32_16x16x32_bf16 v[76:79], v[28:31], v[148:151], v[76:79]
    s_waitcnt lgkmcnt(10)
    v_mfma_f32_16x16x32_bf16 v[48:51], v[32:35], v[152:155], v[48:51]
    ds_read_b64_tr_b16 v[28:29], v7 offset:32768
    ds_read_b64_tr_b16 v[30:31], v7 offset:33280
    v_mfma_f32_16x16x32_bf16 v[64:67], v[32:35], v[156:159], v[64:67]
    v_mfma_f32_16x16x32_bf16 v[52:55], v[36:39], v[152:155], v[52:55]
    ds_read_b64_tr_b16 v[32:33], v4 offset:36864
    ds_read_b64_tr_b16 v[34:35], v4 offset:37376
    v_mfma_f32_16x16x32_bf16 v[68:71], v[36:39], v[156:159], v[68:71]
    s_waitcnt lgkmcnt(10)
    v_mfma_f32_16x16x32_bf16 v[56:59], v[40:43], v[152:155], v[56:59]
    ds_read_b64_tr_b16 v[36:37], v5 offset:36864
    ds_read_b64_tr_b16 v[38:39], v5 offset:37376
    v_mfma_f32_16x16x32_bf16 v[72:75], v[40:43], v[156:159], v[72:75]
    v_mfma_f32_16x16x32_bf16 v[60:63], v[44:47], v[152:155], v[60:63]
    ds_read_b64_tr_b16 v[40:41], v6 offset:36864
    ds_read_b64_tr_b16 v[42:43], v6 offset:37376
    v_mfma_f32_16x16x32_bf16 v[76:79], v[44:47], v[156:159], v[76:79]
    s_waitcnt lgkmcnt(10)
    v_mfma_f32_16x16x32_bf16 v[80:83], v[16:19], v[128:131], v[80:83]
    ds_read_b64_tr_b16 v[44:45], v7 offset:36864
    ds_read_b64_tr_b16 v[46:47], v7 offset:37376
    v_mfma_f32_16x16x32_bf16 v[96:99], v[16:19], v[132:135], v[96:99]
    v_mfma_f32_16x16x32_bf16 v[84:87], v[20:23], v[128:131], v[84:87]
    ds_read_b64_tr_b16 v[16:17], v4 offset:40960
    ds_read_b64_tr_b16 v[18:19], v4 offset:41472
    v_mfma_f32_16x16x32_bf16 v[100:103], v[20:23], v[132:135], v[100:103]
    s_waitcnt lgkmcnt(10)
    v_mfma_f32_16x16x32_bf16 v[88:91], v[24:27], v[128:131], v[88:91]
    ds_read_b64_tr_b16 v[20:21], v5 offset:40960
    ds_read_b64_tr_b16 v[22:23], v5 offset:41472
    v_mfma_f32_16x16x32_bf16 v[104:107], v[24:27], v[132:135], v[104:107]
    v_mfma_f32_16x16x32_bf16 v[92:95], v[28:31], v[128:131], v[92:95]
    ds_read_b64_tr_b16 v[24:25], v6 offset:40960
    ds_read_b64_tr_b16 v[26:27], v6 offset:41472
    v_mfma_f32_16x16x32_bf16 v[108:111], v[28:31], v[132:135], v[108:111]
    s_waitcnt lgkmcnt(10)
    v_mfma_f32_16x16x32_bf16 v[80:83], v[32:35], v[136:139], v[80:83]
    ds_read_b64_tr_b16 v[28:29], v7 offset:40960
    ds_read_b64_tr_b16 v[30:31], v7 offset:41472
    v_mfma_f32_16x16x32_bf16 v[96:99], v[32:35], v[140:143], v[96:99]
    s_waitcnt vmcnt(4)
    ds_read_b128 v[160:163], v11 offset:32768
    ds_read_b128 v[164:167], v11 offset:49152
    ds_read_b128 v[168:171], v12 offset:32768
    ds_read_b128 v[172:175], v12 offset:49152
    v_mfma_f32_16x16x32_bf16 v[84:87], v[36:39], v[136:139], v[84:87]
    ds_read_b64_tr_b16 v[32:33], v4 offset:45056
    ds_read_b64_tr_b16 v[34:35], v4 offset:45568
    v_mfma_f32_16x16x32_bf16 v[100:103], v[36:39], v[140:143], v[100:103]
    s_waitcnt lgkmcnt(14)
    v_mfma_f32_16x16x32_bf16 v[88:91], v[40:43], v[136:139], v[88:91]
    ds_read_b64_tr_b16 v[36:37], v5 offset:45056
    ds_read_b64_tr_b16 v[38:39], v5 offset:45568
    v_mfma_f32_16x16x32_bf16 v[104:107], v[40:43], v[140:143], v[104:107]
    v_mfma_f32_16x16x32_bf16 v[92:95], v[44:47], v[136:139], v[92:95]
    ds_read_b64_tr_b16 v[40:41], v6 offset:45056
    ds_read_b64_tr_b16 v[42:43], v6 offset:45568
    v_mfma_f32_16x16x32_bf16 v[108:111], v[44:47], v[140:143], v[108:111]
    s_waitcnt lgkmcnt(14)
    s_waitcnt lgkmcnt(6)
    v_mfma_f32_16x16x32_bf16 v[48:51], v[16:19], v[160:163], v[48:51]
    ds_read_b64_tr_b16 v[44:45], v7 offset:45056
    ds_read_b64_tr_b16 v[46:47], v7 offset:45568
    v_mfma_f32_16x16x32_bf16 v[64:67], v[16:19], v[164:167], v[64:67]
    s_add_u32 m0, s24, 131072
    s_add_u32 s30, s93, 0
    buffer_load_dwordx4 v3, s[4:7], s30 offen lds
    s_add_u32 m0, s24, 139264
    s_add_u32 s30, s93, 9216
    buffer_load_dwordx4 v15, s[4:7], s30 offen lds
    v_mfma_f32_16x16x32_bf16 v[52:55], v[20:23], v[160:163], v[52:55]
    v_mfma_f32_16x16x32_bf16 v[68:71], v[20:23], v[164:167], v[68:71]
    s_barrier
    ds_read_b64_tr_b16 v[16:17], v4 offset:49152
    ds_read_b64_tr_b16 v[18:19], v4 offset:49664
    s_add_u32 m0, s24, 147456
    s_add_u32 s30, s93, 18432
    buffer_load_dwordx4 v3, s[4:7], s30 offen lds
    s_add_u32 m0, s24, 155648
    s_add_u32 s30, s93, 27648
    buffer_load_dwordx4 v15, s[4:7], s30 offen lds
    v_mfma_f32_16x16x32_bf16 v[56:59], v[24:27], v[160:163], v[56:59]
    ds_read_b64_tr_b16 v[20:21], v5 offset:49152
    ds_read_b64_tr_b16 v[22:23], v5 offset:49664
    v_mfma_f32_16x16x32_bf16 v[72:75], v[24:27], v[164:167], v[72:75]
    v_mfma_f32_16x16x32_bf16 v[60:63], v[28:31], v[160:163], v[60:63]
    ds_read_b64_tr_b16 v[24:25], v6 offset:49152
    ds_read_b64_tr_b16 v[26:27], v6 offset:49664
    v_mfma_f32_16x16x32_bf16 v[76:79], v[28:31], v[164:167], v[76:79]
    s_waitcnt lgkmcnt(10)
    v_mfma_f32_16x16x32_bf16 v[48:51], v[32:35], v[168:171], v[48:51]
    ds_read_b64_tr_b16 v[28:29], v7 offset:49152
    ds_read_b64_tr_b16 v[30:31], v7 offset:49664
    v_mfma_f32_16x16x32_bf16 v[64:67], v[32:35], v[172:175], v[64:67]
    s_waitcnt vmcnt(4)
    ds_read_b128 v[176:179], v11 offset:0
    ds_read_b128 v[180:183], v11 offset:16384
    ds_read_b128 v[184:187], v12 offset:0
    ds_read_b128 v[188:191], v12 offset:16384
    v_mfma_f32_16x16x32_bf16 v[52:55], v[36:39], v[168:171], v[52:55]
    ds_read_b64_tr_b16 v[32:33], v4 offset:53248
    ds_read_b64_tr_b16 v[34:35], v4 offset:53760
    v_mfma_f32_16x16x32_bf16 v[68:71], v[36:39], v[172:175], v[68:71]
    s_waitcnt lgkmcnt(14)
    v_mfma_f32_16x16x32_bf16 v[56:59], v[40:43], v[168:171], v[56:59]
    ds_read_b64_tr_b16 v[36:37], v5 offset:53248
    ds_read_b64_tr_b16 v[38:39], v5 offset:53760
    v_mfma_f32_16x16x32_bf16 v[72:75], v[40:43], v[172:175], v[72:75]
    v_mfma_f32_16x16x32_bf16 v[60:63], v[44:47], v[168:171], v[60:63]
    ds_read_b64_tr_b16 v[40:41], v6 offset:53248
    ds_read_b64_tr_b16 v[42:43], v6 offset:53760
    v_mfma_f32_16x16x32_bf16 v[76:79], v[44:47], v[172:175], v[76:79]
    s_waitcnt lgkmcnt(14)
    s_waitcnt lgkmcnt(6)
    v_mfma_f32_16x16x32_bf16 v[48:51], v[16:19], v[176:179], v[48:51]
    ds_read_b64_tr_b16 v[44:45], v7 offset:53248
    ds_read_b64_tr_b16 v[46:47], v7 offset:53760
    v_mfma_f32_16x16x32_bf16 v[64:67], v[16:19], v[180:183], v[64:67]
    s_add_u32 m0, s24, 98304
    s_add_u32 s30, s94, 0
    buffer_load_dwordx4 v3, s[4:7], s30 offen lds
    s_add_u32 m0, s24, 106496
    s_add_u32 s30, s94, 9216
    buffer_load_dwordx4 v15, s[4:7], s30 offen lds
    v_mfma_f32_16x16x32_bf16 v[52:55], v[20:23], v[176:179], v[52:55]
    ds_read_b64_tr_b16 v[16:17], v4 offset:57344
    ds_read_b64_tr_b16 v[18:19], v4 offset:57856
    v_mfma_f32_16x16x32_bf16 v[68:71], v[20:23], v[180:183], v[68:71]
    s_add_u32 m0, s24, 114688
    s_add_u32 s30, s94, 18432
    buffer_load_dwordx4 v3, s[4:7], s30 offen lds
    s_add_u32 m0, s24, 122880
    s_add_u32 s30, s94, 27648
    buffer_load_dwordx4 v15, s[4:7], s30 offen lds
    v_mfma_f32_16x16x32_bf16 v[56:59], v[24:27], v[176:179], v[56:59]
    ds_read_b64_tr_b16 v[20:21], v5 offset:57344
    ds_read_b64_tr_b16 v[22:23], v5 offset:57856
    v_mfma_f32_16x16x32_bf16 v[72:75], v[24:27], v[180:183], v[72:75]
    v_mfma_f32_16x16x32_bf16 v[60:63], v[28:31], v[176:179], v[60:63]
    ds_read_b64_tr_b16 v[24:25], v6 offset:57344
    ds_read_b64_tr_b16 v[26:27], v6 offset:57856
    v_mfma_f32_16x16x32_bf16 v[76:79], v[28:31], v[180:183], v[76:79]
    s_waitcnt lgkmcnt(10)
    v_mfma_f32_16x16x32_bf16 v[48:51], v[32:35], v[184:187], v[48:51]
    ds_read_b64_tr_b16 v[28:29], v7 offset:57344
    ds_read_b64_tr_b16 v[30:31], v7 offset:57856
    v_mfma_f32_16x16x32_bf16 v[64:67], v[32:35], v[188:191], v[64:67]
    v_mfma_f32_16x16x32_bf16 v[52:55], v[36:39], v[184:187], v[52:55]
    ds_read_b64_tr_b16 v[32:33], v4 offset:61440
    ds_read_b64_tr_b16 v[34:35], v4 offset:61952
    v_mfma_f32_16x16x32_bf16 v[68:71], v[36:39], v[188:191], v[68:71]
    s_waitcnt lgkmcnt(10)
    v_mfma_f32_16x16x32_bf16 v[56:59], v[40:43], v[184:187], v[56:59]
    ds_read_b64_tr_b16 v[36:37], v5 offset:61440
    ds_read_b64_tr_b16 v[38:39], v5 offset:61952
    v_mfma_f32_16x16x32_bf16 v[72:75], v[40:43], v[188:191], v[72:75]
    v_mfma_f32_16x16x32_bf16 v[60:63], v[44:47], v[184:187], v[60:63]
    ds_read_b64_tr_b16 v[40:41], v6 offset:61440
    ds_read_b64_tr_b16 v[42:43], v6 offset:61952
    v_mfma_f32_16x16x32_bf16 v[76:79], v[44:47], v[188:191], v[76:79]
    s_waitcnt lgkmcnt(10)
    v_mfma_f32_16x16x32_bf16 v[80:83], v[16:19], v[144:147], v[80:83]
    ds_read_b64_tr_b16 v[44:45], v7 offset:61440
    ds_read_b64_tr_b16 v[46:47], v7 offset:61952
    v_mfma_f32_16x16x32_bf16 v[96:99], v[16:19], v[148:151], v[96:99]
    v_mfma_f32_16x16x32_bf16 v[84:87], v[20:23], v[144:147], v[84:87]
    ds_read_b64_tr_b16 v[16:17], v8 offset:0
    ds_read_b64_tr_b16 v[18:19], v8 offset:512
    v_mfma_f32_16x16x32_bf16 v[100:103], v[20:23], v[148:151], v[100:103]
    s_waitcnt lgkmcnt(10)
    v_mfma_f32_16x16x32_bf16 v[88:91], v[24:27], v[144:147], v[88:91]
    ds_read_b64_tr_b16 v[20:21], v9 offset:0
    ds_read_b64_tr_b16 v[22:23], v9 offset:512
    v_mfma_f32_16x16x32_bf16 v[104:107], v[24:27], v[148:151], v[104:107]
    v_mfma_f32_16x16x32_bf16 v[92:95], v[28:31], v[144:147], v[92:95]
    ds_read_b64_tr_b16 v[24:25], v1 offset:0
    ds_read_b64_tr_b16 v[26:27], v1 offset:512
    v_mfma_f32_16x16x32_bf16 v[108:111], v[28:31], v[148:151], v[108:111]
    s_waitcnt lgkmcnt(10)
    v_mfma_f32_16x16x32_bf16 v[80:83], v[32:35], v[152:155], v[80:83]
    ds_read_b64_tr_b16 v[28:29], v0 offset:0
    ds_read_b64_tr_b16 v[30:31], v0 offset:512
    v_mfma_f32_16x16x32_bf16 v[96:99], v[32:35], v[156:159], v[96:99]
    s_waitcnt vmcnt(4)
    ds_read_b128 v[192:195], v11 offset:32768
    ds_read_b128 v[196:199], v11 offset:49152
    ds_read_b128 v[200:203], v12 offset:32768
    ds_read_b128 v[204:207], v12 offset:49152
    v_mfma_f32_16x16x32_bf16 v[84:87], v[36:39], v[152:155], v[84:87]
    ds_read_b64_tr_b16 v[32:33], v8 offset:4096
    ds_read_b64_tr_b16 v[34:35], v8 offset:4608
    v_mfma_f32_16x16x32_bf16 v[100:103], v[36:39], v[156:159], v[100:103]
    s_waitcnt lgkmcnt(14)
    v_mfma_f32_16x16x32_bf16 v[88:91], v[40:43], v[152:155], v[88:91]
    ds_read_b64_tr_b16 v[36:37], v9 offset:4096
    ds_read_b64_tr_b16 v[38:39], v9 offset:4608
    v_mfma_f32_16x16x32_bf16 v[104:107], v[40:43], v[156:159], v[104:107]
    v_mfma_f32_16x16x32_bf16 v[92:95], v[44:47], v[152:155], v[92:95]
    ds_read_b64_tr_b16 v[40:41], v1 offset:4096
    ds_read_b64_tr_b16 v[42:43], v1 offset:4608
    v_mfma_f32_16x16x32_bf16 v[108:111], v[44:47], v[156:159], v[108:111]
    s_waitcnt lgkmcnt(14)
    s_waitcnt lgkmcnt(6)
    v_mfma_f32_16x16x32_bf16 v[48:51], v[16:19], v[192:195], v[48:51]
    ds_read_b64_tr_b16 v[44:45], v0 offset:4096
    ds_read_b64_tr_b16 v[46:47], v0 offset:4608
    v_mfma_f32_16x16x32_bf16 v[64:67], v[16:19], v[196:199], v[64:67]
    s_add_u32 m0, s24, 131072
    s_add_u32 s30, s95, 0
    buffer_load_dwordx4 v3, s[4:7], s30 offen lds
    s_add_u32 m0, s24, 139264
    s_add_u32 s30, s95, 9216
    buffer_load_dwordx4 v15, s[4:7], s30 offen lds
    v_mfma_f32_16x16x32_bf16 v[52:55], v[20:23], v[192:195], v[52:55]
    v_mfma_f32_16x16x32_bf16 v[68:71], v[20:23], v[196:199], v[68:71]
    s_barrier
    ds_read_b64_tr_b16 v[16:17], v8 offset:8192
    ds_read_b64_tr_b16 v[18:19], v8 offset:8704
    s_add_u32 m0, s24, 147456
    s_add_u32 s30, s95, 18432
    buffer_load_dwordx4 v3, s[4:7], s30 offen lds
    s_add_u32 m0, s24, 155648
    s_add_u32 s30, s95, 27648
    buffer_load_dwordx4 v15, s[4:7], s30 offen lds
    v_mfma_f32_16x16x32_bf16 v[56:59], v[24:27], v[192:195], v[56:59]
    ds_read_b64_tr_b16 v[20:21], v9 offset:8192
    ds_read_b64_tr_b16 v[22:23], v9 offset:8704
    v_mfma_f32_16x16x32_bf16 v[72:75], v[24:27], v[196:199], v[72:75]
    v_mfma_f32_16x16x32_bf16 v[60:63], v[28:31], v[192:195], v[60:63]
    ds_read_b64_tr_b16 v[24:25], v1 offset:8192
    ds_read_b64_tr_b16 v[26:27], v1 offset:8704
    v_mfma_f32_16x16x32_bf16 v[76:79], v[28:31], v[196:199], v[76:79]
    s_waitcnt lgkmcnt(10)
    v_mfma_f32_16x16x32_bf16 v[48:51], v[32:35], v[200:203], v[48:51]
    ds_read_b64_tr_b16 v[28:29], v0 offset:8192
    ds_read_b64_tr_b16 v[30:31], v0 offset:8704
    v_mfma_f32_16x16x32_bf16 v[64:67], v[32:35], v[204:207], v[64:67]
    s_waitcnt vmcnt(4)
    ds_read_b128 v[208:211], v11 offset:0
    ds_read_b128 v[212:215], v11 offset:16384
    ds_read_b128 v[216:219], v12 offset:0
    ds_read_b128 v[220:223], v12 offset:16384
    v_mfma_f32_16x16x32_bf16 v[52:55], v[36:39], v[200:203], v[52:55]
    ds_read_b64_tr_b16 v[32:33], v8 offset:12288
    ds_read_b64_tr_b16 v[34:35], v8 offset:12800
    v_mfma_f32_16x16x32_bf16 v[68:71], v[36:39], v[204:207], v[68:71]
    s_waitcnt lgkmcnt(14)
    v_mfma_f32_16x16x32_bf16 v[56:59], v[40:43], v[200:203], v[56:59]
    ds_read_b64_tr_b16 v[36:37], v9 offset:12288
    ds_read_b64_tr_b16 v[38:39], v9 offset:12800
    v_mfma_f32_16x16x32_bf16 v[72:75], v[40:43], v[204:207], v[72:75]
    v_mfma_f32_16x16x32_bf16 v[60:63], v[44:47], v[200:203], v[60:63]
    ds_read_b64_tr_b16 v[40:41], v1 offset:12288
    ds_read_b64_tr_b16 v[42:43], v1 offset:12800
    v_mfma_f32_16x16x32_bf16 v[76:79], v[44:47], v[204:207], v[76:79]
    s_waitcnt lgkmcnt(14)
    s_waitcnt lgkmcnt(6)
    v_mfma_f32_16x16x32_bf16 v[48:51], v[16:19], v[208:211], v[48:51]
    ds_read_b64_tr_b16 v[44:45], v0 offset:12288
    ds_read_b64_tr_b16 v[46:47], v0 offset:12800
    v_mfma_f32_16x16x32_bf16 v[64:67], v[16:19], v[212:215], v[64:67]
    s_add_u32 m0, s24, 98304
    s_add_u32 s30, s96, 0
    buffer_load_dwordx4 v3, s[4:7], s30 offen lds
    s_add_u32 m0, s24, 106496
    s_add_u32 s30, s96, 9216
    buffer_load_dwordx4 v15, s[4:7], s30 offen lds
    v_mfma_f32_16x16x32_bf16 v[52:55], v[20:23], v[208:211], v[52:55]
    ds_read_b64_tr_b16 v[16:17], v8 offset:16384
    ds_read_b64_tr_b16 v[18:19], v8 offset:16896
    v_mfma_f32_16x16x32_bf16 v[68:71], v[20:23], v[212:215], v[68:71]
    s_add_u32 m0, s24, 114688
    s_add_u32 s30, s96, 18432
    buffer_load_dwordx4 v3, s[4:7], s30 offen lds
    s_add_u32 m0, s24, 122880
    s_add_u32 s30, s96, 27648
    buffer_load_dwordx4 v15, s[4:7], s30 offen lds
    v_mfma_f32_16x16x32_bf16 v[56:59], v[24:27], v[208:211], v[56:59]
    ds_read_b64_tr_b16 v[20:21], v9 offset:16384
    ds_read_b64_tr_b16 v[22:23], v9 offset:16896
    v_mfma_f32_16x16x32_bf16 v[72:75], v[24:27], v[212:215], v[72:75]
    v_mfma_f32_16x16x32_bf16 v[60:63], v[28:31], v[208:211], v[60:63]
    ds_read_b64_tr_b16 v[24:25], v1 offset:16384
    ds_read_b64_tr_b16 v[26:27], v1 offset:16896
    v_mfma_f32_16x16x32_bf16 v[76:79], v[28:31], v[212:215], v[76:79]
    s_waitcnt lgkmcnt(10)
    v_mfma_f32_16x16x32_bf16 v[48:51], v[32:35], v[216:219], v[48:51]
    ds_read_b64_tr_b16 v[28:29], v0 offset:16384
    ds_read_b64_tr_b16 v[30:31], v0 offset:16896
    v_mfma_f32_16x16x32_bf16 v[64:67], v[32:35], v[220:223], v[64:67]
    v_mfma_f32_16x16x32_bf16 v[52:55], v[36:39], v[216:219], v[52:55]
    ds_read_b64_tr_b16 v[32:33], v8 offset:20480
    ds_read_b64_tr_b16 v[34:35], v8 offset:20992
    v_mfma_f32_16x16x32_bf16 v[68:71], v[36:39], v[220:223], v[68:71]
    s_waitcnt lgkmcnt(10)
    v_mfma_f32_16x16x32_bf16 v[56:59], v[40:43], v[216:219], v[56:59]
    ds_read_b64_tr_b16 v[36:37], v9 offset:20480
    ds_read_b64_tr_b16 v[38:39], v9 offset:20992
    v_mfma_f32_16x16x32_bf16 v[72:75], v[40:43], v[220:223], v[72:75]
    v_mfma_f32_16x16x32_bf16 v[60:63], v[44:47], v[216:219], v[60:63]
    ds_read_b64_tr_b16 v[40:41], v1 offset:20480
    ds_read_b64_tr_b16 v[42:43], v1 offset:20992
    v_mfma_f32_16x16x32_bf16 v[76:79], v[44:47], v[220:223], v[76:79]
    s_waitcnt lgkmcnt(10)
    v_mfma_f32_16x16x32_bf16 v[80:83], v[16:19], v[160:163], v[80:83]
    ds_read_b64_tr_b16 v[44:45], v0 offset:20480
    ds_read_b64_tr_b16 v[46:47], v0 offset:20992
    v_mfma_f32_16x16x32_bf16 v[96:99], v[16:19], v[164:167], v[96:99]
    v_mfma_f32_16x16x32_bf16 v[84:87], v[20:23], v[160:163], v[84:87]
    ds_read_b64_tr_b16 v[16:17], v8 offset:24576
    ds_read_b64_tr_b16 v[18:19], v8 offset:25088
    v_mfma_f32_16x16x32_bf16 v[100:103], v[20:23], v[164:167], v[100:103]
    s_waitcnt lgkmcnt(10)
    v_mfma_f32_16x16x32_bf16 v[88:91], v[24:27], v[160:163], v[88:91]
    ds_read_b64_tr_b16 v[20:21], v9 offset:24576
    ds_read_b64_tr_b16 v[22:23], v9 offset:25088
    v_mfma_f32_16x16x32_bf16 v[104:107], v[24:27], v[164:167], v[104:107]
    v_mfma_f32_16x16x32_bf16 v[92:95], v[28:31], v[160:163], v[92:95]
    ds_read_b64_tr_b16 v[24:25], v1 offset:24576
    ds_read_b64_tr_b16 v[26:27], v1 offset:25088
    v_mfma_f32_16x16x32_bf16 v[108:111], v[28:31], v[164:167], v[108:111]
    s_waitcnt lgkmcnt(10)
    v_mfma_f32_16x16x32_bf16 v[80:83], v[32:35], v[168:171], v[80:83]
    ds_read_b64_tr_b16 v[28:29], v0 offset:24576
    ds_read_b64_tr_b16 v[30:31], v0 offset:25088
    v_mfma_f32_16x16x32_bf16 v[96:99], v[32:35], v[172:175], v[96:99]
    s_waitcnt vmcnt(4)
    ds_read_b128 v[224:227], v11 offset:32768
    ds_read_b128 v[228:231], v11 offset:49152
    ds_read_b128 v[232:235], v12 offset:32768
    ds_read_b128 v[236:239], v12 offset:49152
    v_mfma_f32_16x16x32_bf16 v[84:87], v[36:39], v[168:171], v[84:87]
    ds_read_b64_tr_b16 v[32:33], v8 offset:28672
    ds_read_b64_tr_b16 v[34:35], v8 offset:29184
    v_mfma_f32_16x16x32_bf16 v[100:103], v[36:39], v[172:175], v[100:103]
    s_waitcnt lgkmcnt(14)
    v_mfma_f32_16x16x32_bf16 v[88:91], v[40:43], v[168:171], v[88:91]
    ds_read_b64_tr_b16 v[36:37], v9 offset:28672
    ds_read_b64_tr_b16 v[38:39], v9 offset:29184
    v_mfma_f32_16x16x32_bf16 v[104:107], v[40:43], v[172:175], v[104:107]
    v_mfma_f32_16x16x32_bf16 v[92:95], v[44:47], v[168:171], v[92:95]
    ds_read_b64_tr_b16 v[40:41], v1 offset:28672
    ds_read_b64_tr_b16 v[42:43], v1 offset:29184
    v_mfma_f32_16x16x32_bf16 v[108:111], v[44:47], v[172:175], v[108:111]
    s_waitcnt lgkmcnt(14)
    s_waitcnt lgkmcnt(6)
    v_mfma_f32_16x16x32_bf16 v[48:51], v[16:19], v[224:227], v[48:51]
    ds_read_b64_tr_b16 v[44:45], v0 offset:28672
    ds_read_b64_tr_b16 v[46:47], v0 offset:29184
    v_mfma_f32_16x16x32_bf16 v[64:67], v[16:19], v[228:231], v[64:67]
    v_mfma_f32_16x16x32_bf16 v[52:55], v[20:23], v[224:227], v[52:55]
    v_mfma_f32_16x16x32_bf16 v[68:71], v[20:23], v[228:231], v[68:71]
    s_barrier
    ds_read_b64_tr_b16 v[16:17], v4 offset:0
    ds_read_b64_tr_b16 v[18:19], v4 offset:512
    v_mfma_f32_16x16x32_bf16 v[56:59], v[24:27], v[224:227], v[56:59]
    ds_read_b64_tr_b16 v[20:21], v5 offset:0
    ds_read_b64_tr_b16 v[22:23], v5 offset:512
    v_mfma_f32_16x16x32_bf16 v[72:75], v[24:27], v[228:231], v[72:75]
    v_mfma_f32_16x16x32_bf16 v[60:63], v[28:31], v[224:227], v[60:63]
    ds_read_b64_tr_b16 v[24:25], v6 offset:0
    ds_read_b64_tr_b16 v[26:27], v6 offset:512
    v_mfma_f32_16x16x32_bf16 v[76:79], v[28:31], v[228:231], v[76:79]
    s_waitcnt lgkmcnt(10)
    v_mfma_f32_16x16x32_bf16 v[48:51], v[32:35], v[232:235], v[48:51]
    ds_read_b64_tr_b16 v[28:29], v7 offset:0
    ds_read_b64_tr_b16 v[30:31], v7 offset:512
    v_mfma_f32_16x16x32_bf16 v[64:67], v[32:35], v[236:239], v[64:67]
    s_waitcnt vmcnt(0)
    ds_read_b128 v[240:243], v11 offset:0
    ds_read_b128 v[244:247], v11 offset:16384
    ds_read_b128 v[248:251], v12 offset:0
    ds_read_b128 v[252:255], v12 offset:16384
    v_mfma_f32_16x16x32_bf16 v[52:55], v[36:39], v[232:235], v[52:55]
    ds_read_b64_tr_b16 v[32:33], v4 offset:4096
    ds_read_b64_tr_b16 v[34:35], v4 offset:4608
    v_mfma_f32_16x16x32_bf16 v[68:71], v[36:39], v[236:239], v[68:71]
    s_waitcnt lgkmcnt(14)
    v_mfma_f32_16x16x32_bf16 v[56:59], v[40:43], v[232:235], v[56:59]
    ds_read_b64_tr_b16 v[36:37], v5 offset:4096
    ds_read_b64_tr_b16 v[38:39], v5 offset:4608
    v_mfma_f32_16x16x32_bf16 v[72:75], v[40:43], v[236:239], v[72:75]
    v_mfma_f32_16x16x32_bf16 v[60:63], v[44:47], v[232:235], v[60:63]
    ds_read_b64_tr_b16 v[40:41], v6 offset:4096
    ds_read_b64_tr_b16 v[42:43], v6 offset:4608
    v_mfma_f32_16x16x32_bf16 v[76:79], v[44:47], v[236:239], v[76:79]
    s_waitcnt lgkmcnt(14)
    s_waitcnt lgkmcnt(6)
    v_mfma_f32_16x16x32_bf16 v[48:51], v[16:19], v[240:243], v[48:51]
    ds_read_b64_tr_b16 v[44:45], v7 offset:4096
    ds_read_b64_tr_b16 v[46:47], v7 offset:4608
    v_mfma_f32_16x16x32_bf16 v[64:67], v[16:19], v[244:247], v[64:67]
    v_mfma_f32_16x16x32_bf16 v[52:55], v[20:23], v[240:243], v[52:55]
    ds_read_b64_tr_b16 v[16:17], v4 offset:8192
    ds_read_b64_tr_b16 v[18:19], v4 offset:8704
    v_mfma_f32_16x16x32_bf16 v[68:71], v[20:23], v[244:247], v[68:71]
    v_mfma_f32_16x16x32_bf16 v[56:59], v[24:27], v[240:243], v[56:59]
    ds_read_b64_tr_b16 v[20:21], v5 offset:8192
    ds_read_b64_tr_b16 v[22:23], v5 offset:8704
    v_mfma_f32_16x16x32_bf16 v[72:75], v[24:27], v[244:247], v[72:75]
    v_mfma_f32_16x16x32_bf16 v[60:63], v[28:31], v[240:243], v[60:63]
    ds_read_b64_tr_b16 v[24:25], v6 offset:8192
    ds_read_b64_tr_b16 v[26:27], v6 offset:8704
    v_mfma_f32_16x16x32_bf16 v[76:79], v[28:31], v[244:247], v[76:79]
    s_waitcnt lgkmcnt(10)
    v_mfma_f32_16x16x32_bf16 v[48:51], v[32:35], v[248:251], v[48:51]
    ds_read_b64_tr_b16 v[28:29], v7 offset:8192
    ds_read_b64_tr_b16 v[30:31], v7 offset:8704
    v_mfma_f32_16x16x32_bf16 v[64:67], v[32:35], v[252:255], v[64:67]
    v_mfma_f32_16x16x32_bf16 v[52:55], v[36:39], v[248:251], v[52:55]
    ds_read_b64_tr_b16 v[32:33], v4 offset:12288
    ds_read_b64_tr_b16 v[34:35], v4 offset:12800
    v_mfma_f32_16x16x32_bf16 v[68:71], v[36:39], v[252:255], v[68:71]
    s_waitcnt lgkmcnt(10)
    v_mfma_f32_16x16x32_bf16 v[56:59], v[40:43], v[248:251], v[56:59]
    ds_read_b64_tr_b16 v[36:37], v5 offset:12288
    ds_read_b64_tr_b16 v[38:39], v5 offset:12800
    v_mfma_f32_16x16x32_bf16 v[72:75], v[40:43], v[252:255], v[72:75]
    v_mfma_f32_16x16x32_bf16 v[60:63], v[44:47], v[248:251], v[60:63]
    ds_read_b64_tr_b16 v[40:41], v6 offset:12288
    ds_read_b64_tr_b16 v[42:43], v6 offset:12800
    v_mfma_f32_16x16x32_bf16 v[76:79], v[44:47], v[252:255], v[76:79]
    v_mov_b32 v15, v13
    s_waitcnt lgkmcnt(10)
    v_mfma_f32_16x16x32_bf16 v[80:83], v[16:19], v[176:179], v[80:83]
    ds_read_b64_tr_b16 v[44:45], v7 offset:12288
    ds_read_b64_tr_b16 v[46:47], v7 offset:12800
    v_mfma_f32_16x16x32_bf16 v[96:99], v[16:19], v[180:183], v[96:99]
    v_mfma_f32_16x16x32_bf16 v[84:87], v[20:23], v[176:179], v[84:87]
    ds_read_b64_tr_b16 v[16:17], v4 offset:16384
    ds_read_b64_tr_b16 v[18:19], v4 offset:16896
    v_mfma_f32_16x16x32_bf16 v[100:103], v[20:23], v[180:183], v[100:103]
    s_waitcnt lgkmcnt(10)
    v_mfma_f32_16x16x32_bf16 v[88:91], v[24:27], v[176:179], v[88:91]
    ds_read_b64_tr_b16 v[20:21], v5 offset:16384
    ds_read_b64_tr_b16 v[22:23], v5 offset:16896
    v_mfma_f32_16x16x32_bf16 v[104:107], v[24:27], v[180:183], v[104:107]
    v_mfma_f32_16x16x32_bf16 v[92:95], v[28:31], v[176:179], v[92:95]
    ds_read_b64_tr_b16 v[24:25], v6 offset:16384
    ds_read_b64_tr_b16 v[26:27], v6 offset:16896
    v_mfma_f32_16x16x32_bf16 v[108:111], v[28:31], v[180:183], v[108:111]
    v_mul_f32 v11, v48, v48
    v_mul_f32 v12, v49, v49
    v_mul_f32 v13, v50, v50
    v_mul_f32 v14, v51, v51
    v_fma_f32 v11, v11, s26, v10
    v_fma_f32 v12, v12, s26, v10
    v_fma_f32 v13, v13, s26, v10
    s_waitcnt lgkmcnt(10)
    v_mfma_f32_16x16x32_bf16 v[80:83], v[32:35], v[184:187], v[80:83]
    ds_read_b64_tr_b16 v[28:29], v7 offset:16384
    ds_read_b64_tr_b16 v[30:31], v7 offset:16896
    v_mfma_f32_16x16x32_bf16 v[96:99], v[32:35], v[188:191], v[96:99]
    v_fma_f32 v14, v14, s26, v10
    v_mul_f32 v11, v11, v48
    v_mul_f32 v12, v12, v49
    v_mul_f32 v13, v13, v50
    v_mul_f32 v14, v14, v51
    v_exp_f32 v11, v11
    v_mfma_f32_16x16x32_bf16 v[84:87], v[36:39], v[184:187], v[84:87]
    ds_read_b64_tr_b16 v[32:33], v4 offset:20480
    ds_read_b64_tr_b16 v[34:35], v4 offset:20992
    v_mfma_f32_16x16x32_bf16 v[100:103], v[36:39], v[188:191], v[100:103]
    v_exp_f32 v12, v12
    v_exp_f32 v13, v13
    v_exp_f32 v14, v14
    v_add_f32 v11, 1.0, v11
    v_add_f32 v12, 1.0, v12
    v_add_f32 v13, 1.0, v13
    s_waitcnt lgkmcnt(10)
    v_mfma_f32_16x16x32_bf16 v[88:91], v[40:43], v[184:187], v[88:91]
    ds_read_b64_tr_b16 v[36:37], v5 offset:20480
    ds_read_b64_tr_b16 v[38:39], v5 offset:20992
    v_mfma_f32_16x16x32_bf16 v[104:107], v[40:43], v[188:191], v[104:107]
    v_add_f32 v14, 1.0, v14
    v_rcp_f32 v11, v11
    v_rcp_f32 v12, v12
    v_rcp_f32 v13, v13
    v_rcp_f32 v14, v14
    v_mul_f32 v48, v11, v48
    v_mfma_f32_16x16x32_bf16 v[92:95], v[44:47], v[184:187], v[92:95]
    ds_read_b64_tr_b16 v[40:41], v6 offset:20480
    ds_read_b64_tr_b16 v[42:43], v6 offset:20992
    v_mfma_f32_16x16x32_bf16 v[108:111], v[44:47], v[188:191], v[108:111]
    v_mul_f32 v49, v12, v49
    v_mul_f32 v50, v13, v50
    v_mul_f32 v51, v14, v51
    v_mul_f32 v11, v52, v52
    v_mul_f32 v12, v53, v53
    v_mul_f32 v13, v54, v54
    v_mul_f32 v14, v55, v55
    s_waitcnt lgkmcnt(10)
    v_mfma_f32_16x16x32_bf16 v[80:83], v[16:19], v[192:195], v[80:83]
    ds_read_b64_tr_b16 v[44:45], v7 offset:20480
    ds_read_b64_tr_b16 v[46:47], v7 offset:20992
    v_mfma_f32_16x16x32_bf16 v[96:99], v[16:19], v[196:199], v[96:99]
    v_fma_f32 v11, v11, s26, v10
    v_fma_f32 v12, v12, s26, v10
    v_fma_f32 v13, v13, s26, v10
    v_fma_f32 v14, v14, s26, v10
    v_mul_f32 v11, v11, v52
    v_mul_f32 v12, v12, v53
    v_mfma_f32_16x16x32_bf16 v[84:87], v[20:23], v[192:195], v[84:87]
    v_mfma_f32_16x16x32_bf16 v[100:103], v[20:23], v[196:199], v[100:103]
    s_barrier
    ds_read_b64_tr_b16 v[16:17], v4 offset:24576
    ds_read_b64_tr_b16 v[18:19], v4 offset:25088
    v_mul_f32 v13, v13, v54
    v_mul_f32 v14, v14, v55
    v_exp_f32 v11, v11
    v_exp_f32 v12, v12
    v_exp_f32 v13, v13
    v_exp_f32 v14, v14
    s_waitcnt lgkmcnt(10)
    v_mfma_f32_16x16x32_bf16 v[88:91], v[24:27], v[192:195], v[88:91]
    ds_read_b64_tr_b16 v[20:21], v5 offset:24576
    ds_read_b64_tr_b16 v[22:23], v5 offset:25088
    v_mfma_f32_16x16x32_bf16 v[104:107], v[24:27], v[196:199], v[104:107]
    v_add_f32 v11, 1.0, v11
    v_add_f32 v12, 1.0, v12
    v_add_f32 v13, 1.0, v13
    v_add_f32 v14, 1.0, v14
    v_rcp_f32 v11, v11
    v_rcp_f32 v12, v12
    v_mfma_f32_16x16x32_bf16 v[92:95], v[28:31], v[192:195], v[92:95]
    ds_read_b64_tr_b16 v[24:25], v6 offset:24576
    ds_read_b64_tr_b16 v[26:27], v6 offset:25088
    v_mfma_f32_16x16x32_bf16 v[108:111], v[28:31], v[196:199], v[108:111]
    v_rcp_f32 v13, v13
    v_rcp_f32 v14, v14
    v_mul_f32 v52, v11, v52
    v_mul_f32 v53, v12, v53
    v_mul_f32 v54, v13, v54
    v_mul_f32 v55, v14, v55
    s_waitcnt lgkmcnt(10)
    v_mfma_f32_16x16x32_bf16 v[80:83], v[32:35], v[200:203], v[80:83]
    ds_read_b64_tr_b16 v[28:29], v7 offset:24576
    ds_read_b64_tr_b16 v[30:31], v7 offset:25088
    v_mfma_f32_16x16x32_bf16 v[96:99], v[32:35], v[204:207], v[96:99]
    v_mul_f32 v11, v56, v56
    v_mul_f32 v12, v57, v57
    v_mul_f32 v13, v58, v58
    v_mul_f32 v14, v59, v59
    v_fma_f32 v11, v11, s26, v10
    v_fma_f32 v12, v12, s26, v10
    v_fma_f32 v13, v13, s26, v10
    v_mfma_f32_16x16x32_bf16 v[84:87], v[36:39], v[200:203], v[84:87]
    ds_read_b64_tr_b16 v[32:33], v4 offset:28672
    ds_read_b64_tr_b16 v[34:35], v4 offset:29184
    v_mfma_f32_16x16x32_bf16 v[100:103], v[36:39], v[204:207], v[100:103]
    v_fma_f32 v14, v14, s26, v10
    v_mul_f32 v11, v11, v56
    v_mul_f32 v12, v12, v57
    v_mul_f32 v13, v13, v58
    v_mul_f32 v14, v14, v59
    v_exp_f32 v11, v11
    s_waitcnt lgkmcnt(10)
    v_mfma_f32_16x16x32_bf16 v[88:91], v[40:43], v[200:203], v[88:91]
    ds_read_b64_tr_b16 v[36:37], v5 offset:28672
    ds_read_b64_tr_b16 v[38:39], v5 offset:29184
    v_mfma_f32_16x16x32_bf16 v[104:107], v[40:43], v[204:207], v[104:107]
    v_exp_f32 v12, v12
    v_exp_f32 v13, v13
    v_exp_f32 v14, v14
    v_add_f32 v11, 1.0, v11
    v_add_f32 v12, 1.0, v12
    v_add_f32 v13, 1.0, v13
    v_mfma_f32_16x16x32_bf16 v[92:95], v[44:47], v[200:203], v[92:95]
    ds_read_b64_tr_b16 v[40:41], v6 offset:28672
    ds_read_b64_tr_b16 v[42:43], v6 offset:29184
    v_mfma_f32_16x16x32_bf16 v[108:111], v[44:47], v[204:207], v[108:111]
    v_add_f32 v14, 1.0, v14
    v_rcp_f32 v11, v11
    v_rcp_f32 v12, v12
    v_rcp_f32 v13, v13
    v_rcp_f32 v14, v14
    v_mul_f32 v56, v11, v56
    s_waitcnt lgkmcnt(10)
    v_mfma_f32_16x16x32_bf16 v[80:83], v[16:19], v[208:211], v[80:83]
    ds_read_b64_tr_b16 v[44:45], v7 offset:28672
    ds_read_b64_tr_b16 v[46:47], v7 offset:29184
    v_mfma_f32_16x16x32_bf16 v[96:99], v[16:19], v[212:215], v[96:99]
    v_mul_f32 v57, v12, v57
    v_mul_f32 v58, v13, v58
    v_mul_f32 v59, v14, v59
    v_mul_f32 v11, v60, v60
    v_mul_f32 v12, v61, v61
    v_mul_f32 v13, v62, v62
    v_mul_f32 v14, v63, v63
    v_mfma_f32_16x16x32_bf16 v[84:87], v[20:23], v[208:211], v[84:87]
    ds_read_b64_tr_b16 v[16:17], v4 offset:32768
    ds_read_b64_tr_b16 v[18:19], v4 offset:33280
    v_mfma_f32_16x16x32_bf16 v[100:103], v[20:23], v[212:215], v[100:103]
    v_fma_f32 v11, v11, s26, v10
    v_fma_f32 v12, v12, s26, v10
    v_fma_f32 v13, v13, s26, v10
    v_fma_f32 v14, v14, s26, v10
    v_mul_f32 v11, v11, v60
    v_mul_f32 v12, v12, v61
    s_waitcnt lgkmcnt(10)
    v_mfma_f32_16x16x32_bf16 v[88:91], v[24:27], v[208:211], v[88:91]
    ds_read_b64_tr_b16 v[20:21], v5 offset:32768
    ds_read_b64_tr_b16 v[22:23], v5 offset:33280
    v_mfma_f32_16x16x32_bf16 v[104:107], v[24:27], v[212:215], v[104:107]
    v_mul_f32 v13, v13, v62
    v_mul_f32 v14, v14, v63
    v_exp_f32 v11, v11
    v_exp_f32 v12, v12
    v_exp_f32 v13, v13
    v_exp_f32 v14, v14
    v_mfma_f32_16x16x32_bf16 v[92:95], v[28:31], v[208:211], v[92:95]
    ds_read_b64_tr_b16 v[24:25], v6 offset:32768
    ds_read_b64_tr_b16 v[26:27], v6 offset:33280
    v_mfma_f32_16x16x32_bf16 v[108:111], v[28:31], v[212:215], v[108:111]
    v_add_f32 v11, 1.0, v11
    v_add_f32 v12, 1.0, v12
    v_add_f32 v13, 1.0, v13
    v_add_f32 v14, 1.0, v14
    v_rcp_f32 v11, v11
    v_rcp_f32 v12, v12
    s_waitcnt lgkmcnt(10)
    v_mfma_f32_16x16x32_bf16 v[80:83], v[32:35], v[216:219], v[80:83]
    ds_read_b64_tr_b16 v[28:29], v7 offset:32768
    ds_read_b64_tr_b16 v[30:31], v7 offset:33280
    v_mfma_f32_16x16x32_bf16 v[96:99], v[32:35], v[220:223], v[96:99]
    v_rcp_f32 v13, v13
    v_rcp_f32 v14, v14
    v_mul_f32 v60, v11, v60
    v_mul_f32 v61, v12, v61
    v_mul_f32 v62, v13, v62
    v_mul_f32 v63, v14, v63
    v_mfma_f32_16x16x32_bf16 v[84:87], v[36:39], v[216:219], v[84:87]
    ds_read_b64_tr_b16 v[32:33], v4 offset:36864
    ds_read_b64_tr_b16 v[34:35], v4 offset:37376
    v_mfma_f32_16x16x32_bf16 v[100:103], v[36:39], v[220:223], v[100:103]
    v_mul_f32 v11, v64, v64
    v_mul_f32 v12, v65, v65
    v_mul_f32 v13, v66, v66
    v_mul_f32 v14, v67, v67
    v_fma_f32 v11, v11, s26, v10
    v_fma_f32 v12, v12, s26, v10
    v_fma_f32 v13, v13, s26, v10
    s_waitcnt lgkmcnt(10)
    v_mfma_f32_16x16x32_bf16 v[88:91], v[40:43], v[216:219], v[88:91]
    ds_read_b64_tr_b16 v[36:37], v5 offset:36864
    ds_read_b64_tr_b16 v[38:39], v5 offset:37376
    v_mfma_f32_16x16x32_bf16 v[104:107], v[40:43], v[220:223], v[104:107]
    v_fma_f32 v14, v14, s26, v10
    v_mul_f32 v11, v11, v64
    v_mul_f32 v12, v12, v65
    v_mul_f32 v13, v13, v66
    v_mul_f32 v14, v14, v67
    v_exp_f32 v11, v11
    v_mfma_f32_16x16x32_bf16 v[92:95], v[44:47], v[216:219], v[92:95]
    ds_read_b64_tr_b16 v[40:41], v6 offset:36864
    ds_read_b64_tr_b16 v[42:43], v6 offset:37376
    v_mfma_f32_16x16x32_bf16 v[108:111], v[44:47], v[220:223], v[108:111]
    v_exp_f32 v12, v12
    v_exp_f32 v13, v13
    v_exp_f32 v14, v14
    v_add_f32 v11, 1.0, v11
    v_add_f32 v12, 1.0, v12
    v_add_f32 v13, 1.0, v13
    s_waitcnt lgkmcnt(10)
    v_mfma_f32_16x16x32_bf16 v[80:83], v[16:19], v[224:227], v[80:83]
    ds_read_b64_tr_b16 v[44:45], v7 offset:36864
    ds_read_b64_tr_b16 v[46:47], v7 offset:37376
    v_mfma_f32_16x16x32_bf16 v[96:99], v[16:19], v[228:231], v[96:99]
    v_add_f32 v14, 1.0, v14
    v_rcp_f32 v11, v11
    v_rcp_f32 v12, v12
    v_rcp_f32 v13, v13
    v_rcp_f32 v14, v14
    v_mul_f32 v64, v11, v64
    v_mfma_f32_16x16x32_bf16 v[84:87], v[20:23], v[224:227], v[84:87]
    ds_read_b64_tr_b16 v[16:17], v4 offset:40960
    ds_read_b64_tr_b16 v[18:19], v4 offset:41472
    v_mfma_f32_16x16x32_bf16 v[100:103], v[20:23], v[228:231], v[100:103]
    v_mul_f32 v65, v12, v65
    v_mul_f32 v66, v13, v66
    v_mul_f32 v67, v14, v67
    v_mul_f32 v11, v68, v68
    v_mul_f32 v12, v69, v69
    v_mul_f32 v13, v70, v70
    v_mul_f32 v14, v71, v71
    s_waitcnt lgkmcnt(10)
    v_mfma_f32_16x16x32_bf16 v[88:91], v[24:27], v[224:227], v[88:91]
    ds_read_b64_tr_b16 v[20:21], v5 offset:40960
    ds_read_b64_tr_b16 v[22:23], v5 offset:41472
    v_mfma_f32_16x16x32_bf16 v[104:107], v[24:27], v[228:231], v[104:107]
    v_fma_f32 v11, v11, s26, v10
    v_fma_f32 v12, v12, s26, v10
    v_fma_f32 v13, v13, s26, v10
    v_fma_f32 v14, v14, s26, v10
    v_mul_f32 v11, v11, v68
    v_mul_f32 v12, v12, v69
    v_mfma_f32_16x16x32_bf16 v[92:95], v[28:31], v[224:227], v[92:95]
    ds_read_b64_tr_b16 v[24:25], v6 offset:40960
    ds_read_b64_tr_b16 v[26:27], v6 offset:41472
    v_mfma_f32_16x16x32_bf16 v[108:111], v[28:31], v[228:231], v[108:111]
    v_mul_f32 v13, v13, v70
    v_mul_f32 v14, v14, v71
    v_exp_f32 v11, v11
    v_exp_f32 v12, v12
    v_exp_f32 v13, v13
    v_exp_f32 v14, v14
    s_waitcnt lgkmcnt(10)
    v_mfma_f32_16x16x32_bf16 v[80:83], v[32:35], v[232:235], v[80:83]
    ds_read_b64_tr_b16 v[28:29], v7 offset:40960
    ds_read_b64_tr_b16 v[30:31], v7 offset:41472
    v_mfma_f32_16x16x32_bf16 v[96:99], v[32:35], v[236:239], v[96:99]
    v_add_f32 v11, 1.0, v11
    v_add_f32 v12, 1.0, v12
    v_add_f32 v13, 1.0, v13
    v_add_f32 v14, 1.0, v14
    v_rcp_f32 v11, v11
    v_rcp_f32 v12, v12
    v_mfma_f32_16x16x32_bf16 v[84:87], v[36:39], v[232:235], v[84:87]
    ds_read_b64_tr_b16 v[32:33], v4 offset:45056
    ds_read_b64_tr_b16 v[34:35], v4 offset:45568
    v_mfma_f32_16x16x32_bf16 v[100:103], v[36:39], v[236:239], v[100:103]
    v_rcp_f32 v13, v13
    v_rcp_f32 v14, v14
    v_mul_f32 v68, v11, v68
    v_mul_f32 v69, v12, v69
    v_mul_f32 v70, v13, v70
    v_mul_f32 v71, v14, v71
    s_waitcnt lgkmcnt(10)
    v_mfma_f32_16x16x32_bf16 v[88:91], v[40:43], v[232:235], v[88:91]
    ds_read_b64_tr_b16 v[36:37], v5 offset:45056
    ds_read_b64_tr_b16 v[38:39], v5 offset:45568
    v_mfma_f32_16x16x32_bf16 v[104:107], v[40:43], v[236:239], v[104:107]
    v_mul_f32 v11, v72, v72
    v_mul_f32 v12, v73, v73
    v_mul_f32 v13, v74, v74
    v_mul_f32 v14, v75, v75
    v_fma_f32 v11, v11, s26, v10
    v_fma_f32 v12, v12, s26, v10
    v_fma_f32 v13, v13, s26, v10
    v_mfma_f32_16x16x32_bf16 v[92:95], v[44:47], v[232:235], v[92:95]
    ds_read_b64_tr_b16 v[40:41], v6 offset:45056
    ds_read_b64_tr_b16 v[42:43], v6 offset:45568
    v_mfma_f32_16x16x32_bf16 v[108:111], v[44:47], v[236:239], v[108:111]
    v_fma_f32 v14, v14, s26, v10
    v_mul_f32 v11, v11, v72
    v_mul_f32 v12, v12, v73
    v_mul_f32 v13, v13, v74
    v_mul_f32 v14, v14, v75
    v_exp_f32 v11, v11
    s_waitcnt lgkmcnt(10)
    v_mfma_f32_16x16x32_bf16 v[80:83], v[16:19], v[240:243], v[80:83]
    ds_read_b64_tr_b16 v[44:45], v7 offset:45056
    ds_read_b64_tr_b16 v[46:47], v7 offset:45568
    v_mfma_f32_16x16x32_bf16 v[96:99], v[16:19], v[244:247], v[96:99]
    v_exp_f32 v12, v12
    v_exp_f32 v13, v13
    v_exp_f32 v14, v14
    v_add_f32 v11, 1.0, v11
    v_add_f32 v12, 1.0, v12
    v_add_f32 v13, 1.0, v13
    v_mfma_f32_16x16x32_bf16 v[84:87], v[20:23], v[240:243], v[84:87]
    ds_read_b64_tr_b16 v[16:17], v4 offset:49152
    ds_read_b64_tr_b16 v[18:19], v4 offset:49664
    v_mfma_f32_16x16x32_bf16 v[100:103], v[20:23], v[244:247], v[100:103]
    v_add_f32 v14, 1.0, v14
    v_rcp_f32 v11, v11
    v_rcp_f32 v12, v12
    v_rcp_f32 v13, v13
    v_rcp_f32 v14, v14
    v_mul_f32 v72, v11, v72
    s_waitcnt lgkmcnt(10)
    v_mfma_f32_16x16x32_bf16 v[88:91], v[24:27], v[240:243], v[88:91]
    ds_read_b64_tr_b16 v[20:21], v5 offset:49152
    ds_read_b64_tr_b16 v[22:23], v5 offset:49664
    v_mfma_f32_16x16x32_bf16 v[104:107], v[24:27], v[244:247], v[104:107]
    v_mul_f32 v73, v12, v73
    v_mul_f32 v74, v13, v74
    v_mul_f32 v75, v14, v75
    v_mul_f32 v11, v76, v76
    v_mul_f32 v12, v77, v77
    v_mul_f32 v13, v78, v78
    v_mul_f32 v14, v79, v79
    v_mfma_f32_16x16x32_bf16 v[92:95], v[28:31], v[240:243], v[92:95]
    ds_read_b64_tr_b16 v[24:25], v6 offset:49152
    ds_read_b64_tr_b16 v[26:27], v6 offset:49664
    v_mfma_f32_16x16x32_bf16 v[108:111], v[28:31], v[244:247], v[108:111]
    v_fma_f32 v11, v11, s26, v10
    v_fma_f32 v12, v12, s26, v10
    v_fma_f32 v13, v13, s26, v10
    v_fma_f32 v14, v14, s26, v10
    v_mul_f32 v11, v11, v76
    v_mul_f32 v12, v12, v77
    s_waitcnt lgkmcnt(10)
    v_mfma_f32_16x16x32_bf16 v[80:83], v[32:35], v[248:251], v[80:83]
    ds_read_b64_tr_b16 v[28:29], v7 offset:49152
    ds_read_b64_tr_b16 v[30:31], v7 offset:49664
    v_mfma_f32_16x16x32_bf16 v[96:99], v[32:35], v[252:255], v[96:99]
    v_mul_f32 v13, v13, v78
    v_mul_f32 v14, v14, v79
    v_exp_f32 v11, v11
    v_exp_f32 v12, v12
    v_exp_f32 v13, v13
    v_exp_f32 v14, v14
    v_mfma_f32_16x16x32_bf16 v[84:87], v[36:39], v[248:251], v[84:87]
    ds_read_b64_tr_b16 v[32:33], v4 offset:53248
    ds_read_b64_tr_b16 v[34:35], v4 offset:53760
    v_mfma_f32_16x16x32_bf16 v[100:103], v[36:39], v[252:255], v[100:103]
    v_add_f32 v11, 1.0, v11
    v_add_f32 v12, 1.0, v12
    v_add_f32 v13, 1.0, v13
    v_add_f32 v14, 1.0, v14
    v_rcp_f32 v11, v11
    v_rcp_f32 v12, v12
    s_waitcnt lgkmcnt(10)
    v_mfma_f32_16x16x32_bf16 v[88:91], v[40:43], v[248:251], v[88:91]
    ds_read_b64_tr_b16 v[36:37], v5 offset:53248
    ds_read_b64_tr_b16 v[38:39], v5 offset:53760
    v_mfma_f32_16x16x32_bf16 v[104:107], v[40:43], v[252:255], v[104:107]
    v_rcp_f32 v13, v13
    v_rcp_f32 v14, v14
    v_mul_f32 v76, v11, v76
    v_mul_f32 v77, v12, v77
    v_mul_f32 v78, v13, v78
    v_mul_f32 v79, v14, v79
    v_mfma_f32_16x16x32_bf16 v[92:95], v[44:47], v[248:251], v[92:95]
    ds_read_b64_tr_b16 v[40:41], v6 offset:53248
    ds_read_b64_tr_b16 v[42:43], v6 offset:53760
    v_mfma_f32_16x16x32_bf16 v[108:111], v[44:47], v[252:255], v[108:111]
    v_mul_f32 v80, v48, v80
    v_mul_f32 v81, v49, v81
    v_mul_f32 v82, v50, v82
    v_mul_f32 v83, v51, v83
    v_mul_f32 v96, v64, v96
    v_mul_f32 v97, v65, v97
    v_mul_f32 v98, v66, v98
    v_mul_f32 v99, v67, v99
    s_waitcnt lgkmcnt(10)
    v_mfma_f32_16x16x32_bf16 v[48:51], v[16:19], v[112:115], 0
    ds_read_b64_tr_b16 v[44:45], v7 offset:53248
    ds_read_b64_tr_b16 v[46:47], v7 offset:53760
    v_mfma_f32_16x16x32_bf16 v[64:67], v[16:19], v[116:119], 0
    v_mul_f32 v84, v52, v84
    v_mul_f32 v85, v53, v85
    v_mul_f32 v86, v54, v86
    v_mul_f32 v87, v55, v87
    v_mul_f32 v100, v68, v100
    v_mul_f32 v101, v69, v101
    v_mul_f32 v102, v70, v102
    v_mul_f32 v103, v71, v103
    v_mfma_f32_16x16x32_bf16 v[52:55], v[20:23], v[112:115], 0
    ds_read_b64_tr_b16 v[16:17], v4 offset:57344
    ds_read_b64_tr_b16 v[18:19], v4 offset:57856
    v_mfma_f32_16x16x32_bf16 v[68:71], v[20:23], v[116:119], 0
    v_mul_f32 v88, v56, v88
    v_mul_f32 v89, v57, v89
    v_mul_f32 v90, v58, v90
    v_mul_f32 v91, v59, v91
    v_mul_f32 v104, v72, v104
    v_mul_f32 v105, v73, v105
    v_mul_f32 v106, v74, v106
    v_mul_f32 v107, v75, v107
    s_waitcnt lgkmcnt(10)
    v_mfma_f32_16x16x32_bf16 v[56:59], v[24:27], v[112:115], 0
    ds_read_b64_tr_b16 v[20:21], v5 offset:57344
    ds_read_b64_tr_b16 v[22:23], v5 offset:57856
    v_mfma_f32_16x16x32_bf16 v[72:75], v[24:27], v[116:119], 0
    v_mul_f32 v92, v60, v92
    v_mul_f32 v93, v61, v93
    v_mul_f32 v94, v62, v94
    v_mul_f32 v95, v63, v95
    v_mul_f32 v108, v76, v108
    v_mul_f32 v109, v77, v109
    v_mul_f32 v110, v78, v110
    v_mul_f32 v111, v79, v111
    v_mfma_f32_16x16x32_bf16 v[60:63], v[28:31], v[112:115], 0
    ds_read_b64_tr_b16 v[24:25], v6 offset:57344
    ds_read_b64_tr_b16 v[26:27], v6 offset:57856
    v_mfma_f32_16x16x32_bf16 v[76:79], v[28:31], v[116:119], 0
    s_waitcnt lgkmcnt(10)
    v_mfma_f32_16x16x32_bf16 v[48:51], v[32:35], v[120:123], v[48:51]
    ds_read_b64_tr_b16 v[28:29], v7 offset:57344
    ds_read_b64_tr_b16 v[30:31], v7 offset:57856
    v_mfma_f32_16x16x32_bf16 v[64:67], v[32:35], v[124:127], v[64:67]
    v_cvt_pk_bf16_f32 v80, v80, v81
    v_mfma_f32_16x16x32_bf16 v[52:55], v[36:39], v[120:123], v[52:55]
    ds_read_b64_tr_b16 v[32:33], v4 offset:61440
    ds_read_b64_tr_b16 v[34:35], v4 offset:61952
    v_mfma_f32_16x16x32_bf16 v[68:71], v[36:39], v[124:127], v[68:71]
    v_cvt_pk_bf16_f32 v81, v82, v83
    s_waitcnt lgkmcnt(10)
    v_mfma_f32_16x16x32_bf16 v[56:59], v[40:43], v[120:123], v[56:59]
    ds_read_b64_tr_b16 v[36:37], v5 offset:61440
    ds_read_b64_tr_b16 v[38:39], v5 offset:61952
    v_mfma_f32_16x16x32_bf16 v[72:75], v[40:43], v[124:127], v[72:75]
    v_mfma_f32_16x16x32_bf16 v[60:63], v[44:47], v[120:123], v[60:63]
    ds_read_b64_tr_b16 v[40:41], v6 offset:61440
    ds_read_b64_tr_b16 v[42:43], v6 offset:61952
    v_mfma_f32_16x16x32_bf16 v[76:79], v[44:47], v[124:127], v[76:79]
    v_cvt_pk_bf16_f32 v82, v84, v85
    s_waitcnt lgkmcnt(10)
    v_mfma_f32_16x16x32_bf16 v[48:51], v[16:19], v[128:131], v[48:51]
    ds_read_b64_tr_b16 v[44:45], v7 offset:61440
    ds_read_b64_tr_b16 v[46:47], v7 offset:61952
    v_mfma_f32_16x16x32_bf16 v[64:67], v[16:19], v[132:135], v[64:67]
    v_mfma_f32_16x16x32_bf16 v[52:55], v[20:23], v[128:131], v[52:55]
    ds_read_b64_tr_b16 v[16:17], v8 offset:0
    ds_read_b64_tr_b16 v[18:19], v8 offset:512
    v_mfma_f32_16x16x32_bf16 v[68:71], v[20:23], v[132:135], v[68:71]
    v_cvt_pk_bf16_f32 v83, v86, v87
    s_waitcnt lgkmcnt(10)
    v_mfma_f32_16x16x32_bf16 v[56:59], v[24:27], v[128:131], v[56:59]
    ds_read_b64_tr_b16 v[20:21], v9 offset:0
    ds_read_b64_tr_b16 v[22:23], v9 offset:512
    v_mfma_f32_16x16x32_bf16 v[72:75], v[24:27], v[132:135], v[72:75]
    buffer_store_dwordx4 v[80:83], v15, s[16:19], s25 offen offset:0 sc1
    v_mfma_f32_16x16x32_bf16 v[60:63], v[28:31], v[128:131], v[60:63]
    ds_read_b64_tr_b16 v[24:25], v1 offset:0
    ds_read_b64_tr_b16 v[26:27], v1 offset:512
    v_mfma_f32_16x16x32_bf16 v[76:79], v[28:31], v[132:135], v[76:79]
    s_waitcnt lgkmcnt(10)
    v_mfma_f32_16x16x32_bf16 v[48:51], v[32:35], v[136:139], v[48:51]
    ds_read_b64_tr_b16 v[28:29], v0 offset:0
    ds_read_b64_tr_b16 v[30:31], v0 offset:512
    v_mfma_f32_16x16x32_bf16 v[64:67], v[32:35], v[140:143], v[64:67]
    v_cvt_pk_bf16_f32 v84, v88, v89
    v_mfma_f32_16x16x32_bf16 v[52:55], v[36:39], v[136:139], v[52:55]
    ds_read_b64_tr_b16 v[32:33], v8 offset:4096
    ds_read_b64_tr_b16 v[34:35], v8 offset:4608
    v_mfma_f32_16x16x32_bf16 v[68:71], v[36:39], v[140:143], v[68:71]
    s_waitcnt lgkmcnt(10)
    v_mfma_f32_16x16x32_bf16 v[56:59], v[40:43], v[136:139], v[56:59]
    ds_read_b64_tr_b16 v[36:37], v9 offset:4096
    ds_read_b64_tr_b16 v[38:39], v9 offset:4608
    v_mfma_f32_16x16x32_bf16 v[72:75], v[40:43], v[140:143], v[72:75]
    v_cvt_pk_bf16_f32 v85, v90, v91
    v_mfma_f32_16x16x32_bf16 v[60:63], v[44:47], v[136:139], v[60:63]
    ds_read_b64_tr_b16 v[40:41], v1 offset:4096
    ds_read_b64_tr_b16 v[42:43], v1 offset:4608
    v_mfma_f32_16x16x32_bf16 v[76:79], v[44:47], v[140:143], v[76:79]
    s_waitcnt lgkmcnt(10)
    v_mfma_f32_16x16x32_bf16 v[48:51], v[16:19], v[144:147], v[48:51]
    ds_read_b64_tr_b16 v[44:45], v0 offset:4096
    ds_read_b64_tr_b16 v[46:47], v0 offset:4608
    v_mfma_f32_16x16x32_bf16 v[64:67], v[16:19], v[148:151], v[64:67]
    v_cvt_pk_bf16_f32 v86, v92, v93
    v_mfma_f32_16x16x32_bf16 v[52:55], v[20:23], v[144:147], v[52:55]
    v_mfma_f32_16x16x32_bf16 v[68:71], v[20:23], v[148:151], v[68:71]
    s_barrier
    ds_read_b64_tr_b16 v[16:17], v8 offset:8192
    ds_read_b64_tr_b16 v[18:19], v8 offset:8704
    v_cvt_pk_bf16_f32 v87, v94, v95
    s_waitcnt lgkmcnt(10)
    v_mfma_f32_16x16x32_bf16 v[56:59], v[24:27], v[144:147], v[56:59]
    ds_read_b64_tr_b16 v[20:21], v9 offset:8192
    ds_read_b64_tr_b16 v[22:23], v9 offset:8704
    v_mfma_f32_16x16x32_bf16 v[72:75], v[24:27], v[148:151], v[72:75]
    v_mfma_f32_16x16x32_bf16 v[60:63], v[28:31], v[144:147], v[60:63]
    ds_read_b64_tr_b16 v[24:25], v1 offset:8192
    ds_read_b64_tr_b16 v[26:27], v1 offset:8704
    v_mfma_f32_16x16x32_bf16 v[76:79], v[28:31], v[148:151], v[76:79]
    buffer_store_dwordx4 v[84:87], v15, s[16:19], s25 offen offset:2048 sc1
    s_waitcnt lgkmcnt(10)
    v_mfma_f32_16x16x32_bf16 v[48:51], v[32:35], v[152:155], v[48:51]
    ds_read_b64_tr_b16 v[28:29], v0 offset:8192
    ds_read_b64_tr_b16 v[30:31], v0 offset:8704
    v_mfma_f32_16x16x32_bf16 v[64:67], v[32:35], v[156:159], v[64:67]
    v_mfma_f32_16x16x32_bf16 v[52:55], v[36:39], v[152:155], v[52:55]
    ds_read_b64_tr_b16 v[32:33], v8 offset:12288
    ds_read_b64_tr_b16 v[34:35], v8 offset:12800
    v_mfma_f32_16x16x32_bf16 v[68:71], v[36:39], v[156:159], v[68:71]
    v_cvt_pk_bf16_f32 v96, v96, v97
    s_waitcnt lgkmcnt(10)
    v_mfma_f32_16x16x32_bf16 v[56:59], v[40:43], v[152:155], v[56:59]
    ds_read_b64_tr_b16 v[36:37], v9 offset:12288
    ds_read_b64_tr_b16 v[38:39], v9 offset:12800
    v_mfma_f32_16x16x32_bf16 v[72:75], v[40:43], v[156:159], v[72:75]
    v_cvt_pk_bf16_f32 v97, v98, v99
    v_mfma_f32_16x16x32_bf16 v[60:63], v[44:47], v[152:155], v[60:63]
    ds_read_b64_tr_b16 v[40:41], v1 offset:12288
    ds_read_b64_tr_b16 v[42:43], v1 offset:12800
    v_mfma_f32_16x16x32_bf16 v[76:79], v[44:47], v[156:159], v[76:79]
    s_waitcnt lgkmcnt(10)
    v_mfma_f32_16x16x32_bf16 v[48:51], v[16:19], v[160:163], v[48:51]
    ds_read_b64_tr_b16 v[44:45], v0 offset:12288
    ds_read_b64_tr_b16 v[46:47], v0 offset:12800
    v_mfma_f32_16x16x32_bf16 v[64:67], v[16:19], v[164:167], v[64:67]
    v_cvt_pk_bf16_f32 v98, v100, v101
    v_mfma_f32_16x16x32_bf16 v[52:55], v[20:23], v[160:163], v[52:55]
    ds_read_b64_tr_b16 v[16:17], v8 offset:16384
    ds_read_b64_tr_b16 v[18:19], v8 offset:16896
    v_mfma_f32_16x16x32_bf16 v[68:71], v[20:23], v[164:167], v[68:71]
    s_waitcnt lgkmcnt(10)
    v_mfma_f32_16x16x32_bf16 v[56:59], v[24:27], v[160:163], v[56:59]
    ds_read_b64_tr_b16 v[20:21], v9 offset:16384
    ds_read_b64_tr_b16 v[22:23], v9 offset:16896
    v_mfma_f32_16x16x32_bf16 v[72:75], v[24:27], v[164:167], v[72:75]
    v_cvt_pk_bf16_f32 v99, v102, v103
    v_mfma_f32_16x16x32_bf16 v[60:63], v[28:31], v[160:163], v[60:63]
    ds_read_b64_tr_b16 v[24:25], v1 offset:16384
    ds_read_b64_tr_b16 v[26:27], v1 offset:16896
    v_mfma_f32_16x16x32_bf16 v[76:79], v[28:31], v[164:167], v[76:79]
    s_waitcnt lgkmcnt(10)
    v_mfma_f32_16x16x32_bf16 v[48:51], v[32:35], v[168:171], v[48:51]
    ds_read_b64_tr_b16 v[28:29], v0 offset:16384
    ds_read_b64_tr_b16 v[30:31], v0 offset:16896
    v_mfma_f32_16x16x32_bf16 v[64:67], v[32:35], v[172:175], v[64:67]
    buffer_store_dwordx4 v[96:99], v15, s[16:19], s25 offen offset:256 sc1
    v_mfma_f32_16x16x32_bf16 v[52:55], v[36:39], v[168:171], v[52:55]
    ds_read_b64_tr_b16 v[32:33], v8 offset:20480
    ds_read_b64_tr_b16 v[34:35], v8 offset:20992
    v_mfma_f32_16x16x32_bf16 v[68:71], v[36:39], v[172:175], v[68:71]
    v_cvt_pk_bf16_f32 v100, v104, v105
    s_waitcnt lgkmcnt(10)
    v_mfma_f32_16x16x32_bf16 v[56:59], v[40:43], v[168:171], v[56:59]
    ds_read_b64_tr_b16 v[36:37], v9 offset:20480
    ds_read_b64_tr_b16 v[38:39], v9 offset:20992
    v_mfma_f32_16x16x32_bf16 v[72:75], v[40:43], v[172:175], v[72:75]
    v_mfma_f32_16x16x32_bf16 v[60:63], v[44:47], v[168:171], v[60:63]
    ds_read_b64_tr_b16 v[40:41], v1 offset:20480
    ds_read_b64_tr_b16 v[42:43], v1 offset:20992
    v_mfma_f32_16x16x32_bf16 v[76:79], v[44:47], v[172:175], v[76:79]
    v_cvt_pk_bf16_f32 v101, v106, v107
    s_waitcnt lgkmcnt(10)
    v_mfma_f32_16x16x32_bf16 v[48:51], v[16:19], v[176:179], v[48:51]
    ds_read_b64_tr_b16 v[44:45], v0 offset:20480
    ds_read_b64_tr_b16 v[46:47], v0 offset:20992
    v_mfma_f32_16x16x32_bf16 v[64:67], v[16:19], v[180:183], v[64:67]
    v_mfma_f32_16x16x32_bf16 v[52:55], v[20:23], v[176:179], v[52:55]
    ds_read_b64_tr_b16 v[16:17], v8 offset:24576
    ds_read_b64_tr_b16 v[18:19], v8 offset:25088
    v_mfma_f32_16x16x32_bf16 v[68:71], v[20:23], v[180:183], v[68:71]
    v_cvt_pk_bf16_f32 v102, v108, v109
    s_waitcnt lgkmcnt(10)
    v_mfma_f32_16x16x32_bf16 v[56:59], v[24:27], v[176:179], v[56:59]
    ds_read_b64_tr_b16 v[20:21], v9 offset:24576
    ds_read_b64_tr_b16 v[22:23], v9 offset:25088
    v_mfma_f32_16x16x32_bf16 v[72:75], v[24:27], v[180:183], v[72:75]
    v_cvt_pk_bf16_f32 v103, v110, v111
    v_mfma_f32_16x16x32_bf16 v[60:63], v[28:31], v[176:179], v[60:63]
    ds_read_b64_tr_b16 v[24:25], v1 offset:24576
    ds_read_b64_tr_b16 v[26:27], v1 offset:25088
    v_mfma_f32_16x16x32_bf16 v[76:79], v[28:31], v[180:183], v[76:79]
    s_waitcnt lgkmcnt(10)
    v_mfma_f32_16x16x32_bf16 v[48:51], v[32:35], v[184:187], v[48:51]
    ds_read_b64_tr_b16 v[28:29], v0 offset:24576
    ds_read_b64_tr_b16 v[30:31], v0 offset:25088
    v_mfma_f32_16x16x32_bf16 v[64:67], v[32:35], v[188:191], v[64:67]
    buffer_store_dwordx4 v[100:103], v15, s[16:19], s25 offen offset:2304 sc1
    v_mfma_f32_16x16x32_bf16 v[52:55], v[36:39], v[184:187], v[52:55]
    ds_read_b64_tr_b16 v[32:33], v8 offset:28672
    ds_read_b64_tr_b16 v[34:35], v8 offset:29184
    v_mfma_f32_16x16x32_bf16 v[68:71], v[36:39], v[188:191], v[68:71]
    s_waitcnt lgkmcnt(10)
    v_mfma_f32_16x16x32_bf16 v[56:59], v[40:43], v[184:187], v[56:59]
    ds_read_b64_tr_b16 v[36:37], v9 offset:28672
    ds_read_b64_tr_b16 v[38:39], v9 offset:29184
    v_mfma_f32_16x16x32_bf16 v[72:75], v[40:43], v[188:191], v[72:75]
    s_add_u32 s25, s25, 4096
    v_mfma_f32_16x16x32_bf16 v[60:63], v[44:47], v[184:187], v[60:63]
    ds_read_b64_tr_b16 v[40:41], v1 offset:28672
    ds_read_b64_tr_b16 v[42:43], v1 offset:29184
    v_mfma_f32_16x16x32_bf16 v[76:79], v[44:47], v[188:191], v[76:79]
    s_waitcnt lgkmcnt(10)
    v_mfma_f32_16x16x32_bf16 v[48:51], v[16:19], v[192:195], v[48:51]
    ds_read_b64_tr_b16 v[44:45], v0 offset:28672
    ds_read_b64_tr_b16 v[46:47], v0 offset:29184
    v_mfma_f32_16x16x32_bf16 v[64:67], v[16:19], v[196:199], v[64:67]
    v_mfma_f32_16x16x32_bf16 v[52:55], v[20:23], v[192:195], v[52:55]
    ds_read_b64_tr_b16 v[16:17], v4 offset:0
    ds_read_b64_tr_b16 v[18:19], v4 offset:512
    v_mfma_f32_16x16x32_bf16 v[68:71], v[20:23], v[196:199], v[68:71]
    s_waitcnt lgkmcnt(10)
    v_mfma_f32_16x16x32_bf16 v[56:59], v[24:27], v[192:195], v[56:59]
    ds_read_b64_tr_b16 v[20:21], v5 offset:0
    ds_read_b64_tr_b16 v[22:23], v5 offset:512
    v_mfma_f32_16x16x32_bf16 v[72:75], v[24:27], v[196:199], v[72:75]
    v_mfma_f32_16x16x32_bf16 v[60:63], v[28:31], v[192:195], v[60:63]
    ds_read_b64_tr_b16 v[24:25], v6 offset:0
    ds_read_b64_tr_b16 v[26:27], v6 offset:512
    v_mfma_f32_16x16x32_bf16 v[76:79], v[28:31], v[196:199], v[76:79]
    s_waitcnt lgkmcnt(10)
    v_mfma_f32_16x16x32_bf16 v[48:51], v[32:35], v[200:203], v[48:51]
    ds_read_b64_tr_b16 v[28:29], v7 offset:0
    ds_read_b64_tr_b16 v[30:31], v7 offset:512
    v_mfma_f32_16x16x32_bf16 v[64:67], v[32:35], v[204:207], v[64:67]
    v_mfma_f32_16x16x32_bf16 v[52:55], v[36:39], v[200:203], v[52:55]
    ds_read_b64_tr_b16 v[32:33], v4 offset:4096
    ds_read_b64_tr_b16 v[34:35], v4 offset:4608
    v_mfma_f32_16x16x32_bf16 v[68:71], v[36:39], v[204:207], v[68:71]
    s_waitcnt lgkmcnt(10)
    v_mfma_f32_16x16x32_bf16 v[56:59], v[40:43], v[200:203], v[56:59]
    ds_read_b64_tr_b16 v[36:37], v5 offset:4096
    ds_read_b64_tr_b16 v[38:39], v5 offset:4608
    v_mfma_f32_16x16x32_bf16 v[72:75], v[40:43], v[204:207], v[72:75]
    v_mfma_f32_16x16x32_bf16 v[60:63], v[44:47], v[200:203], v[60:63]
    ds_read_b64_tr_b16 v[40:41], v6 offset:4096
    ds_read_b64_tr_b16 v[42:43], v6 offset:4608
    v_mfma_f32_16x16x32_bf16 v[76:79], v[44:47], v[204:207], v[76:79]
    s_waitcnt lgkmcnt(10)
    v_mfma_f32_16x16x32_bf16 v[48:51], v[16:19], v[208:211], v[48:51]
    ds_read_b64_tr_b16 v[44:45], v7 offset:4096
    ds_read_b64_tr_b16 v[46:47], v7 offset:4608
    v_mfma_f32_16x16x32_bf16 v[64:67], v[16:19], v[212:215], v[64:67]
    v_mfma_f32_16x16x32_bf16 v[52:55], v[20:23], v[208:211], v[52:55]
    ds_read_b64_tr_b16 v[16:17], v4 offset:8192
    ds_read_b64_tr_b16 v[18:19], v4 offset:8704
    v_mfma_f32_16x16x32_bf16 v[68:71], v[20:23], v[212:215], v[68:71]
    s_waitcnt lgkmcnt(10)
    v_mfma_f32_16x16x32_bf16 v[56:59], v[24:27], v[208:211], v[56:59]
    ds_read_b64_tr_b16 v[20:21], v5 offset:8192
    ds_read_b64_tr_b16 v[22:23], v5 offset:8704
    v_mfma_f32_16x16x32_bf16 v[72:75], v[24:27], v[212:215], v[72:75]
    v_mfma_f32_16x16x32_bf16 v[60:63], v[28:31], v[208:211], v[60:63]
    ds_read_b64_tr_b16 v[24:25], v6 offset:8192
    ds_read_b64_tr_b16 v[26:27], v6 offset:8704
    v_mfma_f32_16x16x32_bf16 v[76:79], v[28:31], v[212:215], v[76:79]
    s_waitcnt lgkmcnt(10)
    v_mfma_f32_16x16x32_bf16 v[48:51], v[32:35], v[216:219], v[48:51]
    ds_read_b64_tr_b16 v[28:29], v7 offset:8192
    ds_read_b64_tr_b16 v[30:31], v7 offset:8704
    v_mfma_f32_16x16x32_bf16 v[64:67], v[32:35], v[220:223], v[64:67]
    v_mfma_f32_16x16x32_bf16 v[52:55], v[36:39], v[216:219], v[52:55]
    ds_read_b64_tr_b16 v[32:33], v4 offset:12288
    ds_read_b64_tr_b16 v[34:35], v4 offset:12800
    v_mfma_f32_16x16x32_bf16 v[68:71], v[36:39], v[220:223], v[68:71]
    s_waitcnt lgkmcnt(10)
    v_mfma_f32_16x16x32_bf16 v[56:59], v[40:43], v[216:219], v[56:59]
    ds_read_b64_tr_b16 v[36:37], v5 offset:12288
    ds_read_b64_tr_b16 v[38:39], v5 offset:12800
    v_mfma_f32_16x16x32_bf16 v[72:75], v[40:43], v[220:223], v[72:75]
    v_mfma_f32_16x16x32_bf16 v[60:63], v[44:47], v[216:219], v[60:63]
    ds_read_b64_tr_b16 v[40:41], v6 offset:12288
    ds_read_b64_tr_b16 v[42:43], v6 offset:12800
    v_mfma_f32_16x16x32_bf16 v[76:79], v[44:47], v[220:223], v[76:79]
    s_waitcnt lgkmcnt(10)
    v_mfma_f32_16x16x32_bf16 v[48:51], v[16:19], v[224:227], v[48:51]
    ds_read_b64_tr_b16 v[44:45], v7 offset:12288
    ds_read_b64_tr_b16 v[46:47], v7 offset:12800
    v_mfma_f32_16x16x32_bf16 v[64:67], v[16:19], v[228:231], v[64:67]
    v_mfma_f32_16x16x32_bf16 v[52:55], v[20:23], v[224:227], v[52:55]
    ds_read_b64_tr_b16 v[16:17], v8 offset:32768
    ds_read_b64_tr_b16 v[18:19], v8 offset:33280
    v_mfma_f32_16x16x32_bf16 v[68:71], v[20:23], v[228:231], v[68:71]
    s_waitcnt lgkmcnt(10)
    v_mfma_f32_16x16x32_bf16 v[56:59], v[24:27], v[224:227], v[56:59]
    ds_read_b64_tr_b16 v[20:21], v9 offset:32768
    ds_read_b64_tr_b16 v[22:23], v9 offset:33280
    v_mfma_f32_16x16x32_bf16 v[72:75], v[24:27], v[228:231], v[72:75]
    v_mfma_f32_16x16x32_bf16 v[60:63], v[28:31], v[224:227], v[60:63]
    ds_read_b64_tr_b16 v[24:25], v1 offset:32768
    ds_read_b64_tr_b16 v[26:27], v1 offset:33280
    v_mfma_f32_16x16x32_bf16 v[76:79], v[28:31], v[228:231], v[76:79]
    s_waitcnt lgkmcnt(10)
    v_mfma_f32_16x16x32_bf16 v[48:51], v[32:35], v[232:235], v[48:51]
    ds_read_b64_tr_b16 v[28:29], v0 offset:32768
    ds_read_b64_tr_b16 v[30:31], v0 offset:33280
    v_mfma_f32_16x16x32_bf16 v[64:67], v[32:35], v[236:239], v[64:67]
    v_mfma_f32_16x16x32_bf16 v[52:55], v[36:39], v[232:235], v[52:55]
    ds_read_b64_tr_b16 v[32:33], v8 offset:36864
    ds_read_b64_tr_b16 v[34:35], v8 offset:37376
    v_mfma_f32_16x16x32_bf16 v[68:71], v[36:39], v[236:239], v[68:71]
    s_waitcnt lgkmcnt(10)
    v_mfma_f32_16x16x32_bf16 v[56:59], v[40:43], v[232:235], v[56:59]
    ds_read_b64_tr_b16 v[36:37], v9 offset:36864
    ds_read_b64_tr_b16 v[38:39], v9 offset:37376
    v_mfma_f32_16x16x32_bf16 v[72:75], v[40:43], v[236:239], v[72:75]
    v_mfma_f32_16x16x32_bf16 v[60:63], v[44:47], v[232:235], v[60:63]
    ds_read_b64_tr_b16 v[40:41], v1 offset:36864
    ds_read_b64_tr_b16 v[42:43], v1 offset:37376
    v_mfma_f32_16x16x32_bf16 v[76:79], v[44:47], v[236:239], v[76:79]
    s_waitcnt lgkmcnt(10)
    v_mfma_f32_16x16x32_bf16 v[48:51], v[16:19], v[240:243], v[48:51]
    ds_read_b64_tr_b16 v[44:45], v0 offset:36864
    ds_read_b64_tr_b16 v[46:47], v0 offset:37376
    v_mfma_f32_16x16x32_bf16 v[64:67], v[16:19], v[244:247], v[64:67]
    v_mfma_f32_16x16x32_bf16 v[52:55], v[20:23], v[240:243], v[52:55]
    v_mfma_f32_16x16x32_bf16 v[68:71], v[20:23], v[244:247], v[68:71]
    s_barrier
    ds_read_b64_tr_b16 v[16:17], v8 offset:40960
    ds_read_b64_tr_b16 v[18:19], v8 offset:41472
    s_waitcnt lgkmcnt(10)
    v_mfma_f32_16x16x32_bf16 v[56:59], v[24:27], v[240:243], v[56:59]
    ds_read_b64_tr_b16 v[20:21], v9 offset:40960
    ds_read_b64_tr_b16 v[22:23], v9 offset:41472
    v_mfma_f32_16x16x32_bf16 v[72:75], v[24:27], v[244:247], v[72:75]
    v_mfma_f32_16x16x32_bf16 v[60:63], v[28:31], v[240:243], v[60:63]
    ds_read_b64_tr_b16 v[24:25], v1 offset:40960
    ds_read_b64_tr_b16 v[26:27], v1 offset:41472
    v_mfma_f32_16x16x32_bf16 v[76:79], v[28:31], v[244:247], v[76:79]
    s_waitcnt lgkmcnt(10)
    v_mfma_f32_16x16x32_bf16 v[48:51], v[32:35], v[248:251], v[48:51]
    ds_read_b64_tr_b16 v[28:29], v0 offset:40960
    ds_read_b64_tr_b16 v[30:31], v0 offset:41472
    v_mfma_f32_16x16x32_bf16 v[64:67], v[32:35], v[252:255], v[64:67]
    v_mfma_f32_16x16x32_bf16 v[52:55], v[36:39], v[248:251], v[52:55]
    ds_read_b64_tr_b16 v[32:33], v8 offset:45056
    ds_read_b64_tr_b16 v[34:35], v8 offset:45568
    v_mfma_f32_16x16x32_bf16 v[68:71], v[36:39], v[252:255], v[68:71]
    s_waitcnt lgkmcnt(10)
    v_mfma_f32_16x16x32_bf16 v[56:59], v[40:43], v[248:251], v[56:59]
    ds_read_b64_tr_b16 v[36:37], v9 offset:45056
    ds_read_b64_tr_b16 v[38:39], v9 offset:45568
    v_mfma_f32_16x16x32_bf16 v[72:75], v[40:43], v[252:255], v[72:75]
    v_mfma_f32_16x16x32_bf16 v[60:63], v[44:47], v[248:251], v[60:63]
    ds_read_b64_tr_b16 v[40:41], v1 offset:45056
    ds_read_b64_tr_b16 v[42:43], v1 offset:45568
    v_mfma_f32_16x16x32_bf16 v[76:79], v[44:47], v[252:255], v[76:79]
    s_waitcnt lgkmcnt(10)
    v_mfma_f32_16x16x32_bf16 v[80:83], v[16:19], v[112:115], 0
    ds_read_b64_tr_b16 v[44:45], v0 offset:45056
    ds_read_b64_tr_b16 v[46:47], v0 offset:45568
    v_mfma_f32_16x16x32_bf16 v[96:99], v[16:19], v[116:119], 0
    v_mfma_f32_16x16x32_bf16 v[84:87], v[20:23], v[112:115], 0
    ds_read_b64_tr_b16 v[16:17], v8 offset:49152
    ds_read_b64_tr_b16 v[18:19], v8 offset:49664
    v_mfma_f32_16x16x32_bf16 v[100:103], v[20:23], v[116:119], 0
    s_waitcnt lgkmcnt(10)
    v_mfma_f32_16x16x32_bf16 v[88:91], v[24:27], v[112:115], 0
    ds_read_b64_tr_b16 v[20:21], v9 offset:49152
    ds_read_b64_tr_b16 v[22:23], v9 offset:49664
    v_mfma_f32_16x16x32_bf16 v[104:107], v[24:27], v[116:119], 0
    v_mfma_f32_16x16x32_bf16 v[92:95], v[28:31], v[112:115], 0
    ds_read_b64_tr_b16 v[24:25], v1 offset:49152
    ds_read_b64_tr_b16 v[26:27], v1 offset:49664
    v_mfma_f32_16x16x32_bf16 v[108:111], v[28:31], v[116:119], 0
    v_mul_f32 v11, v48, v48
    v_mul_f32 v12, v49, v49
    v_mul_f32 v13, v50, v50
    v_mul_f32 v14, v51, v51
    s_waitcnt lgkmcnt(10)
    v_mfma_f32_16x16x32_bf16 v[80:83], v[32:35], v[120:123], v[80:83]
    ds_read_b64_tr_b16 v[28:29], v0 offset:49152
    ds_read_b64_tr_b16 v[30:31], v0 offset:49664
    v_mfma_f32_16x16x32_bf16 v[96:99], v[32:35], v[124:127], v[96:99]
    v_fma_f32 v11, v11, s26, v10
    v_fma_f32 v12, v12, s26, v10
    v_fma_f32 v13, v13, s26, v10
    v_mfma_f32_16x16x32_bf16 v[84:87], v[36:39], v[120:123], v[84:87]
    ds_read_b64_tr_b16 v[32:33], v8 offset:53248
    ds_read_b64_tr_b16 v[34:35], v8 offset:53760
    v_mfma_f32_16x16x32_bf16 v[100:103], v[36:39], v[124:127], v[100:103]
    v_fma_f32 v14, v14, s26, v10
    v_mul_f32 v11, v11, v48
    v_mul_f32 v12, v12, v49
    v_mul_f32 v13, v13, v50
    s_waitcnt lgkmcnt(10)
    v_mfma_f32_16x16x32_bf16 v[88:91], v[40:43], v[120:123], v[88:91]
    ds_read_b64_tr_b16 v[36:37], v9 offset:53248
    ds_read_b64_tr_b16 v[38:39], v9 offset:53760
    v_mfma_f32_16x16x32_bf16 v[104:107], v[40:43], v[124:127], v[104:107]
    v_mul_f32 v14, v14, v51
    v_exp_f32 v11, v11
    v_exp_f32 v12, v12
    v_mfma_f32_16x16x32_bf16 v[92:95], v[44:47], v[120:123], v[92:95]
    ds_read_b64_tr_b16 v[40:41], v1 offset:53248
    ds_read_b64_tr_b16 v[42:43], v1 offset:53760
    v_mfma_f32_16x16x32_bf16 v[108:111], v[44:47], v[124:127], v[108:111]
    v_exp_f32 v13, v13
    v_exp_f32 v14, v14
    v_add_f32 v11, 1.0, v11
    s_waitcnt lgkmcnt(10)
    v_mfma_f32_16x16x32_bf16 v[80:83], v[16:19], v[128:131], v[80:83]
    ds_read_b64_tr_b16 v[44:45], v0 offset:53248
    ds_read_b64_tr_b16 v[46:47], v0 offset:53760
    v_mfma_f32_16x16x32_bf16 v[96:99], v[16:19], v[132:135], v[96:99]
    v_add_f32 v12, 1.0, v12
    v_add_f32 v13, 1.0, v13
    v_add_f32 v14, 1.0, v14
    v_rcp_f32 v11, v11
    v_mfma_f32_16x16x32_bf16 v[84:87], v[20:23], v[128:131], v[84:87]
    ds_read_b64_tr_b16 v[16:17], v8 offset:57344
    ds_read_b64_tr_b16 v[18:19], v8 offset:57856
    v_mfma_f32_16x16x32_bf16 v[100:103], v[20:23], v[132:135], v[100:103]
    v_rcp_f32 v12, v12
    v_rcp_f32 v13, v13
    v_rcp_f32 v14, v14
    s_waitcnt lgkmcnt(10)
    v_mfma_f32_16x16x32_bf16 v[88:91], v[24:27], v[128:131], v[88:91]
    ds_read_b64_tr_b16 v[20:21], v9 offset:57344
    ds_read_b64_tr_b16 v[22:23], v9 offset:57856
    v_mfma_f32_16x16x32_bf16 v[104:107], v[24:27], v[132:135], v[104:107]
    v_mul_f32 v48, v11, v48
    v_mul_f32 v49, v12, v49
    v_mul_f32 v50, v13, v50
    v_mfma_f32_16x16x32_bf16 v[92:95], v[28:31], v[128:131], v[92:95]
    ds_read_b64_tr_b16 v[24:25], v1 offset:57344
    ds_read_b64_tr_b16 v[26:27], v1 offset:57856
    v_mfma_f32_16x16x32_bf16 v[108:111], v[28:31], v[132:135], v[108:111]
    v_mul_f32 v51, v14, v51
    v_mul_f32 v11, v52, v52
    v_mul_f32 v12, v53, v53
    v_mul_f32 v13, v54, v54
    s_waitcnt lgkmcnt(10)
    v_mfma_f32_16x16x32_bf16 v[80:83], v[32:35], v[136:139], v[80:83]
    ds_read_b64_tr_b16 v[28:29], v0 offset:57344
    ds_read_b64_tr_b16 v[30:31], v0 offset:57856
    v_mfma_f32_16x16x32_bf16 v[96:99], v[32:35], v[140:143], v[96:99]
    v_mul_f32 v14, v55, v55
    v_fma_f32 v11, v11, s26, v10
    v_fma_f32 v12, v12, s26, v10
    v_mfma_f32_16x16x32_bf16 v[84:87], v[36:39], v[136:139], v[84:87]
    ds_read_b64_tr_b16 v[32:33], v8 offset:61440
    ds_read_b64_tr_b16 v[34:35], v8 offset:61952
    v_mfma_f32_16x16x32_bf16 v[100:103], v[36:39], v[140:143], v[100:103]
    v_fma_f32 v13, v13, s26, v10
    v_fma_f32 v14, v14, s26, v10
    v_mul_f32 v11, v11, v52
    s_waitcnt lgkmcnt(10)
    v_mfma_f32_16x16x32_bf16 v[88:91], v[40:43], v[136:139], v[88:91]
    ds_read_b64_tr_b16 v[36:37], v9 offset:61440
    ds_read_b64_tr_b16 v[38:39], v9 offset:61952
    v_mfma_f32_16x16x32_bf16 v[104:107], v[40:43], v[140:143], v[104:107]
    v_mul_f32 v12, v12, v53
    v_mul_f32 v13, v13, v54
    v_mul_f32 v14, v14, v55
    v_exp_f32 v11, v11
    v_mfma_f32_16x16x32_bf16 v[92:95], v[44:47], v[136:139], v[92:95]
    ds_read_b64_tr_b16 v[40:41], v1 offset:61440
    ds_read_b64_tr_b16 v[42:43], v1 offset:61952
    v_mfma_f32_16x16x32_bf16 v[108:111], v[44:47], v[140:143], v[108:111]
    v_exp_f32 v12, v12
    v_exp_f32 v13, v13
    v_exp_f32 v14, v14
    s_waitcnt lgkmcnt(10)
    v_mfma_f32_16x16x32_bf16 v[80:83], v[16:19], v[144:147], v[80:83]
    ds_read_b64_tr_b16 v[44:45], v0 offset:61440
    ds_read_b64_tr_b16 v[46:47], v0 offset:61952
    v_mfma_f32_16x16x32_bf16 v[96:99], v[16:19], v[148:151], v[96:99]
    v_add_f32 v11, 1.0, v11
    v_add_f32 v12, 1.0, v12
    v_add_f32 v13, 1.0, v13
    v_mfma_f32_16x16x32_bf16 v[84:87], v[20:23], v[144:147], v[84:87]
    ds_read_b64_tr_b16 v[16:17], v4 offset:16384
    ds_read_b64_tr_b16 v[18:19], v4 offset:16896
    v_mfma_f32_16x16x32_bf16 v[100:103], v[20:23], v[148:151], v[100:103]
    v_add_f32 v14, 1.0, v14
    v_rcp_f32 v11, v11
    v_rcp_f32 v12, v12
    v_rcp_f32 v13, v13
    s_waitcnt lgkmcnt(10)
    v_mfma_f32_16x16x32_bf16 v[88:91], v[24:27], v[144:147], v[88:91]
    ds_read_b64_tr_b16 v[20:21], v5 offset:16384
    ds_read_b64_tr_b16 v[22:23], v5 offset:16896
    v_mfma_f32_16x16x32_bf16 v[104:107], v[24:27], v[148:151], v[104:107]
    v_rcp_f32 v14, v14
    v_mul_f32 v52, v11, v52
    v_mul_f32 v53, v12, v53
    v_mfma_f32_16x16x32_bf16 v[92:95], v[28:31], v[144:147], v[92:95]
    ds_read_b64_tr_b16 v[24:25], v6 offset:16384
    ds_read_b64_tr_b16 v[26:27], v6 offset:16896
    v_mfma_f32_16x16x32_bf16 v[108:111], v[28:31], v[148:151], v[108:111]
    v_mul_f32 v54, v13, v54
    v_mul_f32 v55, v14, v55
    v_mul_f32 v11, v56, v56
    s_waitcnt lgkmcnt(10)
    v_mfma_f32_16x16x32_bf16 v[80:83], v[32:35], v[152:155], v[80:83]
    ds_read_b64_tr_b16 v[28:29], v7 offset:16384
    ds_read_b64_tr_b16 v[30:31], v7 offset:16896
    v_mfma_f32_16x16x32_bf16 v[96:99], v[32:35], v[156:159], v[96:99]
    v_mul_f32 v12, v57, v57
    v_mul_f32 v13, v58, v58
    v_mul_f32 v14, v59, v59
    v_fma_f32 v11, v11, s26, v10
    v_mfma_f32_16x16x32_bf16 v[84:87], v[36:39], v[152:155], v[84:87]
    ds_read_b64_tr_b16 v[32:33], v4 offset:20480
    ds_read_b64_tr_b16 v[34:35], v4 offset:20992
    v_mfma_f32_16x16x32_bf16 v[100:103], v[36:39], v[156:159], v[100:103]
    v_fma_f32 v12, v12, s26, v10
    v_fma_f32 v13, v13, s26, v10
    v_fma_f32 v14, v14, s26, v10
    s_waitcnt lgkmcnt(10)
    v_mfma_f32_16x16x32_bf16 v[88:91], v[40:43], v[152:155], v[88:91]
    ds_read_b64_tr_b16 v[36:37], v5 offset:20480
    ds_read_b64_tr_b16 v[38:39], v5 offset:20992
    v_mfma_f32_16x16x32_bf16 v[104:107], v[40:43], v[156:159], v[104:107]
    v_mul_f32 v11, v11, v56
    v_mul_f32 v12, v12, v57
    v_mul_f32 v13, v13, v58
    v_mfma_f32_16x16x32_bf16 v[92:95], v[44:47], v[152:155], v[92:95]
    ds_read_b64_tr_b16 v[40:41], v6 offset:20480
    ds_read_b64_tr_b16 v[42:43], v6 offset:20992
    v_mfma_f32_16x16x32_bf16 v[108:111], v[44:47], v[156:159], v[108:111]
    v_mul_f32 v14, v14, v59
    v_exp_f32 v11, v11
    v_exp_f32 v12, v12
    v_exp_f32 v13, v13
    s_waitcnt lgkmcnt(10)
    v_mfma_f32_16x16x32_bf16 v[80:83], v[16:19], v[160:163], v[80:83]
    ds_read_b64_tr_b16 v[44:45], v7 offset:20480
    ds_read_b64_tr_b16 v[46:47], v7 offset:20992
    v_mfma_f32_16x16x32_bf16 v[96:99], v[16:19], v[164:167], v[96:99]
    v_exp_f32 v14, v14
    v_add_f32 v11, 1.0, v11
    v_add_f32 v12, 1.0, v12
    v_mfma_f32_16x16x32_bf16 v[84:87], v[20:23], v[160:163], v[84:87]
    ds_read_b64_tr_b16 v[16:17], v4 offset:24576
    ds_read_b64_tr_b16 v[18:19], v4 offset:25088
    v_mfma_f32_16x16x32_bf16 v[100:103], v[20:23], v[164:167], v[100:103]
    v_add_f32 v13, 1.0, v13
    v_add_f32 v14, 1.0, v14
    v_rcp_f32 v11, v11
    s_waitcnt lgkmcnt(10)
    v_mfma_f32_16x16x32_bf16 v[88:91], v[24:27], v[160:163], v[88:91]
    ds_read_b64_tr_b16 v[20:21], v5 offset:24576
    ds_read_b64_tr_b16 v[22:23], v5 offset:25088
    v_mfma_f32_16x16x32_bf16 v[104:107], v[24:27], v[164:167], v[104:107]
    v_rcp_f32 v12, v12
    v_rcp_f32 v13, v13
    v_rcp_f32 v14, v14
    v_mul_f32 v56, v11, v56
    v_mfma_f32_16x16x32_bf16 v[92:95], v[28:31], v[160:163], v[92:95]
    ds_read_b64_tr_b16 v[24:25], v6 offset:24576
    ds_read_b64_tr_b16 v[26:27], v6 offset:25088
    v_mfma_f32_16x16x32_bf16 v[108:111], v[28:31], v[164:167], v[108:111]
    v_mul_f32 v57, v12, v57
    v_mul_f32 v58, v13, v58
    v_mul_f32 v59, v14, v59
    s_waitcnt lgkmcnt(10)
    v_mfma_f32_16x16x32_bf16 v[80:83], v[32:35], v[168:171], v[80:83]
    ds_read_b64_tr_b16 v[28:29], v7 offset:24576
    ds_read_b64_tr_b16 v[30:31], v7 offset:25088
    v_mfma_f32_16x16x32_bf16 v[96:99], v[32:35], v[172:175], v[96:99]
    v_mul_f32 v11, v60, v60
    v_mul_f32 v12, v61, v61
    v_mul_f32 v13, v62, v62
    v_mfma_f32_16x16x32_bf16 v[84:87], v[36:39], v[168:171], v[84:87]
    ds_read_b64_tr_b16 v[32:33], v4 offset:28672
    ds_read_b64_tr_b16 v[34:35], v4 offset:29184
    v_mfma_f32_16x16x32_bf16 v[100:103], v[36:39], v[172:175], v[100:103]
    v_mul_f32 v14, v63, v63
    v_fma_f32 v11, v11, s26, v10
    v_fma_f32 v12, v12, s26, v10
    v_fma_f32 v13, v13, s26, v10
    s_waitcnt lgkmcnt(10)
    v_mfma_f32_16x16x32_bf16 v[88:91], v[40:43], v[168:171], v[88:91]
    ds_read_b64_tr_b16 v[36:37], v5 offset:28672
    ds_read_b64_tr_b16 v[38:39], v5 offset:29184
    v_mfma_f32_16x16x32_bf16 v[104:107], v[40:43], v[172:175], v[104:107]
    v_fma_f32 v14, v14, s26, v10
    v_mul_f32 v11, v11, v60
    v_mul_f32 v12, v12, v61
    v_mfma_f32_16x16x32_bf16 v[92:95], v[44:47], v[168:171], v[92:95]
    ds_read_b64_tr_b16 v[40:41], v6 offset:28672
    ds_read_b64_tr_b16 v[42:43], v6 offset:29184
    v_mfma_f32_16x16x32_bf16 v[108:111], v[44:47], v[172:175], v[108:111]
    v_mul_f32 v13, v13, v62
    v_mul_f32 v14, v14, v63
    v_exp_f32 v11, v11
    s_waitcnt lgkmcnt(10)
    v_mfma_f32_16x16x32_bf16 v[80:83], v[16:19], v[176:179], v[80:83]
    ds_read_b64_tr_b16 v[44:45], v7 offset:28672
    ds_read_b64_tr_b16 v[46:47], v7 offset:29184
    v_mfma_f32_16x16x32_bf16 v[96:99], v[16:19], v[180:183], v[96:99]
    v_exp_f32 v12, v12
    v_exp_f32 v13, v13
    v_exp_f32 v14, v14
    v_add_f32 v11, 1.0, v11
    v_mfma_f32_16x16x32_bf16 v[84:87], v[20:23], v[176:179], v[84:87]
    ds_read_b64_tr_b16 v[16:17], v4 offset:32768
    ds_read_b64_tr_b16 v[18:19], v4 offset:33280
    v_mfma_f32_16x16x32_bf16 v[100:103], v[20:23], v[180:183], v[100:103]
    v_add_f32 v12, 1.0, v12
    v_add_f32 v13, 1.0, v13
    v_add_f32 v14, 1.0, v14
    s_waitcnt lgkmcnt(10)
    v_mfma_f32_16x16x32_bf16 v[88:91], v[24:27], v[176:179], v[88:91]
    ds_read_b64_tr_b16 v[20:21], v5 offset:32768
    ds_read_b64_tr_b16 v[22:23], v5 offset:33280
    v_mfma_f32_16x16x32_bf16 v[104:107], v[24:27], v[180:183], v[104:107]
    v_rcp_f32 v11, v11
    v_rcp_f32 v12, v12
    v_rcp_f32 v13, v13
    v_mfma_f32_16x16x32_bf16 v[92:95], v[28:31], v[176:179], v[92:95]
    ds_read_b64_tr_b16 v[24:25], v6 offset:32768
    ds_read_b64_tr_b16 v[26:27], v6 offset:33280
    v_mfma_f32_16x16x32_bf16 v[108:111], v[28:31], v[180:183], v[108:111]
    v_rcp_f32 v14, v14
    v_mul_f32 v60, v11, v60
    v_mul_f32 v61, v12, v61
    v_mul_f32 v62, v13, v62
    s_waitcnt lgkmcnt(10)
    v_mfma_f32_16x16x32_bf16 v[80:83], v[32:35], v[184:187], v[80:83]
    ds_read_b64_tr_b16 v[28:29], v7 offset:32768
    ds_read_b64_tr_b16 v[30:31], v7 offset:33280
    v_mfma_f32_16x16x32_bf16 v[96:99], v[32:35], v[188:191], v[96:99]
    v_mul_f32 v63, v14, v63
    v_mul_f32 v11, v64, v64
    v_mul_f32 v12, v65, v65
    v_mfma_f32_16x16x32_bf16 v[84:87], v[36:39], v[184:187], v[84:87]
    ds_read_b64_tr_b16 v[32:33], v4 offset:36864
    ds_read_b64_tr_b16 v[34:35], v4 offset:37376
    v_mfma_f32_16x16x32_bf16 v[100:103], v[36:39], v[188:191], v[100:103]
    v_mul_f32 v13, v66, v66
    v_mul_f32 v14, v67, v67
    v_fma_f32 v11, v11, s26, v10
    v_fma_f32 v12, v12, s26, v10
    s_waitcnt lgkmcnt(10)
    v_mfma_f32_16x16x32_bf16 v[88:91], v[40:43], v[184:187], v[88:91]
    ds_read_b64_tr_b16 v[36:37], v5 offset:36864
    ds_read_b64_tr_b16 v[38:39], v5 offset:37376
    v_mfma_f32_16x16x32_bf16 v[104:107], v[40:43], v[188:191], v[104:107]
    v_fma_f32 v13, v13, s26, v10
    v_fma_f32 v14, v14, s26, v10
    v_mul_f32 v11, v11, v64
    v_mfma_f32_16x16x32_bf16 v[92:95], v[44:47], v[184:187], v[92:95]
    ds_read_b64_tr_b16 v[40:41], v6 offset:36864
    ds_read_b64_tr_b16 v[42:43], v6 offset:37376
    v_mfma_f32_16x16x32_bf16 v[108:111], v[44:47], v[188:191], v[108:111]
    v_mul_f32 v12, v12, v65
    v_mul_f32 v13, v13, v66
    v_mul_f32 v14, v14, v67
    s_waitcnt lgkmcnt(10)
    v_mfma_f32_16x16x32_bf16 v[80:83], v[16:19], v[192:195], v[80:83]
    ds_read_b64_tr_b16 v[44:45], v7 offset:36864
    ds_read_b64_tr_b16 v[46:47], v7 offset:37376
    v_mfma_f32_16x16x32_bf16 v[96:99], v[16:19], v[196:199], v[96:99]
    v_exp_f32 v11, v11
    v_exp_f32 v12, v12
    v_exp_f32 v13, v13
    v_exp_f32 v14, v14
    v_mfma_f32_16x16x32_bf16 v[84:87], v[20:23], v[192:195], v[84:87]
    v_mfma_f32_16x16x32_bf16 v[100:103], v[20:23], v[196:199], v[100:103]
    s_barrier
    ds_read_b64_tr_b16 v[16:17], v4 offset:40960
    ds_read_b64_tr_b16 v[18:19], v4 offset:41472
    v_add_f32 v11, 1.0, v11
    v_add_f32 v12, 1.0, v12
    v_add_f32 v13, 1.0, v13
    s_waitcnt lgkmcnt(10)
    v_mfma_f32_16x16x32_bf16 v[88:91], v[24:27], v[192:195], v[88:91]
    ds_read_b64_tr_b16 v[20:21], v5 offset:40960
    ds_read_b64_tr_b16 v[22:23], v5 offset:41472
    v_mfma_f32_16x16x32_bf16 v[104:107], v[24:27], v[196:199], v[104:107]
    v_add_f32 v14, 1.0, v14
    v_rcp_f32 v11, v11
    v_rcp_f32 v12, v12
    v_mfma_f32_16x16x32_bf16 v[92:95], v[28:31], v[192:195], v[92:95]
    ds_read_b64_tr_b16 v[24:25], v6 offset:40960
    ds_read_b64_tr_b16 v[26:27], v6 offset:41472
    v_mfma_f32_16x16x32_bf16 v[108:111], v[28:31], v[196:199], v[108:111]
    v_rcp_f32 v13, v13
    v_rcp_f32 v14, v14
    v_mul_f32 v64, v11, v64
    v_mul_f32 v65, v12, v65
    s_waitcnt lgkmcnt(10)
    v_mfma_f32_16x16x32_bf16 v[80:83], v[32:35], v[200:203], v[80:83]
    ds_read_b64_tr_b16 v[28:29], v7 offset:40960
    ds_read_b64_tr_b16 v[30:31], v7 offset:41472
    v_mfma_f32_16x16x32_bf16 v[96:99], v[32:35], v[204:207], v[96:99]
    v_mul_f32 v66, v13, v66
    v_mul_f32 v67, v14, v67
    v_mul_f32 v11, v68, v68
    v_mfma_f32_16x16x32_bf16 v[84:87], v[36:39], v[200:203], v[84:87]
    ds_read_b64_tr_b16 v[32:33], v4 offset:45056
    ds_read_b64_tr_b16 v[34:35], v4 offset:45568
    v_mfma_f32_16x16x32_bf16 v[100:103], v[36:39], v[204:207], v[100:103]
    v_mul_f32 v12, v69, v69
    v_mul_f32 v13, v70, v70
    v_mul_f32 v14, v71, v71
    s_waitcnt lgkmcnt(10)
    v_mfma_f32_16x16x32_bf16 v[88:91], v[40:43], v[200:203], v[88:91]
    ds_read_b64_tr_b16 v[36:37], v5 offset:45056
    ds_read_b64_tr_b16 v[38:39], v5 offset:45568
    v_mfma_f32_16x16x32_bf16 v[104:107], v[40:43], v[204:207], v[104:107]
    v_fma_f32 v11, v11, s26, v10
    v_fma_f32 v12, v12, s26, v10
    v_fma_f32 v13, v13, s26, v10
    v_fma_f32 v14, v14, s26, v10
    v_mfma_f32_16x16x32_bf16 v[92:95], v[44:47], v[200:203], v[92:95]
    ds_read_b64_tr_b16 v[40:41], v6 offset:45056
    ds_read_b64_tr_b16 v[42:43], v6 offset:45568
    v_mfma_f32_16x16x32_bf16 v[108:111], v[44:47], v[204:207], v[108:111]
    v_mul_f32 v11, v11, v68
    v_mul_f32 v12, v12, v69
    v_mul_f32 v13, v13, v70
    s_waitcnt lgkmcnt(10)
    v_mfma_f32_16x16x32_bf16 v[80:83], v[16:19], v[208:211], v[80:83]
    ds_read_b64_tr_b16 v[44:45], v7 offset:45056
    ds_read_b64_tr_b16 v[46:47], v7 offset:45568
    v_mfma_f32_16x16x32_bf16 v[96:99], v[16:19], v[212:215], v[96:99]
    v_mul_f32 v14, v14, v71
    v_exp_f32 v11, v11
    v_exp_f32 v12, v12
    v_mfma_f32_16x16x32_bf16 v[84:87], v[20:23], v[208:211], v[84:87]
    ds_read_b64_tr_b16 v[16:17], v4 offset:49152
    ds_read_b64_tr_b16 v[18:19], v4 offset:49664
    v_mfma_f32_16x16x32_bf16 v[100:103], v[20:23], v[212:215], v[100:103]
    v_exp_f32 v13, v13
    v_exp_f32 v14, v14
    v_add_f32 v11, 1.0, v11
    v_add_f32 v12, 1.0, v12
    s_waitcnt lgkmcnt(10)
    v_mfma_f32_16x16x32_bf16 v[88:91], v[24:27], v[208:211], v[88:91]
    ds_read_b64_tr_b16 v[20:21], v5 offset:49152
    ds_read_b64_tr_b16 v[22:23], v5 offset:49664
    v_mfma_f32_16x16x32_bf16 v[104:107], v[24:27], v[212:215], v[104:107]
    v_add_f32 v13, 1.0, v13
    v_add_f32 v14, 1.0, v14
    v_rcp_f32 v11, v11
    v_mfma_f32_16x16x32_bf16 v[92:95], v[28:31], v[208:211], v[92:95]
    ds_read_b64_tr_b16 v[24:25], v6 offset:49152
    ds_read_b64_tr_b16 v[26:27], v6 offset:49664
    v_mfma_f32_16x16x32_bf16 v[108:111], v[28:31], v[212:215], v[108:111]
    v_rcp_f32 v12, v12
    v_rcp_f32 v13, v13
    v_rcp_f32 v14, v14
    s_waitcnt lgkmcnt(10)
    v_mfma_f32_16x16x32_bf16 v[80:83], v[32:35], v[216:219], v[80:83]
    ds_read_b64_tr_b16 v[28:29], v7 offset:49152
    ds_read_b64_tr_b16 v[30:31], v7 offset:49664
    v_mfma_f32_16x16x32_bf16 v[96:99], v[32:35], v[220:223], v[96:99]
    v_mul_f32 v68, v11, v68
    v_mul_f32 v69, v12, v69
    v_mul_f32 v70, v13, v70
    v_mul_f32 v71, v14, v71
    v_mfma_f32_16x16x32_bf16 v[84:87], v[36:39], v[216:219], v[84:87]
    ds_read_b64_tr_b16 v[32:33], v4 offset:53248
    ds_read_b64_tr_b16 v[34:35], v4 offset:53760
    v_mfma_f32_16x16x32_bf16 v[100:103], v[36:39], v[220:223], v[100:103]
    v_mul_f32 v11, v72, v72
    v_mul_f32 v12, v73, v73
    v_mul_f32 v13, v74, v74
    s_waitcnt lgkmcnt(10)
    v_mfma_f32_16x16x32_bf16 v[88:91], v[40:43], v[216:219], v[88:91]
    ds_read_b64_tr_b16 v[36:37], v5 offset:53248
    ds_read_b64_tr_b16 v[38:39], v5 offset:53760
    v_mfma_f32_16x16x32_bf16 v[104:107], v[40:43], v[220:223], v[104:107]
    v_mul_f32 v14, v75, v75
    v_fma_f32 v11, v11, s26, v10
    v_fma_f32 v12, v12, s26, v10
    v_mfma_f32_16x16x32_bf16 v[92:95], v[44:47], v[216:219], v[92:95]
    ds_read_b64_tr_b16 v[40:41], v6 offset:53248
    ds_read_b64_tr_b16 v[42:43], v6 offset:53760
    v_mfma_f32_16x16x32_bf16 v[108:111], v[44:47], v[220:223], v[108:111]
    v_fma_f32 v13, v13, s26, v10
    v_fma_f32 v14, v14, s26, v10
    v_mul_f32 v11, v11, v72
    v_mul_f32 v12, v12, v73
    s_waitcnt lgkmcnt(10)
    v_mfma_f32_16x16x32_bf16 v[80:83], v[16:19], v[224:227], v[80:83]
    ds_read_b64_tr_b16 v[44:45], v7 offset:53248
    ds_read_b64_tr_b16 v[46:47], v7 offset:53760
    v_mfma_f32_16x16x32_bf16 v[96:99], v[16:19], v[228:231], v[96:99]
    v_mul_f32 v13, v13, v74
    v_mul_f32 v14, v14, v75
    v_exp_f32 v11, v11
    v_mfma_f32_16x16x32_bf16 v[84:87], v[20:23], v[224:227], v[84:87]
    ds_read_b64_tr_b16 v[16:17], v4 offset:57344
    ds_read_b64_tr_b16 v[18:19], v4 offset:57856
    v_mfma_f32_16x16x32_bf16 v[100:103], v[20:23], v[228:231], v[100:103]
    v_exp_f32 v12, v12
    v_exp_f32 v13, v13
    v_exp_f32 v14, v14
    s_waitcnt lgkmcnt(10)
    v_mfma_f32_16x16x32_bf16 v[88:91], v[24:27], v[224:227], v[88:91]
    ds_read_b64_tr_b16 v[20:21], v5 offset:57344
    ds_read_b64_tr_b16 v[22:23], v5 offset:57856
    v_mfma_f32_16x16x32_bf16 v[104:107], v[24:27], v[228:231], v[104:107]
    v_add_f32 v11, 1.0, v11
    v_add_f32 v12, 1.0, v12
    v_add_f32 v13, 1.0, v13
    v_add_f32 v14, 1.0, v14
    v_mfma_f32_16x16x32_bf16 v[92:95], v[28:31], v[224:227], v[92:95]
    ds_read_b64_tr_b16 v[24:25], v6 offset:57344
    ds_read_b64_tr_b16 v[26:27], v6 offset:57856
    v_mfma_f32_16x16x32_bf16 v[108:111], v[28:31], v[228:231], v[108:111]
    v_rcp_f32 v11, v11
    v_rcp_f32 v12, v12
    v_rcp_f32 v13, v13
    s_waitcnt lgkmcnt(10)
    v_mfma_f32_16x16x32_bf16 v[80:83], v[32:35], v[232:235], v[80:83]
    ds_read_b64_tr_b16 v[28:29], v7 offset:57344
    ds_read_b64_tr_b16 v[30:31], v7 offset:57856
    v_mfma_f32_16x16x32_bf16 v[96:99], v[32:35], v[236:239], v[96:99]
    v_rcp_f32 v14, v14
    v_mul_f32 v72, v11, v72
    v_mul_f32 v73, v12, v73
    v_mfma_f32_16x16x32_bf16 v[84:87], v[36:39], v[232:235], v[84:87]
    ds_read_b64_tr_b16 v[32:33], v4 offset:61440
    ds_read_b64_tr_b16 v[34:35], v4 offset:61952
    v_mfma_f32_16x16x32_bf16 v[100:103], v[36:39], v[236:239], v[100:103]
    v_mul_f32 v74, v13, v74
    v_mul_f32 v75, v14, v75
    v_mul_f32 v11, v76, v76
    v_mul_f32 v12, v77, v77
    s_waitcnt lgkmcnt(10)
    v_mfma_f32_16x16x32_bf16 v[88:91], v[40:43], v[232:235], v[88:91]
    ds_read_b64_tr_b16 v[36:37], v5 offset:61440
    ds_read_b64_tr_b16 v[38:39], v5 offset:61952
    v_mfma_f32_16x16x32_bf16 v[104:107], v[40:43], v[236:239], v[104:107]
    v_mul_f32 v13, v78, v78
    v_mul_f32 v14, v79, v79
    v_fma_f32 v11, v11, s26, v10
    v_mfma_f32_16x16x32_bf16 v[92:95], v[44:47], v[232:235], v[92:95]
    ds_read_b64_tr_b16 v[40:41], v6 offset:61440
    ds_read_b64_tr_b16 v[42:43], v6 offset:61952
    v_mfma_f32_16x16x32_bf16 v[108:111], v[44:47], v[236:239], v[108:111]
    v_fma_f32 v12, v12, s26, v10
    v_fma_f32 v13, v13, s26, v10
    v_fma_f32 v14, v14, s26, v10
    s_waitcnt lgkmcnt(10)
    v_mfma_f32_16x16x32_bf16 v[80:83], v[16:19], v[240:243], v[80:83]
    ds_read_b64_tr_b16 v[44:45], v7 offset:61440
    ds_read_b64_tr_b16 v[46:47], v7 offset:61952
    v_mfma_f32_16x16x32_bf16 v[96:99], v[16:19], v[244:247], v[96:99]
    v_mul_f32 v11, v11, v76
    v_mul_f32 v12, v12, v77
    v_mul_f32 v13, v13, v78
    v_mul_f32 v14, v14, v79
    v_mfma_f32_16x16x32_bf16 v[84:87], v[20:23], v[240:243], v[84:87]
    ds_read_b64_tr_b16 v[16:17], v8 offset:0
    ds_read_b64_tr_b16 v[18:19], v8 offset:512
    v_mfma_f32_16x16x32_bf16 v[100:103], v[20:23], v[244:247], v[100:103]
    v_exp_f32 v11, v11
    v_exp_f32 v12, v12
    v_exp_f32 v13, v13
    s_waitcnt lgkmcnt(10)
    v_mfma_f32_16x16x32_bf16 v[88:91], v[24:27], v[240:243], v[88:91]
    ds_read_b64_tr_b16 v[20:21], v9 offset:0
    ds_read_b64_tr_b16 v[22:23], v9 offset:512
    v_mfma_f32_16x16x32_bf16 v[104:107], v[24:27], v[244:247], v[104:107]
    v_exp_f32 v14, v14
    v_add_f32 v11, 1.0, v11
    v_add_f32 v12, 1.0, v12
    v_mfma_f32_16x16x32_bf16 v[92:95], v[28:31], v[240:243], v[92:95]
    ds_read_b64_tr_b16 v[24:25], v1 offset:0
    ds_read_b64_tr_b16 v[26:27], v1 offset:512
    v_mfma_f32_16x16x32_bf16 v[108:111], v[28:31], v[244:247], v[108:111]
    v_add_f32 v13, 1.0, v13
    v_add_f32 v14, 1.0, v14
    v_rcp_f32 v11, v11
    v_rcp_f32 v12, v12
    s_waitcnt lgkmcnt(10)
    v_mfma_f32_16x16x32_bf16 v[80:83], v[32:35], v[248:251], v[80:83]
    ds_read_b64_tr_b16 v[28:29], v0 offset:0
    ds_read_b64_tr_b16 v[30:31], v0 offset:512
    v_mfma_f32_16x16x32_bf16 v[96:99], v[32:35], v[252:255], v[96:99]
    v_rcp_f32 v13, v13
    v_rcp_f32 v14, v14
    v_mul_f32 v76, v11, v76
    v_mfma_f32_16x16x32_bf16 v[84:87], v[36:39], v[248:251], v[84:87]
    ds_read_b64_tr_b16 v[32:33], v8 offset:4096
    ds_read_b64_tr_b16 v[34:35], v8 offset:4608
    v_mfma_f32_16x16x32_bf16 v[100:103], v[36:39], v[252:255], v[100:103]
    v_mul_f32 v77, v12, v77
    v_mul_f32 v78, v13, v78
    v_mul_f32 v79, v14, v79
    s_waitcnt lgkmcnt(10)
    v_mfma_f32_16x16x32_bf16 v[88:91], v[40:43], v[248:251], v[88:91]
    ds_read_b64_tr_b16 v[36:37], v9 offset:4096
    ds_read_b64_tr_b16 v[38:39], v9 offset:4608
    v_mfma_f32_16x16x32_bf16 v[104:107], v[40:43], v[252:255], v[104:107]
    v_mfma_f32_16x16x32_bf16 v[92:95], v[44:47], v[248:251], v[92:95]
    ds_read_b64_tr_b16 v[40:41], v1 offset:4096
    ds_read_b64_tr_b16 v[42:43], v1 offset:4608
    v_mfma_f32_16x16x32_bf16 v[108:111], v[44:47], v[252:255], v[108:111]
    v_mul_f32 v80, v48, v80
    v_mul_f32 v81, v49, v81
    v_mul_f32 v82, v50, v82
    v_mul_f32 v83, v51, v83
    v_mul_f32 v96, v64, v96
    v_mul_f32 v97, v65, v97
    v_mul_f32 v98, v66, v98
    v_mul_f32 v99, v67, v99
    s_waitcnt lgkmcnt(10)
    v_mfma_f32_16x16x32_bf16 v[48:51], v[16:19], v[112:115], 0
    ds_read_b64_tr_b16 v[44:45], v0 offset:4096
    ds_read_b64_tr_b16 v[46:47], v0 offset:4608
    v_mfma_f32_16x16x32_bf16 v[64:67], v[16:19], v[116:119], 0
    v_mul_f32 v84, v52, v84
    v_mul_f32 v85, v53, v85
    v_mul_f32 v86, v54, v86
    v_mul_f32 v87, v55, v87
    v_mul_f32 v100, v68, v100
    v_mul_f32 v101, v69, v101
    v_mul_f32 v102, v70, v102
    v_mul_f32 v103, v71, v103
    v_mfma_f32_16x16x32_bf16 v[52:55], v[20:23], v[112:115], 0
    ds_read_b64_tr_b16 v[16:17], v8 offset:8192
    ds_read_b64_tr_b16 v[18:19], v8 offset:8704
    v_mfma_f32_16x16x32_bf16 v[68:71], v[20:23], v[116:119], 0
    v_mul_f32 v88, v56, v88
    v_mul_f32 v89, v57, v89
    v_mul_f32 v90, v58, v90
    v_mul_f32 v91, v59, v91
    v_mul_f32 v104, v72, v104
    v_mul_f32 v105, v73, v105
    v_mul_f32 v106, v74, v106
    v_mul_f32 v107, v75, v107
    s_waitcnt lgkmcnt(10)
    v_mfma_f32_16x16x32_bf16 v[56:59], v[24:27], v[112:115], 0
    ds_read_b64_tr_b16 v[20:21], v9 offset:8192
    ds_read_b64_tr_b16 v[22:23], v9 offset:8704
    v_mfma_f32_16x16x32_bf16 v[72:75], v[24:27], v[116:119], 0
    v_mul_f32 v92, v60, v92
    v_mul_f32 v93, v61, v93
    v_mul_f32 v94, v62, v94
    v_mul_f32 v95, v63, v95
    v_mul_f32 v108, v76, v108
    v_mul_f32 v109, v77, v109
    v_mul_f32 v110, v78, v110
    v_mul_f32 v111, v79, v111
    v_mfma_f32_16x16x32_bf16 v[60:63], v[28:31], v[112:115], 0
    ds_read_b64_tr_b16 v[24:25], v1 offset:8192
    ds_read_b64_tr_b16 v[26:27], v1 offset:8704
    v_mfma_f32_16x16x32_bf16 v[76:79], v[28:31], v[116:119], 0
    s_waitcnt lgkmcnt(10)
    v_mfma_f32_16x16x32_bf16 v[48:51], v[32:35], v[120:123], v[48:51]
    ds_read_b64_tr_b16 v[28:29], v0 offset:8192
    ds_read_b64_tr_b16 v[30:31], v0 offset:8704
    v_mfma_f32_16x16x32_bf16 v[64:67], v[32:35], v[124:127], v[64:67]
    v_cvt_pk_bf16_f32 v80, v80, v81
    v_mfma_f32_16x16x32_bf16 v[52:55], v[36:39], v[120:123], v[52:55]
    ds_read_b64_tr_b16 v[32:33], v8 offset:12288
    ds_read_b64_tr_b16 v[34:35], v8 offset:12800
    v_mfma_f32_16x16x32_bf16 v[68:71], v[36:39], v[124:127], v[68:71]
    v_cvt_pk_bf16_f32 v81, v82, v83
    s_waitcnt lgkmcnt(10)
    v_mfma_f32_16x16x32_bf16 v[56:59], v[40:43], v[120:123], v[56:59]
    ds_read_b64_tr_b16 v[36:37], v9 offset:12288
    ds_read_b64_tr_b16 v[38:39], v9 offset:12800
    v_mfma_f32_16x16x32_bf16 v[72:75], v[40:43], v[124:127], v[72:75]
    v_mfma_f32_16x16x32_bf16 v[60:63], v[44:47], v[120:123], v[60:63]
    ds_read_b64_tr_b16 v[40:41], v1 offset:12288
    ds_read_b64_tr_b16 v[42:43], v1 offset:12800
    v_mfma_f32_16x16x32_bf16 v[76:79], v[44:47], v[124:127], v[76:79]
    v_cvt_pk_bf16_f32 v82, v84, v85
    s_waitcnt lgkmcnt(10)
    v_mfma_f32_16x16x32_bf16 v[48:51], v[16:19], v[128:131], v[48:51]
    ds_read_b64_tr_b16 v[44:45], v0 offset:12288
    ds_read_b64_tr_b16 v[46:47], v0 offset:12800
    v_mfma_f32_16x16x32_bf16 v[64:67], v[16:19], v[132:135], v[64:67]
    v_mfma_f32_16x16x32_bf16 v[52:55], v[20:23], v[128:131], v[52:55]
    ds_read_b64_tr_b16 v[16:17], v8 offset:16384
    ds_read_b64_tr_b16 v[18:19], v8 offset:16896
    v_mfma_f32_16x16x32_bf16 v[68:71], v[20:23], v[132:135], v[68:71]
    v_cvt_pk_bf16_f32 v83, v86, v87
    s_waitcnt lgkmcnt(10)
    v_mfma_f32_16x16x32_bf16 v[56:59], v[24:27], v[128:131], v[56:59]
    ds_read_b64_tr_b16 v[20:21], v9 offset:16384
    ds_read_b64_tr_b16 v[22:23], v9 offset:16896
    v_mfma_f32_16x16x32_bf16 v[72:75], v[24:27], v[132:135], v[72:75]
    buffer_store_dwordx4 v[80:83], v15, s[16:19], s25 offen offset:0 sc1
    v_mfma_f32_16x16x32_bf16 v[60:63], v[28:31], v[128:131], v[60:63]
    ds_read_b64_tr_b16 v[24:25], v1 offset:16384
    ds_read_b64_tr_b16 v[26:27], v1 offset:16896
    v_mfma_f32_16x16x32_bf16 v[76:79], v[28:31], v[132:135], v[76:79]
    s_waitcnt lgkmcnt(10)
    v_mfma_f32_16x16x32_bf16 v[48:51], v[32:35], v[136:139], v[48:51]
    ds_read_b64_tr_b16 v[28:29], v0 offset:16384
    ds_read_b64_tr_b16 v[30:31], v0 offset:16896
    v_mfma_f32_16x16x32_bf16 v[64:67], v[32:35], v[140:143], v[64:67]
    v_cvt_pk_bf16_f32 v84, v88, v89
    v_mfma_f32_16x16x32_bf16 v[52:55], v[36:39], v[136:139], v[52:55]
    ds_read_b64_tr_b16 v[32:33], v8 offset:20480
    ds_read_b64_tr_b16 v[34:35], v8 offset:20992
    v_mfma_f32_16x16x32_bf16 v[68:71], v[36:39], v[140:143], v[68:71]
    s_waitcnt lgkmcnt(10)
    v_mfma_f32_16x16x32_bf16 v[56:59], v[40:43], v[136:139], v[56:59]
    ds_read_b64_tr_b16 v[36:37], v9 offset:20480
    ds_read_b64_tr_b16 v[38:39], v9 offset:20992
    v_mfma_f32_16x16x32_bf16 v[72:75], v[40:43], v[140:143], v[72:75]
    v_cvt_pk_bf16_f32 v85, v90, v91
    v_mfma_f32_16x16x32_bf16 v[60:63], v[44:47], v[136:139], v[60:63]
    ds_read_b64_tr_b16 v[40:41], v1 offset:20480
    ds_read_b64_tr_b16 v[42:43], v1 offset:20992
    v_mfma_f32_16x16x32_bf16 v[76:79], v[44:47], v[140:143], v[76:79]
    s_waitcnt lgkmcnt(10)
    v_mfma_f32_16x16x32_bf16 v[48:51], v[16:19], v[144:147], v[48:51]
    ds_read_b64_tr_b16 v[44:45], v0 offset:20480
    ds_read_b64_tr_b16 v[46:47], v0 offset:20992
    v_mfma_f32_16x16x32_bf16 v[64:67], v[16:19], v[148:151], v[64:67]
    v_cvt_pk_bf16_f32 v86, v92, v93
    v_mfma_f32_16x16x32_bf16 v[52:55], v[20:23], v[144:147], v[52:55]
    v_mfma_f32_16x16x32_bf16 v[68:71], v[20:23], v[148:151], v[68:71]
    s_barrier
    ds_read_b64_tr_b16 v[16:17], v8 offset:24576
    ds_read_b64_tr_b16 v[18:19], v8 offset:25088
    v_cvt_pk_bf16_f32 v87, v94, v95
    s_waitcnt lgkmcnt(10)
    v_mfma_f32_16x16x32_bf16 v[56:59], v[24:27], v[144:147], v[56:59]
    ds_read_b64_tr_b16 v[20:21], v9 offset:24576
    ds_read_b64_tr_b16 v[22:23], v9 offset:25088
    v_mfma_f32_16x16x32_bf16 v[72:75], v[24:27], v[148:151], v[72:75]
    v_mfma_f32_16x16x32_bf16 v[60:63], v[28:31], v[144:147], v[60:63]
    ds_read_b64_tr_b16 v[24:25], v1 offset:24576
    ds_read_b64_tr_b16 v[26:27], v1 offset:25088
    v_mfma_f32_16x16x32_bf16 v[76:79], v[28:31], v[148:151], v[76:79]
    buffer_store_dwordx4 v[84:87], v15, s[16:19], s25 offen offset:2048 sc1
    s_waitcnt lgkmcnt(10)
    v_mfma_f32_16x16x32_bf16 v[48:51], v[32:35], v[152:155], v[48:51]
    ds_read_b64_tr_b16 v[28:29], v0 offset:24576
    ds_read_b64_tr_b16 v[30:31], v0 offset:25088
    v_mfma_f32_16x16x32_bf16 v[64:67], v[32:35], v[156:159], v[64:67]
    v_mfma_f32_16x16x32_bf16 v[52:55], v[36:39], v[152:155], v[52:55]
    ds_read_b64_tr_b16 v[32:33], v8 offset:28672
    ds_read_b64_tr_b16 v[34:35], v8 offset:29184
    v_mfma_f32_16x16x32_bf16 v[68:71], v[36:39], v[156:159], v[68:71]
    v_cvt_pk_bf16_f32 v96, v96, v97
    s_waitcnt lgkmcnt(10)
    v_mfma_f32_16x16x32_bf16 v[56:59], v[40:43], v[152:155], v[56:59]
    ds_read_b64_tr_b16 v[36:37], v9 offset:28672
    ds_read_b64_tr_b16 v[38:39], v9 offset:29184
    v_mfma_f32_16x16x32_bf16 v[72:75], v[40:43], v[156:159], v[72:75]
    v_cvt_pk_bf16_f32 v97, v98, v99
    v_mfma_f32_16x16x32_bf16 v[60:63], v[44:47], v[152:155], v[60:63]
    ds_read_b64_tr_b16 v[40:41], v1 offset:28672
    ds_read_b64_tr_b16 v[42:43], v1 offset:29184
    v_mfma_f32_16x16x32_bf16 v[76:79], v[44:47], v[156:159], v[76:79]
    s_waitcnt lgkmcnt(10)
    v_mfma_f32_16x16x32_bf16 v[48:51], v[16:19], v[160:163], v[48:51]
    ds_read_b64_tr_b16 v[44:45], v0 offset:28672
    ds_read_b64_tr_b16 v[46:47], v0 offset:29184
    v_mfma_f32_16x16x32_bf16 v[64:67], v[16:19], v[164:167], v[64:67]
    v_cvt_pk_bf16_f32 v98, v100, v101
    v_mfma_f32_16x16x32_bf16 v[52:55], v[20:23], v[160:163], v[52:55]
    ds_read_b64_tr_b16 v[16:17], v4 offset:0
    ds_read_b64_tr_b16 v[18:19], v4 offset:512
    v_mfma_f32_16x16x32_bf16 v[68:71], v[20:23], v[164:167], v[68:71]
    s_waitcnt lgkmcnt(10)
    v_mfma_f32_16x16x32_bf16 v[56:59], v[24:27], v[160:163], v[56:59]
    ds_read_b64_tr_b16 v[20:21], v5 offset:0
    ds_read_b64_tr_b16 v[22:23], v5 offset:512
    v_mfma_f32_16x16x32_bf16 v[72:75], v[24:27], v[164:167], v[72:75]
    v_cvt_pk_bf16_f32 v99, v102, v103
    v_mfma_f32_16x16x32_bf16 v[60:63], v[28:31], v[160:163], v[60:63]
    ds_read_b64_tr_b16 v[24:25], v6 offset:0
    ds_read_b64_tr_b16 v[26:27], v6 offset:512
    v_mfma_f32_16x16x32_bf16 v[76:79], v[28:31], v[164:167], v[76:79]
    s_waitcnt lgkmcnt(10)
    v_mfma_f32_16x16x32_bf16 v[48:51], v[32:35], v[168:171], v[48:51]
    ds_read_b64_tr_b16 v[28:29], v7 offset:0
    ds_read_b64_tr_b16 v[30:31], v7 offset:512
    v_mfma_f32_16x16x32_bf16 v[64:67], v[32:35], v[172:175], v[64:67]
    buffer_store_dwordx4 v[96:99], v15, s[16:19], s25 offen offset:256 sc1
    v_mfma_f32_16x16x32_bf16 v[52:55], v[36:39], v[168:171], v[52:55]
    ds_read_b64_tr_b16 v[32:33], v4 offset:4096
    ds_read_b64_tr_b16 v[34:35], v4 offset:4608
    v_mfma_f32_16x16x32_bf16 v[68:71], v[36:39], v[172:175], v[68:71]
    v_cvt_pk_bf16_f32 v100, v104, v105
    s_waitcnt lgkmcnt(10)
    v_mfma_f32_16x16x32_bf16 v[56:59], v[40:43], v[168:171], v[56:59]
    ds_read_b64_tr_b16 v[36:37], v5 offset:4096
    ds_read_b64_tr_b16 v[38:39], v5 offset:4608
    v_mfma_f32_16x16x32_bf16 v[72:75], v[40:43], v[172:175], v[72:75]
    v_mfma_f32_16x16x32_bf16 v[60:63], v[44:47], v[168:171], v[60:63]
    ds_read_b64_tr_b16 v[40:41], v6 offset:4096
    ds_read_b64_tr_b16 v[42:43], v6 offset:4608
    v_mfma_f32_16x16x32_bf16 v[76:79], v[44:47], v[172:175], v[76:79]
    v_cvt_pk_bf16_f32 v101, v106, v107
    s_waitcnt lgkmcnt(10)
    v_mfma_f32_16x16x32_bf16 v[48:51], v[16:19], v[176:179], v[48:51]
    ds_read_b64_tr_b16 v[44:45], v7 offset:4096
    ds_read_b64_tr_b16 v[46:47], v7 offset:4608
    v_mfma_f32_16x16x32_bf16 v[64:67], v[16:19], v[180:183], v[64:67]
    v_mfma_f32_16x16x32_bf16 v[52:55], v[20:23], v[176:179], v[52:55]
    ds_read_b64_tr_b16 v[16:17], v4 offset:8192
    ds_read_b64_tr_b16 v[18:19], v4 offset:8704
    v_mfma_f32_16x16x32_bf16 v[68:71], v[20:23], v[180:183], v[68:71]
    v_cvt_pk_bf16_f32 v102, v108, v109
    s_waitcnt lgkmcnt(10)
    v_mfma_f32_16x16x32_bf16 v[56:59], v[24:27], v[176:179], v[56:59]
    ds_read_b64_tr_b16 v[20:21], v5 offset:8192
    ds_read_b64_tr_b16 v[22:23], v5 offset:8704
    v_mfma_f32_16x16x32_bf16 v[72:75], v[24:27], v[180:183], v[72:75]
    v_cvt_pk_bf16_f32 v103, v110, v111
    v_mfma_f32_16x16x32_bf16 v[60:63], v[28:31], v[176:179], v[60:63]
    ds_read_b64_tr_b16 v[24:25], v6 offset:8192
    ds_read_b64_tr_b16 v[26:27], v6 offset:8704
    v_mfma_f32_16x16x32_bf16 v[76:79], v[28:31], v[180:183], v[76:79]
    s_waitcnt lgkmcnt(10)
    v_mfma_f32_16x16x32_bf16 v[48:51], v[32:35], v[184:187], v[48:51]
    ds_read_b64_tr_b16 v[28:29], v7 offset:8192
    ds_read_b64_tr_b16 v[30:31], v7 offset:8704
    v_mfma_f32_16x16x32_bf16 v[64:67], v[32:35], v[188:191], v[64:67]
    buffer_store_dwordx4 v[100:103], v15, s[16:19], s25 offen offset:2304 sc1
    v_mfma_f32_16x16x32_bf16 v[52:55], v[36:39], v[184:187], v[52:55]
    ds_read_b64_tr_b16 v[32:33], v4 offset:12288
    ds_read_b64_tr_b16 v[34:35], v4 offset:12800
    v_mfma_f32_16x16x32_bf16 v[68:71], v[36:39], v[188:191], v[68:71]
    s_waitcnt lgkmcnt(10)
    v_mfma_f32_16x16x32_bf16 v[56:59], v[40:43], v[184:187], v[56:59]
    ds_read_b64_tr_b16 v[36:37], v5 offset:12288
    ds_read_b64_tr_b16 v[38:39], v5 offset:12800
    v_mfma_f32_16x16x32_bf16 v[72:75], v[40:43], v[188:191], v[72:75]
    s_add_u32 s25, s25, 4096
    v_mfma_f32_16x16x32_bf16 v[60:63], v[44:47], v[184:187], v[60:63]
    ds_read_b64_tr_b16 v[40:41], v6 offset:12288
    ds_read_b64_tr_b16 v[42:43], v6 offset:12800
    v_mfma_f32_16x16x32_bf16 v[76:79], v[44:47], v[188:191], v[76:79]
    s_waitcnt lgkmcnt(10)
    v_mfma_f32_16x16x32_bf16 v[48:51], v[16:19], v[192:195], v[48:51]
    ds_read_b64_tr_b16 v[44:45], v7 offset:12288
    ds_read_b64_tr_b16 v[46:47], v7 offset:12800
    v_mfma_f32_16x16x32_bf16 v[64:67], v[16:19], v[196:199], v[64:67]
    v_mfma_f32_16x16x32_bf16 v[52:55], v[20:23], v[192:195], v[52:55]
    ds_read_b64_tr_b16 v[16:17], v8 offset:32768
    ds_read_b64_tr_b16 v[18:19], v8 offset:33280
    v_mfma_f32_16x16x32_bf16 v[68:71], v[20:23], v[196:199], v[68:71]
    s_waitcnt lgkmcnt(10)
    v_mfma_f32_16x16x32_bf16 v[56:59], v[24:27], v[192:195], v[56:59]
    ds_read_b64_tr_b16 v[20:21], v9 offset:32768
    ds_read_b64_tr_b16 v[22:23], v9 offset:33280
    v_mfma_f32_16x16x32_bf16 v[72:75], v[24:27], v[196:199], v[72:75]
    v_mfma_f32_16x16x32_bf16 v[60:63], v[28:31], v[192:195], v[60:63]
    ds_read_b64_tr_b16 v[24:25], v1 offset:32768
    ds_read_b64_tr_b16 v[26:27], v1 offset:33280
    v_mfma_f32_16x16x32_bf16 v[76:79], v[28:31], v[196:199], v[76:79]
    s_waitcnt lgkmcnt(10)
    v_mfma_f32_16x16x32_bf16 v[48:51], v[32:35], v[200:203], v[48:51]
    ds_read_b64_tr_b16 v[28:29], v0 offset:32768
    ds_read_b64_tr_b16 v[30:31], v0 offset:33280
    v_mfma_f32_16x16x32_bf16 v[64:67], v[32:35], v[204:207], v[64:67]
    v_mfma_f32_16x16x32_bf16 v[52:55], v[36:39], v[200:203], v[52:55]
    ds_read_b64_tr_b16 v[32:33], v8 offset:36864
    ds_read_b64_tr_b16 v[34:35], v8 offset:37376
    v_mfma_f32_16x16x32_bf16 v[68:71], v[36:39], v[204:207], v[68:71]
    s_waitcnt lgkmcnt(10)
    v_mfma_f32_16x16x32_bf16 v[56:59], v[40:43], v[200:203], v[56:59]
    ds_read_b64_tr_b16 v[36:37], v9 offset:36864
    ds_read_b64_tr_b16 v[38:39], v9 offset:37376
    v_mfma_f32_16x16x32_bf16 v[72:75], v[40:43], v[204:207], v[72:75]
    v_mfma_f32_16x16x32_bf16 v[60:63], v[44:47], v[200:203], v[60:63]
    ds_read_b64_tr_b16 v[40:41], v1 offset:36864
    ds_read_b64_tr_b16 v[42:43], v1 offset:37376
    v_mfma_f32_16x16x32_bf16 v[76:79], v[44:47], v[204:207], v[76:79]
    s_waitcnt lgkmcnt(10)
    v_mfma_f32_16x16x32_bf16 v[48:51], v[16:19], v[208:211], v[48:51]
    ds_read_b64_tr_b16 v[44:45], v0 offset:36864
    ds_read_b64_tr_b16 v[46:47], v0 offset:37376
    v_mfma_f32_16x16x32_bf16 v[64:67], v[16:19], v[212:215], v[64:67]
    v_mfma_f32_16x16x32_bf16 v[52:55], v[20:23], v[208:211], v[52:55]
    ds_read_b64_tr_b16 v[16:17], v8 offset:40960
    ds_read_b64_tr_b16 v[18:19], v8 offset:41472
    v_mfma_f32_16x16x32_bf16 v[68:71], v[20:23], v[212:215], v[68:71]
    s_waitcnt lgkmcnt(10)
    v_mfma_f32_16x16x32_bf16 v[56:59], v[24:27], v[208:211], v[56:59]
    ds_read_b64_tr_b16 v[20:21], v9 offset:40960
    ds_read_b64_tr_b16 v[22:23], v9 offset:41472
    v_mfma_f32_16x16x32_bf16 v[72:75], v[24:27], v[212:215], v[72:75]
    v_mfma_f32_16x16x32_bf16 v[60:63], v[28:31], v[208:211], v[60:63]
    ds_read_b64_tr_b16 v[24:25], v1 offset:40960
    ds_read_b64_tr_b16 v[26:27], v1 offset:41472
    v_mfma_f32_16x16x32_bf16 v[76:79], v[28:31], v[212:215], v[76:79]
    s_waitcnt lgkmcnt(10)
    v_mfma_f32_16x16x32_bf16 v[48:51], v[32:35], v[216:219], v[48:51]
    ds_read_b64_tr_b16 v[28:29], v0 offset:40960
    ds_read_b64_tr_b16 v[30:31], v0 offset:41472
    v_mfma_f32_16x16x32_bf16 v[64:67], v[32:35], v[220:223], v[64:67]
    v_mfma_f32_16x16x32_bf16 v[52:55], v[36:39], v[216:219], v[52:55]
    ds_read_b64_tr_b16 v[32:33], v8 offset:45056
    ds_read_b64_tr_b16 v[34:35], v8 offset:45568
    v_mfma_f32_16x16x32_bf16 v[68:71], v[36:39], v[220:223], v[68:71]
    s_waitcnt lgkmcnt(10)
    v_mfma_f32_16x16x32_bf16 v[56:59], v[40:43], v[216:219], v[56:59]
    ds_read_b64_tr_b16 v[36:37], v9 offset:45056
    ds_read_b64_tr_b16 v[38:39], v9 offset:45568
    v_mfma_f32_16x16x32_bf16 v[72:75], v[40:43], v[220:223], v[72:75]
    v_mfma_f32_16x16x32_bf16 v[60:63], v[44:47], v[216:219], v[60:63]
    ds_read_b64_tr_b16 v[40:41], v1 offset:45056
    ds_read_b64_tr_b16 v[42:43], v1 offset:45568
    v_mfma_f32_16x16x32_bf16 v[76:79], v[44:47], v[220:223], v[76:79]
    s_waitcnt lgkmcnt(10)
    v_mfma_f32_16x16x32_bf16 v[48:51], v[16:19], v[224:227], v[48:51]
    ds_read_b64_tr_b16 v[44:45], v0 offset:45056
    ds_read_b64_tr_b16 v[46:47], v0 offset:45568
    v_mfma_f32_16x16x32_bf16 v[64:67], v[16:19], v[228:231], v[64:67]
    v_mfma_f32_16x16x32_bf16 v[52:55], v[20:23], v[224:227], v[52:55]
    ds_read_b64_tr_b16 v[16:17], v8 offset:49152
    ds_read_b64_tr_b16 v[18:19], v8 offset:49664
    v_mfma_f32_16x16x32_bf16 v[68:71], v[20:23], v[228:231], v[68:71]
    s_waitcnt lgkmcnt(10)
    v_mfma_f32_16x16x32_bf16 v[56:59], v[24:27], v[224:227], v[56:59]
    ds_read_b64_tr_b16 v[20:21], v9 offset:49152
    ds_read_b64_tr_b16 v[22:23], v9 offset:49664
    v_mfma_f32_16x16x32_bf16 v[72:75], v[24:27], v[228:231], v[72:75]
    v_mfma_f32_16x16x32_bf16 v[60:63], v[28:31], v[224:227], v[60:63]
    ds_read_b64_tr_b16 v[24:25], v1 offset:49152
    ds_read_b64_tr_b16 v[26:27], v1 offset:49664
    v_mfma_f32_16x16x32_bf16 v[76:79], v[28:31], v[228:231], v[76:79]
    s_waitcnt lgkmcnt(10)
    v_mfma_f32_16x16x32_bf16 v[48:51], v[32:35], v[232:235], v[48:51]
    ds_read_b64_tr_b16 v[28:29], v0 offset:49152
    ds_read_b64_tr_b16 v[30:31], v0 offset:49664
    v_mfma_f32_16x16x32_bf16 v[64:67], v[32:35], v[236:239], v[64:67]
    v_mfma_f32_16x16x32_bf16 v[52:55], v[36:39], v[232:235], v[52:55]
    ds_read_b64_tr_b16 v[32:33], v8 offset:53248
    ds_read_b64_tr_b16 v[34:35], v8 offset:53760
    v_mfma_f32_16x16x32_bf16 v[68:71], v[36:39], v[236:239], v[68:71]
    s_waitcnt lgkmcnt(10)
    v_mfma_f32_16x16x32_bf16 v[56:59], v[40:43], v[232:235], v[56:59]
    ds_read_b64_tr_b16 v[36:37], v9 offset:53248
    ds_read_b64_tr_b16 v[38:39], v9 offset:53760
    v_mfma_f32_16x16x32_bf16 v[72:75], v[40:43], v[236:239], v[72:75]
    v_mfma_f32_16x16x32_bf16 v[60:63], v[44:47], v[232:235], v[60:63]
    ds_read_b64_tr_b16 v[40:41], v1 offset:53248
    ds_read_b64_tr_b16 v[42:43], v1 offset:53760
    v_mfma_f32_16x16x32_bf16 v[76:79], v[44:47], v[236:239], v[76:79]
    s_waitcnt lgkmcnt(10)
    v_mfma_f32_16x16x32_bf16 v[48:51], v[16:19], v[240:243], v[48:51]
    ds_read_b64_tr_b16 v[44:45], v0 offset:53248
    ds_read_b64_tr_b16 v[46:47], v0 offset:53760
    v_mfma_f32_16x16x32_bf16 v[64:67], v[16:19], v[244:247], v[64:67]
    v_mfma_f32_16x16x32_bf16 v[52:55], v[20:23], v[240:243], v[52:55]
    v_mfma_f32_16x16x32_bf16 v[68:71], v[20:23], v[244:247], v[68:71]
    s_barrier
    ds_read_b64_tr_b16 v[16:17], v8 offset:57344
    ds_read_b64_tr_b16 v[18:19], v8 offset:57856
    s_waitcnt lgkmcnt(10)
    v_mfma_f32_16x16x32_bf16 v[56:59], v[24:27], v[240:243], v[56:59]
    ds_read_b64_tr_b16 v[20:21], v9 offset:57344
    ds_read_b64_tr_b16 v[22:23], v9 offset:57856
    v_mfma_f32_16x16x32_bf16 v[72:75], v[24:27], v[244:247], v[72:75]
    v_mfma_f32_16x16x32_bf16 v[60:63], v[28:31], v[240:243], v[60:63]
    ds_read_b64_tr_b16 v[24:25], v1 offset:57344
    ds_read_b64_tr_b16 v[26:27], v1 offset:57856
    v_mfma_f32_16x16x32_bf16 v[76:79], v[28:31], v[244:247], v[76:79]
    s_waitcnt lgkmcnt(10)
    v_mfma_f32_16x16x32_bf16 v[48:51], v[32:35], v[248:251], v[48:51]
    ds_read_b64_tr_b16 v[28:29], v0 offset:57344
    ds_read_b64_tr_b16 v[30:31], v0 offset:57856
    v_mfma_f32_16x16x32_bf16 v[64:67], v[32:35], v[252:255], v[64:67]
    v_mfma_f32_16x16x32_bf16 v[52:55], v[36:39], v[248:251], v[52:55]
    ds_read_b64_tr_b16 v[32:33], v8 offset:61440
    ds_read_b64_tr_b16 v[34:35], v8 offset:61952
    v_mfma_f32_16x16x32_bf16 v[68:71], v[36:39], v[252:255], v[68:71]
    s_waitcnt lgkmcnt(10)
    v_mfma_f32_16x16x32_bf16 v[56:59], v[40:43], v[248:251], v[56:59]
    ds_read_b64_tr_b16 v[36:37], v9 offset:61440
    ds_read_b64_tr_b16 v[38:39], v9 offset:61952
    v_mfma_f32_16x16x32_bf16 v[72:75], v[40:43], v[252:255], v[72:75]
    v_mfma_f32_16x16x32_bf16 v[60:63], v[44:47], v[248:251], v[60:63]
    ds_read_b64_tr_b16 v[40:41], v1 offset:61440
    ds_read_b64_tr_b16 v[42:43], v1 offset:61952
    v_mfma_f32_16x16x32_bf16 v[76:79], v[44:47], v[252:255], v[76:79]
    s_waitcnt lgkmcnt(10)
    v_mfma_f32_16x16x32_bf16 v[80:83], v[16:19], v[112:115], 0
    ds_read_b64_tr_b16 v[44:45], v0 offset:61440
    ds_read_b64_tr_b16 v[46:47], v0 offset:61952
    v_mfma_f32_16x16x32_bf16 v[96:99], v[16:19], v[116:119], 0
    v_mfma_f32_16x16x32_bf16 v[84:87], v[20:23], v[112:115], 0
    ds_read_b64_tr_b16 v[16:17], v4 offset:16384
    ds_read_b64_tr_b16 v[18:19], v4 offset:16896
    v_mfma_f32_16x16x32_bf16 v[100:103], v[20:23], v[116:119], 0
    s_waitcnt lgkmcnt(10)
    v_mfma_f32_16x16x32_bf16 v[88:91], v[24:27], v[112:115], 0
    ds_read_b64_tr_b16 v[20:21], v5 offset:16384
    ds_read_b64_tr_b16 v[22:23], v5 offset:16896
    v_mfma_f32_16x16x32_bf16 v[104:107], v[24:27], v[116:119], 0
    v_mfma_f32_16x16x32_bf16 v[92:95], v[28:31], v[112:115], 0
    ds_read_b64_tr_b16 v[24:25], v6 offset:16384
    ds_read_b64_tr_b16 v[26:27], v6 offset:16896
    v_mfma_f32_16x16x32_bf16 v[108:111], v[28:31], v[116:119], 0
    v_mul_f32 v11, v48, v48
    v_mul_f32 v12, v49, v49
    v_mul_f32 v13, v50, v50
    v_mul_f32 v14, v51, v51
    s_waitcnt lgkmcnt(10)
    v_mfma_f32_16x16x32_bf16 v[80:83], v[32:35], v[120:123], v[80:83]
    ds_read_b64_tr_b16 v[28:29], v7 offset:16384
    ds_read_b64_tr_b16 v[30:31], v7 offset:16896
    v_mfma_f32_16x16x32_bf16 v[96:99], v[32:35], v[124:127], v[96:99]
    v_fma_f32 v11, v11, s26, v10
    v_fma_f32 v12, v12, s26, v10
    v_fma_f32 v13, v13, s26, v10
    v_mfma_f32_16x16x32_bf16 v[84:87], v[36:39], v[120:123], v[84:87]
    ds_read_b64_tr_b16 v[32:33], v4 offset:20480
    ds_read_b64_tr_b16 v[34:35], v4 offset:20992
    v_mfma_f32_16x16x32_bf16 v[100:103], v[36:39], v[124:127], v[100:103]
    v_fma_f32 v14, v14, s26, v10
    v_mul_f32 v11, v11, v48
    v_mul_f32 v12, v12, v49
    v_mul_f32 v13, v13, v50
    s_waitcnt lgkmcnt(10)
    v_mfma_f32_16x16x32_bf16 v[88:91], v[40:43], v[120:123], v[88:91]
    ds_read_b64_tr_b16 v[36:37], v5 offset:20480
    ds_read_b64_tr_b16 v[38:39], v5 offset:20992
    v_mfma_f32_16x16x32_bf16 v[104:107], v[40:43], v[124:127], v[104:107]
    v_mul_f32 v14, v14, v51
    v_exp_f32 v11, v11
    v_exp_f32 v12, v12
    v_mfma_f32_16x16x32_bf16 v[92:95], v[44:47], v[120:123], v[92:95]
    ds_read_b64_tr_b16 v[40:41], v6 offset:20480
    ds_read_b64_tr_b16 v[42:43], v6 offset:20992
    v_mfma_f32_16x16x32_bf16 v[108:111], v[44:47], v[124:127], v[108:111]
    v_exp_f32 v13, v13
    v_exp_f32 v14, v14
    v_add_f32 v11, 1.0, v11
    s_waitcnt lgkmcnt(10)
    v_mfma_f32_16x16x32_bf16 v[80:83], v[16:19], v[128:131], v[80:83]
    ds_read_b64_tr_b16 v[44:45], v7 offset:20480
    ds_read_b64_tr_b16 v[46:47], v7 offset:20992
    v_mfma_f32_16x16x32_bf16 v[96:99], v[16:19], v[132:135], v[96:99]
    v_add_f32 v12, 1.0, v12
    v_add_f32 v13, 1.0, v13
    v_add_f32 v14, 1.0, v14
    v_rcp_f32 v11, v11
    v_mfma_f32_16x16x32_bf16 v[84:87], v[20:23], v[128:131], v[84:87]
    ds_read_b64_tr_b16 v[16:17], v4 offset:24576
    ds_read_b64_tr_b16 v[18:19], v4 offset:25088
    v_mfma_f32_16x16x32_bf16 v[100:103], v[20:23], v[132:135], v[100:103]
    v_rcp_f32 v12, v12
    v_rcp_f32 v13, v13
    v_rcp_f32 v14, v14
    s_waitcnt lgkmcnt(10)
    v_mfma_f32_16x16x32_bf16 v[88:91], v[24:27], v[128:131], v[88:91]
    ds_read_b64_tr_b16 v[20:21], v5 offset:24576
    ds_read_b64_tr_b16 v[22:23], v5 offset:25088
    v_mfma_f32_16x16x32_bf16 v[104:107], v[24:27], v[132:135], v[104:107]
    v_mul_f32 v48, v11, v48
    v_mul_f32 v49, v12, v49
    v_mul_f32 v50, v13, v50
    v_mfma_f32_16x16x32_bf16 v[92:95], v[28:31], v[128:131], v[92:95]
    ds_read_b64_tr_b16 v[24:25], v6 offset:24576
    ds_read_b64_tr_b16 v[26:27], v6 offset:25088
    v_mfma_f32_16x16x32_bf16 v[108:111], v[28:31], v[132:135], v[108:111]
    v_mul_f32 v51, v14, v51
    v_mul_f32 v11, v52, v52
    v_mul_f32 v12, v53, v53
    v_mul_f32 v13, v54, v54
    s_waitcnt lgkmcnt(10)
    v_mfma_f32_16x16x32_bf16 v[80:83], v[32:35], v[136:139], v[80:83]
    ds_read_b64_tr_b16 v[28:29], v7 offset:24576
    ds_read_b64_tr_b16 v[30:31], v7 offset:25088
    v_mfma_f32_16x16x32_bf16 v[96:99], v[32:35], v[140:143], v[96:99]
    v_mul_f32 v14, v55, v55
    v_fma_f32 v11, v11, s26, v10
    v_fma_f32 v12, v12, s26, v10
    v_mfma_f32_16x16x32_bf16 v[84:87], v[36:39], v[136:139], v[84:87]
    ds_read_b64_tr_b16 v[32:33], v4 offset:28672
    ds_read_b64_tr_b16 v[34:35], v4 offset:29184
    v_mfma_f32_16x16x32_bf16 v[100:103], v[36:39], v[140:143], v[100:103]
    v_fma_f32 v13, v13, s26, v10
    v_fma_f32 v14, v14, s26, v10
    v_mul_f32 v11, v11, v52
    s_waitcnt lgkmcnt(10)
    v_mfma_f32_16x16x32_bf16 v[88:91], v[40:43], v[136:139], v[88:91]
    ds_read_b64_tr_b16 v[36:37], v5 offset:28672
    ds_read_b64_tr_b16 v[38:39], v5 offset:29184
    v_mfma_f32_16x16x32_bf16 v[104:107], v[40:43], v[140:143], v[104:107]
    v_mul_f32 v12, v12, v53
    v_mul_f32 v13, v13, v54
    v_mul_f32 v14, v14, v55
    v_exp_f32 v11, v11
    v_mfma_f32_16x16x32_bf16 v[92:95], v[44:47], v[136:139], v[92:95]
    ds_read_b64_tr_b16 v[40:41], v6 offset:28672
    ds_read_b64_tr_b16 v[42:43], v6 offset:29184
    v_mfma_f32_16x16x32_bf16 v[108:111], v[44:47], v[140:143], v[108:111]
    v_exp_f32 v12, v12
    v_exp_f32 v13, v13
    v_exp_f32 v14, v14
    s_waitcnt lgkmcnt(10)
    v_mfma_f32_16x16x32_bf16 v[80:83], v[16:19], v[144:147], v[80:83]
    ds_read_b64_tr_b16 v[44:45], v7 offset:28672
    ds_read_b64_tr_b16 v[46:47], v7 offset:29184
    v_mfma_f32_16x16x32_bf16 v[96:99], v[16:19], v[148:151], v[96:99]
    v_add_f32 v11, 1.0, v11
    v_add_f32 v12, 1.0, v12
    v_add_f32 v13, 1.0, v13
    v_mfma_f32_16x16x32_bf16 v[84:87], v[20:23], v[144:147], v[84:87]
    ds_read_b64_tr_b16 v[16:17], v4 offset:32768
    ds_read_b64_tr_b16 v[18:19], v4 offset:33280
    v_mfma_f32_16x16x32_bf16 v[100:103], v[20:23], v[148:151], v[100:103]
    v_add_f32 v14, 1.0, v14
    v_rcp_f32 v11, v11
    v_rcp_f32 v12, v12
    v_rcp_f32 v13, v13
    s_waitcnt lgkmcnt(10)
    v_mfma_f32_16x16x32_bf16 v[88:91], v[24:27], v[144:147], v[88:91]
    ds_read_b64_tr_b16 v[20:21], v5 offset:32768
    ds_read_b64_tr_b16 v[22:23], v5 offset:33280
    v_mfma_f32_16x16x32_bf16 v[104:107], v[24:27], v[148:151], v[104:107]
    v_rcp_f32 v14, v14
    v_mul_f32 v52, v11, v52
    v_mul_f32 v53, v12, v53
    v_mfma_f32_16x16x32_bf16 v[92:95], v[28:31], v[144:147], v[92:95]
    ds_read_b64_tr_b16 v[24:25], v6 offset:32768
    ds_read_b64_tr_b16 v[26:27], v6 offset:33280
    v_mfma_f32_16x16x32_bf16 v[108:111], v[28:31], v[148:151], v[108:111]
    v_mul_f32 v54, v13, v54
    v_mul_f32 v55, v14, v55
    v_mul_f32 v11, v56, v56
    s_waitcnt lgkmcnt(10)
    v_mfma_f32_16x16x32_bf16 v[80:83], v[32:35], v[152:155], v[80:83]
    ds_read_b64_tr_b16 v[28:29], v7 offset:32768
    ds_read_b64_tr_b16 v[30:31], v7 offset:33280
    v_mfma_f32_16x16x32_bf16 v[96:99], v[32:35], v[156:159], v[96:99]
    v_mul_f32 v12, v57, v57
    v_mul_f32 v13, v58, v58
    v_mul_f32 v14, v59, v59
    v_fma_f32 v11, v11, s26, v10
    v_mfma_f32_16x16x32_bf16 v[84:87], v[36:39], v[152:155], v[84:87]
    ds_read_b64_tr_b16 v[32:33], v4 offset:36864
    ds_read_b64_tr_b16 v[34:35], v4 offset:37376
    v_mfma_f32_16x16x32_bf16 v[100:103], v[36:39], v[156:159], v[100:103]
    v_fma_f32 v12, v12, s26, v10
    v_fma_f32 v13, v13, s26, v10
    v_fma_f32 v14, v14, s26, v10
    s_waitcnt lgkmcnt(10)
    v_mfma_f32_16x16x32_bf16 v[88:91], v[40:43], v[152:155], v[88:91]
    ds_read_b64_tr_b16 v[36:37], v5 offset:36864
    ds_read_b64_tr_b16 v[38:39], v5 offset:37376
    v_mfma_f32_16x16x32_bf16 v[104:107], v[40:43], v[156:159], v[104:107]
    v_mul_f32 v11, v11, v56
    v_mul_f32 v12, v12, v57
    v_mul_f32 v13, v13, v58
    v_mfma_f32_16x16x32_bf16 v[92:95], v[44:47], v[152:155], v[92:95]
    ds_read_b64_tr_b16 v[40:41], v6 offset:36864
    ds_read_b64_tr_b16 v[42:43], v6 offset:37376
    v_mfma_f32_16x16x32_bf16 v[108:111], v[44:47], v[156:159], v[108:111]
    v_mul_f32 v14, v14, v59
    v_exp_f32 v11, v11
    v_exp_f32 v12, v12
    v_exp_f32 v13, v13
    s_waitcnt lgkmcnt(10)
    v_mfma_f32_16x16x32_bf16 v[80:83], v[16:19], v[160:163], v[80:83]
    ds_read_b64_tr_b16 v[44:45], v7 offset:36864
    ds_read_b64_tr_b16 v[46:47], v7 offset:37376
    v_mfma_f32_16x16x32_bf16 v[96:99], v[16:19], v[164:167], v[96:99]
    v_exp_f32 v14, v14
    v_add_f32 v11, 1.0, v11
    v_add_f32 v12, 1.0, v12
    v_mfma_f32_16x16x32_bf16 v[84:87], v[20:23], v[160:163], v[84:87]
    ds_read_b64_tr_b16 v[16:17], v4 offset:40960
    ds_read_b64_tr_b16 v[18:19], v4 offset:41472
    v_mfma_f32_16x16x32_bf16 v[100:103], v[20:23], v[164:167], v[100:103]
    v_add_f32 v13, 1.0, v13
    v_add_f32 v14, 1.0, v14
    v_rcp_f32 v11, v11
    s_waitcnt lgkmcnt(10)
    v_mfma_f32_16x16x32_bf16 v[88:91], v[24:27], v[160:163], v[88:91]
    ds_read_b64_tr_b16 v[20:21], v5 offset:40960
    ds_read_b64_tr_b16 v[22:23], v5 offset:41472
    v_mfma_f32_16x16x32_bf16 v[104:107], v[24:27], v[164:167], v[104:107]
    v_rcp_f32 v12, v12
    v_rcp_f32 v13, v13
    v_rcp_f32 v14, v14
    v_mul_f32 v56, v11, v56
    v_mfma_f32_16x16x32_bf16 v[92:95], v[28:31], v[160:163], v[92:95]
    ds_read_b64_tr_b16 v[24:25], v6 offset:40960
    ds_read_b64_tr_b16 v[26:27], v6 offset:41472
    v_mfma_f32_16x16x32_bf16 v[108:111], v[28:31], v[164:167], v[108:111]
    v_mul_f32 v57, v12, v57
    v_mul_f32 v58, v13, v58
    v_mul_f32 v59, v14, v59
    s_waitcnt lgkmcnt(10)
    v_mfma_f32_16x16x32_bf16 v[80:83], v[32:35], v[168:171], v[80:83]
    ds_read_b64_tr_b16 v[28:29], v7 offset:40960
    ds_read_b64_tr_b16 v[30:31], v7 offset:41472
    v_mfma_f32_16x16x32_bf16 v[96:99], v[32:35], v[172:175], v[96:99]
    v_mul_f32 v11, v60, v60
    v_mul_f32 v12, v61, v61
    v_mul_f32 v13, v62, v62
    v_mfma_f32_16x16x32_bf16 v[84:87], v[36:39], v[168:171], v[84:87]
    ds_read_b64_tr_b16 v[32:33], v4 offset:45056
    ds_read_b64_tr_b16 v[34:35], v4 offset:45568
    v_mfma_f32_16x16x32_bf16 v[100:103], v[36:39], v[172:175], v[100:103]
    v_mul_f32 v14, v63, v63
    v_fma_f32 v11, v11, s26, v10
    v_fma_f32 v12, v12, s26, v10
    v_fma_f32 v13, v13, s26, v10
    s_waitcnt lgkmcnt(10)
    v_mfma_f32_16x16x32_bf16 v[88:91], v[40:43], v[168:171], v[88:91]
    ds_read_b64_tr_b16 v[36:37], v5 offset:45056
    ds_read_b64_tr_b16 v[38:39], v5 offset:45568
    v_mfma_f32_16x16x32_bf16 v[104:107], v[40:43], v[172:175], v[104:107]
    v_fma_f32 v14, v14, s26, v10
    v_mul_f32 v11, v11, v60
    v_mul_f32 v12, v12, v61
    v_mfma_f32_16x16x32_bf16 v[92:95], v[44:47], v[168:171], v[92:95]
    ds_read_b64_tr_b16 v[40:41], v6 offset:45056
    ds_read_b64_tr_b16 v[42:43], v6 offset:45568
    v_mfma_f32_16x16x32_bf16 v[108:111], v[44:47], v[172:175], v[108:111]
    v_mul_f32 v13, v13, v62
    v_mul_f32 v14, v14, v63
    v_exp_f32 v11, v11
    s_waitcnt lgkmcnt(10)
    v_mfma_f32_16x16x32_bf16 v[80:83], v[16:19], v[176:179], v[80:83]
    ds_read_b64_tr_b16 v[44:45], v7 offset:45056
    ds_read_b64_tr_b16 v[46:47], v7 offset:45568
    v_mfma_f32_16x16x32_bf16 v[96:99], v[16:19], v[180:183], v[96:99]
    v_exp_f32 v12, v12
    v_exp_f32 v13, v13
    v_exp_f32 v14, v14
    v_add_f32 v11, 1.0, v11
    v_mfma_f32_16x16x32_bf16 v[84:87], v[20:23], v[176:179], v[84:87]
    ds_read_b64_tr_b16 v[16:17], v4 offset:49152
    ds_read_b64_tr_b16 v[18:19], v4 offset:49664
    v_mfma_f32_16x16x32_bf16 v[100:103], v[20:23], v[180:183], v[100:103]
    v_add_f32 v12, 1.0, v12
    v_add_f32 v13, 1.0, v13
    v_add_f32 v14, 1.0, v14
    s_waitcnt lgkmcnt(10)
    v_mfma_f32_16x16x32_bf16 v[88:91], v[24:27], v[176:179], v[88:91]
    ds_read_b64_tr_b16 v[20:21], v5 offset:49152
    ds_read_b64_tr_b16 v[22:23], v5 offset:49664
    v_mfma_f32_16x16x32_bf16 v[104:107], v[24:27], v[180:183], v[104:107]
    v_rcp_f32 v11, v11
    v_rcp_f32 v12, v12
    v_rcp_f32 v13, v13
    v_mfma_f32_16x16x32_bf16 v[92:95], v[28:31], v[176:179], v[92:95]
    ds_read_b64_tr_b16 v[24:25], v6 offset:49152
    ds_read_b64_tr_b16 v[26:27], v6 offset:49664
    v_mfma_f32_16x16x32_bf16 v[108:111], v[28:31], v[180:183], v[108:111]
    v_rcp_f32 v14, v14
    v_mul_f32 v60, v11, v60
    v_mul_f32 v61, v12, v61
    v_mul_f32 v62, v13, v62
    s_waitcnt lgkmcnt(10)
    v_mfma_f32_16x16x32_bf16 v[80:83], v[32:35], v[184:187], v[80:83]
    ds_read_b64_tr_b16 v[28:29], v7 offset:49152
    ds_read_b64_tr_b16 v[30:31], v7 offset:49664
    v_mfma_f32_16x16x32_bf16 v[96:99], v[32:35], v[188:191], v[96:99]
    v_mul_f32 v63, v14, v63
    v_mul_f32 v11, v64, v64
    v_mul_f32 v12, v65, v65
    v_mfma_f32_16x16x32_bf16 v[84:87], v[36:39], v[184:187], v[84:87]
    ds_read_b64_tr_b16 v[32:33], v4 offset:53248
    ds_read_b64_tr_b16 v[34:35], v4 offset:53760
    v_mfma_f32_16x16x32_bf16 v[100:103], v[36:39], v[188:191], v[100:103]
    v_mul_f32 v13, v66, v66
    v_mul_f32 v14, v67, v67
    v_fma_f32 v11, v11, s26, v10
    v_fma_f32 v12, v12, s26, v10
    s_waitcnt lgkmcnt(10)
    v_mfma_f32_16x16x32_bf16 v[88:91], v[40:43], v[184:187], v[88:91]
    ds_read_b64_tr_b16 v[36:37], v5 offset:53248
    ds_read_b64_tr_b16 v[38:39], v5 offset:53760
    v_mfma_f32_16x16x32_bf16 v[104:107], v[40:43], v[188:191], v[104:107]
    v_fma_f32 v13, v13, s26, v10
    v_fma_f32 v14, v14, s26, v10
    v_mul_f32 v11, v11, v64
    v_mfma_f32_16x16x32_bf16 v[92:95], v[44:47], v[184:187], v[92:95]
    ds_read_b64_tr_b16 v[40:41], v6 offset:53248
    ds_read_b64_tr_b16 v[42:43], v6 offset:53760
    v_mfma_f32_16x16x32_bf16 v[108:111], v[44:47], v[188:191], v[108:111]
    v_mul_f32 v12, v12, v65
    v_mul_f32 v13, v13, v66
    v_mul_f32 v14, v14, v67
    s_waitcnt lgkmcnt(10)
    v_mfma_f32_16x16x32_bf16 v[80:83], v[16:19], v[192:195], v[80:83]
    ds_read_b64_tr_b16 v[44:45], v7 offset:53248
    ds_read_b64_tr_b16 v[46:47], v7 offset:53760
    v_mfma_f32_16x16x32_bf16 v[96:99], v[16:19], v[196:199], v[96:99]
    v_exp_f32 v11, v11
    v_exp_f32 v12, v12
    v_exp_f32 v13, v13
    v_exp_f32 v14, v14
    v_mfma_f32_16x16x32_bf16 v[84:87], v[20:23], v[192:195], v[84:87]
    v_mfma_f32_16x16x32_bf16 v[100:103], v[20:23], v[196:199], v[100:103]
    s_barrier
    ds_read_b64_tr_b16 v[16:17], v4 offset:57344
    ds_read_b64_tr_b16 v[18:19], v4 offset:57856
    v_add_f32 v11, 1.0, v11
    v_add_f32 v12, 1.0, v12
    v_add_f32 v13, 1.0, v13
    s_waitcnt lgkmcnt(10)
    v_mfma_f32_16x16x32_bf16 v[88:91], v[24:27], v[192:195], v[88:91]
    ds_read_b64_tr_b16 v[20:21], v5 offset:57344
    ds_read_b64_tr_b16 v[22:23], v5 offset:57856
    v_mfma_f32_16x16x32_bf16 v[104:107], v[24:27], v[196:199], v[104:107]
    v_add_f32 v14, 1.0, v14
    v_rcp_f32 v11, v11
    v_rcp_f32 v12, v12
    v_mfma_f32_16x16x32_bf16 v[92:95], v[28:31], v[192:195], v[92:95]
    ds_read_b64_tr_b16 v[24:25], v6 offset:57344
    ds_read_b64_tr_b16 v[26:27], v6 offset:57856
    v_mfma_f32_16x16x32_bf16 v[108:111], v[28:31], v[196:199], v[108:111]
    v_rcp_f32 v13, v13
    v_rcp_f32 v14, v14
    v_mul_f32 v64, v11, v64
    v_mul_f32 v65, v12, v65
    s_waitcnt lgkmcnt(10)
    v_mfma_f32_16x16x32_bf16 v[80:83], v[32:35], v[200:203], v[80:83]
    ds_read_b64_tr_b16 v[28:29], v7 offset:57344
    ds_read_b64_tr_b16 v[30:31], v7 offset:57856
    v_mfma_f32_16x16x32_bf16 v[96:99], v[32:35], v[204:207], v[96:99]
    v_mul_f32 v66, v13, v66
    v_mul_f32 v67, v14, v67
    v_mul_f32 v11, v68, v68
    v_mfma_f32_16x16x32_bf16 v[84:87], v[36:39], v[200:203], v[84:87]
    ds_read_b64_tr_b16 v[32:33], v4 offset:61440
    ds_read_b64_tr_b16 v[34:35], v4 offset:61952
    v_mfma_f32_16x16x32_bf16 v[100:103], v[36:39], v[204:207], v[100:103]
    v_mul_f32 v12, v69, v69
    v_mul_f32 v13, v70, v70
    v_mul_f32 v14, v71, v71
    s_waitcnt lgkmcnt(10)
    v_mfma_f32_16x16x32_bf16 v[88:91], v[40:43], v[200:203], v[88:91]
    ds_read_b64_tr_b16 v[36:37], v5 offset:61440
    ds_read_b64_tr_b16 v[38:39], v5 offset:61952
    v_mfma_f32_16x16x32_bf16 v[104:107], v[40:43], v[204:207], v[104:107]
    v_fma_f32 v11, v11, s26, v10
    v_fma_f32 v12, v12, s26, v10
    v_fma_f32 v13, v13, s26, v10
    v_fma_f32 v14, v14, s26, v10
    v_mfma_f32_16x16x32_bf16 v[92:95], v[44:47], v[200:203], v[92:95]
    ds_read_b64_tr_b16 v[40:41], v6 offset:61440
    ds_read_b64_tr_b16 v[42:43], v6 offset:61952
    v_mfma_f32_16x16x32_bf16 v[108:111], v[44:47], v[204:207], v[108:111]
    v_mul_f32 v11, v11, v68
    v_mul_f32 v12, v12, v69
    v_mul_f32 v13, v13, v70
    s_waitcnt lgkmcnt(10)
    v_mfma_f32_16x16x32_bf16 v[80:83], v[16:19], v[208:211], v[80:83]
    ds_read_b64_tr_b16 v[44:45], v7 offset:61440
    ds_read_b64_tr_b16 v[46:47], v7 offset:61952
    v_mfma_f32_16x16x32_bf16 v[96:99], v[16:19], v[212:215], v[96:99]
    v_mul_f32 v14, v14, v71
    v_exp_f32 v11, v11
    v_exp_f32 v12, v12
    v_mfma_f32_16x16x32_bf16 v[84:87], v[20:23], v[208:211], v[84:87]
    ds_read_b64_tr_b16 v[16:17], v8 offset:0
    ds_read_b64_tr_b16 v[18:19], v8 offset:512
    v_mfma_f32_16x16x32_bf16 v[100:103], v[20:23], v[212:215], v[100:103]
    v_exp_f32 v13, v13
    v_exp_f32 v14, v14
    v_add_f32 v11, 1.0, v11
    v_add_f32 v12, 1.0, v12
    s_waitcnt lgkmcnt(10)
    v_mfma_f32_16x16x32_bf16 v[88:91], v[24:27], v[208:211], v[88:91]
    ds_read_b64_tr_b16 v[20:21], v9 offset:0
    ds_read_b64_tr_b16 v[22:23], v9 offset:512
    v_mfma_f32_16x16x32_bf16 v[104:107], v[24:27], v[212:215], v[104:107]
    v_add_f32 v13, 1.0, v13
    v_add_f32 v14, 1.0, v14
    v_rcp_f32 v11, v11
    v_mfma_f32_16x16x32_bf16 v[92:95], v[28:31], v[208:211], v[92:95]
    ds_read_b64_tr_b16 v[24:25], v1 offset:0
    ds_read_b64_tr_b16 v[26:27], v1 offset:512
    v_mfma_f32_16x16x32_bf16 v[108:111], v[28:31], v[212:215], v[108:111]
    v_rcp_f32 v12, v12
    v_rcp_f32 v13, v13
    v_rcp_f32 v14, v14
    s_waitcnt lgkmcnt(10)
    v_mfma_f32_16x16x32_bf16 v[80:83], v[32:35], v[216:219], v[80:83]
    ds_read_b64_tr_b16 v[28:29], v0 offset:0
    ds_read_b64_tr_b16 v[30:31], v0 offset:512
    v_mfma_f32_16x16x32_bf16 v[96:99], v[32:35], v[220:223], v[96:99]
    v_mul_f32 v68, v11, v68
    v_mul_f32 v69, v12, v69
    v_mul_f32 v70, v13, v70
    v_mul_f32 v71, v14, v71
    v_mfma_f32_16x16x32_bf16 v[84:87], v[36:39], v[216:219], v[84:87]
    ds_read_b64_tr_b16 v[32:33], v8 offset:4096
    ds_read_b64_tr_b16 v[34:35], v8 offset:4608
    v_mfma_f32_16x16x32_bf16 v[100:103], v[36:39], v[220:223], v[100:103]
    v_mul_f32 v11, v72, v72
    v_mul_f32 v12, v73, v73
    v_mul_f32 v13, v74, v74
    s_waitcnt lgkmcnt(10)
    v_mfma_f32_16x16x32_bf16 v[88:91], v[40:43], v[216:219], v[88:91]
    ds_read_b64_tr_b16 v[36:37], v9 offset:4096
    ds_read_b64_tr_b16 v[38:39], v9 offset:4608
    v_mfma_f32_16x16x32_bf16 v[104:107], v[40:43], v[220:223], v[104:107]
    v_mul_f32 v14, v75, v75
    v_fma_f32 v11, v11, s26, v10
    v_fma_f32 v12, v12, s26, v10
    v_mfma_f32_16x16x32_bf16 v[92:95], v[44:47], v[216:219], v[92:95]
    ds_read_b64_tr_b16 v[40:41], v1 offset:4096
    ds_read_b64_tr_b16 v[42:43], v1 offset:4608
    v_mfma_f32_16x16x32_bf16 v[108:111], v[44:47], v[220:223], v[108:111]
    v_fma_f32 v13, v13, s26, v10
    v_fma_f32 v14, v14, s26, v10
    v_mul_f32 v11, v11, v72
    v_mul_f32 v12, v12, v73
    s_waitcnt lgkmcnt(10)
    v_mfma_f32_16x16x32_bf16 v[80:83], v[16:19], v[224:227], v[80:83]
    ds_read_b64_tr_b16 v[44:45], v0 offset:4096
    ds_read_b64_tr_b16 v[46:47], v0 offset:4608
    v_mfma_f32_16x16x32_bf16 v[96:99], v[16:19], v[228:231], v[96:99]
    v_mul_f32 v13, v13, v74
    v_mul_f32 v14, v14, v75
    v_exp_f32 v11, v11
    v_mfma_f32_16x16x32_bf16 v[84:87], v[20:23], v[224:227], v[84:87]
    ds_read_b64_tr_b16 v[16:17], v8 offset:8192
    ds_read_b64_tr_b16 v[18:19], v8 offset:8704
    v_mfma_f32_16x16x32_bf16 v[100:103], v[20:23], v[228:231], v[100:103]
    v_exp_f32 v12, v12
    v_exp_f32 v13, v13
    v_exp_f32 v14, v14
    s_waitcnt lgkmcnt(10)
    v_mfma_f32_16x16x32_bf16 v[88:91], v[24:27], v[224:227], v[88:91]
    ds_read_b64_tr_b16 v[20:21], v9 offset:8192
    ds_read_b64_tr_b16 v[22:23], v9 offset:8704
    v_mfma_f32_16x16x32_bf16 v[104:107], v[24:27], v[228:231], v[104:107]
    v_add_f32 v11, 1.0, v11
    v_add_f32 v12, 1.0, v12
    v_add_f32 v13, 1.0, v13
    v_add_f32 v14, 1.0, v14
    v_mfma_f32_16x16x32_bf16 v[92:95], v[28:31], v[224:227], v[92:95]
    ds_read_b64_tr_b16 v[24:25], v1 offset:8192
    ds_read_b64_tr_b16 v[26:27], v1 offset:8704
    v_mfma_f32_16x16x32_bf16 v[108:111], v[28:31], v[228:231], v[108:111]
    v_rcp_f32 v11, v11
    v_rcp_f32 v12, v12
    v_rcp_f32 v13, v13
    s_waitcnt lgkmcnt(10)
    v_mfma_f32_16x16x32_bf16 v[80:83], v[32:35], v[232:235], v[80:83]
    ds_read_b64_tr_b16 v[28:29], v0 offset:8192
    ds_read_b64_tr_b16 v[30:31], v0 offset:8704
    v_mfma_f32_16x16x32_bf16 v[96:99], v[32:35], v[236:239], v[96:99]
    v_rcp_f32 v14, v14
    v_mul_f32 v72, v11, v72
    v_mul_f32 v73, v12, v73
    v_mfma_f32_16x16x32_bf16 v[84:87], v[36:39], v[232:235], v[84:87]
    ds_read_b64_tr_b16 v[32:33], v8 offset:12288
    ds_read_b64_tr_b16 v[34:35], v8 offset:12800
    v_mfma_f32_16x16x32_bf16 v[100:103], v[36:39], v[236:239], v[100:103]
    v_mul_f32 v74, v13, v74
    v_mul_f32 v75, v14, v75
    v_mul_f32 v11, v76, v76
    v_mul_f32 v12, v77, v77
    s_waitcnt lgkmcnt(10)
    v_mfma_f32_16x16x32_bf16 v[88:91], v[40:43], v[232:235], v[88:91]
    ds_read_b64_tr_b16 v[36:37], v9 offset:12288
    ds_read_b64_tr_b16 v[38:39], v9 offset:12800
    v_mfma_f32_16x16x32_bf16 v[104:107], v[40:43], v[236:239], v[104:107]
    v_mul_f32 v13, v78, v78
    v_mul_f32 v14, v79, v79
    v_fma_f32 v11, v11, s26, v10
    v_mfma_f32_16x16x32_bf16 v[92:95], v[44:47], v[232:235], v[92:95]
    ds_read_b64_tr_b16 v[40:41], v1 offset:12288
    ds_read_b64_tr_b16 v[42:43], v1 offset:12800
    v_mfma_f32_16x16x32_bf16 v[108:111], v[44:47], v[236:239], v[108:111]
    v_fma_f32 v12, v12, s26, v10
    v_fma_f32 v13, v13, s26, v10
    v_fma_f32 v14, v14, s26, v10
    s_waitcnt lgkmcnt(10)
    v_mfma_f32_16x16x32_bf16 v[80:83], v[16:19], v[240:243], v[80:83]
    ds_read_b64_tr_b16 v[44:45], v0 offset:12288
    ds_read_b64_tr_b16 v[46:47], v0 offset:12800
    v_mfma_f32_16x16x32_bf16 v[96:99], v[16:19], v[244:247], v[96:99]
    v_mul_f32 v11, v11, v76
    v_mul_f32 v12, v12, v77
    v_mul_f32 v13, v13, v78
    v_mul_f32 v14, v14, v79
    v_mfma_f32_16x16x32_bf16 v[84:87], v[20:23], v[240:243], v[84:87]
    v_mfma_f32_16x16x32_bf16 v[100:103], v[20:23], v[244:247], v[100:103]
    v_exp_f32 v11, v11
    v_exp_f32 v12, v12
    v_exp_f32 v13, v13
    s_waitcnt lgkmcnt(8)
    v_mfma_f32_16x16x32_bf16 v[88:91], v[24:27], v[240:243], v[88:91]
    v_mfma_f32_16x16x32_bf16 v[104:107], v[24:27], v[244:247], v[104:107]
    v_exp_f32 v14, v14
    v_add_f32 v11, 1.0, v11
    v_add_f32 v12, 1.0, v12
    v_mfma_f32_16x16x32_bf16 v[92:95], v[28:31], v[240:243], v[92:95]
    v_mfma_f32_16x16x32_bf16 v[108:111], v[28:31], v[244:247], v[108:111]
    v_add_f32 v13, 1.0, v13
    v_add_f32 v14, 1.0, v14
    v_rcp_f32 v11, v11
    v_rcp_f32 v12, v12
    s_waitcnt lgkmcnt(4)
    v_mfma_f32_16x16x32_bf16 v[80:83], v[32:35], v[248:251], v[80:83]
    v_mfma_f32_16x16x32_bf16 v[96:99], v[32:35], v[252:255], v[96:99]
    v_rcp_f32 v13, v13
    v_rcp_f32 v14, v14
    v_mul_f32 v76, v11, v76
    v_mfma_f32_16x16x32_bf16 v[84:87], v[36:39], v[248:251], v[84:87]
    v_mfma_f32_16x16x32_bf16 v[100:103], v[36:39], v[252:255], v[100:103]
    v_mul_f32 v77, v12, v77
    v_mul_f32 v78, v13, v78
    v_mul_f32 v79, v14, v79
    s_waitcnt lgkmcnt(0)
    v_mfma_f32_16x16x32_bf16 v[88:91], v[40:43], v[248:251], v[88:91]
    v_mfma_f32_16x16x32_bf16 v[104:107], v[40:43], v[252:255], v[104:107]
    v_mfma_f32_16x16x32_bf16 v[92:95], v[44:47], v[248:251], v[92:95]
    v_mfma_f32_16x16x32_bf16 v[108:111], v[44:47], v[252:255], v[108:111]
    v_mul_f32 v80, v48, v80
    v_mul_f32 v81, v49, v81
    v_mul_f32 v82, v50, v82
    v_mul_f32 v83, v51, v83
    v_mul_f32 v84, v52, v84
    v_mul_f32 v85, v53, v85
    v_mul_f32 v86, v54, v86
    v_mul_f32 v87, v55, v87
    v_mul_f32 v88, v56, v88
    v_mul_f32 v89, v57, v89
    v_mul_f32 v90, v58, v90
    v_mul_f32 v91, v59, v91
    v_mul_f32 v92, v60, v92
    v_mul_f32 v93, v61, v93
    v_mul_f32 v94, v62, v94
    v_mul_f32 v95, v63, v95
    v_mul_f32 v96, v64, v96
    v_mul_f32 v97, v65, v97
    v_mul_f32 v98, v66, v98
    v_mul_f32 v99, v67, v99
    v_mul_f32 v100, v68, v100
    v_mul_f32 v101, v69, v101
    v_mul_f32 v102, v70, v102
    v_mul_f32 v103, v71, v103
    v_mul_f32 v104, v72, v104
    v_mul_f32 v105, v73, v105
    v_mul_f32 v106, v74, v106
    v_mul_f32 v107, v75, v107
    v_mul_f32 v108, v76, v108
    v_mul_f32 v109, v77, v109
    v_mul_f32 v110, v78, v110
    v_mul_f32 v111, v79, v111
    v_cvt_pk_bf16_f32 v80, v80, v81
    v_cvt_pk_bf16_f32 v81, v82, v83
    v_cvt_pk_bf16_f32 v82, v84, v85
    v_cvt_pk_bf16_f32 v83, v86, v87
    buffer_store_dwordx4 v[80:83], v15, s[16:19], s25 offen offset:0 sc1
    v_cvt_pk_bf16_f32 v84, v88, v89
    v_cvt_pk_bf16_f32 v85, v90, v91
    v_cvt_pk_bf16_f32 v86, v92, v93
    v_cvt_pk_bf16_f32 v87, v94, v95
    buffer_store_dwordx4 v[84:87], v15, s[16:19], s25 offen offset:2048 sc1
    v_cvt_pk_bf16_f32 v96, v96, v97
    v_cvt_pk_bf16_f32 v97, v98, v99
    v_cvt_pk_bf16_f32 v98, v100, v101
    v_cvt_pk_bf16_f32 v99, v102, v103
    buffer_store_dwordx4 v[96:99], v15, s[16:19], s25 offen offset:256 sc1
    v_cvt_pk_bf16_f32 v100, v104, v105
    v_cvt_pk_bf16_f32 v101, v106, v107
    v_cvt_pk_bf16_f32 v102, v108, v109
    v_cvt_pk_bf16_f32 v103, v110, v111
    buffer_store_dwordx4 v[100:103], v15, s[16:19], s25 offen offset:2304 sc1
    s_add_u32 s25, s25, 4096
    s_endpgm
L1_QKV:
    v_mul_u32_u24 v2, 3456, v17
    v_add_u32 v2, v2, v20
    s_lshl_b32 s35, s35, 1
    s_add_u32 s35, s35, s22
    s_sub_u32 s22, s35, 6
    s_lshl_b32 s32, s22, 2
    s_mul_i32 s33, s22, 3
    s_add_u32 s33, s33, 3
    s_cmp_le_u32 s22, 3
    s_cselect_b32 s32, s32, s33
    s_lshl_b32 s28, s32, 6
    s_lshl_b32 s35, s32, 7
    s_mov_b32 s10, 1990656
    s_mul_i32 s47, s20, 27648
    s_add_u32 s47, s47, s35
    s_mul_i32 s36, s34, 221184
    s_add_u32 s36, s36, s47
    s_waitcnt lgkmcnt(0)
    s_mov_b32 s4, s48
    s_mov_b32 s5, s49
    s_mov_b32 s8, s50
    s_mov_b32 s9, s51
    s_cmp_ge_u32 s22, 5
    s_cbranch_scc1 L1_V
    s_add_u32 m0, s24, 0
    s_add_u32 s30, s36, 0
    buffer_load_dwordx4 v2, s[8:11], s30 offen lds
    s_add_u32 m0, s24, 98304
    s_add_u32 s30, s88, 0
    buffer_load_dwordx4 v3, s[4:7], s30 offen lds
    s_add_u32 m0, s24, 106496
    s_add_u32 s30, s88, 9216
    buffer_load_dwordx4 v15, s[4:7], s30 offen lds
    s_add_u32 m0, s24, 114688
    s_add_u32 s30, s88, 18432
    buffer_load_dwordx4 v3, s[4:7], s30 offen lds
    s_add_u32 m0, s24, 122880
    s_add_u32 s30, s88, 27648
    buffer_load_dwordx4 v15, s[4:7], s30 offen lds
    s_add_u32 s33, s47, 1990656
    s_add_u32 s35, s29, 1152
    s_add_u32 s37, s36, 221184
    s_cmp_eq_u32 s37, s33
    s_cselect_b32 s37, s47, s37
    s_add_u32 s89, s88, 128
    s_cmp_eq_u32 s89, s35
    s_cselect_b32 s89, s29, s89
    s_add_u32 s38, s37, 221184
    s_cmp_eq_u32 s38, s33
    s_cselect_b32 s38, s47, s38
    s_add_u32 s90, s89, 128
    s_cmp_eq_u32 s90, s35
    s_cselect_b32 s90, s29, s90
    s_add_u32 s39, s38, 221184
    s_cmp_eq_u32 s39, s33
    s_cselect_b32 s39, s47, s39
    s_add_u32 s91, s90, 128
    s_cmp_eq_u32 s91, s35
    s_cselect_b32 s91, s29, s91
    s_add_u32 s40, s39, 221184
    s_cmp_eq_u32 s40, s33
    s_cselect_b32 s40, s47, s40
    s_add_u32 s92, s91, 128
    s_cmp_eq_u32 s92, s35
    s_cselect_b32 s92, s29, s92
    s_add_u32 s41, s40, 221184
    s_cmp_eq_u32 s41, s33
    s_cselect_b32 s41, s47, s41
    s_add_u32 s93, s92, 128
    s_cmp_eq_u32 s93, s35
    s_cselect_b32 s93, s29, s93
    s_add_u32 s42, s41, 221184
    s_cmp_eq_u32 s42, s33
    s_cselect_b32 s42, s47, s42
    s_add_u32 s94, s93, 128
    s_cmp_eq_u32 s94, s35
    s_cselect_b32 s94, s29, s94
    s_add_u32 s43, s42, 221184
    s_cmp_eq_u32 s43, s33
    s_cselect_b32 s43, s47, s43
    s_add_u32 s95, s94, 128
    s_cmp_eq_u32 s95, s35
    s_cselect_b32 s95, s29, s95
    s_add_u32 s44, s43, 221184
    s_cmp_eq_u32 s44, s33
    s_cselect_b32 s44, s47, s44
    s_add_u32 s96, s95, 128
    s_cmp_eq_u32 s96, s35
    s_cselect_b32 s96, s29, s96
    s_barrier
    s_add_u32 m0, s24, 8192
    s_add_u32 s30, s37, 0
    buffer_load_dwordx4 v2, s[8:11], s30 offen lds
    s_add_u32 m0, s24, 16384
    s_add_u32 s30, s38, 0
    buffer_load_dwordx4 v2, s[8:11], s30 offen lds
    s_add_u32 m0, s24, 24576
    s_add_u32 s30, s39, 0
    buffer_load_dwordx4 v2, s[8:11], s30 offen lds
    s_add_u32 m0, s24, 32768
    s_add_u32 s30, s40, 0
    buffer_load_dwordx4 v2, s[8:11], s30 offen lds
    s_mov_b32 s16, s56
    s_mov_b32 s17, s57
    s_mov_b32 s18, 268435456
    s_mov_b32 s19, 0x00020000
    v_lshlrev_b32 v1, 4, v0
    v_and_b32 v21, 15, v0
    v_lshrrev_b32 v22, 2, v21
    v_and_b32 v21, 3, v21
    v_lshrrev_b32 v23, 5, v0
    v_lshl_add_u32 v24, v23, 3, v22
    v_lshlrev_b32 v24, 7, v24
    v_lshl_add_u32 v24, v21, 3, v24
    v_and_b32 v21, 16, v0
    v_lshl_add_u32 v24, v21, 1, v24
    v_and_b32 v22, 2, v22
    v_lshl_add_u32 v4, v22, 5, v24
    v_xor_b32 v5, 64, v4
    v_add_u32 v6, 0x10000, v4
    v_add_u32 v7, 0x10000, v5
    v_add_u32 v8, 0x20000, v4
    v_add_u32 v9, 0x20000, v5
    v_and_b32 v21, 31, v0
    v_lshrrev_b32 v22, 1, v21
    v_and_b32 v22, 7, v22
    v_xor_b32 v22, v22, v23
    v_lshlrev_b32 v22, 4, v22
    v_and_b32 v24, 7, v21
    v_lshl_add_u32 v22, v24, 7, v22
    v_lshrrev_b32 v24, 3, v21
    v_lshl_add_u32 v22, v24, 13, v22
    s_add_u32 s33, s24, 0x18000
    v_add_u32 v11, s33, v22
    v_xor_b32 v12, 32, v11
    v_xor_b32 v13, 64, v11
    v_xor_b32 v14, 96, v11
    s_mul_i32 s25, s23, 36864
    s_add_u32 s25, s25, 18874368
    s_waitcnt vmcnt(4)
    ds_read_b128 v[112:115], v11 offset:0
    ds_read_b128 v[116:119], v12 offset:0
    ds_read_b128 v[120:123], v13 offset:0
    ds_read_b128 v[124:127], v14 offset:0
    s_add_u32 m0, s24, 131072
    s_add_u32 s30, s89, 0
    buffer_load_dwordx4 v3, s[4:7], s30 offen lds
    s_add_u32 m0, s24, 139264
    s_add_u32 s30, s89, 9216
    buffer_load_dwordx4 v15, s[4:7], s30 offen lds
    s_add_u32 m0, s24, 147456
    s_add_u32 s30, s89, 18432
    buffer_load_dwordx4 v3, s[4:7], s30 offen lds
    s_add_u32 m0, s24, 155648
    s_add_u32 s30, s89, 27648
    buffer_load_dwordx4 v15, s[4:7], s30 offen lds
    s_barrier
    ds_read_b64_tr_b16 v[16:17], v4 offset:0
    ds_read_b64_tr_b16 v[18:19], v4 offset:512
    ds_read_b64_tr_b16 v[20:21], v5 offset:0
    ds_read_b64_tr_b16 v[22:23], v5 offset:512
    ds_read_b64_tr_b16 v[24:25], v4 offset:2048
    ds_read_b64_tr_b16 v[26:27], v4 offset:2560
    ds_read_b64_tr_b16 v[28:29], v5 offset:2048
    ds_read_b64_tr_b16 v[30:31], v5 offset:2560
    ds_read_b64_tr_b16 v[32:33], v4 offset:4096
    ds_read_b64_tr_b16 v[34:35], v4 offset:4608
    ds_read_b64_tr_b16 v[36:37], v5 offset:4096
    ds_read_b64_tr_b16 v[38:39], v5 offset:4608
    ds_read_b64_tr_b16 v[40:41], v4 offset:6144
    ds_read_b64_tr_b16 v[42:43], v4 offset:6656
    s_waitcnt lgkmcnt(10)
    v_mfma_f32_32x32x16_bf16 v[48:63], v[16:19], v[112:115], 0
    ds_read_b64_tr_b16 v[44:45], v5 offset:6144
    ds_read_b64_tr_b16 v[46:47], v5 offset:6656
    s_add_u32 m0, s24, 40960
    s_add_u32 s30, s41, 0
    buffer_load_dwordx4 v2, s[8:11], s30 offen lds
    s_add_u32 m0, s24, 98304
    s_add_u32 s30, s90, 0
    buffer_load_dwordx4 v3, s[4:7], s30 offen lds
    v_mfma_f32_32x32x16_bf16 v[64:79], v[20:23], v[112:115], 0
    s_waitcnt vmcnt(9)
    s_barrier
    ds_read_b64_tr_b16 v[16:17], v4 offset:8192
    ds_read_b64_tr_b16 v[18:19], v4 offset:8704
    s_add_u32 m0, s24, 106496
    s_add_u32 s30, s90, 9216
    buffer_load_dwordx4 v15, s[4:7], s30 offen lds
    s_add_u32 m0, s24, 114688
    s_add_u32 s30, s90, 18432
    buffer_load_dwordx4 v3, s[4:7], s30 offen lds
    s_waitcnt lgkmcnt(10)
    v_mfma_f32_32x32x16_bf16 v[48:63], v[24:27], v[116:119], v[48:63]
    ds_read_b64_tr_b16 v[20:21], v5 offset:8192
    ds_read_b64_tr_b16 v[22:23], v5 offset:8704
    s_add_u32 m0, s24, 122880
    s_add_u32 s30, s90, 27648
    buffer_load_dwordx4 v15, s[4:7], s30 offen lds
    s_add_u32 m0, s24, 49152
    s_add_u32 s30, s42, 0
    buffer_load_dwordx4 v2, s[8:11], s30 offen lds
    v_mfma_f32_32x32x16_bf16 v[64:79], v[28:31], v[116:119], v[64:79]
    ds_read_b64_tr_b16 v[24:25], v4 offset:10240
    ds_read_b64_tr_b16 v[26:27], v4 offset:10752
    s_waitcnt lgkmcnt(10)
    v_mfma_f32_32x32x16_bf16 v[48:63], v[32:35], v[120:123], v[48:63]
    ds_read_b64_tr_b16 v[28:29], v5 offset:10240
    ds_read_b64_tr_b16 v[30:31], v5 offset:10752
    s_waitcnt vmcnt(6)
    ds_read_b128 v[128:131], v11 offset:32768
    ds_read_b128 v[132:135], v12 offset:32768
    ds_read_b128 v[136:139], v13 offset:32768
    ds_read_b128 v[140:143], v14 offset:32768
    v_mfma_f32_32x32x16_bf16 v[64:79], v[36:39], v[120:123], v[64:79]
    ds_read_b64_tr_b16 v[32:33], v4 offset:12288
    ds_read_b64_tr_b16 v[34:35], v4 offset:12800
    s_waitcnt lgkmcnt(14)
    v_mfma_f32_32x32x16_bf16 v[48:63], v[40:43], v[124:127], v[48:63]
    ds_read_b64_tr_b16 v[36:37], v5 offset:12288
    ds_read_b64_tr_b16 v[38:39], v5 offset:12800
    v_mfma_f32_32x32x16_bf16 v[64:79], v[44:47], v[124:127], v[64:79]
    ds_read_b64_tr_b16 v[40:41], v4 offset:14336
    ds_read_b64_tr_b16 v[42:43], v4 offset:14848
    s_waitcnt lgkmcnt(14)
    s_waitcnt lgkmcnt(6)
    v_mfma_f32_32x32x16_bf16 v[48:63], v[16:19], v[128:131], v[48:63]
    ds_read_b64_tr_b16 v[44:45], v5 offset:14336
    ds_read_b64_tr_b16 v[46:47], v5 offset:14848
    s_add_u32 m0, s24, 131072
    s_add_u32 s30, s91, 0
    buffer_load_dwordx4 v3, s[4:7], s30 offen lds
    s_add_u32 m0, s24, 139264
    s_add_u32 s30, s91, 9216
    buffer_load_dwordx4 v15, s[4:7], s30 offen lds
    v_mfma_f32_32x32x16_bf16 v[64:79], v[20:23], v[128:131], v[64:79]
    s_barrier
    ds_read_b64_tr_b16 v[16:17], v4 offset:16384
    ds_read_b64_tr_b16 v[18:19], v4 offset:16896
    s_add_u32 m0, s24, 147456
    s_add_u32 s30, s91, 18432
    buffer_load_dwordx4 v3, s[4:7], s30 offen lds
    s_add_u32 m0, s24, 155648
    s_add_u32 s30, s91, 27648
    buffer_load_dwordx4 v15, s[4:7], s30 offen lds
    v_mfma_f32_32x32x16_bf16 v[48:63], v[24:27], v[132:135], v[48:63]
    ds_read_b64_tr_b16 v[20:21], v5 offset:16384
    ds_read_b64_tr_b16 v[22:23], v5 offset:16896
    s_add_u32 m0, s24, 57344
    s_add_u32 s30, s43, 0
    buffer_load_dwordx4 v2, s[8:11], s30 offen lds
    v_mfma_f32_32x32x16_bf16 v[64:79], v[28:31], v[132:135], v[64:79]
    ds_read_b64_tr_b16 v[24:25], v4 offset:18432
    ds_read_b64_tr_b16 v[26:27], v4 offset:18944
    s_waitcnt lgkmcnt(10)
    v_mfma_f32_32x32x16_bf16 v[48:63], v[32:35], v[136:139], v[48:63]
    ds_read_b64_tr_b16 v[28:29], v5 offset:18432
    ds_read_b64_tr_b16 v[30:31], v5 offset:18944
    s_waitcnt vmcnt(6)
    ds_read_b128 v[144:147], v11 offset:0
    ds_read_b128 v[148:151], v12 offset:0
    ds_read_b128 v[152:155], v13 offset:0
    ds_read_b128 v[156:159], v14 offset:0
    v_mfma_f32_32x32x16_bf16 v[64:79], v[36:39], v[136:139], v[64:79]
    ds_read_b64_tr_b16 v[32:33], v4 offset:20480
    ds_read_b64_tr_b16 v[34:35], v4 offset:20992
    s_waitcnt lgkmcnt(14)
    v_mfma_f32_32x32x16_bf16 v[48:63], v[40:43], v[140:143], v[48:63]
    ds_read_b64_tr_b16 v[36:37], v5 offset:20480
    ds_read_b64_tr_b16 v[38:39], v5 offset:20992
    v_mfma_f32_32x32x16_bf16 v[64:79], v[44:47], v[140:143], v[64:79]
    ds_read_b64_tr_b16 v[40:41], v4 offset:22528
    ds_read_b64_tr_b16 v[42:43], v4 offset:23040
    s_waitcnt lgkmcnt(14)
    s_waitcnt lgkmcnt(6)
    v_mfma_f32_32x32x16_bf16 v[48:63], v[16:19], v[144:147], v[48:63]
    ds_read_b64_tr_b16 v[44:45], v5 offset:22528
    ds_read_b64_tr_b16 v[46:47], v5 offset:23040
    s_add_u32 m0, s24, 98304
    s_add_u32 s30, s92, 0
    buffer_load_dwordx4 v3, s[4:7], s30 offen lds
    s_add_u32 m0, s24, 106496
    s_add_u32 s30, s92, 9216
    buffer_load_dwordx4 v15, s[4:7], s30 offen lds
    v_mfma_f32_32x32x16_bf16 v[64:79], v[20:23], v[144:147], v[64:79]
    ds_read_b64_tr_b16 v[16:17], v4 offset:24576
    ds_read_b64_tr_b16 v[18:19], v4 offset:25088
    s_add_u32 m0, s24, 114688
    s_add_u32 s30, s92, 18432
    buffer_load_dwordx4 v3, s[4:7], s30 offen lds
    s_add_u32 m0, s24, 122880
    s_add_u32 s30, s92, 27648
    buffer_load_dwordx4 v15, s[4:7], s30 offen lds
    v_mfma_f32_32x32x16_bf16 v[48:63], v[24:27], v[148:151], v[48:63]
    ds_read_b64_tr_b16 v[20:21], v5 offset:24576
    ds_read_b64_tr_b16 v[22:23], v5 offset:25088
    s_add_u32 m0, s24, 65536
    s_add_u32 s30, s44, 0
    buffer_load_dwordx4 v2, s[8:11], s30 offen lds
    v_mfma_f32_32x32x16_bf16 v[64:79], v[28:31], v[148:151], v[64:79]
    ds_read_b64_tr_b16 v[24:25], v4 offset:26624
    ds_read_b64_tr_b16 v[26:27], v4 offset:27136
    s_waitcnt lgkmcnt(10)
    v_mfma_f32_32x32x16_bf16 v[48:63], v[32:35], v[152:155], v[48:63]
    ds_read_b64_tr_b16 v[28:29], v5 offset:26624
    ds_read_b64_tr_b16 v[30:31], v5 offset:27136
    s_waitcnt vmcnt(6)
    ds_read_b128 v[160:163], v11 offset:32768
    ds_read_b128 v[164:167], v12 offset:32768
    ds_read_b128 v[168:171], v13 offset:32768
    ds_read_b128 v[172:175], v14 offset:32768
    v_mfma_f32_32x32x16_bf16 v[64:79], v[36:39], v[152:155], v[64:79]
    ds_read_b64_tr_b16 v[32:33], v4 offset:28672
    ds_read_b64_tr_b16 v[34:35], v4 offset:29184
    s_waitcnt lgkmcnt(14)
    v_mfma_f32_32x32x16_bf16 v[48:63], v[40:43], v[156:159], v[48:63]
    ds_read_b64_tr_b16 v[36:37], v5 offset:28672
    ds_read_b64_tr_b16 v[38:39], v5 offset:29184
    v_mfma_f32_32x32x16_bf16 v[64:79], v[44:47], v[156:159], v[64:79]
    ds_read_b64_tr_b16 v[40:41], v4 offset:30720
    ds_read_b64_tr_b16 v[42:43], v4 offset:31232
    s_waitcnt lgkmcnt(14)
    s_waitcnt lgkmcnt(6)
    v_mfma_f32_32x32x16_bf16 v[48:63], v[16:19], v[160:163], v[48:63]
    ds_read_b64_tr_b16 v[44:45], v5 offset:30720
    ds_read_b64_tr_b16 v[46:47], v5 offset:31232
    s_add_u32 m0, s24, 131072
    s_add_u32 s30, s93, 0
    buffer_load_dwordx4 v3, s[4:7], s30 offen lds
    s_add_u32 m0, s24, 139264
    s_add_u32 s30, s93, 9216
    buffer_load_dwordx4 v15, s[4:7], s30 offen lds
    v_mfma_f32_32x32x16_bf16 v[64:79], v[20:23], v[160:163], v[64:79]
    ds_read_b64_tr_b16 v[16:17], v4 offset:32768
    ds_read_b64_tr_b16 v[18:19], v4 offset:33280
    s_add_u32 m0, s24, 147456
    s_add_u32 s30, s93, 18432
    buffer_load_dwordx4 v3, s[4:7], s30 offen lds
    s_add_u32 m0, s24, 155648
    s_add_u32 s30, s93, 27648
    buffer_load_dwordx4 v15, s[4:7], s30 offen lds
    v_mfma_f32_32x32x16_bf16 v[48:63], v[24:27], v[164:167], v[48:63]
    ds_read_b64_tr_b16 v[20:21], v5 offset:32768
    ds_read_b64_tr_b16 v[22:23], v5 offset:33280
    s_add_u32 m0, s24, 73728
    s_add_u32 s30, s36, 128
    buffer_load_dwordx4 v2, s[8:11], s30 offen lds
    v_mfma_f32_32x32x16_bf16 v[64:79], v[28:31], v[164:167], v[64:79]
    ds_read_b64_tr_b16 v[24:25], v4 offset:34816
    ds_read_b64_tr_b16 v[26:27], v4 offset:35328
    s_waitcnt lgkmcnt(10)
    v_mfma_f32_32x32x16_bf16 v[48:63], v[32:35], v[168:171], v[48:63]
    ds_read_b64_tr_b16 v[28:29], v5 offset:34816
    ds_read_b64_tr_b16 v[30:31], v5 offset:35328
    s_waitcnt vmcnt(6)
    ds_read_b128 v[176:179], v11 offset:0
    ds_read_b128 v[180:183], v12 offset:0
    ds_read_b128 v[184:187], v13 offset:0
    ds_read_b128 v[188:191], v14 offset:0
    v_mfma_f32_32x32x16_bf16 v[64:79], v[36:39], v[168:171], v[64:79]
    ds_read_b64_tr_b16 v[32:33], v4 offset:36864
    ds_read_b64_tr_b16 v[34:35], v4 offset:37376
    s_waitcnt lgkmcnt(14)
    v_mfma_f32_32x32x16_bf16 v[48:63], v[40:43], v[172:175], v[48:63]
    ds_read_b64_tr_b16 v[36:37], v5 offset:36864
    ds_read_b64_tr_b16 v[38:39], v5 offset:37376
    v_mfma_f32_32x32x16_bf16 v[64:79], v[44:47], v[172:175], v[64:79]
    ds_read_b64_tr_b16 v[40:41], v4 offset:38912
    ds_read_b64_tr_b16 v[42:43], v4 offset:39424
    s_waitcnt lgkmcnt(14)
    s_waitcnt lgkmcnt(6)
    v_mfma_f32_32x32x16_bf16 v[48:63], v[16:19], v[176:179], v[48:63]
    ds_read_b64_tr_b16 v[44:45], v5 offset:38912
    ds_read_b64_tr_b16 v[46:47], v5 offset:39424
    s_add_u32 m0, s24, 98304
    s_add_u32 s30, s94, 0
    buffer_load_dwordx4 v3, s[4:7], s30 offen lds
    s_add_u32 m0, s24, 106496
    s_add_u32 s30, s94, 9216
    buffer_load_dwordx4 v15, s[4:7], s30 offen lds
    v_mfma_f32_32x32x16_bf16 v[64:79], v[20:23], v[176:179], v[64:79]
    s_barrier
    ds_read_b64_tr_b16 v[16:17], v4 offset:40960
    ds_read_b64_tr_b16 v[18:19], v4 offset:41472
    s_add_u32 m0, s24, 114688
    s_add_u32 s30, s94, 18432
    buffer_load_dwordx4 v3, s[4:7], s30 offen lds
    s_add_u32 m0, s24, 122880
    s_add_u32 s30, s94, 27648
    buffer_load_dwordx4 v15, s[4:7], s30 offen lds
    v_mfma_f32_32x32x16_bf16 v[48:63], v[24:27], v[180:183], v[48:63]
    ds_read_b64_tr_b16 v[20:21], v5 offset:40960
    ds_read_b64_tr_b16 v[22:23], v5 offset:41472
    s_add_u32 m0, s24, 81920
    s_add_u32 s30, s37, 128
    buffer_load_dwordx4 v2, s[8:11], s30 offen lds
    v_mfma_f32_32x32x16_bf16 v[64:79], v[28:31], v[180:183], v[64:79]
    ds_read_b64_tr_b16 v[24:25], v4 offset:43008
    ds_read_b64_tr_b16 v[26:27], v4 offset:43520
    s_waitcnt lgkmcnt(10)
    v_mfma_f32_32x32x16_bf16 v[48:63], v[32:35], v[184:187], v[48:63]
    ds_read_b64_tr_b16 v[28:29], v5 offset:43008
    ds_read_b64_tr_b16 v[30:31], v5 offset:43520
    s_waitcnt vmcnt(6)
    ds_read_b128 v[192:195], v11 offset:32768
    ds_read_b128 v[196:199], v12 offset:32768
    ds_read_b128 v[200:203], v13 offset:32768
    ds_read_b128 v[204:207], v14 offset:32768
    v_mfma_f32_32x32x16_bf16 v[64:79], v[36:39], v[184:187], v[64:79]
    ds_read_b64_tr_b16 v[32:33], v4 offset:45056
    ds_read_b64_tr_b16 v[34:35], v4 offset:45568
    s_waitcnt lgkmcnt(14)
    v_mfma_f32_32x32x16_bf16 v[48:63], v[40:43], v[188:191], v[48:63]
    ds_read_b64_tr_b16 v[36:37], v5 offset:45056
    ds_read_b64_tr_b16 v[38:39], v5 offset:45568
    v_mfma_f32_32x32x16_bf16 v[64:79], v[44:47], v[188:191], v[64:79]
    ds_read_b64_tr_b16 v[40:41], v4 offset:47104
    ds_read_b64_tr_b16 v[42:43], v4 offset:47616
    s_waitcnt lgkmcnt(14)
    s_waitcnt lgkmcnt(6)
    v_mfma_f32_32x32x16_bf16 v[48:63], v[16:19], v[192:195], v[48:63]
    ds_read_b64_tr_b16 v[44:45], v5 offset:47104
    ds_read_b64_tr_b16 v[46:47], v5 offset:47616
    s_add_u32 m0, s24, 131072
    s_add_u32 s30, s95, 0
    buffer_load_dwordx4 v3, s[4:7], s30 offen lds
    s_add_u32 m0, s24, 139264
    s_add_u32 s30, s95, 9216
    buffer_load_dwordx4 v15, s[4:7], s30 offen lds
    v_mfma_f32_32x32x16_bf16 v[64:79], v[20:23], v[192:195], v[64:79]
    ds_read_b64_tr_b16 v[16:17], v4 offset:49152
    ds_read_b64_tr_b16 v[18:19], v4 offset:49664
    s_add_u32 m0, s24, 147456
    s_add_u32 s30, s95, 18432
    buffer_load_dwordx4 v3, s[4:7], s30 offen lds
    s_add_u32 m0, s24, 155648
    s_add_u32 s30, s95, 27648
    buffer_load_dwordx4 v15, s[4:7], s30 offen lds
    v_mfma_f32_32x32x16_bf16 v[48:63], v[24:27], v[196:199], v[48:63]
    ds_read_b64_tr_b16 v[20:21], v5 offset:49152
    ds_read_b64_tr_b16 v[22:23], v5 offset:49664
    s_add_u32 m0, s24, 90112
    s_add_u32 s30, s38, 128
    buffer_load_dwordx4 v2, s[8:11], s30 offen lds
    v_mfma_f32_32x32x16_bf16 v[64:79], v[28:31], v[196:199], v[64:79]
    ds_read_b64_tr_b16 v[24:25], v4 offset:51200
    ds_read_b64_tr_b16 v[26:27], v4 offset:51712
    s_waitcnt lgkmcnt(10)
    v_mfma_f32_32x32x16_bf16 v[48:63], v[32:35], v[200:203], v[48:63]
    ds_read_b64_tr_b16 v[28:29], v5 offset:51200
    ds_read_b64_tr_b16 v[30:31], v5 offset:51712
    s_waitcnt vmcnt(6)
    ds_read_b128 v[208:211], v11 offset:0
    ds_read_b128 v[212:215], v12 offset:0
    ds_read_b128 v[216:219], v13 offset:0
    ds_read_b128 v[220:223], v14 offset:0
    v_mfma_f32_32x32x16_bf16 v[64:79], v[36:39], v[200:203], v[64:79]
    ds_read_b64_tr_b16 v[32:33], v4 offset:53248
    ds_read_b64_tr_b16 v[34:35], v4 offset:53760
    s_waitcnt lgkmcnt(14)
    v_mfma_f32_32x32x16_bf16 v[48:63], v[40:43], v[204:207], v[48:63]
    ds_read_b64_tr_b16 v[36:37], v5 offset:53248
    ds_read_b64_tr_b16 v[38:39], v5 offset:53760
    v_mfma_f32_32x32x16_bf16 v[64:79], v[44:47], v[204:207], v[64:79]
    ds_read_b64_tr_b16 v[40:41], v4 offset:55296
    ds_read_b64_tr_b16 v[42:43], v4 offset:55808
    s_waitcnt lgkmcnt(14)
    s_waitcnt lgkmcnt(6)
    v_mfma_f32_32x32x16_bf16 v[48:63], v[16:19], v[208:211], v[48:63]
    ds_read_b64_tr_b16 v[44:45], v5 offset:55296
    ds_read_b64_tr_b16 v[46:47], v5 offset:55808
    s_add_u32 m0, s24, 98304
    s_add_u32 s30, s96, 0
    buffer_load_dwordx4 v3, s[4:7], s30 offen lds
    s_add_u32 m0, s24, 106496
    s_add_u32 s30, s96, 9216
    buffer_load_dwordx4 v15, s[4:7], s30 offen lds
    v_mfma_f32_32x32x16_bf16 v[64:79], v[20:23], v[208:211], v[64:79]
    ds_read_b64_tr_b16 v[16:17], v4 offset:57344
    ds_read_b64_tr_b16 v[18:19], v4 offset:57856
    s_add_u32 m0, s24, 114688
    s_add_u32 s30, s96, 18432
    buffer_load_dwordx4 v3, s[4:7], s30 offen lds
    s_add_u32 m0, s24, 122880
    s_add_u32 s30, s96, 27648
    buffer_load_dwordx4 v15, s[4:7], s30 offen lds
    v_mfma_f32_32x32x16_bf16 v[48:63], v[24:27], v[212:215], v[48:63]
    ds_read_b64_tr_b16 v[20:21], v5 offset:57344
    ds_read_b64_tr_b16 v[22:23], v5 offset:57856
    s_add_u32 m0, s24, 0
    s_add_u32 s30, s39, 128
    buffer_load_dwordx4 v2, s[8:11], s30 offen lds
    s_add_u32 m0, s24, 8192
    s_add_u32 s30, s40, 128
    buffer_load_dwordx4 v2, s[8:11], s30 offen lds
    v_mfma_f32_32x32x16_bf16 v[64:79], v[28:31], v[212:215], v[64:79]
    ds_read_b64_tr_b16 v[24:25], v4 offset:59392
    ds_read_b64_tr_b16 v[26:27], v4 offset:59904
    s_add_u32 m0, s24, 16384
    s_add_u32 s30, s41, 128
    buffer_load_dwordx4 v2, s[8:11], s30 offen lds
    s_add_u32 m0, s24, 24576
    s_add_u32 s30, s42, 128
    buffer_load_dwordx4 v2, s[8:11], s30 offen lds
    s_waitcnt lgkmcnt(10)
    v_mfma_f32_32x32x16_bf16 v[48:63], v[32:35], v[216:219], v[48:63]
    ds_read_b64_tr_b16 v[28:29], v5 offset:59392
    ds_read_b64_tr_b16 v[30:31], v5 offset:59904
    s_waitcnt vmcnt(9)
    ds_read_b128 v[224:227], v11 offset:32768
    ds_read_b128 v[228:231], v12 offset:32768
    ds_read_b128 v[232:235], v13 offset:32768
    ds_read_b128 v[236:239], v14 offset:32768
    v_mfma_f32_32x32x16_bf16 v[64:79], v[36:39], v[216:219], v[64:79]
    ds_read_b64_tr_b16 v[32:33], v4 offset:61440
    ds_read_b64_tr_b16 v[34:35], v4 offset:61952
    s_waitcnt lgkmcnt(14)
    v_mfma_f32_32x32x16_bf16 v[48:63], v[40:43], v[220:223], v[48:63]
    ds_read_b64_tr_b16 v[36:37], v5 offset:61440
    ds_read_b64_tr_b16 v[38:39], v5 offset:61952
    v_mfma_f32_32x32x16_bf16 v[64:79], v[44:47], v[220:223], v[64:79]
    ds_read_b64_tr_b16 v[40:41], v4 offset:63488
    ds_read_b64_tr_b16 v[42:43], v4 offset:64000
    s_waitcnt lgkmcnt(14)
    s_waitcnt lgkmcnt(6)
    v_mfma_f32_32x32x16_bf16 v[48:63], v[16:19], v[224:227], v[48:63]
    ds_read_b64_tr_b16 v[44:45], v5 offset:63488
    ds_read_b64_tr_b16 v[46:47], v5 offset:64000
    s_add_u32 m0, s24, 131072
    s_add_u32 s30, s43, 128
    buffer_load_dwordx4 v2, s[8:11], s30 offen lds
    s_add_u32 m0, s24, 139264
    s_add_u32 s30, s44, 128
    buffer_load_dwordx4 v2, s[8:11], s30 offen lds
    v_mfma_f32_32x32x16_bf16 v[64:79], v[20:23], v[224:227], v[64:79]
    s_barrier
    ds_read_b64_tr_b16 v[16:17], v6 offset:0
    ds_read_b64_tr_b16 v[18:19], v6 offset:512
    s_add_u32 m0, s24, 147456
    s_add_u32 s30, s36, 256
    buffer_load_dwordx4 v2, s[8:11], s30 offen lds
    s_add_u32 m0, s24, 155648
    s_add_u32 s30, s37, 256
    buffer_load_dwordx4 v2, s[8:11], s30 offen lds
    v_mfma_f32_32x32x16_bf16 v[48:63], v[24:27], v[228:231], v[48:63]
    ds_read_b64_tr_b16 v[20:21], v7 offset:0
    ds_read_b64_tr_b16 v[22:23], v7 offset:512
    s_add_u32 m0, s24, 32768
    s_add_u32 s30, s38, 256
    buffer_load_dwordx4 v2, s[8:11], s30 offen lds
    v_mfma_f32_32x32x16_bf16 v[64:79], v[28:31], v[228:231], v[64:79]
    ds_read_b64_tr_b16 v[24:25], v6 offset:2048
    ds_read_b64_tr_b16 v[26:27], v6 offset:2560
    s_waitcnt lgkmcnt(10)
    v_mfma_f32_32x32x16_bf16 v[48:63], v[32:35], v[232:235], v[48:63]
    ds_read_b64_tr_b16 v[28:29], v7 offset:2048
    ds_read_b64_tr_b16 v[30:31], v7 offset:2560
    s_waitcnt vmcnt(9)
    ds_read_b128 v[240:243], v11 offset:0
    ds_read_b128 v[244:247], v12 offset:0
    ds_read_b128 v[248:251], v13 offset:0
    ds_read_b128 v[252:255], v14 offset:0
    s_add_u32 m0, s24, 40960
    s_add_u32 s30, s39, 256
    buffer_load_dwordx4 v2, s[8:11], s30 offen lds
    s_add_u32 m0, s24, 49152
    s_add_u32 s30, s40, 256
    buffer_load_dwordx4 v2, s[8:11], s30 offen lds
    v_mfma_f32_32x32x16_bf16 v[64:79], v[36:39], v[232:235], v[64:79]
    ds_read_b64_tr_b16 v[32:33], v6 offset:4096
    ds_read_b64_tr_b16 v[34:35], v6 offset:4608
    s_waitcnt lgkmcnt(14)
    v_mfma_f32_32x32x16_bf16 v[48:63], v[40:43], v[236:239], v[48:63]
    ds_read_b64_tr_b16 v[36:37], v7 offset:4096
    ds_read_b64_tr_b16 v[38:39], v7 offset:4608
    v_mfma_f32_32x32x16_bf16 v[64:79], v[44:47], v[236:239], v[64:79]
    ds_read_b64_tr_b16 v[40:41], v6 offset:6144
    ds_read_b64_tr_b16 v[42:43], v6 offset:6656
    s_waitcnt lgkmcnt(14)
    s_waitcnt lgkmcnt(6)
    v_mfma_f32_32x32x16_bf16 v[48:63], v[16:19], v[240:243], v[48:63]
    ds_read_b64_tr_b16 v[44:45], v7 offset:6144
    ds_read_b64_tr_b16 v[46:47], v7 offset:6656
    s_add_u32 m0, s24, 98304
    s_add_u32 s30, s41, 256
    buffer_load_dwordx4 v2, s[8:11], s30 offen lds
    s_add_u32 m0, s24, 106496
    s_add_u32 s30, s42, 256
    buffer_load_dwordx4 v2, s[8:11], s30 offen lds
    v_mfma_f32_32x32x16_bf16 v[64:79], v[20:23], v[240:243], v[64:79]
    ds_read_b64_tr_b16 v[16:17], v6 offset:8192
    ds_read_b64_tr_b16 v[18:19], v6 offset:8704
    s_add_u32 m0, s24, 114688
    s_add_u32 s30, s43, 256
    buffer_load_dwordx4 v2, s[8:11], s30 offen lds
    v_mfma_f32_32x32x16_bf16 v[48:63], v[24:27], v[244:247], v[48:63]
    ds_read_b64_tr_b16 v[20:21], v7 offset:8192
    ds_read_b64_tr_b16 v[22:23], v7 offset:8704
    v_mfma_f32_32x32x16_bf16 v[64:79], v[28:31], v[244:247], v[64:79]
    ds_read_b64_tr_b16 v[24:25], v6 offset:10240
    ds_read_b64_tr_b16 v[26:27], v6 offset:10752
    s_waitcnt lgkmcnt(10)
    v_mfma_f32_32x32x16_bf16 v[48:63], v[32:35], v[248:251], v[48:63]
    ds_read_b64_tr_b16 v[28:29], v7 offset:10240
    ds_read_b64_tr_b16 v[30:31], v7 offset:10752
    v_mfma_f32_32x32x16_bf16 v[64:79], v[36:39], v[248:251], v[64:79]
    ds_read_b64_tr_b16 v[32:33], v6 offset:12288
    ds_read_b64_tr_b16 v[34:35], v6 offset:12800
    s_waitcnt lgkmcnt(10)
    v_mfma_f32_32x32x16_bf16 v[48:63], v[40:43], v[252:255], v[48:63]
    ds_read_b64_tr_b16 v[36:37], v7 offset:12288
    ds_read_b64_tr_b16 v[38:39], v7 offset:12800
    v_mfma_f32_32x32x16_bf16 v[64:79], v[44:47], v[252:255], v[64:79]
    ds_read_b64_tr_b16 v[40:41], v6 offset:14336
    ds_read_b64_tr_b16 v[42:43], v6 offset:14848
    s_waitcnt lgkmcnt(10)
    v_mfma_f32_32x32x16_bf16 v[80:95], v[16:19], v[112:115], 0
    ds_read_b64_tr_b16 v[44:45], v7 offset:14336
    ds_read_b64_tr_b16 v[46:47], v7 offset:14848
    v_mfma_f32_32x32x16_bf16 v[96:111], v[20:23], v[112:115], 0
    ds_read_b64_tr_b16 v[16:17], v6 offset:16384
    ds_read_b64_tr_b16 v[18:19], v6 offset:16896
    s_waitcnt lgkmcnt(10)
    v_mfma_f32_32x32x16_bf16 v[80:95], v[24:27], v[116:119], v[80:95]
    ds_read_b64_tr_b16 v[20:21], v7 offset:16384
    ds_read_b64_tr_b16 v[22:23], v7 offset:16896
    v_mfma_f32_32x32x16_bf16 v[96:111], v[28:31], v[116:119], v[96:111]
    ds_read_b64_tr_b16 v[24:25], v6 offset:18432
    ds_read_b64_tr_b16 v[26:27], v6 offset:18944
    s_cmp_ge_u32 s28, 576
    s_cselect_b32 s45, 1.0, 0x3eae1a93
    s_cselect_b32 s46, 2322432, 0
    s_lshl_b32 s31, s28, 6
    s_add_u32 s46, s46, s31
    s_add_u32 s46, s46, s25
    s_add_u32 s28, s28, 64
    v_mul_f32 v48, s45, v48
    s_waitcnt lgkmcnt(10)
    v_mfma_f32_32x32x16_bf16 v[80:95], v[32:35], v[120:123], v[80:95]
    ds_read_b64_tr_b16 v[28:29], v7 offset:18432
    ds_read_b64_tr_b16 v[30:31], v7 offset:18944
    v_mul_f32 v49, s45, v49
    v_mfma_f32_32x32x16_bf16 v[96:111], v[36:39], v[120:123], v[96:111]
    ds_read_b64_tr_b16 v[32:33], v6 offset:20480
    ds_read_b64_tr_b16 v[34:35], v6 offset:20992
    v_mul_f32 v50, s45, v50
    s_waitcnt lgkmcnt(10)
    v_mfma_f32_32x32x16_bf16 v[80:95], v[40:43], v[124:127], v[80:95]
    ds_read_b64_tr_b16 v[36:37], v7 offset:20480
    ds_read_b64_tr_b16 v[38:39], v7 offset:20992
    v_mul_f32 v51, s45, v51
    v_mul_f32 v52, s45, v52
    v_mfma_f32_32x32x16_bf16 v[96:111], v[44:47], v[124:127], v[96:111]
    ds_read_b64_tr_b16 v[40:41], v6 offset:22528
    ds_read_b64_tr_b16 v[42:43], v6 offset:23040
    v_mul_f32 v53, s45, v53
    s_waitcnt lgkmcnt(10)
    v_mfma_f32_32x32x16_bf16 v[80:95], v[16:19], v[128:131], v[80:95]
    ds_read_b64_tr_b16 v[44:45], v7 offset:22528
    ds_read_b64_tr_b16 v[46:47], v7 offset:23040
    v_mul_f32 v54, s45, v54
    v_mfma_f32_32x32x16_bf16 v[96:111], v[20:23], v[128:131], v[96:111]
    s_waitcnt vmcnt(9)
    s_barrier
    ds_read_b64_tr_b16 v[16:17], v6 offset:24576
    ds_read_b64_tr_b16 v[18:19], v6 offset:25088
    s_add_u32 m0, s24, 122880
    s_add_u32 s30, s44, 256
    buffer_load_dwordx4 v2, s[8:11], s30 offen lds
    s_add_u32 m0, s24, 57344
    s_add_u32 s30, s36, 384
    buffer_load_dwordx4 v2, s[8:11], s30 offen lds
    v_mul_f32 v55, s45, v55
    v_mul_f32 v56, s45, v56
    s_waitcnt lgkmcnt(10)
    v_mfma_f32_32x32x16_bf16 v[80:95], v[24:27], v[132:135], v[80:95]
    ds_read_b64_tr_b16 v[20:21], v7 offset:24576
    ds_read_b64_tr_b16 v[22:23], v7 offset:25088
    s_add_u32 m0, s24, 65536
    s_add_u32 s30, s37, 384
    buffer_load_dwordx4 v2, s[8:11], s30 offen lds
    s_add_u32 m0, s24, 73728
    s_add_u32 s30, s38, 384
    buffer_load_dwordx4 v2, s[8:11], s30 offen lds
    v_mul_f32 v57, s45, v57
    v_mfma_f32_32x32x16_bf16 v[96:111], v[28:31], v[132:135], v[96:111]
    ds_read_b64_tr_b16 v[24:25], v6 offset:26624
    ds_read_b64_tr_b16 v[26:27], v6 offset:27136
    v_mul_f32 v58, s45, v58
    s_waitcnt lgkmcnt(10)
    v_mfma_f32_32x32x16_bf16 v[80:95], v[32:35], v[136:139], v[80:95]
    ds_read_b64_tr_b16 v[28:29], v7 offset:26624
    ds_read_b64_tr_b16 v[30:31], v7 offset:27136
    v_mul_f32 v59, s45, v59
    v_mfma_f32_32x32x16_bf16 v[96:111], v[36:39], v[136:139], v[96:111]
    ds_read_b64_tr_b16 v[32:33], v6 offset:28672
    ds_read_b64_tr_b16 v[34:35], v6 offset:29184
    v_mul_f32 v60, s45, v60
    v_mul_f32 v61, s45, v61
    s_waitcnt lgkmcnt(10)
    v_mfma_f32_32x32x16_bf16 v[80:95], v[40:43], v[140:143], v[80:95]
    ds_read_b64_tr_b16 v[36:37], v7 offset:28672
    ds_read_b64_tr_b16 v[38:39], v7 offset:29184
    v_mul_f32 v62, s45, v62
    v_mfma_f32_32x32x16_bf16 v[96:111], v[44:47], v[140:143], v[96:111]
    ds_read_b64_tr_b16 v[40:41], v6 offset:30720
    ds_read_b64_tr_b16 v[42:43], v6 offset:31232
    v_mul_f32 v63, s45, v63
    s_waitcnt lgkmcnt(10)
    v_mfma_f32_32x32x16_bf16 v[80:95], v[16:19], v[144:147], v[80:95]
    ds_read_b64_tr_b16 v[44:45], v7 offset:30720
    ds_read_b64_tr_b16 v[46:47], v7 offset:31232
    v_cvt_pk_bf16_f32 v48, v48, v49
    v_cvt_pk_bf16_f32 v49, v50, v51
    v_mfma_f32_32x32x16_bf16 v[96:111], v[20:23], v[144:147], v[96:111]
    ds_read_b64_tr_b16 v[16:17], v4 offset:0
    ds_read_b64_tr_b16 v[18:19], v4 offset:512
    v_cvt_pk_bf16_f32 v50, v52, v53
    s_waitcnt lgkmcnt(10)
    v_mfma_f32_32x32x16_bf16 v[80:95], v[24:27], v[148:151], v[80:95]
    ds_read_b64_tr_b16 v[20:21], v5 offset:0
    ds_read_b64_tr_b16 v[22:23], v5 offset:512
    v_cvt_pk_bf16_f32 v51, v54, v55
    v_mfma_f32_32x32x16_bf16 v[96:111], v[28:31], v[148:151], v[96:111]
    ds_read_b64_tr_b16 v[24:25], v4 offset:2048
    ds_read_b64_tr_b16 v[26:27], v4 offset:2560
    v_cvt_pk_bf16_f32 v52, v56, v57
    v_cvt_pk_bf16_f32 v53, v58, v59
    s_waitcnt lgkmcnt(10)
    v_mfma_f32_32x32x16_bf16 v[80:95], v[32:35], v[152:155], v[80:95]
    ds_read_b64_tr_b16 v[28:29], v5 offset:2048
    ds_read_b64_tr_b16 v[30:31], v5 offset:2560
    v_cvt_pk_bf16_f32 v54, v60, v61
    v_mfma_f32_32x32x16_bf16 v[96:111], v[36:39], v[152:155], v[96:111]
    ds_read_b64_tr_b16 v[32:33], v4 offset:4096
    ds_read_b64_tr_b16 v[34:35], v4 offset:4608
    v_cvt_pk_bf16_f32 v55, v62, v63
    s_waitcnt lgkmcnt(10)
    v_mfma_f32_32x32x16_bf16 v[80:95], v[40:43], v[156:159], v[80:95]
    ds_read_b64_tr_b16 v[36:37], v5 offset:4096
    ds_read_b64_tr_b16 v[38:39], v5 offset:4608
    v_permlane32_swap_b32 v48, v50
    v_mfma_f32_32x32x16_bf16 v[96:111], v[44:47], v[156:159], v[96:111]
    ds_read_b64_tr_b16 v[40:41], v4 offset:6144
    ds_read_b64_tr_b16 v[42:43], v4 offset:6656
    v_permlane32_swap_b32 v49, v51
    v_permlane32_swap_b32 v52, v54
    s_waitcnt lgkmcnt(10)
    v_mfma_f32_32x32x16_bf16 v[80:95], v[16:19], v[160:163], v[80:95]
    ds_read_b64_tr_b16 v[44:45], v5 offset:6144
    ds_read_b64_tr_b16 v[46:47], v5 offset:6656
    v_permlane32_swap_b32 v53, v55
    v_mfma_f32_32x32x16_bf16 v[96:111], v[20:23], v[160:163], v[96:111]
    ds_read_b64_tr_b16 v[16:17], v4 offset:8192
    ds_read_b64_tr_b16 v[18:19], v4 offset:8704
    buffer_store_dwordx4 v[48:51], v1, s[16:19], s46 offen offset:0 sc1
    s_waitcnt lgkmcnt(10)
    v_mfma_f32_32x32x16_bf16 v[80:95], v[24:27], v[164:167], v[80:95]
    ds_read_b64_tr_b16 v[20:21], v5 offset:8192
    ds_read_b64_tr_b16 v[22:23], v5 offset:8704
    buffer_store_dwordx4 v[52:55], v1, s[16:19], s46 offen offset:1024 sc1
    v_mul_f32 v64, s45, v64
    v_mfma_f32_32x32x16_bf16 v[96:111], v[28:31], v[164:167], v[96:111]
    ds_read_b64_tr_b16 v[24:25], v4 offset:10240
    ds_read_b64_tr_b16 v[26:27], v4 offset:10752
    v_mul_f32 v65, s45, v65
    s_waitcnt lgkmcnt(10)
    v_mfma_f32_32x32x16_bf16 v[80:95], v[32:35], v[168:171], v[80:95]
    ds_read_b64_tr_b16 v[28:29], v5 offset:10240
    ds_read_b64_tr_b16 v[30:31], v5 offset:10752
    v_mul_f32 v66, s45, v66
    v_mfma_f32_32x32x16_bf16 v[96:111], v[36:39], v[168:171], v[96:111]
    ds_read_b64_tr_b16 v[32:33], v4 offset:12288
    ds_read_b64_tr_b16 v[34:35], v4 offset:12800
    v_mul_f32 v67, s45, v67
    v_mul_f32 v68, s45, v68
    s_waitcnt lgkmcnt(10)
    v_mfma_f32_32x32x16_bf16 v[80:95], v[40:43], v[172:175], v[80:95]
    ds_read_b64_tr_b16 v[36:37], v5 offset:12288
    ds_read_b64_tr_b16 v[38:39], v5 offset:12800
    v_mul_f32 v69, s45, v69
    v_mfma_f32_32x32x16_bf16 v[96:111], v[44:47], v[172:175], v[96:111]
    ds_read_b64_tr_b16 v[40:41], v4 offset:14336
    ds_read_b64_tr_b16 v[42:43], v4 offset:14848
    v_mul_f32 v70, s45, v70
    s_waitcnt lgkmcnt(10)
    v_mfma_f32_32x32x16_bf16 v[80:95], v[16:19], v[176:179], v[80:95]
    ds_read_b64_tr_b16 v[44:45], v5 offset:14336
    ds_read_b64_tr_b16 v[46:47], v5 offset:14848
    v_mul_f32 v71, s45, v71
    v_mfma_f32_32x32x16_bf16 v[96:111], v[20:23], v[176:179], v[96:111]
    ds_read_b64_tr_b16 v[16:17], v4 offset:16384
    ds_read_b64_tr_b16 v[18:19], v4 offset:16896
    v_mul_f32 v72, s45, v72
    v_mul_f32 v73, s45, v73
    s_waitcnt lgkmcnt(10)
    v_mfma_f32_32x32x16_bf16 v[80:95], v[24:27], v[180:183], v[80:95]
    ds_read_b64_tr_b16 v[20:21], v5 offset:16384
    ds_read_b64_tr_b16 v[22:23], v5 offset:16896
    v_mul_f32 v74, s45, v74
    v_mfma_f32_32x32x16_bf16 v[96:111], v[28:31], v[180:183], v[96:111]
    ds_read_b64_tr_b16 v[24:25], v4 offset:18432
    ds_read_b64_tr_b16 v[26:27], v4 offset:18944
    v_mul_f32 v75, s45, v75
    s_waitcnt lgkmcnt(10)
    v_mfma_f32_32x32x16_bf16 v[80:95], v[32:35], v[184:187], v[80:95]
    ds_read_b64_tr_b16 v[28:29], v5 offset:18432
    ds_read_b64_tr_b16 v[30:31], v5 offset:18944
    v_mul_f32 v76, s45, v76
    v_mul_f32 v77, s45, v77
    v_mfma_f32_32x32x16_bf16 v[96:111], v[36:39], v[184:187], v[96:111]
    ds_read_b64_tr_b16 v[32:33], v4 offset:20480
    ds_read_b64_tr_b16 v[34:35], v4 offset:20992
    v_mul_f32 v78, s45, v78
    s_waitcnt lgkmcnt(10)
    v_mfma_f32_32x32x16_bf16 v[80:95], v[40:43], v[188:191], v[80:95]
    ds_read_b64_tr_b16 v[36:37], v5 offset:20480
    ds_read_b64_tr_b16 v[38:39], v5 offset:20992
    v_mul_f32 v79, s45, v79
    v_mfma_f32_32x32x16_bf16 v[96:111], v[44:47], v[188:191], v[96:111]
    ds_read_b64_tr_b16 v[40:41], v4 offset:22528
    ds_read_b64_tr_b16 v[42:43], v4 offset:23040
    v_cvt_pk_bf16_f32 v64, v64, v65
    v_cvt_pk_bf16_f32 v65, v66, v67
    s_waitcnt lgkmcnt(10)
    v_mfma_f32_32x32x16_bf16 v[80:95], v[16:19], v[192:195], v[80:95]
    ds_read_b64_tr_b16 v[44:45], v5 offset:22528
    ds_read_b64_tr_b16 v[46:47], v5 offset:23040
    v_cvt_pk_bf16_f32 v66, v68, v69
    v_mfma_f32_32x32x16_bf16 v[96:111], v[20:23], v[192:195], v[96:111]
    ds_read_b64_tr_b16 v[16:17], v4 offset:24576
    ds_read_b64_tr_b16 v[18:19], v4 offset:25088
    v_cvt_pk_bf16_f32 v67, v70, v71
    s_waitcnt lgkmcnt(10)
    v_mfma_f32_32x32x16_bf16 v[80:95], v[24:27], v[196:199], v[80:95]
    ds_read_b64_tr_b16 v[20:21], v5 offset:24576
    ds_read_b64_tr_b16 v[22:23], v5 offset:25088
    v_cvt_pk_bf16_f32 v68, v72, v73
    v_mfma_f32_32x32x16_bf16 v[96:111], v[28:31], v[196:199], v[96:111]
    ds_read_b64_tr_b16 v[24:25], v4 offset:26624
    ds_read_b64_tr_b16 v[26:27], v4 offset:27136
    v_cvt_pk_bf16_f32 v69, v74, v75
    v_cvt_pk_bf16_f32 v70, v76, v77
    s_waitcnt lgkmcnt(10)
    v_mfma_f32_32x32x16_bf16 v[80:95], v[32:35], v[200:203], v[80:95]
    ds_read_b64_tr_b16 v[28:29], v5 offset:26624
    ds_read_b64_tr_b16 v[30:31], v5 offset:27136
    v_cvt_pk_bf16_f32 v71, v78, v79
    v_mfma_f32_32x32x16_bf16 v[96:111], v[36:39], v[200:203], v[96:111]
    ds_read_b64_tr_b16 v[32:33], v4 offset:28672
    ds_read_b64_tr_b16 v[34:35], v4 offset:29184
    v_permlane32_swap_b32 v64, v66
    s_waitcnt lgkmcnt(10)
    v_mfma_f32_32x32x16_bf16 v[80:95], v[40:43], v[204:207], v[80:95]
    ds_read_b64_tr_b16 v[36:37], v5 offset:28672
    ds_read_b64_tr_b16 v[38:39], v5 offset:29184
    v_permlane32_swap_b32 v65, v67
    v_permlane32_swap_b32 v68, v70
    v_mfma_f32_32x32x16_bf16 v[96:111], v[44:47], v[204:207], v[96:111]
    ds_read_b64_tr_b16 v[40:41], v4 offset:30720
    ds_read_b64_tr_b16 v[42:43], v4 offset:31232
    v_permlane32_swap_b32 v69, v71
    s_waitcnt lgkmcnt(10)
    v_mfma_f32_32x32x16_bf16 v[80:95], v[16:19], v[208:211], v[80:95]
    ds_read_b64_tr_b16 v[44:45], v5 offset:30720
    ds_read_b64_tr_b16 v[46:47], v5 offset:31232
    buffer_store_dwordx4 v[64:67], v1, s[16:19], s46 offen offset:2048 sc1
    v_mfma_f32_32x32x16_bf16 v[96:111], v[20:23], v[208:211], v[96:111]
    ds_read_b64_tr_b16 v[16:17], v8 offset:0
    ds_read_b64_tr_b16 v[18:19], v8 offset:512
    buffer_store_dwordx4 v[68:71], v1, s[16:19], s46 offen offset:3072 sc1
    s_waitcnt lgkmcnt(10)
    v_mfma_f32_32x32x16_bf16 v[80:95], v[24:27], v[212:215], v[80:95]
    ds_read_b64_tr_b16 v[20:21], v9 offset:0
    ds_read_b64_tr_b16 v[22:23], v9 offset:512
    v_mfma_f32_32x32x16_bf16 v[96:111], v[28:31], v[212:215], v[96:111]
    ds_read_b64_tr_b16 v[24:25], v8 offset:2048
    ds_read_b64_tr_b16 v[26:27], v8 offset:2560
    s_waitcnt lgkmcnt(10)
    v_mfma_f32_32x32x16_bf16 v[80:95], v[32:35], v[216:219], v[80:95]
    ds_read_b64_tr_b16 v[28:29], v9 offset:2048
    ds_read_b64_tr_b16 v[30:31], v9 offset:2560
    v_mfma_f32_32x32x16_bf16 v[96:111], v[36:39], v[216:219], v[96:111]
    ds_read_b64_tr_b16 v[32:33], v8 offset:4096
    ds_read_b64_tr_b16 v[34:35], v8 offset:4608
    s_waitcnt lgkmcnt(10)
    v_mfma_f32_32x32x16_bf16 v[80:95], v[40:43], v[220:223], v[80:95]
    ds_read_b64_tr_b16 v[36:37], v9 offset:4096
    ds_read_b64_tr_b16 v[38:39], v9 offset:4608
    v_mfma_f32_32x32x16_bf16 v[96:111], v[44:47], v[220:223], v[96:111]
    ds_read_b64_tr_b16 v[40:41], v8 offset:6144
    ds_read_b64_tr_b16 v[42:43], v8 offset:6656
    s_waitcnt lgkmcnt(10)
    v_mfma_f32_32x32x16_bf16 v[80:95], v[16:19], v[224:227], v[80:95]
    ds_read_b64_tr_b16 v[44:45], v9 offset:6144
    ds_read_b64_tr_b16 v[46:47], v9 offset:6656
    v_mfma_f32_32x32x16_bf16 v[96:111], v[20:23], v[224:227], v[96:111]
    s_waitcnt vmcnt(11)
    s_barrier
    ds_read_b64_tr_b16 v[16:17], v8 offset:8192
    ds_read_b64_tr_b16 v[18:19], v8 offset:8704
    s_add_u32 m0, s24, 81920
    s_add_u32 s30, s39, 384
    buffer_load_dwordx4 v2, s[8:11], s30 offen lds
    s_add_u32 m0, s24, 90112
    s_add_u32 s30, s40, 384
    buffer_load_dwordx4 v2, s[8:11], s30 offen lds
    s_waitcnt lgkmcnt(10)
    v_mfma_f32_32x32x16_bf16 v[80:95], v[24:27], v[228:231], v[80:95]
    ds_read_b64_tr_b16 v[20:21], v9 offset:8192
    ds_read_b64_tr_b16 v[22:23], v9 offset:8704
    s_add_u32 m0, s24, 0
    s_add_u32 s30, s41, 384
    buffer_load_dwordx4 v2, s[8:11], s30 offen lds
    s_add_u32 m0, s24, 8192
    s_add_u32 s30, s42, 384
    buffer_load_dwordx4 v2, s[8:11], s30 offen lds
    v_mfma_f32_32x32x16_bf16 v[96:111], v[28:31], v[228:231], v[96:111]
    ds_read_b64_tr_b16 v[24:25], v8 offset:10240
    ds_read_b64_tr_b16 v[26:27], v8 offset:10752
    s_add_u32 m0, s24, 16384
    s_add_u32 s30, s43, 384
    buffer_load_dwordx4 v2, s[8:11], s30 offen lds
    s_add_u32 m0, s24, 24576
    s_add_u32 s30, s44, 384
    buffer_load_dwordx4 v2, s[8:11], s30 offen lds
    s_waitcnt lgkmcnt(10)
    v_mfma_f32_32x32x16_bf16 v[80:95], v[32:35], v[232:235], v[80:95]
    ds_read_b64_tr_b16 v[28:29], v9 offset:10240
    ds_read_b64_tr_b16 v[30:31], v9 offset:10752
    v_mfma_f32_32x32x16_bf16 v[96:111], v[36:39], v[232:235], v[96:111]
    ds_read_b64_tr_b16 v[32:33], v8 offset:12288
    ds_read_b64_tr_b16 v[34:35], v8 offset:12800
    s_waitcnt lgkmcnt(10)
    v_mfma_f32_32x32x16_bf16 v[80:95], v[40:43], v[236:239], v[80:95]
    ds_read_b64_tr_b16 v[36:37], v9 offset:12288
    ds_read_b64_tr_b16 v[38:39], v9 offset:12800
    v_mfma_f32_32x32x16_bf16 v[96:111], v[44:47], v[236:239], v[96:111]
    ds_read_b64_tr_b16 v[40:41], v8 offset:14336
    ds_read_b64_tr_b16 v[42:43], v8 offset:14848
    s_waitcnt lgkmcnt(10)
    v_mfma_f32_32x32x16_bf16 v[80:95], v[16:19], v[240:243], v[80:95]
    ds_read_b64_tr_b16 v[44:45], v9 offset:14336
    ds_read_b64_tr_b16 v[46:47], v9 offset:14848
    v_mfma_f32_32x32x16_bf16 v[96:111], v[20:23], v[240:243], v[96:111]
    ds_read_b64_tr_b16 v[16:17], v8 offset:16384
    ds_read_b64_tr_b16 v[18:19], v8 offset:16896
    s_waitcnt lgkmcnt(10)
    v_mfma_f32_32x32x16_bf16 v[80:95], v[24:27], v[244:247], v[80:95]
    ds_read_b64_tr_b16 v[20:21], v9 offset:16384
    ds_read_b64_tr_b16 v[22:23], v9 offset:16896
    v_mfma_f32_32x32x16_bf16 v[96:111], v[28:31], v[244:247], v[96:111]
    ds_read_b64_tr_b16 v[24:25], v8 offset:18432
    ds_read_b64_tr_b16 v[26:27], v8 offset:18944
    s_waitcnt lgkmcnt(10)
    v_mfma_f32_32x32x16_bf16 v[80:95], v[32:35], v[248:251], v[80:95]
    ds_read_b64_tr_b16 v[28:29], v9 offset:18432
    ds_read_b64_tr_b16 v[30:31], v9 offset:18944
    v_mfma_f32_32x32x16_bf16 v[96:111], v[36:39], v[248:251], v[96:111]
    ds_read_b64_tr_b16 v[32:33], v8 offset:20480
    ds_read_b64_tr_b16 v[34:35], v8 offset:20992
    s_waitcnt lgkmcnt(10)
    v_mfma_f32_32x32x16_bf16 v[80:95], v[40:43], v[252:255], v[80:95]
    ds_read_b64_tr_b16 v[36:37], v9 offset:20480
    ds_read_b64_tr_b16 v[38:39], v9 offset:20992
    v_mfma_f32_32x32x16_bf16 v[96:111], v[44:47], v[252:255], v[96:111]
    ds_read_b64_tr_b16 v[40:41], v8 offset:22528
    ds_read_b64_tr_b16 v[42:43], v8 offset:23040
    s_waitcnt lgkmcnt(10)
    v_mfma_f32_32x32x16_bf16 v[48:63], v[16:19], v[112:115], 0
    ds_read_b64_tr_b16 v[44:45], v9 offset:22528
    ds_read_b64_tr_b16 v[46:47], v9 offset:23040
    v_mfma_f32_32x32x16_bf16 v[64:79], v[20:23], v[112:115], 0
    ds_read_b64_tr_b16 v[16:17], v8 offset:24576
    ds_read_b64_tr_b16 v[18:19], v8 offset:25088
    s_waitcnt lgkmcnt(10)
    v_mfma_f32_32x32x16_bf16 v[48:63], v[24:27], v[116:119], v[48:63]
    ds_read_b64_tr_b16 v[20:21], v9 offset:24576
    ds_read_b64_tr_b16 v[22:23], v9 offset:25088
    v_mfma_f32_32x32x16_bf16 v[64:79], v[28:31], v[116:119], v[64:79]
    ds_read_b64_tr_b16 v[24:25], v8 offset:26624
    ds_read_b64_tr_b16 v[26:27], v8 offset:27136
    s_cmp_ge_u32 s28, 576
    s_cselect_b32 s45, 1.0, 0x3eae1a93
    s_cselect_b32 s46, 2322432, 0
    s_lshl_b32 s31, s28, 6
    s_add_u32 s46, s46, s31
    s_add_u32 s46, s46, s25
    s_add_u32 s28, s28, 64
    v_mul_f32 v80, s45, v80
    s_waitcnt lgkmcnt(10)
    v_mfma_f32_32x32x16_bf16 v[48:63], v[32:35], v[120:123], v[48:63]
    ds_read_b64_tr_b16 v[28:29], v9 offset:26624
    ds_read_b64_tr_b16 v[30:31], v9 offset:27136
    v_mul_f32 v81, s45, v81
    v_mfma_f32_32x32x16_bf16 v[64:79], v[36:39], v[120:123], v[64:79]
    ds_read_b64_tr_b16 v[32:33], v8 offset:28672
    ds_read_b64_tr_b16 v[34:35], v8 offset:29184
    v_mul_f32 v82, s45, v82
    s_waitcnt lgkmcnt(10)
    v_mfma_f32_32x32x16_bf16 v[48:63], v[40:43], v[124:127], v[48:63]
    ds_read_b64_tr_b16 v[36:37], v9 offset:28672
    ds_read_b64_tr_b16 v[38:39], v9 offset:29184
    v_mul_f32 v83, s45, v83
    v_mul_f32 v84, s45, v84
    v_mfma_f32_32x32x16_bf16 v[64:79], v[44:47], v[124:127], v[64:79]
    ds_read_b64_tr_b16 v[40:41], v8 offset:30720
    ds_read_b64_tr_b16 v[42:43], v8 offset:31232
    v_mul_f32 v85, s45, v85
    s_waitcnt lgkmcnt(10)
    v_mfma_f32_32x32x16_bf16 v[48:63], v[16:19], v[128:131], v[48:63]
    ds_read_b64_tr_b16 v[44:45], v9 offset:30720
    ds_read_b64_tr_b16 v[46:47], v9 offset:31232
    v_mul_f32 v86, s45, v86
    v_mfma_f32_32x32x16_bf16 v[64:79], v[20:23], v[128:131], v[64:79]
    ds_read_b64_tr_b16 v[16:17], v4 offset:32768
    ds_read_b64_tr_b16 v[18:19], v4 offset:33280
    v_mul_f32 v87, s45, v87
    v_mul_f32 v88, s45, v88
    s_waitcnt lgkmcnt(10)
    v_mfma_f32_32x32x16_bf16 v[48:63], v[24:27], v[132:135], v[48:63]
    ds_read_b64_tr_b16 v[20:21], v5 offset:32768
    ds_read_b64_tr_b16 v[22:23], v5 offset:33280
    v_mul_f32 v89, s45, v89
    v_mfma_f32_32x32x16_bf16 v[64:79], v[28:31], v[132:135], v[64:79]
    ds_read_b64_tr_b16 v[24:25], v4 offset:34816
    ds_read_b64_tr_b16 v[26:27], v4 offset:35328
    v_mul_f32 v90, s45, v90
    s_waitcnt lgkmcnt(10)
    v_mfma_f32_32x32x16_bf16 v[48:63], v[32:35], v[136:139], v[48:63]
    ds_read_b64_tr_b16 v[28:29], v5 offset:34816
    ds_read_b64_tr_b16 v[30:31], v5 offset:35328
    v_mul_f32 v91, s45, v91
    v_mfma_f32_32x32x16_bf16 v[64:79], v[36:39], v[136:139], v[64:79]
    ds_read_b64_tr_b16 v[32:33], v4 offset:36864
    ds_read_b64_tr_b16 v[34:35], v4 offset:37376
    v_mul_f32 v92, s45, v92
    v_mul_f32 v93, s45, v93
    s_waitcnt lgkmcnt(10)
    v_mfma_f32_32x32x16_bf16 v[48:63], v[40:43], v[140:143], v[48:63]
    ds_read_b64_tr_b16 v[36:37], v5 offset:36864
    ds_read_b64_tr_b16 v[38:39], v5 offset:37376
    v_mul_f32 v94, s45, v94
    v_mfma_f32_32x32x16_bf16 v[64:79], v[44:47], v[140:143], v[64:79]
    ds_read_b64_tr_b16 v[40:41], v4 offset:38912
    ds_read_b64_tr_b16 v[42:43], v4 offset:39424
    v_mul_f32 v95, s45, v95
    s_waitcnt lgkmcnt(10)
    v_mfma_f32_32x32x16_bf16 v[48:63], v[16:19], v[144:147], v[48:63]
    ds_read_b64_tr_b16 v[44:45], v5 offset:38912
    ds_read_b64_tr_b16 v[46:47], v5 offset:39424
    v_cvt_pk_bf16_f32 v80, v80, v81
    v_cvt_pk_bf16_f32 v81, v82, v83
    v_mfma_f32_32x32x16_bf16 v[64:79], v[20:23], v[144:147], v[64:79]
    ds_read_b64_tr_b16 v[16:17], v4 offset:40960
    ds_read_b64_tr_b16 v[18:19], v4 offset:41472
    v_cvt_pk_bf16_f32 v82, v84, v85
    s_waitcnt lgkmcnt(10)
    v_mfma_f32_32x32x16_bf16 v[48:63], v[24:27], v[148:151], v[48:63]
    ds_read_b64_tr_b16 v[20:21], v5 offset:40960
    ds_read_b64_tr_b16 v[22:23], v5 offset:41472
    v_cvt_pk_bf16_f32 v83, v86, v87
    v_mfma_f32_32x32x16_bf16 v[64:79], v[28:31], v[148:151], v[64:79]
    ds_read_b64_tr_b16 v[24:25], v4 offset:43008
    ds_read_b64_tr_b16 v[26:27], v4 offset:43520
    v_cvt_pk_bf16_f32 v84, v88, v89
    v_cvt_pk_bf16_f32 v85, v90, v91
    s_waitcnt lgkmcnt(10)
    v_mfma_f32_32x32x16_bf16 v[48:63], v[32:35], v[152:155], v[48:63]
    ds_read_b64_tr_b16 v[28:29], v5 offset:43008
    ds_read_b64_tr_b16 v[30:31], v5 offset:43520
    v_cvt_pk_bf16_f32 v86, v92, v93
    v_mfma_f32_32x32x16_bf16 v[64:79], v[36:39], v[152:155], v[64:79]
    ds_read_b64_tr_b16 v[32:33], v4 offset:45056
    ds_read_b64_tr_b16 v[34:35], v4 offset:45568
    v_cvt_pk_bf16_f32 v87, v94, v95
    s_waitcnt lgkmcnt(10)
    v_mfma_f32_32x32x16_bf16 v[48:63], v[40:43], v[156:159], v[48:63]
    ds_read_b64_tr_b16 v[36:37], v5 offset:45056
    ds_read_b64_tr_b16 v[38:39], v5 offset:45568
    v_permlane32_swap_b32 v80, v82
    v_mfma_f32_32x32x16_bf16 v[64:79], v[44:47], v[156:159], v[64:79]
    ds_read_b64_tr_b16 v[40:41], v4 offset:47104
    ds_read_b64_tr_b16 v[42:43], v4 offset:47616
    v_permlane32_swap_b32 v81, v83
    v_permlane32_swap_b32 v84, v86
    s_waitcnt lgkmcnt(10)
    v_mfma_f32_32x32x16_bf16 v[48:63], v[16:19], v[160:163], v[48:63]
    ds_read_b64_tr_b16 v[44:45], v5 offset:47104
    ds_read_b64_tr_b16 v[46:47], v5 offset:47616
    v_permlane32_swap_b32 v85, v87
    v_mfma_f32_32x32x16_bf16 v[64:79], v[20:23], v[160:163], v[64:79]
    ds_read_b64_tr_b16 v[16:17], v4 offset:49152
    ds_read_b64_tr_b16 v[18:19], v4 offset:49664
    buffer_store_dwordx4 v[80:83], v1, s[16:19], s46 offen offset:0 sc1
    s_waitcnt lgkmcnt(10)
    v_mfma_f32_32x32x16_bf16 v[48:63], v[24:27], v[164:167], v[48:63]
    ds_read_b64_tr_b16 v[20:21], v5 offset:49152
    ds_read_b64_tr_b16 v[22:23], v5 offset:49664
    buffer_store_dwordx4 v[84:87], v1, s[16:19], s46 offen offset:1024 sc1
    v_mul_f32 v96, s45, v96
    v_mfma_f32_32x32x16_bf16 v[64:79], v[28:31], v[164:167], v[64:79]
    ds_read_b64_tr_b16 v[24:25], v4 offset:51200
    ds_read_b64_tr_b16 v[26:27], v4 offset:51712
    v_mul_f32 v97, s45, v97
    s_waitcnt lgkmcnt(10)
    v_mfma_f32_32x32x16_bf16 v[48:63], v[32:35], v[168:171], v[48:63]
    ds_read_b64_tr_b16 v[28:29], v5 offset:51200
    ds_read_b64_tr_b16 v[30:31], v5 offset:51712
    v_mul_f32 v98, s45, v98
    v_mfma_f32_32x32x16_bf16 v[64:79], v[36:39], v[168:171], v[64:79]
    ds_read_b64_tr_b16 v[32:33], v4 offset:53248
    ds_read_b64_tr_b16 v[34:35], v4 offset:53760
    v_mul_f32 v99, s45, v99
    v_mul_f32 v100, s45, v100
    s_waitcnt lgkmcnt(10)
    v_mfma_f32_32x32x16_bf16 v[48:63], v[40:43], v[172:175], v[48:63]
    ds_read_b64_tr_b16 v[36:37], v5 offset:53248
    ds_read_b64_tr_b16 v[38:39], v5 offset:53760
    v_mul_f32 v101, s45, v101
    v_mfma_f32_32x32x16_bf16 v[64:79], v[44:47], v[172:175], v[64:79]
    ds_read_b64_tr_b16 v[40:41], v4 offset:55296
    ds_read_b64_tr_b16 v[42:43], v4 offset:55808
    v_mul_f32 v102, s45, v102
    s_waitcnt lgkmcnt(10)
    v_mfma_f32_32x32x16_bf16 v[48:63], v[16:19], v[176:179], v[48:63]
    ds_read_b64_tr_b16 v[44:45], v5 offset:55296
    ds_read_b64_tr_b16 v[46:47], v5 offset:55808
    v_mul_f32 v103, s45, v103
    v_mfma_f32_32x32x16_bf16 v[64:79], v[20:23], v[176:179], v[64:79]
    s_waitcnt vmcnt(13)
    s_barrier
    ds_read_b64_tr_b16 v[16:17], v6 offset:32768
    ds_read_b64_tr_b16 v[18:19], v6 offset:33280
    v_mul_f32 v104, s45, v104
    v_mul_f32 v105, s45, v105
    s_waitcnt lgkmcnt(10)
    v_mfma_f32_32x32x16_bf16 v[48:63], v[24:27], v[180:183], v[48:63]
    ds_read_b64_tr_b16 v[20:21], v7 offset:32768
    ds_read_b64_tr_b16 v[22:23], v7 offset:33280
    v_mul_f32 v106, s45, v106
    v_mfma_f32_32x32x16_bf16 v[64:79], v[28:31], v[180:183], v[64:79]
    ds_read_b64_tr_b16 v[24:25], v6 offset:34816
    ds_read_b64_tr_b16 v[26:27], v6 offset:35328
    v_mul_f32 v107, s45, v107
    s_waitcnt lgkmcnt(10)
    v_mfma_f32_32x32x16_bf16 v[48:63], v[32:35], v[184:187], v[48:63]
    ds_read_b64_tr_b16 v[28:29], v7 offset:34816
    ds_read_b64_tr_b16 v[30:31], v7 offset:35328
    v_mul_f32 v108, s45, v108
    v_mul_f32 v109, s45, v109
    v_mfma_f32_32x32x16_bf16 v[64:79], v[36:39], v[184:187], v[64:79]
    ds_read_b64_tr_b16 v[32:33], v6 offset:36864
    ds_read_b64_tr_b16 v[34:35], v6 offset:37376
    v_mul_f32 v110, s45, v110
    s_waitcnt lgkmcnt(10)
    v_mfma_f32_32x32x16_bf16 v[48:63], v[40:43], v[188:191], v[48:63]
    ds_read_b64_tr_b16 v[36:37], v7 offset:36864
    ds_read_b64_tr_b16 v[38:39], v7 offset:37376
    v_mul_f32 v111, s45, v111
    v_mfma_f32_32x32x16_bf16 v[64:79], v[44:47], v[188:191], v[64:79]
    ds_read_b64_tr_b16 v[40:41], v6 offset:38912
    ds_read_b64_tr_b16 v[42:43], v6 offset:39424
    v_cvt_pk_bf16_f32 v96, v96, v97
    v_cvt_pk_bf16_f32 v97, v98, v99
    s_waitcnt lgkmcnt(10)
    v_mfma_f32_32x32x16_bf16 v[48:63], v[16:19], v[192:195], v[48:63]
    ds_read_b64_tr_b16 v[44:45], v7 offset:38912
    ds_read_b64_tr_b16 v[46:47], v7 offset:39424
    v_cvt_pk_bf16_f32 v98, v100, v101
    v_mfma_f32_32x32x16_bf16 v[64:79], v[20:23], v[192:195], v[64:79]
    ds_read_b64_tr_b16 v[16:17], v6 offset:40960
    ds_read_b64_tr_b16 v[18:19], v6 offset:41472
    v_cvt_pk_bf16_f32 v99, v102, v103
    s_waitcnt lgkmcnt(10)
    v_mfma_f32_32x32x16_bf16 v[48:63], v[24:27], v[196:199], v[48:63]
    ds_read_b64_tr_b16 v[20:21], v7 offset:40960
    ds_read_b64_tr_b16 v[22:23], v7 offset:41472
    v_cvt_pk_bf16_f32 v100, v104, v105
    v_mfma_f32_32x32x16_bf16 v[64:79], v[28:31], v[196:199], v[64:79]
    ds_read_b64_tr_b16 v[24:25], v6 offset:43008
    ds_read_b64_tr_b16 v[26:27], v6 offset:43520
    v_cvt_pk_bf16_f32 v101, v106, v107
    v_cvt_pk_bf16_f32 v102, v108, v109
    s_waitcnt lgkmcnt(10)
    v_mfma_f32_32x32x16_bf16 v[48:63], v[32:35], v[200:203], v[48:63]
    ds_read_b64_tr_b16 v[28:29], v7 offset:43008
    ds_read_b64_tr_b16 v[30:31], v7 offset:43520
    v_cvt_pk_bf16_f32 v103, v110, v111
    v_mfma_f32_32x32x16_bf16 v[64:79], v[36:39], v[200:203], v[64:79]
    ds_read_b64_tr_b16 v[32:33], v6 offset:45056
    ds_read_b64_tr_b16 v[34:35], v6 offset:45568
    v_permlane32_swap_b32 v96, v98
    s_waitcnt lgkmcnt(10)
    v_mfma_f32_32x32x16_bf16 v[48:63], v[40:43], v[204:207], v[48:63]
    ds_read_b64_tr_b16 v[36:37], v7 offset:45056
    ds_read_b64_tr_b16 v[38:39], v7 offset:45568
    v_permlane32_swap_b32 v97, v99
    v_permlane32_swap_b32 v100, v102
    v_mfma_f32_32x32x16_bf16 v[64:79], v[44:47], v[204:207], v[64:79]
    ds_read_b64_tr_b16 v[40:41], v6 offset:47104
    ds_read_b64_tr_b16 v[42:43], v6 offset:47616
    v_permlane32_swap_b32 v101, v103
    s_waitcnt lgkmcnt(10)
    v_mfma_f32_32x32x16_bf16 v[48:63], v[16:19], v[208:211], v[48:63]
    ds_read_b64_tr_b16 v[44:45], v7 offset:47104
    ds_read_b64_tr_b16 v[46:47], v7 offset:47616
    buffer_store_dwordx4 v[96:99], v1, s[16:19], s46 offen offset:2048 sc1
    v_mfma_f32_32x32x16_bf16 v[64:79], v[20:23], v[208:211], v[64:79]
    ds_read_b64_tr_b16 v[16:17], v6 offset:49152
    ds_read_b64_tr_b16 v[18:19], v6 offset:49664
    buffer_store_dwordx4 v[100:103], v1, s[16:19], s46 offen offset:3072 sc1
    s_waitcnt lgkmcnt(10)
    v_mfma_f32_32x32x16_bf16 v[48:63], v[24:27], v[212:215], v[48:63]
    ds_read_b64_tr_b16 v[20:21], v7 offset:49152
    ds_read_b64_tr_b16 v[22:23], v7 offset:49664
    v_mfma_f32_32x32x16_bf16 v[64:79], v[28:31], v[212:215], v[64:79]
    ds_read_b64_tr_b16 v[24:25], v6 offset:51200
    ds_read_b64_tr_b16 v[26:27], v6 offset:51712
    s_waitcnt lgkmcnt(10)
    v_mfma_f32_32x32x16_bf16 v[48:63], v[32:35], v[216:219], v[48:63]
    ds_read_b64_tr_b16 v[28:29], v7 offset:51200
    ds_read_b64_tr_b16 v[30:31], v7 offset:51712
    v_mfma_f32_32x32x16_bf16 v[64:79], v[36:39], v[216:219], v[64:79]
    ds_read_b64_tr_b16 v[32:33], v6 offset:53248
    ds_read_b64_tr_b16 v[34:35], v6 offset:53760
    s_waitcnt lgkmcnt(10)
    v_mfma_f32_32x32x16_bf16 v[48:63], v[40:43], v[220:223], v[48:63]
    ds_read_b64_tr_b16 v[36:37], v7 offset:53248
    ds_read_b64_tr_b16 v[38:39], v7 offset:53760
    v_mfma_f32_32x32x16_bf16 v[64:79], v[44:47], v[220:223], v[64:79]
    ds_read_b64_tr_b16 v[40:41], v6 offset:55296
    ds_read_b64_tr_b16 v[42:43], v6 offset:55808
    s_waitcnt lgkmcnt(10)
    v_mfma_f32_32x32x16_bf16 v[48:63], v[16:19], v[224:227], v[48:63]
    ds_read_b64_tr_b16 v[44:45], v7 offset:55296
    ds_read_b64_tr_b16 v[46:47], v7 offset:55808
    v_mfma_f32_32x32x16_bf16 v[64:79], v[20:23], v[224:227], v[64:79]
    ds_read_b64_tr_b16 v[16:17], v6 offset:57344
    ds_read_b64_tr_b16 v[18:19], v6 offset:57856
    s_waitcnt lgkmcnt(10)
    v_mfma_f32_32x32x16_bf16 v[48:63], v[24:27], v[228:231], v[48:63]
    ds_read_b64_tr_b16 v[20:21], v7 offset:57344
    ds_read_b64_tr_b16 v[22:23], v7 offset:57856
    v_mfma_f32_32x32x16_bf16 v[64:79], v[28:31], v[228:231], v[64:79]
    ds_read_b64_tr_b16 v[24:25], v6 offset:59392
    ds_read_b64_tr_b16 v[26:27], v6 offset:59904
    s_waitcnt lgkmcnt(10)
    v_mfma_f32_32x32x16_bf16 v[48:63], v[32:35], v[232:235], v[48:63]
    ds_read_b64_tr_b16 v[28:29], v7 offset:59392
    ds_read_b64_tr_b16 v[30:31], v7 offset:59904
    v_mfma_f32_32x32x16_bf16 v[64:79], v[36:39], v[232:235], v[64:79]
    ds_read_b64_tr_b16 v[32:33], v6 offset:61440
    ds_read_b64_tr_b16 v[34:35], v6 offset:61952
    s_waitcnt lgkmcnt(10)
    v_mfma_f32_32x32x16_bf16 v[48:63], v[40:43], v[236:239], v[48:63]
    ds_read_b64_tr_b16 v[36:37], v7 offset:61440
    ds_read_b64_tr_b16 v[38:39], v7 offset:61952
    v_mfma_f32_32x32x16_bf16 v[64:79], v[44:47], v[236:239], v[64:79]
    ds_read_b64_tr_b16 v[40:41], v6 offset:63488
    ds_read_b64_tr_b16 v[42:43], v6 offset:64000
    s_waitcnt lgkmcnt(10)
    v_mfma_f32_32x32x16_bf16 v[48:63], v[16:19], v[240:243], v[48:63]
    ds_read_b64_tr_b16 v[44:45], v7 offset:63488
    ds_read_b64_tr_b16 v[46:47], v7 offset:64000
    v_mfma_f32_32x32x16_bf16 v[64:79], v[20:23], v[240:243], v[64:79]
    ds_read_b64_tr_b16 v[16:17], v4 offset:57344
    ds_read_b64_tr_b16 v[18:19], v4 offset:57856
    s_waitcnt lgkmcnt(10)
    v_mfma_f32_32x32x16_bf16 v[48:63], v[24:27], v[244:247], v[48:63]
    ds_read_b64_tr_b16 v[20:21], v5 offset:57344
    ds_read_b64_tr_b16 v[22:23], v5 offset:57856
    v_mfma_f32_32x32x16_bf16 v[64:79], v[28:31], v[244:247], v[64:79]
    ds_read_b64_tr_b16 v[24:25], v4 offset:59392
    ds_read_b64_tr_b16 v[26:27], v4 offset:59904
    s_waitcnt lgkmcnt(10)
    v_mfma_f32_32x32x16_bf16 v[48:63], v[32:35], v[248:251], v[48:63]
    ds_read_b64_tr_b16 v[28:29], v5 offset:59392
    ds_read_b64_tr_b16 v[30:31], v5 offset:59904
    v_mfma_f32_32x32x16_bf16 v[64:79], v[36:39], v[248:251], v[64:79]
    ds_read_b64_tr_b16 v[32:33], v4 offset:61440
    ds_read_b64_tr_b16 v[34:35], v4 offset:61952
    s_waitcnt lgkmcnt(10)
    v_mfma_f32_32x32x16_bf16 v[48:63], v[40:43], v[252:255], v[48:63]
    ds_read_b64_tr_b16 v[36:37], v5 offset:61440
    ds_read_b64_tr_b16 v[38:39], v5 offset:61952
    v_mfma_f32_32x32x16_bf16 v[64:79], v[44:47], v[252:255], v[64:79]
    ds_read_b64_tr_b16 v[40:41], v4 offset:63488
    ds_read_b64_tr_b16 v[42:43], v4 offset:64000
    s_cmp_ge_u32 s22, 3
    s_cbranch_scc1 L1_QK3
    s_waitcnt lgkmcnt(10)
    v_mfma_f32_32x32x16_bf16 v[80:95], v[16:19], v[112:115], 0
    ds_read_b64_tr_b16 v[44:45], v5 offset:63488
    ds_read_b64_tr_b16 v[46:47], v5 offset:64000
    v_mfma_f32_32x32x16_bf16 v[96:111], v[20:23], v[112:115], 0
    ds_read_b64_tr_b16 v[16:17], v6 offset:0
    ds_read_b64_tr_b16 v[18:19], v6 offset:512
    s_waitcnt lgkmcnt(10)
    v_mfma_f32_32x32x16_bf16 v[80:95], v[24:27], v[116:119], v[80:95]
    ds_read_b64_tr_b16 v[20:21], v7 offset:0
    ds_read_b64_tr_b16 v[22:23], v7 offset:512
    v_mfma_f32_32x32x16_bf16 v[96:111], v[28:31], v[116:119], v[96:111]
    ds_read_b64_tr_b16 v[24:25], v6 offset:2048
    ds_read_b64_tr_b16 v[26:27], v6 offset:2560
    s_cmp_ge_u32 s28, 576
    s_cselect_b32 s45, 1.0, 0x3eae1a93
    s_cselect_b32 s46, 2322432, 0
    s_lshl_b32 s31, s28, 6
    s_add_u32 s46, s46, s31
    s_add_u32 s46, s46, s25
    s_add_u32 s28, s28, 64
    v_mul_f32 v48, s45, v48
    s_waitcnt lgkmcnt(10)
    v_mfma_f32_32x32x16_bf16 v[80:95], v[32:35], v[120:123], v[80:95]
    ds_read_b64_tr_b16 v[28:29], v7 offset:2048
    ds_read_b64_tr_b16 v[30:31], v7 offset:2560
    v_mul_f32 v49, s45, v49
    v_mfma_f32_32x32x16_bf16 v[96:111], v[36:39], v[120:123], v[96:111]
    ds_read_b64_tr_b16 v[32:33], v6 offset:4096
    ds_read_b64_tr_b16 v[34:35], v6 offset:4608
    v_mul_f32 v50, s45, v50
    s_waitcnt lgkmcnt(10)
    v_mfma_f32_32x32x16_bf16 v[80:95], v[40:43], v[124:127], v[80:95]
    ds_read_b64_tr_b16 v[36:37], v7 offset:4096
    ds_read_b64_tr_b16 v[38:39], v7 offset:4608
    v_mul_f32 v51, s45, v51
    v_mul_f32 v52, s45, v52
    v_mfma_f32_32x32x16_bf16 v[96:111], v[44:47], v[124:127], v[96:111]
    ds_read_b64_tr_b16 v[40:41], v6 offset:6144
    ds_read_b64_tr_b16 v[42:43], v6 offset:6656
    v_mul_f32 v53, s45, v53
    s_waitcnt lgkmcnt(10)
    v_mfma_f32_32x32x16_bf16 v[80:95], v[16:19], v[128:131], v[80:95]
    ds_read_b64_tr_b16 v[44:45], v7 offset:6144
    ds_read_b64_tr_b16 v[46:47], v7 offset:6656
    v_mul_f32 v54, s45, v54
    v_mfma_f32_32x32x16_bf16 v[96:111], v[20:23], v[128:131], v[96:111]
    s_waitcnt vmcnt(5)
    s_barrier
    ds_read_b64_tr_b16 v[16:17], v6 offset:8192
    ds_read_b64_tr_b16 v[18:19], v6 offset:8704
    v_mul_f32 v55, s45, v55
    v_mul_f32 v56, s45, v56
    s_waitcnt lgkmcnt(10)
    v_mfma_f32_32x32x16_bf16 v[80:95], v[24:27], v[132:135], v[80:95]
    ds_read_b64_tr_b16 v[20:21], v7 offset:8192
    ds_read_b64_tr_b16 v[22:23], v7 offset:8704
    v_mul_f32 v57, s45, v57
    v_mfma_f32_32x32x16_bf16 v[96:111], v[28:31], v[132:135], v[96:111]
    ds_read_b64_tr_b16 v[24:25], v6 offset:10240
    ds_read_b64_tr_b16 v[26:27], v6 offset:10752
    v_mul_f32 v58, s45, v58
    s_waitcnt lgkmcnt(10)
    v_mfma_f32_32x32x16_bf16 v[80:95], v[32:35], v[136:139], v[80:95]
    ds_read_b64_tr_b16 v[28:29], v7 offset:10240
    ds_read_b64_tr_b16 v[30:31], v7 offset:10752
    v_mul_f32 v59, s45, v59
    v_mfma_f32_32x32x16_bf16 v[96:111], v[36:39], v[136:139], v[96:111]
    ds_read_b64_tr_b16 v[32:33], v6 offset:12288
    ds_read_b64_tr_b16 v[34:35], v6 offset:12800
    v_mul_f32 v60, s45, v60
    v_mul_f32 v61, s45, v61
    s_waitcnt lgkmcnt(10)
    v_mfma_f32_32x32x16_bf16 v[80:95], v[40:43], v[140:143], v[80:95]
    ds_read_b64_tr_b16 v[36:37], v7 offset:12288
    ds_read_b64_tr_b16 v[38:39], v7 offset:12800
    v_mul_f32 v62, s45, v62
    v_mfma_f32_32x32x16_bf16 v[96:111], v[44:47], v[140:143], v[96:111]
    ds_read_b64_tr_b16 v[40:41], v6 offset:14336
    ds_read_b64_tr_b16 v[42:43], v6 offset:14848
    v_mul_f32 v63, s45, v63
    s_waitcnt lgkmcnt(10)
    v_mfma_f32_32x32x16_bf16 v[80:95], v[16:19], v[144:147], v[80:95]
    ds_read_b64_tr_b16 v[44:45], v7 offset:14336
    ds_read_b64_tr_b16 v[46:47], v7 offset:14848
    v_cvt_pk_bf16_f32 v48, v48, v49
    v_cvt_pk_bf16_f32 v49, v50, v51
    v_mfma_f32_32x32x16_bf16 v[96:111], v[20:23], v[144:147], v[96:111]
    ds_read_b64_tr_b16 v[16:17], v6 offset:16384
    ds_read_b64_tr_b16 v[18:19], v6 offset:16896
    v_cvt_pk_bf16_f32 v50, v52, v53
    s_waitcnt lgkmcnt(10)
    v_mfma_f32_32x32x16_bf16 v[80:95], v[24:27], v[148:151], v[80:95]
    ds_read_b64_tr_b16 v[20:21], v7 offset:16384
    ds_read_b64_tr_b16 v[22:23], v7 offset:16896
    v_cvt_pk_bf16_f32 v51, v54, v55
    v_mfma_f32_32x32x16_bf16 v[96:111], v[28:31], v[148:151], v[96:111]
    ds_read_b64_tr_b16 v[24:25], v6 offset:18432
    ds_read_b64_tr_b16 v[26:27], v6 offset:18944
    v_cvt_pk_bf16_f32 v52, v56, v57
    v_cvt_pk_bf16_f32 v53, v58, v59
    s_waitcnt lgkmcnt(10)
    v_mfma_f32_32x32x16_bf16 v[80:95], v[32:35], v[152:155], v[80:95]
    ds_read_b64_tr_b16 v[28:29], v7 offset:18432
    ds_read_b64_tr_b16 v[30:31], v7 offset:18944
    v_cvt_pk_bf16_f32 v54, v60, v61
    v_mfma_f32_32x32x16_bf16 v[96:111], v[36:39], v[152:155], v[96:111]
    ds_read_b64_tr_b16 v[32:33], v6 offset:20480
    ds_read_b64_tr_b16 v[34:35], v6 offset:20992
    v_cvt_pk_bf16_f32 v55, v62, v63
    s_waitcnt lgkmcnt(10)
    v_mfma_f32_32x32x16_bf16 v[80:95], v[40:43], v[156:159], v[80:95]
    ds_read_b64_tr_b16 v[36:37], v7 offset:20480
    ds_read_b64_tr_b16 v[38:39], v7 offset:20992
    v_permlane32_swap_b32 v48, v50
    v_mfma_f32_32x32x16_bf16 v[96:111], v[44:47], v[156:159], v[96:111]
    ds_read_b64_tr_b16 v[40:41], v6 offset:22528
    ds_read_b64_tr_b16 v[42:43], v6 offset:23040
    v_permlane32_swap_b32 v49, v51
    v_permlane32_swap_b32 v52, v54
    s_waitcnt lgkmcnt(10)
    v_mfma_f32_32x32x16_bf16 v[80:95], v[16:19], v[160:163], v[80:95]
    ds_read_b64_tr_b16 v[44:45], v7 offset:22528
    ds_read_b64_tr_b16 v[46:47], v7 offset:23040
    v_permlane32_swap_b32 v53, v55
    v_mfma_f32_32x32x16_bf16 v[96:111], v[20:23], v[160:163], v[96:111]
    ds_read_b64_tr_b16 v[16:17], v6 offset:24576
    ds_read_b64_tr_b16 v[18:19], v6 offset:25088
    buffer_store_dwordx4 v[48:51], v1, s[16:19], s46 offen offset:0 sc1
    s_waitcnt lgkmcnt(10)
    v_mfma_f32_32x32x16_bf16 v[80:95], v[24:27], v[164:167], v[80:95]
    ds_read_b64_tr_b16 v[20:21], v7 offset:24576
    ds_read_b64_tr_b16 v[22:23], v7 offset:25088
    buffer_store_dwordx4 v[52:55], v1, s[16:19], s46 offen offset:1024 sc1
    v_mul_f32 v64, s45, v64
    v_mfma_f32_32x32x16_bf16 v[96:111], v[28:31], v[164:167], v[96:111]
    ds_read_b64_tr_b16 v[24:25], v6 offset:26624
    ds_read_b64_tr_b16 v[26:27], v6 offset:27136
    v_mul_f32 v65, s45, v65
    s_waitcnt lgkmcnt(10)
    v_mfma_f32_32x32x16_bf16 v[80:95], v[32:35], v[168:171], v[80:95]
    ds_read_b64_tr_b16 v[28:29], v7 offset:26624
    ds_read_b64_tr_b16 v[30:31], v7 offset:27136
    v_mul_f32 v66, s45, v66
    v_mfma_f32_32x32x16_bf16 v[96:111], v[36:39], v[168:171], v[96:111]
    ds_read_b64_tr_b16 v[32:33], v6 offset:28672
    ds_read_b64_tr_b16 v[34:35], v6 offset:29184
    v_mul_f32 v67, s45, v67
    v_mul_f32 v68, s45, v68
    s_waitcnt lgkmcnt(10)
    v_mfma_f32_32x32x16_bf16 v[80:95], v[40:43], v[172:175], v[80:95]
    ds_read_b64_tr_b16 v[36:37], v7 offset:28672
    ds_read_b64_tr_b16 v[38:39], v7 offset:29184
    v_mul_f32 v69, s45, v69
    v_mfma_f32_32x32x16_bf16 v[96:111], v[44:47], v[172:175], v[96:111]
    ds_read_b64_tr_b16 v[40:41], v6 offset:30720
    ds_read_b64_tr_b16 v[42:43], v6 offset:31232
    v_mul_f32 v70, s45, v70
    s_waitcnt lgkmcnt(10)
    v_mfma_f32_32x32x16_bf16 v[80:95], v[16:19], v[176:179], v[80:95]
    ds_read_b64_tr_b16 v[44:45], v7 offset:30720
    ds_read_b64_tr_b16 v[46:47], v7 offset:31232
    v_mul_f32 v71, s45, v71
    v_mfma_f32_32x32x16_bf16 v[96:111], v[20:23], v[176:179], v[96:111]
    ds_read_b64_tr_b16 v[16:17], v4 offset:0
    ds_read_b64_tr_b16 v[18:19], v4 offset:512
    v_mul_f32 v72, s45, v72
    v_mul_f32 v73, s45, v73
    s_waitcnt lgkmcnt(10)
    v_mfma_f32_32x32x16_bf16 v[80:95], v[24:27], v[180:183], v[80:95]
    ds_read_b64_tr_b16 v[20:21], v5 offset:0
    ds_read_b64_tr_b16 v[22:23], v5 offset:512
    v_mul_f32 v74, s45, v74
    v_mfma_f32_32x32x16_bf16 v[96:111], v[28:31], v[180:183], v[96:111]
    ds_read_b64_tr_b16 v[24:25], v4 offset:2048
    ds_read_b64_tr_b16 v[26:27], v4 offset:2560
    v_mul_f32 v75, s45, v75
    s_waitcnt lgkmcnt(10)
    v_mfma_f32_32x32x16_bf16 v[80:95], v[32:35], v[184:187], v[80:95]
    ds_read_b64_tr_b16 v[28:29], v5 offset:2048
    ds_read_b64_tr_b16 v[30:31], v5 offset:2560
    v_mul_f32 v76, s45, v76
    v_mul_f32 v77, s45, v77
    v_mfma_f32_32x32x16_bf16 v[96:111], v[36:39], v[184:187], v[96:111]
    ds_read_b64_tr_b16 v[32:33], v4 offset:4096
    ds_read_b64_tr_b16 v[34:35], v4 offset:4608
    v_mul_f32 v78, s45, v78
    s_waitcnt lgkmcnt(10)
    v_mfma_f32_32x32x16_bf16 v[80:95], v[40:43], v[188:191], v[80:95]
    ds_read_b64_tr_b16 v[36:37], v5 offset:4096
    ds_read_b64_tr_b16 v[38:39], v5 offset:4608
    v_mul_f32 v79, s45, v79
    v_mfma_f32_32x32x16_bf16 v[96:111], v[44:47], v[188:191], v[96:111]
    ds_read_b64_tr_b16 v[40:41], v4 offset:6144
    ds_read_b64_tr_b16 v[42:43], v4 offset:6656
    v_cvt_pk_bf16_f32 v64, v64, v65
    v_cvt_pk_bf16_f32 v65, v66, v67
    s_waitcnt lgkmcnt(10)
    v_mfma_f32_32x32x16_bf16 v[80:95], v[16:19], v[192:195], v[80:95]
    ds_read_b64_tr_b16 v[44:45], v5 offset:6144
    ds_read_b64_tr_b16 v[46:47], v5 offset:6656
    v_cvt_pk_bf16_f32 v66, v68, v69
    v_mfma_f32_32x32x16_bf16 v[96:111], v[20:23], v[192:195], v[96:111]
    ds_read_b64_tr_b16 v[16:17], v4 offset:8192
    ds_read_b64_tr_b16 v[18:19], v4 offset:8704
    v_cvt_pk_bf16_f32 v67, v70, v71
    s_waitcnt lgkmcnt(10)
    v_mfma_f32_32x32x16_bf16 v[80:95], v[24:27], v[196:199], v[80:95]
    ds_read_b64_tr_b16 v[20:21], v5 offset:8192
    ds_read_b64_tr_b16 v[22:23], v5 offset:8704
    v_cvt_pk_bf16_f32 v68, v72, v73
    v_mfma_f32_32x32x16_bf16 v[96:111], v[28:31], v[196:199], v[96:111]
    ds_read_b64_tr_b16 v[24:25], v4 offset:10240
    ds_read_b64_tr_b16 v[26:27], v4 offset:10752
    v_cvt_pk_bf16_f32 v69, v74, v75
    v_cvt_pk_bf16_f32 v70, v76, v77
    s_waitcnt lgkmcnt(10)
    v_mfma_f32_32x32x16_bf16 v[80:95], v[32:35], v[200:203], v[80:95]
    ds_read_b64_tr_b16 v[28:29], v5 offset:10240
    ds_read_b64_tr_b16 v[30:31], v5 offset:10752
    v_cvt_pk_bf16_f32 v71, v78, v79
    v_mfma_f32_32x32x16_bf16 v[96:111], v[36:39], v[200:203], v[96:111]
    ds_read_b64_tr_b16 v[32:33], v4 offset:12288
    ds_read_b64_tr_b16 v[34:35], v4 offset:12800
    v_permlane32_swap_b32 v64, v66
    s_waitcnt lgkmcnt(10)
    v_mfma_f32_32x32x16_bf16 v[80:95], v[40:43], v[204:207], v[80:95]
    ds_read_b64_tr_b16 v[36:37], v5 offset:12288
    ds_read_b64_tr_b16 v[38:39], v5 offset:12800
    v_permlane32_swap_b32 v65, v67
    v_permlane32_swap_b32 v68, v70
    v_mfma_f32_32x32x16_bf16 v[96:111], v[44:47], v[204:207], v[96:111]
    ds_read_b64_tr_b16 v[40:41], v4 offset:14336
    ds_read_b64_tr_b16 v[42:43], v4 offset:14848
    v_permlane32_swap_b32 v69, v71
    s_waitcnt lgkmcnt(10)
    v_mfma_f32_32x32x16_bf16 v[80:95], v[16:19], v[208:211], v[80:95]
    ds_read_b64_tr_b16 v[44:45], v5 offset:14336
    ds_read_b64_tr_b16 v[46:47], v5 offset:14848
    buffer_store_dwordx4 v[64:67], v1, s[16:19], s46 offen offset:2048 sc1
    v_mfma_f32_32x32x16_bf16 v[96:111], v[20:23], v[208:211], v[96:111]
    ds_read_b64_tr_b16 v[16:17], v4 offset:16384
    ds_read_b64_tr_b16 v[18:19], v4 offset:16896
    buffer_store_dwordx4 v[68:71], v1, s[16:19], s46 offen offset:3072 sc1
    s_waitcnt lgkmcnt(10)
    v_mfma_f32_32x32x16_bf16 v[80:95], v[24:27], v[212:215], v[80:95]
    ds_read_b64_tr_b16 v[20:21], v5 offset:16384
    ds_read_b64_tr_b16 v[22:23], v5 offset:16896
    v_mfma_f32_32x32x16_bf16 v[96:111], v[28:31], v[212:215], v[96:111]
    ds_read_b64_tr_b16 v[24:25], v4 offset:18432
    ds_read_b64_tr_b16 v[26:27], v4 offset:18944
    s_waitcnt lgkmcnt(10)
    v_mfma_f32_32x32x16_bf16 v[80:95], v[32:35], v[216:219], v[80:95]
    ds_read_b64_tr_b16 v[28:29], v5 offset:18432
    ds_read_b64_tr_b16 v[30:31], v5 offset:18944
    v_mfma_f32_32x32x16_bf16 v[96:111], v[36:39], v[216:219], v[96:111]
    ds_read_b64_tr_b16 v[32:33], v4 offset:20480
    ds_read_b64_tr_b16 v[34:35], v4 offset:20992
    s_waitcnt lgkmcnt(10)
    v_mfma_f32_32x32x16_bf16 v[80:95], v[40:43], v[220:223], v[80:95]
    ds_read_b64_tr_b16 v[36:37], v5 offset:20480
    ds_read_b64_tr_b16 v[38:39], v5 offset:20992
    v_mfma_f32_32x32x16_bf16 v[96:111], v[44:47], v[220:223], v[96:111]
    ds_read_b64_tr_b16 v[40:41], v4 offset:22528
    ds_read_b64_tr_b16 v[42:43], v4 offset:23040
    s_waitcnt lgkmcnt(10)
    v_mfma_f32_32x32x16_bf16 v[80:95], v[16:19], v[224:227], v[80:95]
    ds_read_b64_tr_b16 v[44:45], v5 offset:22528
    ds_read_b64_tr_b16 v[46:47], v5 offset:23040
    v_mfma_f32_32x32x16_bf16 v[96:111], v[20:23], v[224:227], v[96:111]
    s_waitcnt vmcnt(8)
    s_barrier
    ds_read_b64_tr_b16 v[16:17], v4 offset:24576
    ds_read_b64_tr_b16 v[18:19], v4 offset:25088
    s_waitcnt lgkmcnt(10)
    v_mfma_f32_32x32x16_bf16 v[80:95], v[24:27], v[228:231], v[80:95]
    ds_read_b64_tr_b16 v[20:21], v5 offset:24576
    ds_read_b64_tr_b16 v[22:23], v5 offset:25088
    v_mfma_f32_32x32x16_bf16 v[96:111], v[28:31], v[228:231], v[96:111]
    ds_read_b64_tr_b16 v[24:25], v4 offset:26624
    ds_read_b64_tr_b16 v[26:27], v4 offset:27136
    s_waitcnt lgkmcnt(10)
    v_mfma_f32_32x32x16_bf16 v[80:95], v[32:35], v[232:235], v[80:95]
    ds_read_b64_tr_b16 v[28:29], v5 offset:26624
    ds_read_b64_tr_b16 v[30:31], v5 offset:27136
    v_mfma_f32_32x32x16_bf16 v[96:111], v[36:39], v[232:235], v[96:111]
    ds_read_b64_tr_b16 v[32:33], v4 offset:28672
    ds_read_b64_tr_b16 v[34:35], v4 offset:29184
    s_waitcnt lgkmcnt(10)
    v_mfma_f32_32x32x16_bf16 v[80:95], v[40:43], v[236:239], v[80:95]
    ds_read_b64_tr_b16 v[36:37], v5 offset:28672
    ds_read_b64_tr_b16 v[38:39], v5 offset:29184
    v_mfma_f32_32x32x16_bf16 v[96:111], v[44:47], v[236:239], v[96:111]
    ds_read_b64_tr_b16 v[40:41], v4 offset:30720
    ds_read_b64_tr_b16 v[42:43], v4 offset:31232
    s_waitcnt lgkmcnt(10)
    v_mfma_f32_32x32x16_bf16 v[80:95], v[16:19], v[240:243], v[80:95]
    ds_read_b64_tr_b16 v[44:45], v5 offset:30720
    ds_read_b64_tr_b16 v[46:47], v5 offset:31232
    v_mfma_f32_32x32x16_bf16 v[96:111], v[20:23], v[240:243], v[96:111]
    s_waitcnt lgkmcnt(8)
    v_mfma_f32_32x32x16_bf16 v[80:95], v[24:27], v[244:247], v[80:95]
    v_mfma_f32_32x32x16_bf16 v[96:111], v[28:31], v[244:247], v[96:111]
    s_waitcnt lgkmcnt(4)
    v_mfma_f32_32x32x16_bf16 v[80:95], v[32:35], v[248:251], v[80:95]
    v_mfma_f32_32x32x16_bf16 v[96:111], v[36:39], v[248:251], v[96:111]
    s_waitcnt lgkmcnt(0)
    v_mfma_f32_32x32x16_bf16 v[80:95], v[40:43], v[252:255], v[80:95]
    v_mfma_f32_32x32x16_bf16 v[96:111], v[44:47], v[252:255], v[96:111]
    s_cmp_ge_u32 s28, 576
    s_cselect_b32 s45, 1.0, 0x3eae1a93
    s_cselect_b32 s46, 2322432, 0
    s_lshl_b32 s31, s28, 6
    s_add_u32 s46, s46, s31
    s_add_u32 s46, s46, s25
    s_add_u32 s28, s28, 64
    s_nop 3
    v_mul_f32 v80, s45, v80
    v_mul_f32 v81, s45, v81
    v_mul_f32 v82, s45, v82
    v_mul_f32 v83, s45, v83
    v_mul_f32 v84, s45, v84
    v_mul_f32 v85, s45, v85
    v_mul_f32 v86, s45, v86
    v_mul_f32 v87, s45, v87
    v_mul_f32 v88, s45, v88
    v_mul_f32 v89, s45, v89
    v_mul_f32 v90, s45, v90
    v_mul_f32 v91, s45, v91
    v_mul_f32 v92, s45, v92
    v_mul_f32 v93, s45, v93
    v_mul_f32 v94, s45, v94
    v_mul_f32 v95, s45, v95
    v_cvt_pk_bf16_f32 v80, v80, v81
    v_cvt_pk_bf16_f32 v81, v82, v83
    v_cvt_pk_bf16_f32 v82, v84, v85
    v_cvt_pk_bf16_f32 v83, v86, v87
    v_cvt_pk_bf16_f32 v84, v88, v89
    v_cvt_pk_bf16_f32 v85, v90, v91
    v_cvt_pk_bf16_f32 v86, v92, v93
    v_cvt_pk_bf16_f32 v87, v94, v95
    v_permlane32_swap_b32 v80, v82
    v_permlane32_swap_b32 v81, v83
    v_permlane32_swap_b32 v84, v86
    v_permlane32_swap_b32 v85, v87
    buffer_store_dwordx4 v[80:83], v1, s[16:19], s46 offen offset:0 sc1
    buffer_store_dwordx4 v[84:87], v1, s[16:19], s46 offen offset:1024 sc1
    v_mul_f32 v96, s45, v96
    v_mul_f32 v97, s45, v97
    v_mul_f32 v98, s45, v98
    v_mul_f32 v99, s45, v99
    v_mul_f32 v100, s45, v100
    v_mul_f32 v101, s45, v101
    v_mul_f32 v102, s45, v102
    v_mul_f32 v103, s45, v103
    v_mul_f32 v104, s45, v104
    v_mul_f32 v105, s45, v105
    v_mul_f32 v106, s45, v106
    v_mul_f32 v107, s45, v107
    v_mul_f32 v108, s45, v108
    v_mul_f32 v109, s45, v109
    v_mul_f32 v110, s45, v110
    v_mul_f32 v111, s45, v111
    v_cvt_pk_bf16_f32 v96, v96, v97
    v_cvt_pk_bf16_f32 v97, v98, v99
    v_cvt_pk_bf16_f32 v98, v100, v101
    v_cvt_pk_bf16_f32 v99, v102, v103
    v_cvt_pk_bf16_f32 v100, v104, v105
    v_cvt_pk_bf16_f32 v101, v106, v107
    v_cvt_pk_bf16_f32 v102, v108, v109
    v_cvt_pk_bf16_f32 v103, v110, v111
    v_permlane32_swap_b32 v96, v98
    v_permlane32_swap_b32 v97, v99
    v_permlane32_swap_b32 v100, v102
    v_permlane32_swap_b32 v101, v103
    buffer_store_dwordx4 v[96:99], v1, s[16:19], s46 offen offset:2048 sc1
    buffer_store_dwordx4 v[100:103], v1, s[16:19], s46 offen offset:3072 sc1
    s_branch L1_PF
L1_QK3:
    s_cmp_ge_u32 s28, 576
    s_cselect_b32 s45, 1.0, 0x3eae1a93
    s_cselect_b32 s46, 2322432, 0
    s_lshl_b32 s31, s28, 6
    s_add_u32 s46, s46, s31
    s_add_u32 s46, s46, s25
    s_add_u32 s28, s28, 64
    v_mul_f32 v48, s45, v48
    v_mul_f32 v49, s45, v49
    v_mul_f32 v50, s45, v50
    v_mul_f32 v51, s45, v51
    v_mul_f32 v52, s45, v52
    v_mul_f32 v53, s45, v53
    v_mul_f32 v54, s45, v54
    v_mul_f32 v55, s45, v55
    v_mul_f32 v56, s45, v56
    v_mul_f32 v57, s45, v57
    v_mul_f32 v58, s45, v58
    v_mul_f32 v59, s45, v59
    v_mul_f32 v60, s45, v60
    v_mul_f32 v61, s45, v61
    v_mul_f32 v62, s45, v62
    v_mul_f32 v63, s45, v63
    v_cvt_pk_bf16_f32 v48, v48, v49
    v_cvt_pk_bf16_f32 v49, v50, v51
    v_cvt_pk_bf16_f32 v50, v52, v53
    v_cvt_pk_bf16_f32 v51, v54, v55
    v_cvt_pk_bf16_f32 v52, v56, v57
    v_cvt_pk_bf16_f32 v53, v58, v59
    v_cvt_pk_bf16_f32 v54, v60, v61
    v_cvt_pk_bf16_f32 v55, v62, v63
    v_permlane32_swap_b32 v48, v50
    v_permlane32_swap_b32 v49, v51
    v_permlane32_swap_b32 v52, v54
    v_permlane32_swap_b32 v53, v55
    buffer_store_dwordx4 v[48:51], v1, s[16:19], s46 offen offset:0 sc1
    buffer_store_dwordx4 v[52:55], v1, s[16:19], s46 offen offset:1024 sc1
    v_mul_f32 v64, s45, v64
    v_mul_f32 v65, s45, v65
    v_mul_f32 v66, s45, v66
    v_mul_f32 v67, s45, v67
    v_mul_f32 v68, s45, v68
    v_mul_f32 v69, s45, v69
    v_mul_f32 v70, s45, v70
    v_mul_f32 v71, s45, v71
    v_mul_f32 v72, s45, v72
    v_mul_f32 v73, s45, v73
    v_mul_f32 v74, s45, v74
    v_mul_f32 v75, s45, v75
    v_mul_f32 v76, s45, v76
    v_mul_f32 v77, s45, v77
    v_mul_f32 v78, s45, v78
    v_mul_f32 v79, s45, v79
    v_cvt_pk_bf16_f32 v64, v64, v65
    v_cvt_pk_bf16_f32 v65, v66, v67
    v_cvt_pk_bf16_f32 v66, v68, v69
    v_cvt_pk_bf16_f32 v67, v70, v71
    v_cvt_pk_bf16_f32 v68, v72, v73
    v_cvt_pk_bf16_f32 v69, v74, v75
    v_cvt_pk_bf16_f32 v70, v76, v77
    v_cvt_pk_bf16_f32 v71, v78, v79
    v_permlane32_swap_b32 v64, v66
    v_permlane32_swap_b32 v65, v67
    v_permlane32_swap_b32 v68, v70
    v_permlane32_swap_b32 v69, v71
    buffer_store_dwordx4 v[64:67], v1, s[16:19], s46 offen offset:2048 sc1
    buffer_store_dwordx4 v[68:71], v1, s[16:19], s46 offen offset:3072 sc1
    s_branch L1_PF
L1_V:
    s_add_u32 m0, s24, 0
    s_add_u32 s30, s36, 0
    buffer_load_dwordx4 v2, s[8:11], s30 offen lds
    s_add_u32 m0, s24, 98304
    s_add_u32 s30, s88, 0
    buffer_load_dwordx4 v3, s[4:7], s30 offen lds
    s_add_u32 m0, s24, 106496
    s_add_u32 s30, s88, 9216
    buffer_load_dwordx4 v15, s[4:7], s30 offen lds
    s_add_u32 m0, s24, 114688
    s_add_u32 s30, s88, 18432
    buffer_load_dwordx4 v3, s[4:7], s30 offen lds
    s_add_u32 m0, s24, 122880
    s_add_u32 s30, s88, 27648
    buffer_load_dwordx4 v15, s[4:7], s30 offen lds
    s_add_u32 s33, s47, 1990656
    s_add_u32 s35, s29, 1152
    s_add_u32 s37, s36, 221184
    s_cmp_eq_u32 s37, s33
    s_cselect_b32 s37, s47, s37
    s_add_u32 s89, s88, 128
    s_cmp_eq_u32 s89, s35
    s_cselect_b32 s89, s29, s89
    s_add_u32 s38, s37, 221184
    s_cmp_eq_u32 s38, s33
    s_cselect_b32 s38, s47, s38
    s_add_u32 s90, s89, 128
    s_cmp_eq_u32 s90, s35
    s_cselect_b32 s90, s29, s90
    s_add_u32 s39, s38, 221184
    s_cmp_eq_u32 s39, s33
    s_cselect_b32 s39, s47, s39
    s_add_u32 s91, s90, 128
    s_cmp_eq_u32 s91, s35
    s_cselect_b32 s91, s29, s91
    s_add_u32 s40, s39, 221184
    s_cmp_eq_u32 s40, s33
    s_cselect_b32 s40, s47, s40
    s_add_u32 s92, s91, 128
    s_cmp_eq_u32 s92, s35
    s_cselect_b32 s92, s29, s92
    s_add_u32 s41, s40, 221184
    s_cmp_eq_u32 s41, s33
    s_cselect_b32 s41, s47, s41
    s_add_u32 s93, s92, 128
    s_cmp_eq_u32 s93, s35
    s_cselect_b32 s93, s29, s93
    s_add_u32 s42, s41, 221184
    s_cmp_eq_u32 s42, s33
    s_cselect_b32 s42, s47, s42
    s_add_u32 s94, s93, 128
    s_cmp_eq_u32 s94, s35
    s_cselect_b32 s94, s29, s94
    s_add_u32 s43, s42, 221184
    s_cmp_eq_u32 s43, s33
    s_cselect_b32 s43, s47, s43
    s_add_u32 s95, s94, 128
    s_cmp_eq_u32 s95, s35
    s_cselect_b32 s95, s29, s95
    s_add_u32 s44, s43, 221184
    s_cmp_eq_u32 s44, s33
    s_cselect_b32 s44, s47, s44
    s_add_u32 s96, s95, 128
    s_cmp_eq_u32 s96, s35
    s_cselect_b32 s96, s29, s96
    s_barrier
    s_add_u32 m0, s24, 8192
    s_add_u32 s30, s37, 0
    buffer_load_dwordx4 v2, s[8:11], s30 offen lds
    s_add_u32 m0, s24, 16384
    s_add_u32 s30, s38, 0
    buffer_load_dwordx4 v2, s[8:11], s30 offen lds
    s_add_u32 m0, s24, 24576
    s_add_u32 s30, s39, 0
    buffer_load_dwordx4 v2, s[8:11], s30 offen lds
    s_add_u32 m0, s24, 32768
    s_add_u32 s30, s40, 0
    buffer_load_dwordx4 v2, s[8:11], s30 offen lds
    s_mov_b32 s16, s56
    s_mov_b32 s17, s57
    s_mov_b32 s18, 268435456
    s_mov_b32 s19, 0x00020000
    v_lshlrev_b32 v1, 4, v0
    v_and_b32 v21, 15, v0
    v_lshrrev_b32 v22, 2, v21
    v_and_b32 v21, 3, v21
    v_lshrrev_b32 v23, 5, v0
    v_lshl_add_u32 v24, v23, 3, v22
    v_lshlrev_b32 v24, 7, v24
    v_lshl_add_u32 v24, v21, 3, v24
    v_and_b32 v21, 16, v0
    v_lshl_add_u32 v24, v21, 1, v24
    v_and_b32 v22, 2, v22
    v_lshl_add_u32 v4, v22, 5, v24
    v_xor_b32 v5, 64, v4
    v_add_u32 v6, 0x10000, v4
    v_add_u32 v7, 0x10000, v5
    v_add_u32 v8, 0x20000, v4
    v_add_u32 v9, 0x20000, v5
    v_and_b32 v21, 31, v0
    v_lshrrev_b32 v22, 1, v21
    v_and_b32 v22, 7, v22
    v_xor_b32 v22, v22, v23
    v_lshlrev_b32 v22, 4, v22
    v_and_b32 v24, 7, v21
    v_lshl_add_u32 v22, v24, 7, v22
    v_lshrrev_b32 v24, 3, v21
    v_lshl_add_u32 v22, v24, 13, v22
    s_add_u32 s33, s24, 0x18000
    v_add_u32 v11, s33, v22
    v_xor_b32 v12, 32, v11
    v_xor_b32 v13, 64, v11
    v_xor_b32 v14, 96, v11
    s_mul_i32 s25, s23, 36864
    s_add_u32 s25, s25, 23574528
    v_mov_b32 v10, v21
    v_mul_u32_u24 v0, 9216, v23
    v_lshl_add_u32 v0, v21, 4, v0
    s_waitcnt vmcnt(4)
    ds_read_b128 v[112:115], v11 offset:0
    ds_read_b128 v[116:119], v12 offset:0
    ds_read_b128 v[120:123], v13 offset:0
    ds_read_b128 v[124:127], v14 offset:0
    s_add_u32 m0, s24, 131072
    s_add_u32 s30, s89, 0
    buffer_load_dwordx4 v3, s[4:7], s30 offen lds
    s_add_u32 m0, s24, 139264
    s_add_u32 s30, s89, 9216
    buffer_load_dwordx4 v15, s[4:7], s30 offen lds
    s_add_u32 m0, s24, 147456
    s_add_u32 s30, s89, 18432
    buffer_load_dwordx4 v3, s[4:7], s30 offen lds
    s_add_u32 m0, s24, 155648
    s_add_u32 s30, s89, 27648
    buffer_load_dwordx4 v15, s[4:7], s30 offen lds
    s_barrier
    ds_read_b64_tr_b16 v[16:17], v4 offset:0
    ds_read_b64_tr_b16 v[18:19], v4 offset:512
    ds_read_b64_tr_b16 v[20:21], v5 offset:0
    ds_read_b64_tr_b16 v[22:23], v5 offset:512
    ds_read_b64_tr_b16 v[24:25], v4 offset:2048
    ds_read_b64_tr_b16 v[26:27], v4 offset:2560
    ds_read_b64_tr_b16 v[28:29], v5 offset:2048
    ds_read_b64_tr_b16 v[30:31], v5 offset:2560
    ds_read_b64_tr_b16 v[32:33], v4 offset:4096
    ds_read_b64_tr_b16 v[34:35], v4 offset:4608
    ds_read_b64_tr_b16 v[36:37], v5 offset:4096
    ds_read_b64_tr_b16 v[38:39], v5 offset:4608
    ds_read_b64_tr_b16 v[40:41], v4 offset:6144
    ds_read_b64_tr_b16 v[42:43], v4 offset:6656
    s_waitcnt lgkmcnt(10)
    v_mfma_f32_32x32x16_bf16 v[48:63], v[112:115], v[16:19], 0
    ds_read_b64_tr_b16 v[44:45], v5 offset:6144
    ds_read_b64_tr_b16 v[46:47], v5 offset:6656
    s_add_u32 m0, s24, 40960
    s_add_u32 s30, s41, 0
    buffer_load_dwordx4 v2, s[8:11], s30 offen lds
    s_add_u32 m0, s24, 98304
    s_add_u32 s30, s90, 0
    buffer_load_dwordx4 v3, s[4:7], s30 offen lds
    v_mfma_f32_32x32x16_bf16 v[64:79], v[112:115], v[20:23], 0
    s_waitcnt vmcnt(9)
    s_barrier
    ds_read_b64_tr_b16 v[16:17], v4 offset:8192
    ds_read_b64_tr_b16 v[18:19], v4 offset:8704
    s_add_u32 m0, s24, 106496
    s_add_u32 s30, s90, 9216
    buffer_load_dwordx4 v15, s[4:7], s30 offen lds
    s_add_u32 m0, s24, 114688
    s_add_u32 s30, s90, 18432
    buffer_load_dwordx4 v3, s[4:7], s30 offen lds
    s_waitcnt lgkmcnt(10)
    v_mfma_f32_32x32x16_bf16 v[48:63], v[116:119], v[24:27], v[48:63]
    ds_read_b64_tr_b16 v[20:21], v5 offset:8192
    ds_read_b64_tr_b16 v[22:23], v5 offset:8704
    s_add_u32 m0, s24, 122880
    s_add_u32 s30, s90, 27648
    buffer_load_dwordx4 v15, s[4:7], s30 offen lds
    s_add_u32 m0, s24, 49152
    s_add_u32 s30, s42, 0
    buffer_load_dwordx4 v2, s[8:11], s30 offen lds
    v_mfma_f32_32x32x16_bf16 v[64:79], v[116:119], v[28:31], v[64:79]
    ds_read_b64_tr_b16 v[24:25], v4 offset:10240
    ds_read_b64_tr_b16 v[26:27], v4 offset:10752
    s_waitcnt lgkmcnt(10)
    v_mfma_f32_32x32x16_bf16 v[48:63], v[120:123], v[32:35], v[48:63]
    ds_read_b64_tr_b16 v[28:29], v5 offset:10240
    ds_read_b64_tr_b16 v[30:31], v5 offset:10752
    s_waitcnt vmcnt(6)
    ds_read_b128 v[128:131], v11 offset:32768
    ds_read_b128 v[132:135], v12 offset:32768
    ds_read_b128 v[136:139], v13 offset:32768
    ds_read_b128 v[140:143], v14 offset:32768
    v_mfma_f32_32x32x16_bf16 v[64:79], v[120:123], v[36:39], v[64:79]
    ds_read_b64_tr_b16 v[32:33], v4 offset:12288
    ds_read_b64_tr_b16 v[34:35], v4 offset:12800
    s_waitcnt lgkmcnt(14)
    v_mfma_f32_32x32x16_bf16 v[48:63], v[124:127], v[40:43], v[48:63]
    ds_read_b64_tr_b16 v[36:37], v5 offset:12288
    ds_read_b64_tr_b16 v[38:39], v5 offset:12800
    v_mfma_f32_32x32x16_bf16 v[64:79], v[124:127], v[44:47], v[64:79]
    ds_read_b64_tr_b16 v[40:41], v4 offset:14336
    ds_read_b64_tr_b16 v[42:43], v4 offset:14848
    s_waitcnt lgkmcnt(14)
    s_waitcnt lgkmcnt(6)
    v_mfma_f32_32x32x16_bf16 v[48:63], v[128:131], v[16:19], v[48:63]
    ds_read_b64_tr_b16 v[44:45], v5 offset:14336
    ds_read_b64_tr_b16 v[46:47], v5 offset:14848
    s_add_u32 m0, s24, 131072
    s_add_u32 s30, s91, 0
    buffer_load_dwordx4 v3, s[4:7], s30 offen lds
    s_add_u32 m0, s24, 139264
    s_add_u32 s30, s91, 9216
    buffer_load_dwordx4 v15, s[4:7], s30 offen lds
    v_mfma_f32_32x32x16_bf16 v[64:79], v[128:131], v[20:23], v[64:79]
    s_barrier
    ds_read_b64_tr_b16 v[16:17], v4 offset:16384
    ds_read_b64_tr_b16 v[18:19], v4 offset:16896
    s_add_u32 m0, s24, 147456
    s_add_u32 s30, s91, 18432
    buffer_load_dwordx4 v3, s[4:7], s30 offen lds
    s_add_u32 m0, s24, 155648
    s_add_u32 s30, s91, 27648
    buffer_load_dwordx4 v15, s[4:7], s30 offen lds
    v_mfma_f32_32x32x16_bf16 v[48:63], v[132:135], v[24:27], v[48:63]
    ds_read_b64_tr_b16 v[20:21], v5 offset:16384
    ds_read_b64_tr_b16 v[22:23], v5 offset:16896
    s_add_u32 m0, s24, 57344
    s_add_u32 s30, s43, 0
    buffer_load_dwordx4 v2, s[8:11], s30 offen lds
    v_mfma_f32_32x32x16_bf16 v[64:79], v[132:135], v[28:31], v[64:79]
    ds_read_b64_tr_b16 v[24:25], v4 offset:18432
    ds_read_b64_tr_b16 v[26:27], v4 offset:18944
    s_waitcnt lgkmcnt(10)
    v_mfma_f32_32x32x16_bf16 v[48:63], v[136:139], v[32:35], v[48:63]
    ds_read_b64_tr_b16 v[28:29], v5 offset:18432
    ds_read_b64_tr_b16 v[30:31], v5 offset:18944
    s_waitcnt vmcnt(6)
    ds_read_b128 v[144:147], v11 offset:0
    ds_read_b128 v[148:151], v12 offset:0
    ds_read_b128 v[152:155], v13 offset:0
    ds_read_b128 v[156:159], v14 offset:0
    v_mfma_f32_32x32x16_bf16 v[64:79], v[136:139], v[36:39], v[64:79]
    ds_read_b64_tr_b16 v[32:33], v4 offset:20480
    ds_read_b64_tr_b16 v[34:35], v4 offset:20992
    s_waitcnt lgkmcnt(14)
    v_mfma_f32_32x32x16_bf16 v[48:63], v[140:143], v[40:43], v[48:63]
    ds_read_b64_tr_b16 v[36:37], v5 offset:20480
    ds_read_b64_tr_b16 v[38:39], v5 offset:20992
    v_mfma_f32_32x32x16_bf16 v[64:79], v[140:143], v[44:47], v[64:79]
    ds_read_b64_tr_b16 v[40:41], v4 offset:22528
    ds_read_b64_tr_b16 v[42:43], v4 offset:23040
    s_waitcnt lgkmcnt(14)
    s_waitcnt lgkmcnt(6)
    v_mfma_f32_32x32x16_bf16 v[48:63], v[144:147], v[16:19], v[48:63]
    ds_read_b64_tr_b16 v[44:45], v5 offset:22528
    ds_read_b64_tr_b16 v[46:47], v5 offset:23040
    s_add_u32 m0, s24, 98304
    s_add_u32 s30, s92, 0
    buffer_load_dwordx4 v3, s[4:7], s30 offen lds
    s_add_u32 m0, s24, 106496
    s_add_u32 s30, s92, 9216
    buffer_load_dwordx4 v15, s[4:7], s30 offen lds
    v_mfma_f32_32x32x16_bf16 v[64:79], v[144:147], v[20:23], v[64:79]
    ds_read_b64_tr_b16 v[16:17], v4 offset:24576
    ds_read_b64_tr_b16 v[18:19], v4 offset:25088
    s_add_u32 m0, s24, 114688
    s_add_u32 s30, s92, 18432
    buffer_load_dwordx4 v3, s[4:7], s30 offen lds
    s_add_u32 m0, s24, 122880
    s_add_u32 s30, s92, 27648
    buffer_load_dwordx4 v15, s[4:7], s30 offen lds
    v_mfma_f32_32x32x16_bf16 v[48:63], v[148:151], v[24:27], v[48:63]
    ds_read_b64_tr_b16 v[20:21], v5 offset:24576
    ds_read_b64_tr_b16 v[22:23], v5 offset:25088
    s_add_u32 m0, s24, 65536
    s_add_u32 s30, s44, 0
    buffer_load_dwordx4 v2, s[8:11], s30 offen lds
    v_mfma_f32_32x32x16_bf16 v[64:79], v[148:151], v[28:31], v[64:79]
    ds_read_b64_tr_b16 v[24:25], v4 offset:26624
    ds_read_b64_tr_b16 v[26:27], v4 offset:27136
    s_waitcnt lgkmcnt(10)
    v_mfma_f32_32x32x16_bf16 v[48:63], v[152:155], v[32:35], v[48:63]
    ds_read_b64_tr_b16 v[28:29], v5 offset:26624
    ds_read_b64_tr_b16 v[30:31], v5 offset:27136
    s_waitcnt vmcnt(6)
    ds_read_b128 v[160:163], v11 offset:32768
    ds_read_b128 v[164:167], v12 offset:32768
    ds_read_b128 v[168:171], v13 offset:32768
    ds_read_b128 v[172:175], v14 offset:32768
    v_mfma_f32_32x32x16_bf16 v[64:79], v[152:155], v[36:39], v[64:79]
    ds_read_b64_tr_b16 v[32:33], v4 offset:28672
    ds_read_b64_tr_b16 v[34:35], v4 offset:29184
    s_waitcnt lgkmcnt(14)
    v_mfma_f32_32x32x16_bf16 v[48:63], v[156:159], v[40:43], v[48:63]
    ds_read_b64_tr_b16 v[36:37], v5 offset:28672
    ds_read_b64_tr_b16 v[38:39], v5 offset:29184
    v_mfma_f32_32x32x16_bf16 v[64:79], v[156:159], v[44:47], v[64:79]
    ds_read_b64_tr_b16 v[40:41], v4 offset:30720
    ds_read_b64_tr_b16 v[42:43], v4 offset:31232
    s_waitcnt lgkmcnt(14)
    s_waitcnt lgkmcnt(6)
    v_mfma_f32_32x32x16_bf16 v[48:63], v[160:163], v[16:19], v[48:63]
    ds_read_b64_tr_b16 v[44:45], v5 offset:30720
    ds_read_b64_tr_b16 v[46:47], v5 offset:31232
    s_add_u32 m0, s24, 131072
    s_add_u32 s30, s93, 0
    buffer_load_dwordx4 v3, s[4:7], s30 offen lds
    s_add_u32 m0, s24, 139264
    s_add_u32 s30, s93, 9216
    buffer_load_dwordx4 v15, s[4:7], s30 offen lds
    v_mfma_f32_32x32x16_bf16 v[64:79], v[160:163], v[20:23], v[64:79]
    ds_read_b64_tr_b16 v[16:17], v4 offset:32768
    ds_read_b64_tr_b16 v[18:19], v4 offset:33280
    s_add_u32 m0, s24, 147456
    s_add_u32 s30, s93, 18432
    buffer_load_dwordx4 v3, s[4:7], s30 offen lds
    s_add_u32 m0, s24, 155648
    s_add_u32 s30, s93, 27648
    buffer_load_dwordx4 v15, s[4:7], s30 offen lds
    v_mfma_f32_32x32x16_bf16 v[48:63], v[164:167], v[24:27], v[48:63]
    ds_read_b64_tr_b16 v[20:21], v5 offset:32768
    ds_read_b64_tr_b16 v[22:23], v5 offset:33280
    s_add_u32 m0, s24, 73728
    s_add_u32 s30, s36, 128
    buffer_load_dwordx4 v2, s[8:11], s30 offen lds
    v_mfma_f32_32x32x16_bf16 v[64:79], v[164:167], v[28:31], v[64:79]
    ds_read_b64_tr_b16 v[24:25], v4 offset:34816
    ds_read_b64_tr_b16 v[26:27], v4 offset:35328
    s_waitcnt lgkmcnt(10)
    v_mfma_f32_32x32x16_bf16 v[48:63], v[168:171], v[32:35], v[48:63]
    ds_read_b64_tr_b16 v[28:29], v5 offset:34816
    ds_read_b64_tr_b16 v[30:31], v5 offset:35328
    s_waitcnt vmcnt(6)
    ds_read_b128 v[176:179], v11 offset:0
    ds_read_b128 v[180:183], v12 offset:0
    ds_read_b128 v[184:187], v13 offset:0
    ds_read_b128 v[188:191], v14 offset:0
    v_mfma_f32_32x32x16_bf16 v[64:79], v[168:171], v[36:39], v[64:79]
    ds_read_b64_tr_b16 v[32:33], v4 offset:36864
    ds_read_b64_tr_b16 v[34:35], v4 offset:37376
    s_waitcnt lgkmcnt(14)
    v_mfma_f32_32x32x16_bf16 v[48:63], v[172:175], v[40:43], v[48:63]
    ds_read_b64_tr_b16 v[36:37], v5 offset:36864
    ds_read_b64_tr_b16 v[38:39], v5 offset:37376
    v_mfma_f32_32x32x16_bf16 v[64:79], v[172:175], v[44:47], v[64:79]
    ds_read_b64_tr_b16 v[40:41], v4 offset:38912
    ds_read_b64_tr_b16 v[42:43], v4 offset:39424
    s_waitcnt lgkmcnt(14)
    s_waitcnt lgkmcnt(6)
    v_mfma_f32_32x32x16_bf16 v[48:63], v[176:179], v[16:19], v[48:63]
    ds_read_b64_tr_b16 v[44:45], v5 offset:38912
    ds_read_b64_tr_b16 v[46:47], v5 offset:39424
    s_add_u32 m0, s24, 98304
    s_add_u32 s30, s94, 0
    buffer_load_dwordx4 v3, s[4:7], s30 offen lds
    s_add_u32 m0, s24, 106496
    s_add_u32 s30, s94, 9216
    buffer_load_dwordx4 v15, s[4:7], s30 offen lds
    v_mfma_f32_32x32x16_bf16 v[64:79], v[176:179], v[20:23], v[64:79]
    s_barrier
    ds_read_b64_tr_b16 v[16:17], v4 offset:40960
    ds_read_b64_tr_b16 v[18:19], v4 offset:41472
    s_add_u32 m0, s24, 114688
    s_add_u32 s30, s94, 18432
    buffer_load_dwordx4 v3, s[4:7], s30 offen lds
    s_add_u32 m0, s24, 122880
    s_add_u32 s30, s94, 27648
    buffer_load_dwordx4 v15, s[4:7], s30 offen lds
    v_mfma_f32_32x32x16_bf16 v[48:63], v[180:183], v[24:27], v[48:63]
    ds_read_b64_tr_b16 v[20:21], v5 offset:40960
    ds_read_b64_tr_b16 v[22:23], v5 offset:41472
    s_add_u32 m0, s24, 81920
    s_add_u32 s30, s37, 128
    buffer_load_dwordx4 v2, s[8:11], s30 offen lds
    v_mfma_f32_32x32x16_bf16 v[64:79], v[180:183], v[28:31], v[64:79]
    ds_read_b64_tr_b16 v[24:25], v4 offset:43008
    ds_read_b64_tr_b16 v[26:27], v4 offset:43520
    s_waitcnt lgkmcnt(10)
    v_mfma_f32_32x32x16_bf16 v[48:63], v[184:187], v[32:35], v[48:63]
    ds_read_b64_tr_b16 v[28:29], v5 offset:43008
    ds_read_b64_tr_b16 v[30:31], v5 offset:43520
    s_waitcnt vmcnt(6)
    ds_read_b128 v[192:195], v11 offset:32768
    ds_read_b128 v[196:199], v12 offset:32768
    ds_read_b128 v[200:203], v13 offset:32768
    ds_read_b128 v[204:207], v14 offset:32768
    v_mfma_f32_32x32x16_bf16 v[64:79], v[184:187], v[36:39], v[64:79]
    ds_read_b64_tr_b16 v[32:33], v4 offset:45056
    ds_read_b64_tr_b16 v[34:35], v4 offset:45568
    s_waitcnt lgkmcnt(14)
    v_mfma_f32_32x32x16_bf16 v[48:63], v[188:191], v[40:43], v[48:63]
    ds_read_b64_tr_b16 v[36:37], v5 offset:45056
    ds_read_b64_tr_b16 v[38:39], v5 offset:45568
    v_mfma_f32_32x32x16_bf16 v[64:79], v[188:191], v[44:47], v[64:79]
    ds_read_b64_tr_b16 v[40:41], v4 offset:47104
    ds_read_b64_tr_b16 v[42:43], v4 offset:47616
    s_waitcnt lgkmcnt(14)
    s_waitcnt lgkmcnt(6)
    v_mfma_f32_32x32x16_bf16 v[48:63], v[192:195], v[16:19], v[48:63]
    ds_read_b64_tr_b16 v[44:45], v5 offset:47104
    ds_read_b64_tr_b16 v[46:47], v5 offset:47616
    s_add_u32 m0, s24, 131072
    s_add_u32 s30, s95, 0
    buffer_load_dwordx4 v3, s[4:7], s30 offen lds
    s_add_u32 m0, s24, 139264
    s_add_u32 s30, s95, 9216
    buffer_load_dwordx4 v15, s[4:7], s30 offen lds
    v_mfma_f32_32x32x16_bf16 v[64:79], v[192:195], v[20:23], v[64:79]
    ds_read_b64_tr_b16 v[16:17], v4 offset:49152
    ds_read_b64_tr_b16 v[18:19], v4 offset:49664
    s_add_u32 m0, s24, 147456
    s_add_u32 s30, s95, 18432
    buffer_load_dwordx4 v3, s[4:7], s30 offen lds
    s_add_u32 m0, s24, 155648
    s_add_u32 s30, s95, 27648
    buffer_load_dwordx4 v15, s[4:7], s30 offen lds
    v_mfma_f32_32x32x16_bf16 v[48:63], v[196:199], v[24:27], v[48:63]
    ds_read_b64_tr_b16 v[20:21], v5 offset:49152
    ds_read_b64_tr_b16 v[22:23], v5 offset:49664
    s_add_u32 m0, s24, 90112
    s_add_u32 s30, s38, 128
    buffer_load_dwordx4 v2, s[8:11], s30 offen lds
    v_mfma_f32_32x32x16_bf16 v[64:79], v[196:199], v[28:31], v[64:79]
    ds_read_b64_tr_b16 v[24:25], v4 offset:51200
    ds_read_b64_tr_b16 v[26:27], v4 offset:51712
    s_waitcnt lgkmcnt(10)
    v_mfma_f32_32x32x16_bf16 v[48:63], v[200:203], v[32:35], v[48:63]
    ds_read_b64_tr_b16 v[28:29], v5 offset:51200
    ds_read_b64_tr_b16 v[30:31], v5 offset:51712
    s_waitcnt vmcnt(6)
    ds_read_b128 v[208:211], v11 offset:0
    ds_read_b128 v[212:215], v12 offset:0
    ds_read_b128 v[216:219], v13 offset:0
    ds_read_b128 v[220:223], v14 offset:0
    v_mfma_f32_32x32x16_bf16 v[64:79], v[200:203], v[36:39], v[64:79]
    ds_read_b64_tr_b16 v[32:33], v4 offset:53248
    ds_read_b64_tr_b16 v[34:35], v4 offset:53760
    s_waitcnt lgkmcnt(14)
    v_mfma_f32_32x32x16_bf16 v[48:63], v[204:207], v[40:43], v[48:63]
    ds_read_b64_tr_b16 v[36:37], v5 offset:53248
    ds_read_b64_tr_b16 v[38:39], v5 offset:53760
    v_mfma_f32_32x32x16_bf16 v[64:79], v[204:207], v[44:47], v[64:79]
    ds_read_b64_tr_b16 v[40:41], v4 offset:55296
    ds_read_b64_tr_b16 v[42:43], v4 offset:55808
    s_waitcnt lgkmcnt(14)
    s_waitcnt lgkmcnt(6)
    v_mfma_f32_32x32x16_bf16 v[48:63], v[208:211], v[16:19], v[48:63]
    ds_read_b64_tr_b16 v[44:45], v5 offset:55296
    ds_read_b64_tr_b16 v[46:47], v5 offset:55808
    s_add_u32 m0, s24, 98304
    s_add_u32 s30, s96, 0
    buffer_load_dwordx4 v3, s[4:7], s30 offen lds
    s_add_u32 m0, s24, 106496
    s_add_u32 s30, s96, 9216
    buffer_load_dwordx4 v15, s[4:7], s30 offen lds
    v_mfma_f32_32x32x16_bf16 v[64:79], v[208:211], v[20:23], v[64:79]
    ds_read_b64_tr_b16 v[16:17], v4 offset:57344
    ds_read_b64_tr_b16 v[18:19], v4 offset:57856
    s_add_u32 m0, s24, 114688
    s_add_u32 s30, s96, 18432
    buffer_load_dwordx4 v3, s[4:7], s30 offen lds
    s_add_u32 m0, s24, 122880
    s_add_u32 s30, s96, 27648
    buffer_load_dwordx4 v15, s[4:7], s30 offen lds
    v_mfma_f32_32x32x16_bf16 v[48:63], v[212:215], v[24:27], v[48:63]
    ds_read_b64_tr_b16 v[20:21], v5 offset:57344
    ds_read_b64_tr_b16 v[22:23], v5 offset:57856
    s_add_u32 m0, s24, 0
    s_add_u32 s30, s39, 128
    buffer_load_dwordx4 v2, s[8:11], s30 offen lds
    s_add_u32 m0, s24, 8192
    s_add_u32 s30, s40, 128
    buffer_load_dwordx4 v2, s[8:11], s30 offen lds
    v_mfma_f32_32x32x16_bf16 v[64:79], v[212:215], v[28:31], v[64:79]
    ds_read_b64_tr_b16 v[24:25], v4 offset:59392
    ds_read_b64_tr_b16 v[26:27], v4 offset:59904
    s_add_u32 m0, s24, 16384
    s_add_u32 s30, s41, 128
    buffer_load_dwordx4 v2, s[8:11], s30 offen lds
    s_add_u32 m0, s24, 24576
    s_add_u32 s30, s42, 128
    buffer_load_dwordx4 v2, s[8:11], s30 offen lds
    s_waitcnt lgkmcnt(10)
    v_mfma_f32_32x32x16_bf16 v[48:63], v[216:219], v[32:35], v[48:63]
    ds_read_b64_tr_b16 v[28:29], v5 offset:59392
    ds_read_b64_tr_b16 v[30:31], v5 offset:59904
    s_waitcnt vmcnt(9)
    ds_read_b128 v[224:227], v11 offset:32768
    ds_read_b128 v[228:231], v12 offset:32768
    ds_read_b128 v[232:235], v13 offset:32768
    ds_read_b128 v[236:239], v14 offset:32768
    v_mfma_f32_32x32x16_bf16 v[64:79], v[216:219], v[36:39], v[64:79]
    ds_read_b64_tr_b16 v[32:33], v4 offset:61440
    ds_read_b64_tr_b16 v[34:35], v4 offset:61952
    s_waitcnt lgkmcnt(14)
    v_mfma_f32_32x32x16_bf16 v[48:63], v[220:223], v[40:43], v[48:63]
    ds_read_b64_tr_b16 v[36:37], v5 offset:61440
    ds_read_b64_tr_b16 v[38:39], v5 offset:61952
    v_mfma_f32_32x32x16_bf16 v[64:79], v[220:223], v[44:47], v[64:79]
    ds_read_b64_tr_b16 v[40:41], v4 offset:63488
    ds_read_b64_tr_b16 v[42:43], v4 offset:64000
    s_waitcnt lgkmcnt(14)
    s_waitcnt lgkmcnt(6)
    v_mfma_f32_32x32x16_bf16 v[48:63], v[224:227], v[16:19], v[48:63]
    ds_read_b64_tr_b16 v[44:45], v5 offset:63488
    ds_read_b64_tr_b16 v[46:47], v5 offset:64000
    s_add_u32 m0, s24, 131072
    s_add_u32 s30, s43, 128
    buffer_load_dwordx4 v2, s[8:11], s30 offen lds
    s_add_u32 m0, s24, 139264
    s_add_u32 s30, s44, 128
    buffer_load_dwordx4 v2, s[8:11], s30 offen lds
    v_mfma_f32_32x32x16_bf16 v[64:79], v[224:227], v[20:23], v[64:79]
    s_barrier
    ds_read_b64_tr_b16 v[16:17], v6 offset:0
    ds_read_b64_tr_b16 v[18:19], v6 offset:512
    s_add_u32 m0, s24, 147456
    s_add_u32 s30, s36, 256
    buffer_load_dwordx4 v2, s[8:11], s30 offen lds
    s_add_u32 m0, s24, 155648
    s_add_u32 s30, s37, 256
    buffer_load_dwordx4 v2, s[8:11], s30 offen lds
    v_mfma_f32_32x32x16_bf16 v[48:63], v[228:231], v[24:27], v[48:63]
    ds_read_b64_tr_b16 v[20:21], v7 offset:0
    ds_read_b64_tr_b16 v[22:23], v7 offset:512
    s_add_u32 m0, s24, 32768
    s_add_u32 s30, s38, 256
    buffer_load_dwordx4 v2, s[8:11], s30 offen lds
    v_mfma_f32_32x32x16_bf16 v[64:79], v[228:231], v[28:31], v[64:79]
    ds_read_b64_tr_b16 v[24:25], v6 offset:2048
    ds_read_b64_tr_b16 v[26:27], v6 offset:2560
    s_waitcnt lgkmcnt(10)
    v_mfma_f32_32x32x16_bf16 v[48:63], v[232:235], v[32:35], v[48:63]
    ds_read_b64_tr_b16 v[28:29], v7 offset:2048
    ds_read_b64_tr_b16 v[30:31], v7 offset:2560
    s_waitcnt vmcnt(9)
    ds_read_b128 v[240:243], v11 offset:0
    ds_read_b128 v[244:247], v12 offset:0
    ds_read_b128 v[248:251], v13 offset:0
    ds_read_b128 v[252:255], v14 offset:0
    s_add_u32 m0, s24, 40960
    s_add_u32 s30, s39, 256
    buffer_load_dwordx4 v2, s[8:11], s30 offen lds
    s_add_u32 m0, s24, 49152
    s_add_u32 s30, s40, 256
    buffer_load_dwordx4 v2, s[8:11], s30 offen lds
    v_mfma_f32_32x32x16_bf16 v[64:79], v[232:235], v[36:39], v[64:79]
    ds_read_b64_tr_b16 v[32:33], v6 offset:4096
    ds_read_b64_tr_b16 v[34:35], v6 offset:4608
    s_waitcnt lgkmcnt(14)
    v_mfma_f32_32x32x16_bf16 v[48:63], v[236:239], v[40:43], v[48:63]
    ds_read_b64_tr_b16 v[36:37], v7 offset:4096
    ds_read_b64_tr_b16 v[38:39], v7 offset:4608
    v_mfma_f32_32x32x16_bf16 v[64:79], v[236:239], v[44:47], v[64:79]
    ds_read_b64_tr_b16 v[40:41], v6 offset:6144
    ds_read_b64_tr_b16 v[42:43], v6 offset:6656
    s_waitcnt lgkmcnt(14)
    s_waitcnt lgkmcnt(6)
    v_mfma_f32_32x32x16_bf16 v[48:63], v[240:243], v[16:19], v[48:63]
    ds_read_b64_tr_b16 v[44:45], v7 offset:6144
    ds_read_b64_tr_b16 v[46:47], v7 offset:6656
    s_add_u32 m0, s24, 98304
    s_add_u32 s30, s41, 256
    buffer_load_dwordx4 v2, s[8:11], s30 offen lds
    s_add_u32 m0, s24, 106496
    s_add_u32 s30, s42, 256
    buffer_load_dwordx4 v2, s[8:11], s30 offen lds
    v_mfma_f32_32x32x16_bf16 v[64:79], v[240:243], v[20:23], v[64:79]
    ds_read_b64_tr_b16 v[16:17], v6 offset:8192
    ds_read_b64_tr_b16 v[18:19], v6 offset:8704
    s_add_u32 m0, s24, 114688
    s_add_u32 s30, s43, 256
    buffer_load_dwordx4 v2, s[8:11], s30 offen lds
    v_mfma_f32_32x32x16_bf16 v[48:63], v[244:247], v[24:27], v[48:63]
    ds_read_b64_tr_b16 v[20:21], v7 offset:8192
    ds_read_b64_tr_b16 v[22:23], v7 offset:8704
    v_mfma_f32_32x32x16_bf16 v[64:79], v[244:247], v[28:31], v[64:79]
    ds_read_b64_tr_b16 v[24:25], v6 offset:10240
    ds_read_b64_tr_b16 v[26:27], v6 offset:10752
    s_waitcnt lgkmcnt(10)
    v_mfma_f32_32x32x16_bf16 v[48:63], v[248:251], v[32:35], v[48:63]
    ds_read_b64_tr_b16 v[28:29], v7 offset:10240
    ds_read_b64_tr_b16 v[30:31], v7 offset:10752
    v_mfma_f32_32x32x16_bf16 v[64:79], v[248:251], v[36:39], v[64:79]
    ds_read_b64_tr_b16 v[32:33], v6 offset:12288
    ds_read_b64_tr_b16 v[34:35], v6 offset:12800
    s_waitcnt lgkmcnt(10)
    v_mfma_f32_32x32x16_bf16 v[48:63], v[252:255], v[40:43], v[48:63]
    ds_read_b64_tr_b16 v[36:37], v7 offset:12288
    ds_read_b64_tr_b16 v[38:39], v7 offset:12800
    v_mfma_f32_32x32x16_bf16 v[64:79], v[252:255], v[44:47], v[64:79]
    ds_read_b64_tr_b16 v[40:41], v6 offset:14336
    ds_read_b64_tr_b16 v[42:43], v6 offset:14848
    s_waitcnt lgkmcnt(10)
    v_mfma_f32_32x32x16_bf16 v[80:95], v[112:115], v[16:19], 0
    ds_read_b64_tr_b16 v[44:45], v7 offset:14336
    ds_read_b64_tr_b16 v[46:47], v7 offset:14848
    v_mfma_f32_32x32x16_bf16 v[96:111], v[112:115], v[20:23], 0
    ds_read_b64_tr_b16 v[16:17], v6 offset:16384
    ds_read_b64_tr_b16 v[18:19], v6 offset:16896
    s_waitcnt lgkmcnt(10)
    v_mfma_f32_32x32x16_bf16 v[80:95], v[116:119], v[24:27], v[80:95]
    ds_read_b64_tr_b16 v[20:21], v7 offset:16384
    ds_read_b64_tr_b16 v[22:23], v7 offset:16896
    v_mfma_f32_32x32x16_bf16 v[96:111], v[116:119], v[28:31], v[96:111]
    ds_read_b64_tr_b16 v[24:25], v6 offset:18432
    ds_read_b64_tr_b16 v[26:27], v6 offset:18944
    s_lshl_b32 s46, s28, 4
    s_add_u32 s46, s46, s25
    s_add_u32 s45, s46, 18432
    s_add_u32 s28, s28, 64
    s_waitcnt lgkmcnt(10)
    v_mfma_f32_32x32x16_bf16 v[80:95], v[120:123], v[32:35], v[80:95]
    ds_read_b64_tr_b16 v[28:29], v7 offset:18432
    ds_read_b64_tr_b16 v[30:31], v7 offset:18944
    v_cvt_pk_bf16_f32 v48, v48, v49
    v_mfma_f32_32x32x16_bf16 v[96:111], v[120:123], v[36:39], v[96:111]
    ds_read_b64_tr_b16 v[32:33], v6 offset:20480
    ds_read_b64_tr_b16 v[34:35], v6 offset:20992
    s_waitcnt lgkmcnt(10)
    v_mfma_f32_32x32x16_bf16 v[80:95], v[124:127], v[40:43], v[80:95]
    ds_read_b64_tr_b16 v[36:37], v7 offset:20480
    ds_read_b64_tr_b16 v[38:39], v7 offset:20992
    v_cvt_pk_bf16_f32 v49, v50, v51
    v_mfma_f32_32x32x16_bf16 v[96:111], v[124:127], v[44:47], v[96:111]
    ds_read_b64_tr_b16 v[40:41], v6 offset:22528
    ds_read_b64_tr_b16 v[42:43], v6 offset:23040
    s_waitcnt lgkmcnt(10)
    v_mfma_f32_32x32x16_bf16 v[80:95], v[128:131], v[16:19], v[80:95]
    ds_read_b64_tr_b16 v[44:45], v7 offset:22528
    ds_read_b64_tr_b16 v[46:47], v7 offset:23040
    v_cvt_pk_bf16_f32 v50, v52, v53
    v_mfma_f32_32x32x16_bf16 v[96:111], v[128:131], v[20:23], v[96:111]
    s_waitcnt vmcnt(9)
    s_barrier
    ds_read_b64_tr_b16 v[16:17], v6 offset:24576
    ds_read_b64_tr_b16 v[18:19], v6 offset:25088
    s_add_u32 m0, s24, 122880
    s_add_u32 s30, s44, 256
    buffer_load_dwordx4 v2, s[8:11], s30 offen lds
    s_waitcnt lgkmcnt(10)
    v_mfma_f32_32x32x16_bf16 v[80:95], v[132:135], v[24:27], v[80:95]
    ds_read_b64_tr_b16 v[20:21], v7 offset:24576
    ds_read_b64_tr_b16 v[22:23], v7 offset:25088
    v_cvt_pk_bf16_f32 v51, v54, v55
    v_mfma_f32_32x32x16_bf16 v[96:111], v[132:135], v[28:31], v[96:111]
    ds_read_b64_tr_b16 v[24:25], v6 offset:26624
    ds_read_b64_tr_b16 v[26:27], v6 offset:27136
    v_cvt_pk_bf16_f32 v52, v56, v57
    s_waitcnt lgkmcnt(10)
    v_mfma_f32_32x32x16_bf16 v[80:95], v[136:139], v[32:35], v[80:95]
    ds_read_b64_tr_b16 v[28:29], v7 offset:26624
    ds_read_b64_tr_b16 v[30:31], v7 offset:27136
    v_mfma_f32_32x32x16_bf16 v[96:111], v[136:139], v[36:39], v[96:111]
    ds_read_b64_tr_b16 v[32:33], v6 offset:28672
    ds_read_b64_tr_b16 v[34:35], v6 offset:29184
    v_cvt_pk_bf16_f32 v53, v58, v59
    s_waitcnt lgkmcnt(10)
    v_mfma_f32_32x32x16_bf16 v[80:95], v[140:143], v[40:43], v[80:95]
    ds_read_b64_tr_b16 v[36:37], v7 offset:28672
    ds_read_b64_tr_b16 v[38:39], v7 offset:29184
    v_mfma_f32_32x32x16_bf16 v[96:111], v[140:143], v[44:47], v[96:111]
    ds_read_b64_tr_b16 v[40:41], v6 offset:30720
    ds_read_b64_tr_b16 v[42:43], v6 offset:31232
    v_cvt_pk_bf16_f32 v54, v60, v61
    s_waitcnt lgkmcnt(10)
    v_mfma_f32_32x32x16_bf16 v[80:95], v[144:147], v[16:19], v[80:95]
    ds_read_b64_tr_b16 v[44:45], v7 offset:30720
    ds_read_b64_tr_b16 v[46:47], v7 offset:31232
    v_mfma_f32_32x32x16_bf16 v[96:111], v[144:147], v[20:23], v[96:111]
    ds_read_b64_tr_b16 v[16:17], v4 offset:0
    ds_read_b64_tr_b16 v[18:19], v4 offset:512
    v_cvt_pk_bf16_f32 v55, v62, v63
    s_waitcnt lgkmcnt(10)
    v_mfma_f32_32x32x16_bf16 v[80:95], v[148:151], v[24:27], v[80:95]
    ds_read_b64_tr_b16 v[20:21], v5 offset:0
    ds_read_b64_tr_b16 v[22:23], v5 offset:512
    buffer_store_dwordx4 v[48:51], v0, s[16:19], s46 offen offset:0 sc1
    v_mfma_f32_32x32x16_bf16 v[96:111], v[148:151], v[28:31], v[96:111]
    ds_read_b64_tr_b16 v[24:25], v4 offset:2048
    ds_read_b64_tr_b16 v[26:27], v4 offset:2560
    s_waitcnt lgkmcnt(10)
    v_mfma_f32_32x32x16_bf16 v[80:95], v[152:155], v[32:35], v[80:95]
    ds_read_b64_tr_b16 v[28:29], v5 offset:2048
    ds_read_b64_tr_b16 v[30:31], v5 offset:2560
    buffer_store_dwordx4 v[52:55], v0, s[16:19], s45 offen offset:0 sc1
    v_mfma_f32_32x32x16_bf16 v[96:111], v[152:155], v[36:39], v[96:111]
    ds_read_b64_tr_b16 v[32:33], v4 offset:4096
    ds_read_b64_tr_b16 v[34:35], v4 offset:4608
    s_waitcnt lgkmcnt(10)
    v_mfma_f32_32x32x16_bf16 v[80:95], v[156:159], v[40:43], v[80:95]
    ds_read_b64_tr_b16 v[36:37], v5 offset:4096
    ds_read_b64_tr_b16 v[38:39], v5 offset:4608
    v_cvt_pk_bf16_f32 v64, v64, v65
    v_mfma_f32_32x32x16_bf16 v[96:111], v[156:159], v[44:47], v[96:111]
    ds_read_b64_tr_b16 v[40:41], v4 offset:6144
    ds_read_b64_tr_b16 v[42:43], v4 offset:6656
    s_waitcnt lgkmcnt(10)
    v_mfma_f32_32x32x16_bf16 v[80:95], v[160:163], v[16:19], v[80:95]
    ds_read_b64_tr_b16 v[44:45], v5 offset:6144
    ds_read_b64_tr_b16 v[46:47], v5 offset:6656
    v_cvt_pk_bf16_f32 v65, v66, v67
    v_mfma_f32_32x32x16_bf16 v[96:111], v[160:163], v[20:23], v[96:111]
    ds_read_b64_tr_b16 v[16:17], v4 offset:8192
    ds_read_b64_tr_b16 v[18:19], v4 offset:8704
    v_cvt_pk_bf16_f32 v66, v68, v69
    s_waitcnt lgkmcnt(10)
    v_mfma_f32_32x32x16_bf16 v[80:95], v[164:167], v[24:27], v[80:95]
    ds_read_b64_tr_b16 v[20:21], v5 offset:8192
    ds_read_b64_tr_b16 v[22:23], v5 offset:8704
    v_mfma_f32_32x32x16_bf16 v[96:111], v[164:167], v[28:31], v[96:111]
    ds_read_b64_tr_b16 v[24:25], v4 offset:10240
    ds_read_b64_tr_b16 v[26:27], v4 offset:10752
    v_cvt_pk_bf16_f32 v67, v70, v71
    s_waitcnt lgkmcnt(10)
    v_mfma_f32_32x32x16_bf16 v[80:95], v[168:171], v[32:35], v[80:95]
    ds_read_b64_tr_b16 v[28:29], v5 offset:10240
    ds_read_b64_tr_b16 v[30:31], v5 offset:10752
    v_mfma_f32_32x32x16_bf16 v[96:111], v[168:171], v[36:39], v[96:111]
    ds_read_b64_tr_b16 v[32:33], v4 offset:12288
    ds_read_b64_tr_b16 v[34:35], v4 offset:12800
    v_cvt_pk_bf16_f32 v68, v72, v73
    s_waitcnt lgkmcnt(10)
    v_mfma_f32_32x32x16_bf16 v[80:95], v[172:175], v[40:43], v[80:95]
    ds_read_b64_tr_b16 v[36:37], v5 offset:12288
    ds_read_b64_tr_b16 v[38:39], v5 offset:12800
    v_mfma_f32_32x32x16_bf16 v[96:111], v[172:175], v[44:47], v[96:111]
    ds_read_b64_tr_b16 v[40:41], v4 offset:14336
    ds_read_b64_tr_b16 v[42:43], v4 offset:14848
    v_cvt_pk_bf16_f32 v69, v74, v75
    s_waitcnt lgkmcnt(10)
    v_mfma_f32_32x32x16_bf16 v[80:95], v[176:179], v[16:19], v[80:95]
    ds_read_b64_tr_b16 v[44:45], v5 offset:14336
    ds_read_b64_tr_b16 v[46:47], v5 offset:14848
    v_cvt_pk_bf16_f32 v70, v76, v77
    v_mfma_f32_32x32x16_bf16 v[96:111], v[176:179], v[20:23], v[96:111]
    ds_read_b64_tr_b16 v[16:17], v4 offset:16384
    ds_read_b64_tr_b16 v[18:19], v4 offset:16896
    s_waitcnt lgkmcnt(10)
    v_mfma_f32_32x32x16_bf16 v[80:95], v[180:183], v[24:27], v[80:95]
    ds_read_b64_tr_b16 v[20:21], v5 offset:16384
    ds_read_b64_tr_b16 v[22:23], v5 offset:16896
    v_cvt_pk_bf16_f32 v71, v78, v79
    v_mfma_f32_32x32x16_bf16 v[96:111], v[180:183], v[28:31], v[96:111]
    ds_read_b64_tr_b16 v[24:25], v4 offset:18432
    ds_read_b64_tr_b16 v[26:27], v4 offset:18944
    s_waitcnt lgkmcnt(10)
    v_mfma_f32_32x32x16_bf16 v[80:95], v[184:187], v[32:35], v[80:95]
    ds_read_b64_tr_b16 v[28:29], v5 offset:18432
    ds_read_b64_tr_b16 v[30:31], v5 offset:18944
    buffer_store_dwordx4 v[64:67], v0, s[16:19], s46 offen offset:512 sc1
    v_mfma_f32_32x32x16_bf16 v[96:111], v[184:187], v[36:39], v[96:111]
    ds_read_b64_tr_b16 v[32:33], v4 offset:20480
    ds_read_b64_tr_b16 v[34:35], v4 offset:20992
    s_waitcnt lgkmcnt(10)
    v_mfma_f32_32x32x16_bf16 v[80:95], v[188:191], v[40:43], v[80:95]
    ds_read_b64_tr_b16 v[36:37], v5 offset:20480
    ds_read_b64_tr_b16 v[38:39], v5 offset:20992
    buffer_store_dwordx4 v[68:71], v0, s[16:19], s45 offen offset:512 sc1
    v_mfma_f32_32x32x16_bf16 v[96:111], v[188:191], v[44:47], v[96:111]
    ds_read_b64_tr_b16 v[40:41], v4 offset:22528
    ds_read_b64_tr_b16 v[42:43], v4 offset:23040
    s_waitcnt lgkmcnt(10)
    v_mfma_f32_32x32x16_bf16 v[80:95], v[192:195], v[16:19], v[80:95]
    ds_read_b64_tr_b16 v[44:45], v5 offset:22528
    ds_read_b64_tr_b16 v[46:47], v5 offset:23040
    v_mfma_f32_32x32x16_bf16 v[96:111], v[192:195], v[20:23], v[96:111]
    ds_read_b64_tr_b16 v[16:17], v4 offset:24576
    ds_read_b64_tr_b16 v[18:19], v4 offset:25088
    s_waitcnt lgkmcnt(10)
    v_mfma_f32_32x32x16_bf16 v[80:95], v[196:199], v[24:27], v[80:95]
    ds_read_b64_tr_b16 v[20:21], v5 offset:24576
    ds_read_b64_tr_b16 v[22:23], v5 offset:25088
    v_mfma_f32_32x32x16_bf16 v[96:111], v[196:199], v[28:31], v[96:111]
    ds_read_b64_tr_b16 v[24:25], v4 offset:26624
    ds_read_b64_tr_b16 v[26:27], v4 offset:27136
    s_waitcnt lgkmcnt(10)
    v_mfma_f32_32x32x16_bf16 v[80:95], v[200:203], v[32:35], v[80:95]
    ds_read_b64_tr_b16 v[28:29], v5 offset:26624
    ds_read_b64_tr_b16 v[30:31], v5 offset:27136
    v_mfma_f32_32x32x16_bf16 v[96:111], v[200:203], v[36:39], v[96:111]
    ds_read_b64_tr_b16 v[32:33], v4 offset:28672
    ds_read_b64_tr_b16 v[34:35], v4 offset:29184
    s_waitcnt lgkmcnt(10)
    v_mfma_f32_32x32x16_bf16 v[80:95], v[204:207], v[40:43], v[80:95]
    ds_read_b64_tr_b16 v[36:37], v5 offset:28672
    ds_read_b64_tr_b16 v[38:39], v5 offset:29184
    v_mfma_f32_32x32x16_bf16 v[96:111], v[204:207], v[44:47], v[96:111]
    ds_read_b64_tr_b16 v[40:41], v4 offset:30720
    ds_read_b64_tr_b16 v[42:43], v4 offset:31232
    s_waitcnt lgkmcnt(10)
    v_mfma_f32_32x32x16_bf16 v[80:95], v[208:211], v[16:19], v[80:95]
    ds_read_b64_tr_b16 v[44:45], v5 offset:30720
    ds_read_b64_tr_b16 v[46:47], v5 offset:31232
    v_mfma_f32_32x32x16_bf16 v[96:111], v[208:211], v[20:23], v[96:111]
    ds_read_b64_tr_b16 v[16:17], v8 offset:0
    ds_read_b64_tr_b16 v[18:19], v8 offset:512
    s_waitcnt lgkmcnt(10)
    v_mfma_f32_32x32x16_bf16 v[80:95], v[212:215], v[24:27], v[80:95]
    ds_read_b64_tr_b16 v[20:21], v9 offset:0
    ds_read_b64_tr_b16 v[22:23], v9 offset:512
    v_mfma_f32_32x32x16_bf16 v[96:111], v[212:215], v[28:31], v[96:111]
    ds_read_b64_tr_b16 v[24:25], v8 offset:2048
    ds_read_b64_tr_b16 v[26:27], v8 offset:2560
    s_waitcnt lgkmcnt(10)
    v_mfma_f32_32x32x16_bf16 v[80:95], v[216:219], v[32:35], v[80:95]
    ds_read_b64_tr_b16 v[28:29], v9 offset:2048
    ds_read_b64_tr_b16 v[30:31], v9 offset:2560
    v_mfma_f32_32x32x16_bf16 v[96:111], v[216:219], v[36:39], v[96:111]
    ds_read_b64_tr_b16 v[32:33], v8 offset:4096
    ds_read_b64_tr_b16 v[34:35], v8 offset:4608
    s_waitcnt lgkmcnt(10)
    v_mfma_f32_32x32x16_bf16 v[80:95], v[220:223], v[40:43], v[80:95]
    ds_read_b64_tr_b16 v[36:37], v9 offset:4096
    ds_read_b64_tr_b16 v[38:39], v9 offset:4608
    v_mfma_f32_32x32x16_bf16 v[96:111], v[220:223], v[44:47], v[96:111]
    ds_read_b64_tr_b16 v[40:41], v8 offset:6144
    ds_read_b64_tr_b16 v[42:43], v8 offset:6656
    s_waitcnt lgkmcnt(10)
    v_mfma_f32_32x32x16_bf16 v[80:95], v[224:227], v[16:19], v[80:95]
    ds_read_b64_tr_b16 v[44:45], v9 offset:6144
    ds_read_b64_tr_b16 v[46:47], v9 offset:6656
    v_mfma_f32_32x32x16_bf16 v[96:111], v[224:227], v[20:23], v[96:111]
    s_waitcnt vmcnt(8)
    s_barrier
    ds_read_b64_tr_b16 v[16:17], v8 offset:8192
    ds_read_b64_tr_b16 v[18:19], v8 offset:8704
    s_waitcnt lgkmcnt(10)
    v_mfma_f32_32x32x16_bf16 v[80:95], v[228:231], v[24:27], v[80:95]
    ds_read_b64_tr_b16 v[20:21], v9 offset:8192
    ds_read_b64_tr_b16 v[22:23], v9 offset:8704
    v_mfma_f32_32x32x16_bf16 v[96:111], v[228:231], v[28:31], v[96:111]
    ds_read_b64_tr_b16 v[24:25], v8 offset:10240
    ds_read_b64_tr_b16 v[26:27], v8 offset:10752
    s_waitcnt lgkmcnt(10)
    v_mfma_f32_32x32x16_bf16 v[80:95], v[232:235], v[32:35], v[80:95]
    ds_read_b64_tr_b16 v[28:29], v9 offset:10240
    ds_read_b64_tr_b16 v[30:31], v9 offset:10752
    v_mfma_f32_32x32x16_bf16 v[96:111], v[232:235], v[36:39], v[96:111]
    ds_read_b64_tr_b16 v[32:33], v8 offset:12288
    ds_read_b64_tr_b16 v[34:35], v8 offset:12800
    s_waitcnt lgkmcnt(10)
    v_mfma_f32_32x32x16_bf16 v[80:95], v[236:239], v[40:43], v[80:95]
    ds_read_b64_tr_b16 v[36:37], v9 offset:12288
    ds_read_b64_tr_b16 v[38:39], v9 offset:12800
    v_mfma_f32_32x32x16_bf16 v[96:111], v[236:239], v[44:47], v[96:111]
    ds_read_b64_tr_b16 v[40:41], v8 offset:14336
    ds_read_b64_tr_b16 v[42:43], v8 offset:14848
    s_waitcnt lgkmcnt(10)
    v_mfma_f32_32x32x16_bf16 v[80:95], v[240:243], v[16:19], v[80:95]
    ds_read_b64_tr_b16 v[44:45], v9 offset:14336
    ds_read_b64_tr_b16 v[46:47], v9 offset:14848
    v_mfma_f32_32x32x16_bf16 v[96:111], v[240:243], v[20:23], v[96:111]
    ds_read_b64_tr_b16 v[16:17], v8 offset:16384
    ds_read_b64_tr_b16 v[18:19], v8 offset:16896
    s_waitcnt lgkmcnt(10)
    v_mfma_f32_32x32x16_bf16 v[80:95], v[244:247], v[24:27], v[80:95]
    ds_read_b64_tr_b16 v[20:21], v9 offset:16384
    ds_read_b64_tr_b16 v[22:23], v9 offset:16896
    v_mfma_f32_32x32x16_bf16 v[96:111], v[244:247], v[28:31], v[96:111]
    ds_read_b64_tr_b16 v[24:25], v8 offset:18432
    ds_read_b64_tr_b16 v[26:27], v8 offset:18944
    s_waitcnt lgkmcnt(10)
    v_mfma_f32_32x32x16_bf16 v[80:95], v[248:251], v[32:35], v[80:95]
    ds_read_b64_tr_b16 v[28:29], v9 offset:18432
    ds_read_b64_tr_b16 v[30:31], v9 offset:18944
    v_mfma_f32_32x32x16_bf16 v[96:111], v[248:251], v[36:39], v[96:111]
    ds_read_b64_tr_b16 v[32:33], v8 offset:20480
    ds_read_b64_tr_b16 v[34:35], v8 offset:20992
    s_waitcnt lgkmcnt(10)
    v_mfma_f32_32x32x16_bf16 v[80:95], v[252:255], v[40:43], v[80:95]
    ds_read_b64_tr_b16 v[36:37], v9 offset:20480
    ds_read_b64_tr_b16 v[38:39], v9 offset:20992
    v_mfma_f32_32x32x16_bf16 v[96:111], v[252:255], v[44:47], v[96:111]
    ds_read_b64_tr_b16 v[40:41], v8 offset:22528
    ds_read_b64_tr_b16 v[42:43], v8 offset:23040
    s_waitcnt lgkmcnt(10)
    v_mfma_f32_32x32x16_bf16 v[48:63], v[112:115], v[16:19], 0
    ds_read_b64_tr_b16 v[44:45], v9 offset:22528
    ds_read_b64_tr_b16 v[46:47], v9 offset:23040
    v_mfma_f32_32x32x16_bf16 v[64:79], v[112:115], v[20:23], 0
    ds_read_b64_tr_b16 v[16:17], v8 offset:24576
    ds_read_b64_tr_b16 v[18:19], v8 offset:25088
    s_waitcnt lgkmcnt(10)
    v_mfma_f32_32x32x16_bf16 v[48:63], v[116:119], v[24:27], v[48:63]
    ds_read_b64_tr_b16 v[20:21], v9 offset:24576
    ds_read_b64_tr_b16 v[22:23], v9 offset:25088
    v_mfma_f32_32x32x16_bf16 v[64:79], v[116:119], v[28:31], v[64:79]
    ds_read_b64_tr_b16 v[24:25], v8 offset:26624
    ds_read_b64_tr_b16 v[26:27], v8 offset:27136
    s_lshl_b32 s46, s28, 4
    s_add_u32 s46, s46, s25
    s_add_u32 s45, s46, 18432
    s_add_u32 s28, s28, 64
    s_waitcnt lgkmcnt(10)
    v_mfma_f32_32x32x16_bf16 v[48:63], v[120:123], v[32:35], v[48:63]
    ds_read_b64_tr_b16 v[28:29], v9 offset:26624
    ds_read_b64_tr_b16 v[30:31], v9 offset:27136
    v_cvt_pk_bf16_f32 v80, v80, v81
    v_mfma_f32_32x32x16_bf16 v[64:79], v[120:123], v[36:39], v[64:79]
    ds_read_b64_tr_b16 v[32:33], v8 offset:28672
    ds_read_b64_tr_b16 v[34:35], v8 offset:29184
    s_waitcnt lgkmcnt(10)
    v_mfma_f32_32x32x16_bf16 v[48:63], v[124:127], v[40:43], v[48:63]
    ds_read_b64_tr_b16 v[36:37], v9 offset:28672
    ds_read_b64_tr_b16 v[38:39], v9 offset:29184
    v_cvt_pk_bf16_f32 v81, v82, v83
    v_mfma_f32_32x32x16_bf16 v[64:79], v[124:127], v[44:47], v[64:79]
    ds_read_b64_tr_b16 v[40:41], v8 offset:30720
    ds_read_b64_tr_b16 v[42:43], v8 offset:31232
    s_waitcnt lgkmcnt(10)
    v_mfma_f32_32x32x16_bf16 v[48:63], v[128:131], v[16:19], v[48:63]
    ds_read_b64_tr_b16 v[44:45], v9 offset:30720
    ds_read_b64_tr_b16 v[46:47], v9 offset:31232
    v_cvt_pk_bf16_f32 v82, v84, v85
    v_mfma_f32_32x32x16_bf16 v[64:79], v[128:131], v[20:23], v[64:79]
    ds_read_b64_tr_b16 v[16:17], v4 offset:32768
    ds_read_b64_tr_b16 v[18:19], v4 offset:33280
    s_waitcnt lgkmcnt(10)
    v_mfma_f32_32x32x16_bf16 v[48:63], v[132:135], v[24:27], v[48:63]
    ds_read_b64_tr_b16 v[20:21], v5 offset:32768
    ds_read_b64_tr_b16 v[22:23], v5 offset:33280
    v_cvt_pk_bf16_f32 v83, v86, v87
    v_mfma_f32_32x32x16_bf16 v[64:79], v[132:135], v[28:31], v[64:79]
    ds_read_b64_tr_b16 v[24:25], v4 offset:34816
    ds_read_b64_tr_b16 v[26:27], v4 offset:35328
    v_cvt_pk_bf16_f32 v84, v88, v89
    s_waitcnt lgkmcnt(10)
    v_mfma_f32_32x32x16_bf16 v[48:63], v[136:139], v[32:35], v[48:63]
    ds_read_b64_tr_b16 v[28:29], v5 offset:34816
    ds_read_b64_tr_b16 v[30:31], v5 offset:35328
    v_mfma_f32_32x32x16_bf16 v[64:79], v[136:139], v[36:39], v[64:79]
    ds_read_b64_tr_b16 v[32:33], v4 offset:36864
    ds_read_b64_tr_b16 v[34:35], v4 offset:37376
    v_cvt_pk_bf16_f32 v85, v90, v91
    s_waitcnt lgkmcnt(10)
    v_mfma_f32_32x32x16_bf16 v[48:63], v[140:143], v[40:43], v[48:63]
    ds_read_b64_tr_b16 v[36:37], v5 offset:36864
    ds_read_b64_tr_b16 v[38:39], v5 offset:37376
    v_mfma_f32_32x32x16_bf16 v[64:79], v[140:143], v[44:47], v[64:79]
    ds_read_b64_tr_b16 v[40:41], v4 offset:38912
    ds_read_b64_tr_b16 v[42:43], v4 offset:39424
    v_cvt_pk_bf16_f32 v86, v92, v93
    s_waitcnt lgkmcnt(10)
    v_mfma_f32_32x32x16_bf16 v[48:63], v[144:147], v[16:19], v[48:63]
    ds_read_b64_tr_b16 v[44:45], v5 offset:38912
    ds_read_b64_tr_b16 v[46:47], v5 offset:39424
    v_mfma_f32_32x32x16_bf16 v[64:79], v[144:147], v[20:23], v[64:79]
    ds_read_b64_tr_b16 v[16:17], v4 offset:40960
    ds_read_b64_tr_b16 v[18:19], v4 offset:41472
    v_cvt_pk_bf16_f32 v87, v94, v95
    s_waitcnt lgkmcnt(10)
    v_mfma_f32_32x32x16_bf16 v[48:63], v[148:151], v[24:27], v[48:63]
    ds_read_b64_tr_b16 v[20:21], v5 offset:40960
    ds_read_b64_tr_b16 v[22:23], v5 offset:41472
    buffer_store_dwordx4 v[80:83], v0, s[16:19], s46 offen offset:0 sc1
    v_mfma_f32_32x32x16_bf16 v[64:79], v[148:151], v[28:31], v[64:79]
    ds_read_b64_tr_b16 v[24:25], v4 offset:43008
    ds_read_b64_tr_b16 v[26:27], v4 offset:43520
    s_waitcnt lgkmcnt(10)
    v_mfma_f32_32x32x16_bf16 v[48:63], v[152:155], v[32:35], v[48:63]
    ds_read_b64_tr_b16 v[28:29], v5 offset:43008
    ds_read_b64_tr_b16 v[30:31], v5 offset:43520
    buffer_store_dwordx4 v[84:87], v0, s[16:19], s45 offen offset:0 sc1
    v_mfma_f32_32x32x16_bf16 v[64:79], v[152:155], v[36:39], v[64:79]
    ds_read_b64_tr_b16 v[32:33], v4 offset:45056
    ds_read_b64_tr_b16 v[34:35], v4 offset:45568
    s_waitcnt lgkmcnt(10)
    v_mfma_f32_32x32x16_bf16 v[48:63], v[156:159], v[40:43], v[48:63]
    ds_read_b64_tr_b16 v[36:37], v5 offset:45056
    ds_read_b64_tr_b16 v[38:39], v5 offset:45568
    v_cvt_pk_bf16_f32 v96, v96, v97
    v_mfma_f32_32x32x16_bf16 v[64:79], v[156:159], v[44:47], v[64:79]
    ds_read_b64_tr_b16 v[40:41], v4 offset:47104
    ds_read_b64_tr_b16 v[42:43], v4 offset:47616
    s_waitcnt lgkmcnt(10)
    v_mfma_f32_32x32x16_bf16 v[48:63], v[160:163], v[16:19], v[48:63]
    ds_read_b64_tr_b16 v[44:45], v5 offset:47104
    ds_read_b64_tr_b16 v[46:47], v5 offset:47616
    v_cvt_pk_bf16_f32 v97, v98, v99
    v_mfma_f32_32x32x16_bf16 v[64:79], v[160:163], v[20:23], v[64:79]
    ds_read_b64_tr_b16 v[16:17], v4 offset:49152
    ds_read_b64_tr_b16 v[18:19], v4 offset:49664
    v_cvt_pk_bf16_f32 v98, v100, v101
    s_waitcnt lgkmcnt(10)
    v_mfma_f32_32x32x16_bf16 v[48:63], v[164:167], v[24:27], v[48:63]
    ds_read_b64_tr_b16 v[20:21], v5 offset:49152
    ds_read_b64_tr_b16 v[22:23], v5 offset:49664
    v_mfma_f32_32x32x16_bf16 v[64:79], v[164:167], v[28:31], v[64:79]
    ds_read_b64_tr_b16 v[24:25], v4 offset:51200
    ds_read_b64_tr_b16 v[26:27], v4 offset:51712
    v_cvt_pk_bf16_f32 v99, v102, v103
    s_waitcnt lgkmcnt(10)
    v_mfma_f32_32x32x16_bf16 v[48:63], v[168:171], v[32:35], v[48:63]
    ds_read_b64_tr_b16 v[28:29], v5 offset:51200
    ds_read_b64_tr_b16 v[30:31], v5 offset:51712
    v_mfma_f32_32x32x16_bf16 v[64:79], v[168:171], v[36:39], v[64:79]
    ds_read_b64_tr_b16 v[32:33], v4 offset:53248
    ds_read_b64_tr_b16 v[34:35], v4 offset:53760
    v_cvt_pk_bf16_f32 v100, v104, v105
    s_waitcnt lgkmcnt(10)
    v_mfma_f32_32x32x16_bf16 v[48:63], v[172:175], v[40:43], v[48:63]
    ds_read_b64_tr_b16 v[36:37], v5 offset:53248
    ds_read_b64_tr_b16 v[38:39], v5 offset:53760
    v_mfma_f32_32x32x16_bf16 v[64:79], v[172:175], v[44:47], v[64:79]
    ds_read_b64_tr_b16 v[40:41], v4 offset:55296
    ds_read_b64_tr_b16 v[42:43], v4 offset:55808
    v_cvt_pk_bf16_f32 v101, v106, v107
    s_waitcnt lgkmcnt(10)
    v_mfma_f32_32x32x16_bf16 v[48:63], v[176:179], v[16:19], v[48:63]
    ds_read_b64_tr_b16 v[44:45], v5 offset:55296
    ds_read_b64_tr_b16 v[46:47], v5 offset:55808
    v_cvt_pk_bf16_f32 v102, v108, v109
    v_mfma_f32_32x32x16_bf16 v[64:79], v[176:179], v[20:23], v[64:79]
    s_waitcnt vmcnt(6)
    s_barrier
    ds_read_b64_tr_b16 v[16:17], v6 offset:32768
    ds_read_b64_tr_b16 v[18:19], v6 offset:33280
    s_waitcnt lgkmcnt(10)
    v_mfma_f32_32x32x16_bf16 v[48:63], v[180:183], v[24:27], v[48:63]
    ds_read_b64_tr_b16 v[20:21], v7 offset:32768
    ds_read_b64_tr_b16 v[22:23], v7 offset:33280
    v_cvt_pk_bf16_f32 v103, v110, v111
    v_mfma_f32_32x32x16_bf16 v[64:79], v[180:183], v[28:31], v[64:79]
    ds_read_b64_tr_b16 v[24:25], v6 offset:34816
    ds_read_b64_tr_b16 v[26:27], v6 offset:35328
    s_waitcnt lgkmcnt(10)
    v_mfma_f32_32x32x16_bf16 v[48:63], v[184:187], v[32:35], v[48:63]
    ds_read_b64_tr_b16 v[28:29], v7 offset:34816
    ds_read_b64_tr_b16 v[30:31], v7 offset:35328
    buffer_store_dwordx4 v[96:99], v0, s[16:19], s46 offen offset:512 sc1
    v_mfma_f32_32x32x16_bf16 v[64:79], v[184:187], v[36:39], v[64:79]
    ds_read_b64_tr_b16 v[32:33], v6 offset:36864
    ds_read_b64_tr_b16 v[34:35], v6 offset:37376
    s_waitcnt lgkmcnt(10)
    v_mfma_f32_32x32x16_bf16 v[48:63], v[188:191], v[40:43], v[48:63]
    ds_read_b64_tr_b16 v[36:37], v7 offset:36864
    ds_read_b64_tr_b16 v[38:39], v7 offset:37376
    buffer_store_dwordx4 v[100:103], v0, s[16:19], s45 offen offset:512 sc1
    v_mfma_f32_32x32x16_bf16 v[64:79], v[188:191], v[44:47], v[64:79]
    ds_read_b64_tr_b16 v[40:41], v6 offset:38912
    ds_read_b64_tr_b16 v[42:43], v6 offset:39424
    s_waitcnt lgkmcnt(10)
    v_mfma_f32_32x32x16_bf16 v[48:63], v[192:195], v[16:19], v[48:63]
    ds_read_b64_tr_b16 v[44:45], v7 offset:38912
    ds_read_b64_tr_b16 v[46:47], v7 offset:39424
    v_mfma_f32_32x32x16_bf16 v[64:79], v[192:195], v[20:23], v[64:79]
    ds_read_b64_tr_b16 v[16:17], v6 offset:40960
    ds_read_b64_tr_b16 v[18:19], v6 offset:41472
    s_waitcnt lgkmcnt(10)
    v_mfma_f32_32x32x16_bf16 v[48:63], v[196:199], v[24:27], v[48:63]
    ds_read_b64_tr_b16 v[20:21], v7 offset:40960
    ds_read_b64_tr_b16 v[22:23], v7 offset:41472
    v_mfma_f32_32x32x16_bf16 v[64:79], v[196:199], v[28:31], v[64:79]
    ds_read_b64_tr_b16 v[24:25], v6 offset:43008
    ds_read_b64_tr_b16 v[26:27], v6 offset:43520
    s_waitcnt lgkmcnt(10)
    v_mfma_f32_32x32x16_bf16 v[48:63], v[200:203], v[32:35], v[48:63]
    ds_read_b64_tr_b16 v[28:29], v7 offset:43008
    ds_read_b64_tr_b16 v[30:31], v7 offset:43520
    v_mfma_f32_32x32x16_bf16 v[64:79], v[200:203], v[36:39], v[64:79]
    ds_read_b64_tr_b16 v[32:33], v6 offset:45056
    ds_read_b64_tr_b16 v[34:35], v6 offset:45568
    s_waitcnt lgkmcnt(10)
    v_mfma_f32_32x32x16_bf16 v[48:63], v[204:207], v[40:43], v[48:63]
    ds_read_b64_tr_b16 v[36:37], v7 offset:45056
    ds_read_b64_tr_b16 v[38:39], v7 offset:45568
    v_mfma_f32_32x32x16_bf16 v[64:79], v[204:207], v[44:47], v[64:79]
    ds_read_b64_tr_b16 v[40:41], v6 offset:47104
    ds_read_b64_tr_b16 v[42:43], v6 offset:47616
    s_waitcnt lgkmcnt(10)
    v_mfma_f32_32x32x16_bf16 v[48:63], v[208:211], v[16:19], v[48:63]
    ds_read_b64_tr_b16 v[44:45], v7 offset:47104
    ds_read_b64_tr_b16 v[46:47], v7 offset:47616
    v_mfma_f32_32x32x16_bf16 v[64:79], v[208:211], v[20:23], v[64:79]
    ds_read_b64_tr_b16 v[16:17], v6 offset:49152
    ds_read_b64_tr_b16 v[18:19], v6 offset:49664
    s_waitcnt lgkmcnt(10)
    v_mfma_f32_32x32x16_bf16 v[48:63], v[212:215], v[24:27], v[48:63]
    ds_read_b64_tr_b16 v[20:21], v7 offset:49152
    ds_read_b64_tr_b16 v[22:23], v7 offset:49664
    v_mfma_f32_32x32x16_bf16 v[64:79], v[212:215], v[28:31], v[64:79]
    ds_read_b64_tr_b16 v[24:25], v6 offset:51200
    ds_read_b64_tr_b16 v[26:27], v6 offset:51712
    s_waitcnt lgkmcnt(10)
    v_mfma_f32_32x32x16_bf16 v[48:63], v[216:219], v[32:35], v[48:63]
    ds_read_b64_tr_b16 v[28:29], v7 offset:51200
    ds_read_b64_tr_b16 v[30:31], v7 offset:51712
    v_mfma_f32_32x32x16_bf16 v[64:79], v[216:219], v[36:39], v[64:79]
    ds_read_b64_tr_b16 v[32:33], v6 offset:53248
    ds_read_b64_tr_b16 v[34:35], v6 offset:53760
    s_waitcnt lgkmcnt(10)
    v_mfma_f32_32x32x16_bf16 v[48:63], v[220:223], v[40:43], v[48:63]
    ds_read_b64_tr_b16 v[36:37], v7 offset:53248
    ds_read_b64_tr_b16 v[38:39], v7 offset:53760
    v_mfma_f32_32x32x16_bf16 v[64:79], v[220:223], v[44:47], v[64:79]
    ds_read_b64_tr_b16 v[40:41], v6 offset:55296
    ds_read_b64_tr_b16 v[42:43], v6 offset:55808
    s_waitcnt lgkmcnt(10)
    v_mfma_f32_32x32x16_bf16 v[48:63], v[224:227], v[16:19], v[48:63]
    ds_read_b64_tr_b16 v[44:45], v7 offset:55296
    ds_read_b64_tr_b16 v[46:47], v7 offset:55808
    v_mfma_f32_32x32x16_bf16 v[64:79], v[224:227], v[20:23], v[64:79]
    ds_read_b64_tr_b16 v[16:17], v6 offset:57344
    ds_read_b64_tr_b16 v[18:19], v6 offset:57856
    s_waitcnt lgkmcnt(10)
    v_mfma_f32_32x32x16_bf16 v[48:63], v[228:231], v[24:27], v[48:63]
    ds_read_b64_tr_b16 v[20:21], v7 offset:57344
    ds_read_b64_tr_b16 v[22:23], v7 offset:57856
    v_mfma_f32_32x32x16_bf16 v[64:79], v[228:231], v[28:31], v[64:79]
    ds_read_b64_tr_b16 v[24:25], v6 offset:59392
    ds_read_b64_tr_b16 v[26:27], v6 offset:59904
    s_waitcnt lgkmcnt(10)
    v_mfma_f32_32x32x16_bf16 v[48:63], v[232:235], v[32:35], v[48:63]
    ds_read_b64_tr_b16 v[28:29], v7 offset:59392
    ds_read_b64_tr_b16 v[30:31], v7 offset:59904
    v_mfma_f32_32x32x16_bf16 v[64:79], v[232:235], v[36:39], v[64:79]
    ds_read_b64_tr_b16 v[32:33], v6 offset:61440
    ds_read_b64_tr_b16 v[34:35], v6 offset:61952
    s_waitcnt lgkmcnt(10)
    v_mfma_f32_32x32x16_bf16 v[48:63], v[236:239], v[40:43], v[48:63]
    ds_read_b64_tr_b16 v[36:37], v7 offset:61440
    ds_read_b64_tr_b16 v[38:39], v7 offset:61952
    v_mfma_f32_32x32x16_bf16 v[64:79], v[236:239], v[44:47], v[64:79]
    ds_read_b64_tr_b16 v[40:41], v6 offset:63488
    ds_read_b64_tr_b16 v[42:43], v6 offset:64000
    s_waitcnt lgkmcnt(10)
    v_mfma_f32_32x32x16_bf16 v[48:63], v[240:243], v[16:19], v[48:63]
    ds_read_b64_tr_b16 v[44:45], v7 offset:63488
    ds_read_b64_tr_b16 v[46:47], v7 offset:64000
    v_mfma_f32_32x32x16_bf16 v[64:79], v[240:243], v[20:23], v[64:79]
    s_waitcnt lgkmcnt(8)
    v_mfma_f32_32x32x16_bf16 v[48:63], v[244:247], v[24:27], v[48:63]
    v_mfma_f32_32x32x16_bf16 v[64:79], v[244:247], v[28:31], v[64:79]
    s_waitcnt lgkmcnt(4)
    v_mfma_f32_32x32x16_bf16 v[48:63], v[248:251], v[32:35], v[48:63]
    v_mfma_f32_32x32x16_bf16 v[64:79], v[248:251], v[36:39], v[64:79]
    s_waitcnt lgkmcnt(0)
    v_mfma_f32_32x32x16_bf16 v[48:63], v[252:255], v[40:43], v[48:63]
    v_mfma_f32_32x32x16_bf16 v[64:79], v[252:255], v[44:47], v[64:79]
    s_lshl_b32 s46, s28, 4
    s_add_u32 s46, s46, s25
    s_add_u32 s45, s46, 18432
    s_add_u32 s28, s28, 64
    s_nop 6
    v_cvt_pk_bf16_f32 v48, v48, v49
    v_cvt_pk_bf16_f32 v49, v50, v51
    v_cvt_pk_bf16_f32 v50, v52, v53
    v_cvt_pk_bf16_f32 v51, v54, v55
    v_cvt_pk_bf16_f32 v52, v56, v57
    v_cvt_pk_bf16_f32 v53, v58, v59
    v_cvt_pk_bf16_f32 v54, v60, v61
    v_cvt_pk_bf16_f32 v55, v62, v63
    buffer_store_dwordx4 v[48:51], v0, s[16:19], s46 offen offset:0 sc1
    buffer_store_dwordx4 v[52:55], v0, s[16:19], s45 offen offset:0 sc1
    v_cvt_pk_bf16_f32 v64, v64, v65
    v_cvt_pk_bf16_f32 v65, v66, v67
    v_cvt_pk_bf16_f32 v66, v68, v69
    v_cvt_pk_bf16_f32 v67, v70, v71
    v_cvt_pk_bf16_f32 v68, v72, v73
    v_cvt_pk_bf16_f32 v69, v74, v75
    v_cvt_pk_bf16_f32 v70, v76, v77
    v_cvt_pk_bf16_f32 v71, v78, v79
    buffer_store_dwordx4 v[64:67], v0, s[16:19], s46 offen offset:512 sc1
    buffer_store_dwordx4 v[68:71], v0, s[16:19], s45 offen offset:512 sc1
    s_cmp_lg_u32 s22, 7
    s_cbranch_scc1 L1_WO
    s_mov_b32 s12, s58
    s_mov_b32 s13, s59
    s_mov_b32 s14, 1152
    s_mov_b32 s15, 0x00020000
    v_lshrrev_b32 v11, 9, v1
    v_lshlrev_b32 v11, 4, v11
    s_sub_u32 s30, s88, s29
    buffer_load_dwordx4 v[16:19], v11, s[12:15], s30 offen offset:0
    buffer_load_dwordx4 v[20:23], v11, s[12:15], s30 offen offset:32
    buffer_load_dwordx4 v[24:27], v11, s[12:15], s30 offen offset:64
    buffer_load_dwordx4 v[28:31], v11, s[12:15], s30 offen offset:96
    s_sub_u32 s30, s89, s29
    buffer_load_dwordx4 v[32:35], v11, s[12:15], s30 offen offset:0
    buffer_load_dwordx4 v[36:39], v11, s[12:15], s30 offen offset:32
    buffer_load_dwordx4 v[40:43], v11, s[12:15], s30 offen offset:64
    buffer_load_dwordx4 v[44:47], v11, s[12:15], s30 offen offset:96
    s_sub_u32 s30, s90, s29
    buffer_load_dwordx4 v[96:99], v11, s[12:15], s30 offen offset:0
    buffer_load_dwordx4 v[100:103], v11, s[12:15], s30 offen offset:32
    buffer_load_dwordx4 v[104:107], v11, s[12:15], s30 offen offset:64
    buffer_load_dwordx4 v[108:111], v11, s[12:15], s30 offen offset:96
    s_waitcnt vmcnt(11)
    v_mfma_f32_32x32x16_bf16 v[80:95], v[16:19], v[112:115], 0
    s_waitcnt vmcnt(10)
    v_mfma_f32_32x32x16_bf16 v[80:95], v[20:23], v[116:119], v[80:95]
    s_waitcnt vmcnt(9)
    v_mfma_f32_32x32x16_bf16 v[80:95], v[24:27], v[120:123], v[80:95]
    s_waitcnt vmcnt(8)
    v_mfma_f32_32x32x16_bf16 v[80:95], v[28:31], v[124:127], v[80:95]
    s_waitcnt vmcnt(7)
    v_mfma_f32_32x32x16_bf16 v[80:95], v[32:35], v[128:131], v[80:95]
    s_waitcnt vmcnt(6)
    v_mfma_f32_32x32x16_bf16 v[80:95], v[36:39], v[132:135], v[80:95]
    s_waitcnt vmcnt(5)
    v_mfma_f32_32x32x16_bf16 v[80:95], v[40:43], v[136:139], v[80:95]
    s_waitcnt vmcnt(4)
    v_mfma_f32_32x32x16_bf16 v[80:95], v[44:47], v[140:143], v[80:95]
    s_waitcnt vmcnt(3)
    v_mfma_f32_32x32x16_bf16 v[80:95], v[96:99], v[144:147], v[80:95]
    s_waitcnt vmcnt(2)
    v_mfma_f32_32x32x16_bf16 v[80:95], v[100:103], v[148:151], v[80:95]
    s_waitcnt vmcnt(1)
    v_mfma_f32_32x32x16_bf16 v[80:95], v[104:107], v[152:155], v[80:95]
    s_waitcnt vmcnt(0)
    v_mfma_f32_32x32x16_bf16 v[80:95], v[108:111], v[156:159], v[80:95]
    s_sub_u32 s30, s91, s29
    buffer_load_dwordx4 v[16:19], v11, s[12:15], s30 offen offset:0
    buffer_load_dwordx4 v[20:23], v11, s[12:15], s30 offen offset:32
    buffer_load_dwordx4 v[24:27], v11, s[12:15], s30 offen offset:64
    buffer_load_dwordx4 v[28:31], v11, s[12:15], s30 offen offset:96
    s_sub_u32 s30, s92, s29
    buffer_load_dwordx4 v[32:35], v11, s[12:15], s30 offen offset:0
    buffer_load_dwordx4 v[36:39], v11, s[12:15], s30 offen offset:32
    buffer_load_dwordx4 v[40:43], v11, s[12:15], s30 offen offset:64
    buffer_load_dwordx4 v[44:47], v11, s[12:15], s30 offen offset:96
    s_sub_u32 s30, s93, s29
    buffer_load_dwordx4 v[96:99], v11, s[12:15], s30 offen offset:0
    buffer_load_dwordx4 v[100:103], v11, s[12:15], s30 offen offset:32
    buffer_load_dwordx4 v[104:107], v11, s[12:15], s30 offen offset:64
    buffer_load_dwordx4 v[108:111], v11, s[12:15], s30 offen offset:96
    s_waitcnt vmcnt(11)
    v_mfma_f32_32x32x16_bf16 v[80:95], v[16:19], v[160:163], v[80:95]
    s_waitcnt vmcnt(10)
    v_mfma_f32_32x32x16_bf16 v[80:95], v[20:23], v[164:167], v[80:95]
    s_waitcnt vmcnt(9)
    v_mfma_f32_32x32x16_bf16 v[80:95], v[24:27], v[168:171], v[80:95]
    s_waitcnt vmcnt(8)
    v_mfma_f32_32x32x16_bf16 v[80:95], v[28:31], v[172:175], v[80:95]
    s_waitcnt vmcnt(7)
    v_mfma_f32_32x32x16_bf16 v[80:95], v[32:35], v[176:179], v[80:95]
    s_waitcnt vmcnt(6)
    v_mfma_f32_32x32x16_bf16 v[80:95], v[36:39], v[180:183], v[80:95]
    s_waitcnt vmcnt(5)
    v_mfma_f32_32x32x16_bf16 v[80:95], v[40:43], v[184:187], v[80:95]
    s_waitcnt vmcnt(4)
    v_mfma_f32_32x32x16_bf16 v[80:95], v[44:47], v[188:191], v[80:95]
    s_waitcnt vmcnt(3)
    v_mfma_f32_32x32x16_bf16 v[80:95], v[96:99], v[192:195], v[80:95]
    s_waitcnt vmcnt(2)
    v_mfma_f32_32x32x16_bf16 v[80:95], v[100:103], v[196:199], v[80:95]
    s_waitcnt vmcnt(1)
    v_mfma_f32_32x32x16_bf16 v[80:95], v[104:107], v[200:203], v[80:95]
    s_waitcnt vmcnt(0)
    v_mfma_f32_32x32x16_bf16 v[80:95], v[108:111], v[204:207], v[80:95]
    s_sub_u32 s30, s94, s29
    buffer_load_dwordx4 v[16:19], v11, s[12:15], s30 offen offset:0
    buffer_load_dwordx4 v[20:23], v11, s[12:15], s30 offen offset:32
    buffer_load_dwordx4 v[24:27], v11, s[12:15], s30 offen offset:64
    buffer_load_dwordx4 v[28:31], v11, s[12:15], s30 offen offset:96
    s_sub_u32 s30, s95, s29
    buffer_load_dwordx4 v[32:35], v11, s[12:15], s30 offen offset:0
    buffer_load_dwordx4 v[36:39], v11, s[12:15], s30 offen offset:32
    buffer_load_dwordx4 v[40:43], v11, s[12:15], s30 offen offset:64
    buffer_load_dwordx4 v[44:47], v11, s[12:15], s30 offen offset:96
    s_sub_u32 s30, s96, s29
    buffer_load_dwordx4 v[96:99], v11, s[12:15], s30 offen offset:0
    buffer_load_dwordx4 v[100:103], v11, s[12:15], s30 offen offset:32
    buffer_load_dwordx4 v[104:107], v11, s[12:15], s30 offen offset:64
    buffer_load_dwordx4 v[108:111], v11, s[12:15], s30 offen offset:96
    s_waitcnt vmcnt(11)
    v_mfma_f32_32x32x16_bf16 v[80:95], v[16:19], v[208:211], v[80:95]
    s_waitcnt vmcnt(10)
    v_mfma_f32_32x32x16_bf16 v[80:95], v[20:23], v[212:215], v[80:95]
    s_waitcnt vmcnt(9)
    v_mfma_f32_32x32x16_bf16 v[80:95], v[24:27], v[216:219], v[80:95]
    s_waitcnt vmcnt(8)
    v_mfma_f32_32x32x16_bf16 v[80:95], v[28:31], v[220:223], v[80:95]
    s_waitcnt vmcnt(7)
    v_mfma_f32_32x32x16_bf16 v[80:95], v[32:35], v[224:227], v[80:95]
    s_waitcnt vmcnt(6)
    v_mfma_f32_32x32x16_bf16 v[80:95], v[36:39], v[228:231], v[80:95]
    s_waitcnt vmcnt(5)
    v_mfma_f32_32x32x16_bf16 v[80:95], v[40:43], v[232:235], v[80:95]
    s_waitcnt vmcnt(4)
    v_mfma_f32_32x32x16_bf16 v[80:95], v[44:47], v[236:239], v[80:95]
    s_waitcnt vmcnt(3)
    v_mfma_f32_32x32x16_bf16 v[80:95], v[96:99], v[240:243], v[80:95]
    s_waitcnt vmcnt(2)
    v_mfma_f32_32x32x16_bf16 v[80:95], v[100:103], v[244:247], v[80:95]
    s_waitcnt vmcnt(1)
    v_mfma_f32_32x32x16_bf16 v[80:95], v[104:107], v[248:251], v[80:95]
    s_waitcnt vmcnt(0)
    v_mfma_f32_32x32x16_bf16 v[80:95], v[108:111], v[252:255], v[80:95]
    s_nop 11
    v_mul_f32 v12, 0xbfb8aa3b, v80
    v_exp_f32 v12, v12
    s_nop 0
    v_add_f32 v12, 1.0, v12
    v_rcp_f32 v12, v12
    v_lshlrev_b32 v13, 2, v10
    s_lshl_b32 s30, s23, 7
    s_add_u32 s30, s30, 29196288
    buffer_store_dword v12, v13, s[16:19], s30 offen sc1
    s_branch L1_PF
L1_WO:
    s_load_dwordx2 s[58:59], s[0:1], 16
    s_lshl_b32 s46, s21, 1
    s_add_u32 s46, s46, s22
    s_sub_u32 s46, s46, 5
    s_mul_i32 s34, s46, 41472
    s_add_u32 s34, s34, s24
    v_lshrrev_b32 v0, 4, v1
    s_waitcnt vmcnt(0) lgkmcnt(0)
    s_barrier
    s_mov_b32 s12, s58
    s_mov_b32 s13, s59
    s_mov_b32 s14, 663552
    s_mov_b32 s15, 0x00020000
    s_add_u32 m0, s24, 0
    s_add_u32 s47, s34, 0
    buffer_load_dwordx4 v1, s[12:15], s47 offen lds
    s_add_u32 m0, s24, 8192
    s_add_u32 s47, s34, 8192
    buffer_load_dwordx4 v1, s[12:15], s47 offen lds
    s_add_u32 m0, s24, 16384
    s_add_u32 s47, s34, 16384
    buffer_load_dwordx4 v1, s[12:15], s47 offen lds
    s_add_u32 m0, s24, 24576
    s_add_u32 s47, s34, 24576
    buffer_load_dwordx4 v1, s[12:15], s47 offen lds
    s_add_u32 m0, s24, 32768
    s_add_u32 s47, s34, 32768
    buffer_load_dwordx4 v1, s[12:15], s47 offen lds
    s_add_u32 m0, s24, 40960
    s_add_u32 s47, s34, 40960
    buffer_load_dwordx4 v1, s[12:15], s47 offen lds
    v_and_b32 v16, 15, v0
    v_lshrrev_b32 v17, 2, v16
    v_and_b32 v16, 3, v16
    v_lshrrev_b32 v18, 5, v0
    v_lshl_add_u32 v19, v18, 2, v17
    v_mul_u32_u24 v19, 1152, v19
    v_lshlrev_b32 v16, 3, v16
    v_and_b32 v20, 16, v0
    v_lshl_add_u32 v16, v20, 1, v16
    v_add_u32 v19, v19, v16
    v_lshrrev_b32 v20, 1, v17
    v_mul_u32_u24 v20, 18, v20
    v_and_b32 v21, 1, v17
    v_add3_u32 v20, v20, v21, 16
    v_mul_u32_u24 v20, 1152, v20
    v_add_u32 v20, v20, v16
    s_lshl_b32 s47, s20, 6
    v_add_u32 v19, s47, v19
    v_add_u32 v20, s47, v20
    v_lshlrev_b32 v21, 4, v10
    s_mul_i32 s34, s20, 36864
    s_add_u32 s34, s34, 28532736
    s_lshl_b32 s35, s46, 11
    s_add_u32 s35, s35, s34
    s_lshr_b32 s47, s46, 1
    s_lshl_b32 s47, s47, 9
    s_add_u32 s34, s34, s47
    s_and_b32 s47, s46, 1
    s_lshl_b32 s47, s47, 3
    s_add_u32 s34, s34, s47
    s_add_u32 s34, s34, 32768
    s_waitcnt vmcnt(0)
    s_barrier
    ds_read_b64_tr_b16 v[112:113], v19 offset:0
    ds_read_b64_tr_b16 v[114:115], v19 offset:9216
    ds_read_b64_tr_b16 v[116:117], v19 offset:20736
    ds_read_b64_tr_b16 v[118:119], v19 offset:29952
    ds_read_b64_tr_b16 v[120:121], v20 offset:0
    s_waitcnt lgkmcnt(0)
    buffer_store_dwordx4 v[112:115], v1, s[16:19], s35 offen sc1
    buffer_store_dwordx4 v[116:119], v1, s[16:19], s35 offen offset:1024 sc1
    buffer_store_dwordx2 v[120:121], v21, s[16:19], s34 offen sc1
    s_add_u32 s35, s35, 294912
    s_add_u32 s34, s34, 294912
    ds_read_b64_tr_b16 v[124:125], v19 offset:512
    ds_read_b64_tr_b16 v[126:127], v19 offset:9728
    ds_read_b64_tr_b16 v[128:129], v19 offset:21248
    ds_read_b64_tr_b16 v[130:131], v19 offset:30464
    ds_read_b64_tr_b16 v[132:133], v20 offset:512
    s_waitcnt lgkmcnt(0)
    buffer_store_dwordx4 v[124:127], v1, s[16:19], s35 offen sc1
    buffer_store_dwordx4 v[128:131], v1, s[16:19], s35 offen offset:1024 sc1
    buffer_store_dwordx2 v[132:133], v21, s[16:19], s34 offen sc1
    s_add_u32 s35, s35, 294912
    s_add_u32 s34, s34, 294912
    s_cmp_ge_u32 s20, 2
    s_cbranch_scc1 L1_PF
    ds_read_b64_tr_b16 v[136:137], v19 offset:1024
    ds_read_b64_tr_b16 v[138:139], v19 offset:10240
    ds_read_b64_tr_b16 v[140:141], v19 offset:21760
    ds_read_b64_tr_b16 v[142:143], v19 offset:30976
    ds_read_b64_tr_b16 v[144:145], v20 offset:1024
    s_waitcnt lgkmcnt(0)
    buffer_store_dwordx4 v[136:139], v1, s[16:19], s35 offen sc1
    buffer_store_dwordx4 v[140:143], v1, s[16:19], s35 offen offset:1024 sc1
    buffer_store_dwordx2 v[144:145], v21, s[16:19], s34 offen sc1
    s_add_u32 s35, s35, 294912
    s_add_u32 s34, s34, 294912
L1_PF:
    s_load_dwordx2 s[58:59], s[0:1], 48
    s_and_b32 s30, s2, 7
    s_mul_i32 s30, s30, 10
    s_add_u32 s31, s30, 9
    s_lshr_b32 s30, s30, 4
    s_lshr_b32 s31, s31, 4
    s_lshr_b32 s32, s2, 3
    s_sub_u32 s32, s32, 24
    s_lshl_b32 s32, s32, 3
    s_add_u32 s32, s32, s20
    s_lshl_b32 s32, s32, 13
    s_mul_i32 s33, s30, 1069056
    s_add_u32 s33, s33, s32
    s_mul_i32 s34, s31, 1069056
    s_add_u32 s34, s34, s32
    v_lshlrev_b32 v16, 3, v1
    s_waitcnt lgkmcnt(0)
    s_mov_b32 s12, s58
    s_mov_b32 s13, s59
    s_mov_b32 s14, 5308416
    s_mov_b32 s15, 0x00020000
    buffer_load_dword v17, v16, s[12:15], s33 offen
    s_add_u32 s33, s33, 524288
    buffer_load_dword v17, v16, s[12:15], s33 offen
    s_add_u32 s33, s33, 524288
    s_cmp_eq_u32 s30, s31
    s_cbranch_scc1 L1_END
    buffer_load_dword v17, v16, s[12:15], s34 offen
    s_add_u32 s34, s34, 524288
    buffer_load_dword v17, v16, s[12:15], s34 offen
    s_add_u32 s34, s34, 524288
L1_END:
    s_endpgm
.globl l2_kernel
.p2align 8
.type l2_kernel,@function
l2_kernel:
    s_cmp_ge_u32 s2, 512
    s_cbranch_scc1 L2_END
    s_load_dwordx2 s[48:49], s[0:1], 80
    s_load_dwordx2 s[50:51], s[0:1], 48
    s_load_dwordx4 s[52:55], s[0:1], 64
    v_lshrrev_b32 v8, 6, v0
    v_and_b32 v0, 63, v0
    v_readfirstlane_b32 s20, v8
    s_cmp_ge_u32 s2, 256
    s_cbranch_scc1 L2_ATT
    s_setprio 3
    s_and_b32 s34, s2, 7
    s_lshr_b32 s35, s2, 3
    s_mul_i32 s36, s35, 43
    s_lshr_b32 s36, s36, 7
    s_mul_i32 s37, s36, 3
    s_sub_u32 s37, s35, s37
    s_mul_i32 s40, s36, 3
    s_mul_i32 s41, s37, 10
    s_add_u32 s40, s40, s41
    s_cmp_ge_u32 s40, 28
    s_cselect_b32 s41, 28, 0
    s_sub_u32 s40, s40, s41
    s_mul_i32 s40, s40, 0
    s_mul_i32 s34, s34, 10
    s_add_u32 s34, s34, s36
    s_lshr_b32 s35, s34, 4
    s_and_b32 s34, s34, 15
    s_lshl_b32 s42, s34, 8
    s_add_u32 s42, s42, 52832256
    s_lshl_b32 s34, s34, 2
    s_add_u32 s34, s34, s20
    s_mul_i32 s36, s35, 29
    s_add_u32 s36, s36, 0
    s_cmp_eq_u32 s35, 4
    s_cselect_b32 s24, 28, 29
    s_mul_i32 s22, s34, 288
    s_lshl_b32 s38, s36, 1
    s_add_u32 s22, s22, s38
    s_lshl_b32 s22, s22, 10
    s_lshl_b32 s38, s36, 2
    s_add_u32 s38, s38, s20
    s_mul_i32 s21, s38, 9216
    s_mul_i32 s38, s37, 384
    s_add_u32 s21, s21, s38
    s_lshl_b32 s23, s20, 10
    s_mov_b32 s26, s21
    s_mov_b32 s28, s22
    s_mul_i32 s38, s24, 36864
    s_add_u32 s27, s26, s38
    s_lshl_b32 s38, s24, 11
    s_add_u32 s29, s28, s38
    s_mul_i32 s38, s40, 36864
    s_add_u32 s21, s21, s38
    s_lshl_b32 s38, s40, 11
    s_add_u32 s22, s22, s38
    s_lshl_b32 s38, s35, 6
    s_add_u32 s38, s38, s34
    s_mul_i32 s38, s38, 18
    s_mul_i32 s39, s37, 6
    s_add_u32 s38, s38, s39
    s_lshl_b32 s25, s38, 11
    s_add_u32 s25, s25, 29237248
    v_lshlrev_b32 v1, 4, v0
    v_lshrrev_b32 v9, 3, v0
    v_and_b32 v10, 7, v0
    v_lshlrev_b32 v12, 1, v9
    v_and_b32 v12, 4, v12
    v_xor_b32 v12, v12, v10
    v_lshlrev_b32 v12, 4, v12
    v_mul_u32_u24 v4, 1152, v9
    v_add_u32 v4, v4, v12
    v_and_b32 v13, 15, v0
    v_lshrrev_b32 v14, 2, v13
    v_and_b32 v13, 3, v13
    v_lshrrev_b32 v15, 5, v0
    v_lshl_add_u32 v15, v15, 2, v14
    v_lshlrev_b32 v15, 7, v15
    v_lshl_add_u32 v15, v13, 3, v15
    v_and_b32 v13, 16, v0
    v_lshl_add_u32 v15, v13, 1, v15
    v_and_b32 v14, 2, v14
    v_lshl_add_u32 v2, v14, 5, v15
    v_xor_b32 v3, 64, v2
    v_lshlrev_b32 v5, 7, v0
    s_mov_b32 s30, 0x49249249
    s_mov_b32 s31, 0x92492492
    s_lshl_b64 s[30:31], s[30:31], s37
    s_waitcnt lgkmcnt(0)
    s_mov_b32 s4, s48
    s_mov_b32 s5, s49
    s_mov_b32 s6, 268435456
    s_mov_b32 s7, 0x00020000
    s_mov_b32 s8, s50
    s_mov_b32 s9, s51
    s_mov_b32 s10, 5308416
    s_mov_b32 s11, 0x00020000
    s_mov_b32 s16, s52
    s_mov_b32 s17, s53
    s_mov_b32 s18, 2359296
    s_mov_b32 s19, 0x00020000
    s_cmp_ge_u32 s2, 240
    s_cbranch_scc1 L2_END
    s_add_u32 m0, s23, 0
    s_nop 0
    buffer_load_dwordx4 v4, s[8:11], s21 offen offset:0 lds
    s_add_u32 m0, s23, 3968
    s_nop 0
    buffer_load_dwordx4 v4, s[8:11], s21 offen offset:128 lds
    s_add_u32 m0, s23, 7936
    s_nop 0
    buffer_load_dwordx4 v4, s[8:11], s21 offen offset:256 lds
    s_add_u32 s21, s21, 36864
    s_add_u32 m0, s23, 12288
    s_nop 0
    buffer_load_dwordx4 v4, s[8:11], s21 offen offset:0 lds
    buffer_load_dwordx4 v[24:27], v1, s[4:7], s22 offen
    s_add_u32 s22, s22, 1024
    s_add_u32 m0, s23, 16256
    s_nop 0
    buffer_load_dwordx4 v4, s[8:11], s21 offen offset:128 lds
    s_add_u32 m0, s23, 20224
    s_nop 0
    buffer_load_dwordx4 v4, s[8:11], s21 offen offset:256 lds
    s_add_u32 s21, s21, 36864
    buffer_load_dwordx4 v[28:31], v1, s[4:7], s22 offen
    s_add_u32 s22, s22, 1024
    s_add_u32 m0, s23, 24576
    s_nop 0
    buffer_load_dwordx4 v4, s[8:11], s21 offen offset:0 lds
    buffer_load_dwordx4 v[32:35], v1, s[4:7], s22 offen
    s_add_u32 s22, s22, 1024
    s_add_u32 m0, s23, 28544
    s_nop 0
    buffer_load_dwordx4 v4, s[8:11], s21 offen offset:128 lds
    s_add_u32 m0, s23, 32512
    s_nop 0
    buffer_load_dwordx4 v4, s[8:11], s21 offen offset:256 lds
    s_add_u32 s21, s21, 36864
    buffer_load_dwordx4 v[36:39], v1, s[4:7], s22 offen
    s_add_u32 s22, s22, 1024
    v_mov_b32 v8, 0
    v_mov_b32 v9, 0
    v_mov_b32 v10, 0
    v_mov_b32 v11, 0
    s_nop 1
    v_mfma_f32_32x32x16_bf16 v[72:87], v[8:11], v[8:11], 0
    v_mfma_f32_32x32x16_bf16 v[88:103], v[8:11], v[8:11], 0
    v_mfma_f32_32x32x16_bf16 v[104:119], v[8:11], v[8:11], 0
    v_mfma_f32_32x32x16_bf16 v[120:135], v[8:11], v[8:11], 0
    v_mfma_f32_32x32x16_bf16 v[136:151], v[8:11], v[8:11], 0
    v_mfma_f32_32x32x16_bf16 v[152:167], v[8:11], v[8:11], 0
    s_waitcnt vmcnt(10)
    s_barrier
    ds_read_b64_tr_b16 v[40:41], v2 offset:0
    ds_read_b64_tr_b16 v[42:43], v2 offset:2048
    ds_read_b64_tr_b16 v[44:45], v3 offset:0
    ds_read_b64_tr_b16 v[46:47], v3 offset:2048
    ds_read_b64_tr_b16 v[48:49], v2 offset:4096
    ds_read_b64_tr_b16 v[50:51], v2 offset:6144
    ds_read_b64_tr_b16 v[52:53], v3 offset:4096
    ds_read_b64_tr_b16 v[54:55], v3 offset:6144
    ds_read_b64_tr_b16 v[56:57], v2 offset:8192
    ds_read_b64_tr_b16 v[58:59], v2 offset:10240
    ds_read_b64_tr_b16 v[60:61], v3 offset:8192
    ds_read_b64_tr_b16 v[62:63], v3 offset:10240
    ds_read_b64_tr_b16 v[64:65], v2 offset:1024
    ds_read_b64_tr_b16 v[66:67], v2 offset:3072
    s_setprio 0
L2_GL:
    s_waitcnt lgkmcnt(12)
    s_waitcnt vmcnt(8)
    v_mfma_f32_32x32x16_bf16 v[72:87], v[40:43], v[24:27], v[72:87]
    ds_read_b64_tr_b16 v[68:69], v3 offset:1024
    ds_read_b64_tr_b16 v[70:71], v3 offset:3072
    s_waitcnt lgkmcnt(12)
    v_mfma_f32_32x32x16_bf16 v[88:103], v[44:47], v[24:27], v[88:103]
    ds_read_b64_tr_b16 v[40:41], v2 offset:5120
    ds_read_b64_tr_b16 v[42:43], v2 offset:7168
    s_waitcnt lgkmcnt(12)
    v_mfma_f32_32x32x16_bf16 v[104:119], v[48:51], v[24:27], v[104:119]
    ds_read_b64_tr_b16 v[44:45], v3 offset:5120
    ds_read_b64_tr_b16 v[46:47], v3 offset:7168
    s_waitcnt lgkmcnt(12)
    v_mfma_f32_32x32x16_bf16 v[120:135], v[52:55], v[24:27], v[120:135]
    ds_read_b64_tr_b16 v[48:49], v2 offset:9216
    ds_read_b64_tr_b16 v[50:51], v2 offset:11264
    s_waitcnt lgkmcnt(12)
    v_mfma_f32_32x32x16_bf16 v[136:151], v[56:59], v[24:27], v[136:151]
    ds_read_b64_tr_b16 v[52:53], v3 offset:9216
    ds_read_b64_tr_b16 v[54:55], v3 offset:11264
    s_waitcnt lgkmcnt(12)
    v_mfma_f32_32x32x16_bf16 v[152:167], v[60:63], v[24:27], v[152:167]
    s_waitcnt vmcnt(6)
    s_barrier
    ds_read_b64_tr_b16 v[56:57], v2 offset:12288
    ds_read_b64_tr_b16 v[58:59], v2 offset:14336
    s_add_u32 m0, s23, 36864
    s_nop 0
    buffer_load_dwordx4 v4, s[8:11], s21 offen offset:0 lds
    buffer_load_dwordx4 v[24:27], v1, s[4:7], s22 offen
    s_add_u32 s22, s22, 1024
    s_waitcnt lgkmcnt(12)
    s_waitcnt vmcnt(7)
    v_mfma_f32_32x32x16_bf16 v[72:87], v[64:67], v[28:31], v[72:87]
    ds_read_b64_tr_b16 v[60:61], v3 offset:12288
    ds_read_b64_tr_b16 v[62:63], v3 offset:14336
    s_add_u32 m0, s23, 40832
    s_nop 0
    buffer_load_dwordx4 v4, s[8:11], s21 offen offset:128 lds
    s_waitcnt lgkmcnt(12)
    v_mfma_f32_32x32x16_bf16 v[88:103], v[68:71], v[28:31], v[88:103]
    ds_read_b64_tr_b16 v[64:65], v2 offset:16384
    ds_read_b64_tr_b16 v[66:67], v2 offset:18432
    s_add_u32 m0, s23, 44800
    s_nop 0
    buffer_load_dwordx4 v4, s[8:11], s21 offen offset:256 lds
    s_add_u32 s21, s21, 36864
    s_waitcnt lgkmcnt(12)
    v_mfma_f32_32x32x16_bf16 v[104:119], v[40:43], v[28:31], v[104:119]
    ds_read_b64_tr_b16 v[68:69], v3 offset:16384
    ds_read_b64_tr_b16 v[70:71], v3 offset:18432
    s_waitcnt lgkmcnt(12)
    v_mfma_f32_32x32x16_bf16 v[120:135], v[44:47], v[28:31], v[120:135]
    ds_read_b64_tr_b16 v[40:41], v2 offset:20480
    ds_read_b64_tr_b16 v[42:43], v2 offset:22528
    s_waitcnt lgkmcnt(12)
    v_mfma_f32_32x32x16_bf16 v[136:151], v[48:51], v[28:31], v[136:151]
    ds_read_b64_tr_b16 v[44:45], v3 offset:20480
    ds_read_b64_tr_b16 v[46:47], v3 offset:22528
    s_waitcnt lgkmcnt(12)
    v_mfma_f32_32x32x16_bf16 v[152:167], v[52:55], v[28:31], v[152:167]
    ds_read_b64_tr_b16 v[48:49], v2 offset:13312
    ds_read_b64_tr_b16 v[50:51], v2 offset:15360
    buffer_load_dwordx4 v[28:31], v1, s[4:7], s22 offen
    s_add_u32 s22, s22, 1024
    s_sub_u32 s24, s24, 1
    s_cmp_eq_u32 s24, 0
    s_cbranch_scc1 L2_GE
    s_waitcnt lgkmcnt(12)
    s_waitcnt vmcnt(8)
    v_mfma_f32_32x32x16_bf16 v[72:87], v[56:59], v[32:35], v[72:87]
    ds_read_b64_tr_b16 v[52:53], v3 offset:13312
    ds_read_b64_tr_b16 v[54:55], v3 offset:15360
    s_waitcnt lgkmcnt(12)
    v_mfma_f32_32x32x16_bf16 v[88:103], v[60:63], v[32:35], v[88:103]
    ds_read_b64_tr_b16 v[56:57], v2 offset:17408
    ds_read_b64_tr_b16 v[58:59], v2 offset:19456
    s_waitcnt lgkmcnt(12)
    v_mfma_f32_32x32x16_bf16 v[104:119], v[64:67], v[32:35], v[104:119]
    ds_read_b64_tr_b16 v[60:61], v3 offset:17408
    ds_read_b64_tr_b16 v[62:63], v3 offset:19456
    s_waitcnt lgkmcnt(12)
    v_mfma_f32_32x32x16_bf16 v[120:135], v[68:71], v[32:35], v[120:135]
    ds_read_b64_tr_b16 v[64:65], v2 offset:21504
    ds_read_b64_tr_b16 v[66:67], v2 offset:23552
    s_waitcnt lgkmcnt(12)
    v_mfma_f32_32x32x16_bf16 v[136:151], v[40:43], v[32:35], v[136:151]
    ds_read_b64_tr_b16 v[68:69], v3 offset:21504
    ds_read_b64_tr_b16 v[70:71], v3 offset:23552
    s_waitcnt lgkmcnt(12)
    v_mfma_f32_32x32x16_bf16 v[152:167], v[44:47], v[32:35], v[152:167]
    s_waitcnt vmcnt(6)
    s_barrier
    ds_read_b64_tr_b16 v[40:41], v2 offset:24576
    ds_read_b64_tr_b16 v[42:43], v2 offset:26624
    s_add_u32 m0, s23, 0
    s_nop 0
    buffer_load_dwordx4 v4, s[8:11], s21 offen offset:0 lds
    buffer_load_dwordx4 v[32:35], v1, s[4:7], s22 offen
    s_add_u32 s22, s22, 1024
    s_waitcnt lgkmcnt(12)
    s_waitcnt vmcnt(7)
    v_mfma_f32_32x32x16_bf16 v[72:87], v[48:51], v[36:39], v[72:87]
    ds_read_b64_tr_b16 v[44:45], v3 offset:24576
    ds_read_b64_tr_b16 v[46:47], v3 offset:26624
    s_add_u32 m0, s23, 3968
    s_nop 0
    buffer_load_dwordx4 v4, s[8:11], s21 offen offset:128 lds
    s_waitcnt lgkmcnt(12)
    v_mfma_f32_32x32x16_bf16 v[88:103], v[52:55], v[36:39], v[88:103]
    ds_read_b64_tr_b16 v[48:49], v2 offset:28672
    ds_read_b64_tr_b16 v[50:51], v2 offset:30720
    s_add_u32 m0, s23, 7936
    s_nop 0
    buffer_load_dwordx4 v4, s[8:11], s21 offen offset:256 lds
    s_add_u32 s21, s21, 36864
    s_waitcnt lgkmcnt(12)
    v_mfma_f32_32x32x16_bf16 v[104:119], v[56:59], v[36:39], v[104:119]
    ds_read_b64_tr_b16 v[52:53], v3 offset:28672
    ds_read_b64_tr_b16 v[54:55], v3 offset:30720
    s_waitcnt lgkmcnt(12)
    v_mfma_f32_32x32x16_bf16 v[120:135], v[60:63], v[36:39], v[120:135]
    ds_read_b64_tr_b16 v[56:57], v2 offset:32768
    ds_read_b64_tr_b16 v[58:59], v2 offset:34816
    s_waitcnt lgkmcnt(12)
    v_mfma_f32_32x32x16_bf16 v[136:151], v[64:67], v[36:39], v[136:151]
    ds_read_b64_tr_b16 v[60:61], v3 offset:32768
    ds_read_b64_tr_b16 v[62:63], v3 offset:34816
    s_waitcnt lgkmcnt(12)
    v_mfma_f32_32x32x16_bf16 v[152:167], v[68:71], v[36:39], v[152:167]
    ds_read_b64_tr_b16 v[64:65], v2 offset:25600
    ds_read_b64_tr_b16 v[66:67], v2 offset:27648
    buffer_load_dwordx4 v[36:39], v1, s[4:7], s22 offen
    s_add_u32 s22, s22, 1024
    s_sub_u32 s24, s24, 1
    s_cmp_eq_u32 s24, 0
    s_cbranch_scc1 L2_GE
    s_waitcnt lgkmcnt(12)
    s_waitcnt vmcnt(8)
    v_mfma_f32_32x32x16_bf16 v[72:87], v[40:43], v[24:27], v[72:87]
    ds_read_b64_tr_b16 v[68:69], v3 offset:25600
    ds_read_b64_tr_b16 v[70:71], v3 offset:27648
    s_waitcnt lgkmcnt(12)
    v_mfma_f32_32x32x16_bf16 v[88:103], v[44:47], v[24:27], v[88:103]
    ds_read_b64_tr_b16 v[40:41], v2 offset:29696
    ds_read_b64_tr_b16 v[42:43], v2 offset:31744
    s_waitcnt lgkmcnt(12)
    v_mfma_f32_32x32x16_bf16 v[104:119], v[48:51], v[24:27], v[104:119]
    ds_read_b64_tr_b16 v[44:45], v3 offset:29696
    ds_read_b64_tr_b16 v[46:47], v3 offset:31744
    s_waitcnt lgkmcnt(12)
    v_mfma_f32_32x32x16_bf16 v[120:135], v[52:55], v[24:27], v[120:135]
    ds_read_b64_tr_b16 v[48:49], v2 offset:33792
    ds_read_b64_tr_b16 v[50:51], v2 offset:35840
    s_waitcnt lgkmcnt(12)
    v_mfma_f32_32x32x16_bf16 v[136:151], v[56:59], v[24:27], v[136:151]
    ds_read_b64_tr_b16 v[52:53], v3 offset:33792
    ds_read_b64_tr_b16 v[54:55], v3 offset:35840
    s_waitcnt lgkmcnt(12)
    v_mfma_f32_32x32x16_bf16 v[152:167], v[60:63], v[24:27], v[152:167]
    s_waitcnt vmcnt(6)
    s_barrier
    ds_read_b64_tr_b16 v[56:57], v2 offset:36864
    ds_read_b64_tr_b16 v[58:59], v2 offset:38912
    s_add_u32 m0, s23, 12288
    s_nop 0
    buffer_load_dwordx4 v4, s[8:11], s21 offen offset:0 lds
    buffer_load_dwordx4 v[24:27], v1, s[4:7], s22 offen
    s_add_u32 s22, s22, 1024
    s_waitcnt lgkmcnt(12)
    s_waitcnt vmcnt(7)
    v_mfma_f32_32x32x16_bf16 v[72:87], v[64:67], v[28:31], v[72:87]
    ds_read_b64_tr_b16 v[60:61], v3 offset:36864
    ds_read_b64_tr_b16 v[62:63], v3 offset:38912
    s_add_u32 m0, s23, 16256
    s_nop 0
    buffer_load_dwordx4 v4, s[8:11], s21 offen offset:128 lds
    s_waitcnt lgkmcnt(12)
    v_mfma_f32_32x32x16_bf16 v[88:103], v[68:71], v[28:31], v[88:103]
    ds_read_b64_tr_b16 v[64:65], v2 offset:40960
    ds_read_b64_tr_b16 v[66:67], v2 offset:43008
    s_add_u32 m0, s23, 20224
    s_nop 0
    buffer_load_dwordx4 v4, s[8:11], s21 offen offset:256 lds
    s_add_u32 s21, s21, 36864
    s_waitcnt lgkmcnt(12)
    v_mfma_f32_32x32x16_bf16 v[104:119], v[40:43], v[28:31], v[104:119]
    ds_read_b64_tr_b16 v[68:69], v3 offset:40960
    ds_read_b64_tr_b16 v[70:71], v3 offset:43008
    s_waitcnt lgkmcnt(12)
    v_mfma_f32_32x32x16_bf16 v[120:135], v[44:47], v[28:31], v[120:135]
    ds_read_b64_tr_b16 v[40:41], v2 offset:45056
    ds_read_b64_tr_b16 v[42:43], v2 offset:47104
    s_waitcnt lgkmcnt(12)
    v_mfma_f32_32x32x16_bf16 v[136:151], v[48:51], v[28:31], v[136:151]
    ds_read_b64_tr_b16 v[44:45], v3 offset:45056
    ds_read_b64_tr_b16 v[46:47], v3 offset:47104
    s_waitcnt lgkmcnt(12)
    v_mfma_f32_32x32x16_bf16 v[152:167], v[52:55], v[28:31], v[152:167]
    ds_read_b64_tr_b16 v[48:49], v2 offset:37888
    ds_read_b64_tr_b16 v[50:51], v2 offset:39936
    buffer_load_dwordx4 v[28:31], v1, s[4:7], s22 offen
    s_add_u32 s22, s22, 1024
    s_sub_u32 s24, s24, 1
    s_cmp_eq_u32 s24, 0
    s_cbranch_scc1 L2_GE
    s_waitcnt lgkmcnt(12)
    s_waitcnt vmcnt(8)
    v_mfma_f32_32x32x16_bf16 v[72:87], v[56:59], v[32:35], v[72:87]
    ds_read_b64_tr_b16 v[52:53], v3 offset:37888
    ds_read_b64_tr_b16 v[54:55], v3 offset:39936
    s_waitcnt lgkmcnt(12)
    v_mfma_f32_32x32x16_bf16 v[88:103], v[60:63], v[32:35], v[88:103]
    ds_read_b64_tr_b16 v[56:57], v2 offset:41984
    ds_read_b64_tr_b16 v[58:59], v2 offset:44032
    s_waitcnt lgkmcnt(12)
    v_mfma_f32_32x32x16_bf16 v[104:119], v[64:67], v[32:35], v[104:119]
    ds_read_b64_tr_b16 v[60:61], v3 offset:41984
    ds_read_b64_tr_b16 v[62:63], v3 offset:44032
    s_waitcnt lgkmcnt(12)
    v_mfma_f32_32x32x16_bf16 v[120:135], v[68:71], v[32:35], v[120:135]
    ds_read_b64_tr_b16 v[64:65], v2 offset:46080
    ds_read_b64_tr_b16 v[66:67], v2 offset:48128
    s_waitcnt lgkmcnt(12)
    v_mfma_f32_32x32x16_bf16 v[136:151], v[40:43], v[32:35], v[136:151]
    ds_read_b64_tr_b16 v[68:69], v3 offset:46080
    ds_read_b64_tr_b16 v[70:71], v3 offset:48128
    s_waitcnt lgkmcnt(12)
    v_mfma_f32_32x32x16_bf16 v[152:167], v[44:47], v[32:35], v[152:167]
    s_waitcnt vmcnt(6)
    s_barrier
    ds_read_b64_tr_b16 v[40:41], v2 offset:0
    ds_read_b64_tr_b16 v[42:43], v2 offset:2048
    s_add_u32 m0, s23, 24576
    s_nop 0
    buffer_load_dwordx4 v4, s[8:11], s21 offen offset:0 lds
    buffer_load_dwordx4 v[32:35], v1, s[4:7], s22 offen
    s_add_u32 s22, s22, 1024
    s_waitcnt lgkmcnt(12)
    s_waitcnt vmcnt(7)
    v_mfma_f32_32x32x16_bf16 v[72:87], v[48:51], v[36:39], v[72:87]
    ds_read_b64_tr_b16 v[44:45], v3 offset:0
    ds_read_b64_tr_b16 v[46:47], v3 offset:2048
    s_add_u32 m0, s23, 28544
    s_nop 0
    buffer_load_dwordx4 v4, s[8:11], s21 offen offset:128 lds
    s_waitcnt lgkmcnt(12)
    v_mfma_f32_32x32x16_bf16 v[88:103], v[52:55], v[36:39], v[88:103]
    ds_read_b64_tr_b16 v[48:49], v2 offset:4096
    ds_read_b64_tr_b16 v[50:51], v2 offset:6144
    s_add_u32 m0, s23, 32512
    s_nop 0
    buffer_load_dwordx4 v4, s[8:11], s21 offen offset:256 lds
    s_add_u32 s21, s21, 36864
    s_waitcnt lgkmcnt(12)
    v_mfma_f32_32x32x16_bf16 v[104:119], v[56:59], v[36:39], v[104:119]
    ds_read_b64_tr_b16 v[52:53], v3 offset:4096
    ds_read_b64_tr_b16 v[54:55], v3 offset:6144
    s_waitcnt lgkmcnt(12)
    v_mfma_f32_32x32x16_bf16 v[120:135], v[60:63], v[36:39], v[120:135]
    ds_read_b64_tr_b16 v[56:57], v2 offset:8192
    ds_read_b64_tr_b16 v[58:59], v2 offset:10240
    s_waitcnt lgkmcnt(12)
    v_mfma_f32_32x32x16_bf16 v[136:151], v[64:67], v[36:39], v[136:151]
    ds_read_b64_tr_b16 v[60:61], v3 offset:8192
    ds_read_b64_tr_b16 v[62:63], v3 offset:10240
    s_waitcnt lgkmcnt(12)
    v_mfma_f32_32x32x16_bf16 v[152:167], v[68:71], v[36:39], v[152:167]
    ds_read_b64_tr_b16 v[64:65], v2 offset:1024
    ds_read_b64_tr_b16 v[66:67], v2 offset:3072
    buffer_load_dwordx4 v[36:39], v1, s[4:7], s22 offen
    s_add_u32 s22, s22, 1024
    s_sub_u32 s24, s24, 1
    s_cmp_eq_u32 s24, 0
    s_cbranch_scc1 L2_GE
    s_branch L2_GL
L2_GE:
    s_setprio 3
    s_lshr_b32 s34, s2, 3
    s_lshl_b32 s34, s34, 2
    s_add_u32 s34, s34, s20
    s_mul_i32 s34, s34, 5632
    s_add_u32 s34, s34, 28532736
    v_lshlrev_b32 v8, 3, v1
    s_mov_b32 exec_hi, 0xfff
    buffer_load_dword v9, v8, s[4:7], s34 offen
    s_mov_b32 exec_hi, -1
    v_cvt_pk_bf16_f32 v72, v72, v73
    v_cvt_pk_bf16_f32 v73, v74, v75
    v_cvt_pk_bf16_f32 v74, v76, v77
    v_cvt_pk_bf16_f32 v75, v78, v79
    v_cvt_pk_bf16_f32 v76, v80, v81
    v_cvt_pk_bf16_f32 v77, v82, v83
    v_cvt_pk_bf16_f32 v78, v84, v85
    v_cvt_pk_bf16_f32 v79, v86, v87
    buffer_store_dwordx4 v[72:75], v1, s[4:7], s25 offen offset:0 sc1
    buffer_store_dwordx4 v[76:79], v1, s[4:7], s25 offen offset:1024 sc1
    v_cvt_pk_bf16_f32 v88, v88, v89
    v_cvt_pk_bf16_f32 v89, v90, v91
    v_cvt_pk_bf16_f32 v90, v92, v93
    v_cvt_pk_bf16_f32 v91, v94, v95
    v_cvt_pk_bf16_f32 v92, v96, v97
    v_cvt_pk_bf16_f32 v93, v98, v99
    v_cvt_pk_bf16_f32 v94, v100, v101
    v_cvt_pk_bf16_f32 v95, v102, v103
    buffer_store_dwordx4 v[88:91], v1, s[4:7], s25 offen offset:2048 sc1
    buffer_store_dwordx4 v[92:95], v1, s[4:7], s25 offen offset:3072 sc1
    s_add_u32 s25, s25, 4096
    v_cvt_pk_bf16_f32 v104, v104, v105
    v_cvt_pk_bf16_f32 v105, v106, v107
    v_cvt_pk_bf16_f32 v106, v108, v109
    v_cvt_pk_bf16_f32 v107, v110, v111
    v_cvt_pk_bf16_f32 v108, v112, v113
    v_cvt_pk_bf16_f32 v109, v114, v115
    v_cvt_pk_bf16_f32 v110, v116, v117
    v_cvt_pk_bf16_f32 v111, v118, v119
    buffer_store_dwordx4 v[104:107], v1, s[4:7], s25 offen offset:0 sc1
    buffer_store_dwordx4 v[108:111], v1, s[4:7], s25 offen offset:1024 sc1
    v_cvt_pk_bf16_f32 v120, v120, v121
    v_cvt_pk_bf16_f32 v121, v122, v123
    v_cvt_pk_bf16_f32 v122, v124, v125
    v_cvt_pk_bf16_f32 v123, v126, v127
    v_cvt_pk_bf16_f32 v124, v128, v129
    v_cvt_pk_bf16_f32 v125, v130, v131
    v_cvt_pk_bf16_f32 v126, v132, v133
    v_cvt_pk_bf16_f32 v127, v134, v135
    buffer_store_dwordx4 v[120:123], v1, s[4:7], s25 offen offset:2048 sc1
    buffer_store_dwordx4 v[124:127], v1, s[4:7], s25 offen offset:3072 sc1
    s_add_u32 s25, s25, 4096
    v_cvt_pk_bf16_f32 v136, v136, v137
    v_cvt_pk_bf16_f32 v137, v138, v139
    v_cvt_pk_bf16_f32 v138, v140, v141
    v_cvt_pk_bf16_f32 v139, v142, v143
    v_cvt_pk_bf16_f32 v140, v144, v145
    v_cvt_pk_bf16_f32 v141, v146, v147
    v_cvt_pk_bf16_f32 v142, v148, v149
    v_cvt_pk_bf16_f32 v143, v150, v151
    buffer_store_dwordx4 v[136:139], v1, s[4:7], s25 offen offset:0 sc1
    buffer_store_dwordx4 v[140:143], v1, s[4:7], s25 offen offset:1024 sc1
    v_cvt_pk_bf16_f32 v152, v152, v153
    v_cvt_pk_bf16_f32 v153, v154, v155
    v_cvt_pk_bf16_f32 v154, v156, v157
    v_cvt_pk_bf16_f32 v155, v158, v159
    v_cvt_pk_bf16_f32 v156, v160, v161
    v_cvt_pk_bf16_f32 v157, v162, v163
    v_cvt_pk_bf16_f32 v158, v164, v165
    v_cvt_pk_bf16_f32 v159, v166, v167
    buffer_store_dwordx4 v[152:155], v1, s[4:7], s25 offen offset:2048 sc1
    buffer_store_dwordx4 v[156:159], v1, s[4:7], s25 offen offset:3072 sc1
    s_add_u32 s25, s25, 4096
    s_endpgm
L2_ATT:
    s_setprio 3
    s_sub_u32 s34, s2, 256
    s_and_b32 s35, s34, 7
    s_lshr_b32 s34, s34, 3
    s_lshl_b32 s34, s34, 1
    s_lshr_b32 s36, s20, 1
    s_add_u32 s34, s34, s36
    s_and_b32 s29, s20, 1
    s_lshr_b32 s36, s34, 4
    s_lshl_b32 s35, s35, 2
    s_add_u32 s32, s35, s36
    s_and_b32 s33, s34, 15
    v_lshlrev_b32 v1, 4, v0
    v_and_b32 v8, 31, v0
    v_lshrrev_b32 v9, 5, v0
    v_mul_u32_u24 v10, 9216, v9
    v_lshl_add_u32 v3, v8, 4, v10
    v_add_u32 v2, 18432, v3
    s_mov_b32 s30, 0x3ffff
    s_mov_b32 s31, 0x3ffff
    s_mul_i32 s34, s32, 9
    s_lshr_b32 s34, s34, 2
    s_lshl_b32 s34, s34, 9
    s_mul_i32 s35, s33, 147456
    s_add_u32 s35, s35, s34
    s_add_u32 s38, s35, 18874368
    s_add_u32 s39, s38, 36864
    s_add_u32 s40, s38, 73728
    s_add_u32 s41, s38, 110592
    s_mul_i32 s37, s29, 1179648
    s_add_u32 s24, s34, s37
    s_add_u32 s24, s24, 21233664
    s_mul_i32 s34, s32, 288
    s_add_u32 s26, s34, s37
    s_add_u32 s26, s26, 23592960
    s_mov_b32 s28, 1
    s_add_u32 s22, s24, 1179648
    s_add_u32 s25, s26, 1179648
    s_mul_i32 s34, s33, 0
    s_add_u32 s21, s34, s24
    s_add_u32 s23, s34, s26
    v_cmp_eq_u32 vcc, 18, v8
    v_mov_b32 v10, 0x3f803f80
    s_nop 0
    v_cndmask_b32 v11, 0, v10, vcc
    v_mov_b32 v128, 0
    v_mov_b32 v129, 0
    v_mov_b32 v130, 0
    v_mov_b32 v131, 0
    v_mov_b32 v132, 0
    v_mov_b32 v133, 0
    v_mov_b32 v134, 0
    v_mov_b32 v135, 0
    v_mov_b32 v140, v10
    v_mov_b32 v141, v10
    v_mov_b32 v142, 0
    v_mov_b32 v143, 0
    v_mov_b32 v156, v10
    v_mov_b32 v157, v10
    v_mov_b32 v158, 0
    v_mov_b32 v159, 0
    v_mov_b32 v172, v10
    v_mov_b32 v173, v10
    v_mov_b32 v174, 0
    v_mov_b32 v175, 0
    v_mov_b32 v188, v10
    v_mov_b32 v189, v10
    v_mov_b32 v190, 0
    v_mov_b32 v191, 0
    v_mfma_f32_32x32x16_bf16 v[28:43], v[132:135], v[132:135], 0
    v_mov_b32 v144, v11
    v_mov_b32 v145, v11
    v_mov_b32 v146, v11
    v_mov_b32 v147, v11
    v_mov_b32 v148, v11
    v_mov_b32 v149, v11
    v_mov_b32 v150, v11
    v_mov_b32 v151, v11
    v_mov_b32 v160, v11
    v_mov_b32 v161, v11
    v_mov_b32 v162, v11
    v_mov_b32 v163, v11
    v_mov_b32 v164, v11
    v_mov_b32 v165, v11
    v_mov_b32 v166, v11
    v_mov_b32 v167, v11
    v_mov_b32 v176, v11
    v_mov_b32 v177, v11
    v_mov_b32 v178, v11
    v_mov_b32 v179, v11
    v_mov_b32 v180, v11
    v_mov_b32 v181, v11
    v_mov_b32 v182, v11
    v_mov_b32 v183, v11
    s_waitcnt lgkmcnt(0)
    s_mov_b32 s4, s48
    s_mov_b32 s5, s49
    s_mov_b32 s6, 268435456
    s_mov_b32 s7, 0x00020000
    buffer_load_dwordx4 v[136:139], v1, s[4:7], s21 offen
    s_mov_b32 exec_hi, 0
    buffer_load_dwordx4 v[140:143], v1, s[4:7], s21 offen offset:1024
    s_mov_b32 exec_hi, -1
    s_add_u32 s21, s21, 36864
    buffer_load_dwordx4 v[12:15], v1, s[4:7], s38 offen
    buffer_load_dwordx4 v[16:19], v1, s[4:7], s39 offen
    buffer_load_dwordx4 v[20:23], v1, s[4:7], s40 offen
    buffer_load_dwordx4 v[24:27], v1, s[4:7], s41 offen
    s_mov_b32 exec_hi, 0
    buffer_load_dwordx4 v[28:31], v1, s[4:7], s38 offen offset:1024
    buffer_load_dwordx4 v[32:35], v1, s[4:7], s39 offen offset:1024
    buffer_load_dwordx4 v[36:39], v1, s[4:7], s40 offen offset:1024
    buffer_load_dwordx4 v[40:43], v1, s[4:7], s41 offen offset:1024
    s_mov_b64 exec, s[30:31]
    buffer_load_dwordx4 v[144:147], v3, s[4:7], s23 offen
    buffer_load_dwordx4 v[148:151], v2, s[4:7], s23 offen
    s_mov_b64 exec, -1
    s_add_u32 s23, s23, 36864
    buffer_load_dwordx4 v[152:155], v1, s[4:7], s21 offen
    s_mov_b32 exec_hi, 0
    buffer_load_dwordx4 v[156:159], v1, s[4:7], s21 offen offset:1024
    s_mov_b32 exec_hi, -1
    s_add_u32 s21, s21, 36864
    v_mov_b32 v192, v11
    v_mov_b32 v193, v11
    v_mov_b32 v194, v11
    v_mov_b32 v195, v11
    v_mov_b32 v196, v11
    v_mov_b32 v197, v11
    v_mov_b32 v198, v11
    v_mov_b32 v199, v11
    v_mov_b32 v92, 0
    v_mov_b32 v4, 0xff800000
    v_mov_b32 v93, 0
    v_mov_b32 v5, 0xff800000
    v_mov_b32 v94, 0
    v_mov_b32 v6, 0xff800000
    v_mov_b32 v95, 0
    v_mov_b32 v7, 0xff800000
    v_mfma_f32_32x32x16_bf16 v[44:59], v[132:135], v[132:135], 0
    v_mfma_f32_32x32x16_bf16 v[60:75], v[132:135], v[132:135], 0
    v_mfma_f32_32x32x16_bf16 v[76:91], v[132:135], v[132:135], 0
    s_waitcnt vmcnt(4)
    s_mov_b32 exec_hi, 0
    s_cmp_gt_u32 s36, 0
    s_cbranch_scc1 L2_Z0a
    v_mov_b32 v29, 0
    v_mov_b32 v33, 0
    v_mov_b32 v37, 0
    v_mov_b32 v41, 0
    s_branch L2_Z0b
L2_Z0a:
    v_mov_b32 v12, 0
    v_mov_b32 v16, 0
    v_mov_b32 v20, 0
    v_mov_b32 v24, 0
L2_Z0b:
    s_cmp_gt_u32 s36, 1
    s_cbranch_scc1 L2_Z1a
    v_mov_b32 v30, 0
    v_mov_b32 v34, 0
    v_mov_b32 v38, 0
    v_mov_b32 v42, 0
    s_branch L2_Z1b
L2_Z1a:
    v_mov_b32 v13, 0
    v_mov_b32 v17, 0
    v_mov_b32 v21, 0
    v_mov_b32 v25, 0
L2_Z1b:
    s_cmp_gt_u32 s36, 2
    s_cbranch_scc1 L2_Z2a
    v_mov_b32 v31, 0
    v_mov_b32 v35, 0
    v_mov_b32 v39, 0
    v_mov_b32 v43, 0
    s_branch L2_Z2b
L2_Z2a:
    v_mov_b32 v14, 0
    v_mov_b32 v18, 0
    v_mov_b32 v22, 0
    v_mov_b32 v26, 0
L2_Z2b:
    s_mov_b32 exec_hi, -1
    v_mfma_f32_32x32x16_bf16 v[96:111], v[136:139], v[12:15], 0
    v_mfma_f32_32x32x16_bf16 v[96:111], v[140:143], v[28:31], v[96:111]
    v_mfma_f32_32x32x16_bf16 v[112:127], v[136:139], v[16:19], 0
    v_mfma_f32_32x32x16_bf16 v[112:127], v[140:143], v[32:35], v[112:127]
    s_mov_b64 exec, s[30:31]
    buffer_load_dwordx4 v[160:163], v3, s[4:7], s23 offen
    buffer_load_dwordx4 v[164:167], v2, s[4:7], s23 offen
    s_mov_b64 exec, -1
    s_add_u32 s23, s23, 36864
    buffer_load_dwordx4 v[168:171], v1, s[4:7], s21 offen
    s_mov_b32 exec_hi, 0
    buffer_load_dwordx4 v[172:175], v1, s[4:7], s21 offen offset:1024
    s_mov_b32 exec_hi, -1
    s_add_u32 s21, s21, 36864
    v_max3_f32 v4, v96, v97, v4
    v_max3_f32 v4, v98, v99, v4
    v_max3_f32 v4, v100, v101, v4
    v_max3_f32 v4, v102, v103, v4
    v_max3_f32 v4, v104, v105, v4
    v_max3_f32 v4, v106, v107, v4
    v_max3_f32 v4, v108, v109, v4
    v_max3_f32 v4, v110, v111, v4
    v_mfma_f32_32x32x16_bf16 v[96:111], v[136:139], v[20:23], 0
    v_mfma_f32_32x32x16_bf16 v[96:111], v[140:143], v[36:39], v[96:111]
    v_max3_f32 v5, v112, v113, v5
    v_max3_f32 v5, v114, v115, v5
    v_max3_f32 v5, v116, v117, v5
    v_max3_f32 v5, v118, v119, v5
    v_max3_f32 v5, v120, v121, v5
    v_max3_f32 v5, v122, v123, v5
    v_max3_f32 v5, v124, v125, v5
    v_max3_f32 v5, v126, v127, v5
    v_mfma_f32_32x32x16_bf16 v[112:127], v[136:139], v[24:27], 0
    v_mfma_f32_32x32x16_bf16 v[112:127], v[140:143], v[40:43], v[112:127]
    s_nop 1
    v_max3_f32 v6, v96, v97, v6
    v_max3_f32 v6, v98, v99, v6
    v_max3_f32 v6, v100, v101, v6
    v_max3_f32 v6, v102, v103, v6
    v_max3_f32 v6, v104, v105, v6
    v_max3_f32 v6, v106, v107, v6
    v_max3_f32 v6, v108, v109, v6
    v_max3_f32 v6, v110, v111, v6
    s_nop 1
    v_max3_f32 v7, v112, v113, v7
    v_max3_f32 v7, v114, v115, v7
    v_max3_f32 v7, v116, v117, v7
    v_max3_f32 v7, v118, v119, v7
    v_max3_f32 v7, v120, v121, v7
    v_max3_f32 v7, v122, v123, v7
    v_max3_f32 v7, v124, v125, v7
    v_max3_f32 v7, v126, v127, v7
    s_mov_b32 exec_lo, 0
    v_and_b32 v4, 0xffff0000, v4
    v_lshrrev_b32 v8, 16, v4
    v_xor_b32 v28, 0x8000, v8
    v_and_b32 v5, 0xffff0000, v5
    v_lshrrev_b32 v8, 16, v5
    v_xor_b32 v32, 0x8000, v8
    v_and_b32 v6, 0xffff0000, v6
    v_lshrrev_b32 v8, 16, v6
    v_xor_b32 v36, 0x8000, v8
    v_and_b32 v7, 0xffff0000, v7
    v_lshrrev_b32 v8, 16, v7
    v_xor_b32 v40, 0x8000, v8
    s_mov_b32 exec_lo, -1
    v_mfma_f32_32x32x16_bf16 v[96:111], v[136:139], v[12:15], 0
    v_mfma_f32_32x32x16_bf16 v[96:111], v[140:143], v[28:31], v[96:111]
    s_mov_b64 exec, s[30:31]
    buffer_load_dwordx4 v[176:179], v3, s[4:7], s23 offen
    buffer_load_dwordx4 v[180:183], v2, s[4:7], s23 offen
    s_mov_b64 exec, -1
    s_add_u32 s23, s23, 36864
    buffer_load_dwordx4 v[184:187], v1, s[4:7], s21 offen
    s_mov_b32 exec_hi, 0
    buffer_load_dwordx4 v[188:191], v1, s[4:7], s21 offen offset:1024
    s_mov_b32 exec_hi, -1
    s_add_u32 s21, s21, 36864
L2_GO:
    s_mov_b32 s27, 7
L2_AL:
    v_mfma_f32_32x32x16_bf16 v[80:95], v[192:195], v[128:131], v[80:95]
    v_exp_f32 v96, v96
    v_exp_f32 v97, v97
    v_exp_f32 v98, v98
    v_mfma_f32_32x32x16_bf16 v[80:95], v[196:199], v[132:135], v[80:95]
    v_exp_f32 v99, v99
    v_cvt_pk_bf16_f32 v128, v96, v97
    v_exp_f32 v100, v100
    v_cvt_pk_bf16_f32 v129, v98, v99
    v_mfma_f32_32x32x16_bf16 v[112:127], v[136:139], v[16:19], 0
    v_exp_f32 v101, v101
    v_exp_f32 v102, v102
    v_exp_f32 v103, v103
    v_mfma_f32_32x32x16_bf16 v[112:127], v[140:143], v[32:35], v[112:127]
    v_cvt_pk_bf16_f32 v130, v100, v101
    v_exp_f32 v104, v104
    v_cvt_pk_bf16_f32 v131, v102, v103
    v_exp_f32 v105, v105
    s_mov_b64 exec, s[30:31]
    buffer_load_dwordx4 v[192:195], v3, s[4:7], s23 offen
    buffer_load_dwordx4 v[196:199], v2, s[4:7], s23 offen
    s_mov_b64 exec, -1
    s_add_u32 s23, s23, 36864
    v_exp_f32 v106, v106
    v_cvt_pk_bf16_f32 v132, v104, v105
    v_exp_f32 v107, v107
    v_exp_f32 v108, v108
    v_cvt_pk_bf16_f32 v133, v106, v107
    v_exp_f32 v109, v109
    v_exp_f32 v110, v110
    v_exp_f32 v111, v111
    s_waitcnt vmcnt(12)
    v_cvt_pk_bf16_f32 v134, v108, v109
    v_cvt_pk_bf16_f32 v135, v110, v111
    v_mfma_f32_32x32x16_bf16 v[44:59], v[144:147], v[128:131], v[44:59]
    v_exp_f32 v112, v112
    v_exp_f32 v113, v113
    v_exp_f32 v114, v114
    v_mfma_f32_32x32x16_bf16 v[44:59], v[148:151], v[132:135], v[44:59]
    v_exp_f32 v115, v115
    v_cvt_pk_bf16_f32 v128, v112, v113
    v_exp_f32 v116, v116
    v_cvt_pk_bf16_f32 v129, v114, v115
    v_mfma_f32_32x32x16_bf16 v[96:111], v[136:139], v[20:23], 0
    v_exp_f32 v117, v117
    v_exp_f32 v118, v118
    v_exp_f32 v119, v119
    v_mfma_f32_32x32x16_bf16 v[96:111], v[140:143], v[36:39], v[96:111]
    v_cvt_pk_bf16_f32 v130, v116, v117
    v_exp_f32 v120, v120
    v_cvt_pk_bf16_f32 v131, v118, v119
    v_exp_f32 v121, v121
    v_exp_f32 v122, v122
    v_cvt_pk_bf16_f32 v132, v120, v121
    v_exp_f32 v123, v123
    v_exp_f32 v124, v124
    v_cvt_pk_bf16_f32 v133, v122, v123
    v_exp_f32 v125, v125
    v_exp_f32 v126, v126
    v_exp_f32 v127, v127
    v_cvt_pk_bf16_f32 v134, v124, v125
    v_cvt_pk_bf16_f32 v135, v126, v127
    v_mfma_f32_32x32x16_bf16 v[56:71], v[144:147], v[128:131], v[56:71]
    v_exp_f32 v96, v96
    v_exp_f32 v97, v97
    v_exp_f32 v98, v98
    v_mfma_f32_32x32x16_bf16 v[56:71], v[148:151], v[132:135], v[56:71]
    v_exp_f32 v99, v99
    v_cvt_pk_bf16_f32 v128, v96, v97
    v_exp_f32 v100, v100
    v_cvt_pk_bf16_f32 v129, v98, v99
    v_mfma_f32_32x32x16_bf16 v[112:127], v[136:139], v[24:27], 0
    v_exp_f32 v101, v101
    v_exp_f32 v102, v102
    v_exp_f32 v103, v103
    v_mfma_f32_32x32x16_bf16 v[112:127], v[140:143], v[40:43], v[112:127]
    v_cvt_pk_bf16_f32 v130, v100, v101
    v_exp_f32 v104, v104
    v_cvt_pk_bf16_f32 v131, v102, v103
    v_exp_f32 v105, v105
    buffer_load_dwordx4 v[136:139], v1, s[4:7], s21 offen
    s_mov_b32 exec_hi, 0
    buffer_load_dwordx4 v[140:143], v1, s[4:7], s21 offen offset:1024
    s_mov_b32 exec_hi, -1
    s_add_u32 s21, s21, 36864
    v_exp_f32 v106, v106
    v_cvt_pk_bf16_f32 v132, v104, v105
    v_exp_f32 v107, v107
    v_exp_f32 v108, v108
    v_cvt_pk_bf16_f32 v133, v106, v107
    v_exp_f32 v109, v109
    v_exp_f32 v110, v110
    v_exp_f32 v111, v111
    s_waitcnt vmcnt(12)
    v_cvt_pk_bf16_f32 v134, v108, v109
    v_cvt_pk_bf16_f32 v135, v110, v111
    v_mfma_f32_32x32x16_bf16 v[68:83], v[144:147], v[128:131], v[68:83]
    v_exp_f32 v112, v112
    v_exp_f32 v113, v113
    v_exp_f32 v114, v114
    v_mfma_f32_32x32x16_bf16 v[68:83], v[148:151], v[132:135], v[68:83]
    v_exp_f32 v115, v115
    v_cvt_pk_bf16_f32 v128, v112, v113
    v_exp_f32 v116, v116
    v_cvt_pk_bf16_f32 v129, v114, v115
    v_mfma_f32_32x32x16_bf16 v[96:111], v[152:155], v[12:15], 0
    v_exp_f32 v117, v117
    v_exp_f32 v118, v118
    v_exp_f32 v119, v119
    v_mfma_f32_32x32x16_bf16 v[96:111], v[156:159], v[28:31], v[96:111]
    v_cvt_pk_bf16_f32 v130, v116, v117
    v_exp_f32 v120, v120
    v_cvt_pk_bf16_f32 v131, v118, v119
    v_exp_f32 v121, v121
    v_exp_f32 v122, v122
    v_cvt_pk_bf16_f32 v132, v120, v121
    v_exp_f32 v123, v123
    v_exp_f32 v124, v124
    v_cvt_pk_bf16_f32 v133, v122, v123
    v_exp_f32 v125, v125
    v_exp_f32 v126, v126
    v_exp_f32 v127, v127
    v_cvt_pk_bf16_f32 v134, v124, v125
    v_cvt_pk_bf16_f32 v135, v126, v127
    v_mfma_f32_32x32x16_bf16 v[80:95], v[144:147], v[128:131], v[80:95]
    v_exp_f32 v96, v96
    v_exp_f32 v97, v97
    v_exp_f32 v98, v98
    v_mfma_f32_32x32x16_bf16 v[80:95], v[148:151], v[132:135], v[80:95]
    v_exp_f32 v99, v99
    v_cvt_pk_bf16_f32 v128, v96, v97
    v_exp_f32 v100, v100
    v_cvt_pk_bf16_f32 v129, v98, v99
    v_mfma_f32_32x32x16_bf16 v[112:127], v[152:155], v[16:19], 0
    v_exp_f32 v101, v101
    v_exp_f32 v102, v102
    v_exp_f32 v103, v103
    v_mfma_f32_32x32x16_bf16 v[112:127], v[156:159], v[32:35], v[112:127]
    v_cvt_pk_bf16_f32 v130, v100, v101
    v_exp_f32 v104, v104
    v_cvt_pk_bf16_f32 v131, v102, v103
    v_exp_f32 v105, v105
    s_mov_b64 exec, s[30:31]
    buffer_load_dwordx4 v[144:147], v3, s[4:7], s23 offen
    buffer_load_dwordx4 v[148:151], v2, s[4:7], s23 offen
    s_mov_b64 exec, -1
    s_add_u32 s23, s23, 36864
    v_exp_f32 v106, v106
    v_cvt_pk_bf16_f32 v132, v104, v105
    v_exp_f32 v107, v107
    v_exp_f32 v108, v108
    v_cvt_pk_bf16_f32 v133, v106, v107
    v_exp_f32 v109, v109
    v_exp_f32 v110, v110
    v_exp_f32 v111, v111
    s_waitcnt vmcnt(12)
    v_cvt_pk_bf16_f32 v134, v108, v109
    v_cvt_pk_bf16_f32 v135, v110, v111
    v_mfma_f32_32x32x16_bf16 v[44:59], v[160:163], v[128:131], v[44:59]
    v_exp_f32 v112, v112
    v_exp_f32 v113, v113
    v_exp_f32 v114, v114
    v_mfma_f32_32x32x16_bf16 v[44:59], v[164:167], v[132:135], v[44:59]
    v_exp_f32 v115, v115
    v_cvt_pk_bf16_f32 v128, v112, v113
    v_exp_f32 v116, v116
    v_cvt_pk_bf16_f32 v129, v114, v115
    v_mfma_f32_32x32x16_bf16 v[96:111], v[152:155], v[20:23], 0
    v_exp_f32 v117, v117
    v_exp_f32 v118, v118
    v_exp_f32 v119, v119
    v_mfma_f32_32x32x16_bf16 v[96:111], v[156:159], v[36:39], v[96:111]
    v_cvt_pk_bf16_f32 v130, v116, v117
    v_exp_f32 v120, v120
    v_cvt_pk_bf16_f32 v131, v118, v119
    v_exp_f32 v121, v121
    v_exp_f32 v122, v122
    v_cvt_pk_bf16_f32 v132, v120, v121
    v_exp_f32 v123, v123
    v_exp_f32 v124, v124
    v_cvt_pk_bf16_f32 v133, v122, v123
    v_exp_f32 v125, v125
    v_exp_f32 v126, v126
    v_exp_f32 v127, v127
    v_cvt_pk_bf16_f32 v134, v124, v125
    v_cvt_pk_bf16_f32 v135, v126, v127
    v_mfma_f32_32x32x16_bf16 v[56:71], v[160:163], v[128:131], v[56:71]
    v_exp_f32 v96, v96
    v_exp_f32 v97, v97
    v_exp_f32 v98, v98
    v_mfma_f32_32x32x16_bf16 v[56:71], v[164:167], v[132:135], v[56:71]
    v_exp_f32 v99, v99
    v_cvt_pk_bf16_f32 v128, v96, v97
    v_exp_f32 v100, v100
    v_cvt_pk_bf16_f32 v129, v98, v99
    v_mfma_f32_32x32x16_bf16 v[112:127], v[152:155], v[24:27], 0
    v_exp_f32 v101, v101
    v_exp_f32 v102, v102
    v_exp_f32 v103, v103
    v_mfma_f32_32x32x16_bf16 v[112:127], v[156:159], v[40:43], v[112:127]
    v_cvt_pk_bf16_f32 v130, v100, v101
    v_exp_f32 v104, v104
    v_cvt_pk_bf16_f32 v131, v102, v103
    v_exp_f32 v105, v105
    buffer_load_dwordx4 v[152:155], v1, s[4:7], s21 offen
    s_mov_b32 exec_hi, 0
    buffer_load_dwordx4 v[156:159], v1, s[4:7], s21 offen offset:1024
    s_mov_b32 exec_hi, -1
    s_add_u32 s21, s21, 36864
    v_exp_f32 v106, v106
    v_cvt_pk_bf16_f32 v132, v104, v105
    v_exp_f32 v107, v107
    v_exp_f32 v108, v108
    v_cvt_pk_bf16_f32 v133, v106, v107
    v_exp_f32 v109, v109
    v_exp_f32 v110, v110
    v_exp_f32 v111, v111
    s_waitcnt vmcnt(12)
    v_cvt_pk_bf16_f32 v134, v108, v109
    v_cvt_pk_bf16_f32 v135, v110, v111
    v_mfma_f32_32x32x16_bf16 v[68:83], v[160:163], v[128:131], v[68:83]
    v_exp_f32 v112, v112
    v_exp_f32 v113, v113
    v_exp_f32 v114, v114
    v_mfma_f32_32x32x16_bf16 v[68:83], v[164:167], v[132:135], v[68:83]
    v_exp_f32 v115, v115
    v_cvt_pk_bf16_f32 v128, v112, v113
    v_exp_f32 v116, v116
    v_cvt_pk_bf16_f32 v129, v114, v115
    v_mfma_f32_32x32x16_bf16 v[96:111], v[168:171], v[12:15], 0
    v_exp_f32 v117, v117
    v_exp_f32 v118, v118
    v_exp_f32 v119, v119
    v_mfma_f32_32x32x16_bf16 v[96:111], v[172:175], v[28:31], v[96:111]
    v_cvt_pk_bf16_f32 v130, v116, v117
    v_exp_f32 v120, v120
    v_cvt_pk_bf16_f32 v131, v118, v119
    v_exp_f32 v121, v121
    v_exp_f32 v122, v122
    v_cvt_pk_bf16_f32 v132, v120, v121
    v_exp_f32 v123, v123
    v_exp_f32 v124, v124
    v_cvt_pk_bf16_f32 v133, v122, v123
    v_exp_f32 v125, v125
    v_exp_f32 v126, v126
    v_exp_f32 v127, v127
    v_cvt_pk_bf16_f32 v134, v124, v125
    v_cvt_pk_bf16_f32 v135, v126, v127
    v_mfma_f32_32x32x16_bf16 v[80:95], v[160:163], v[128:131], v[80:95]
    v_exp_f32 v96, v96
    v_exp_f32 v97, v97
    v_exp_f32 v98, v98
    v_mfma_f32_32x32x16_bf16 v[80:95], v[164:167], v[132:135], v[80:95]
    v_exp_f32 v99, v99
    v_cvt_pk_bf16_f32 v128, v96, v97
    v_exp_f32 v100, v100
    v_cvt_pk_bf16_f32 v129, v98, v99
    v_mfma_f32_32x32x16_bf16 v[112:127], v[168:171], v[16:19], 0
    v_exp_f32 v101, v101
    v_exp_f32 v102, v102
    v_exp_f32 v103, v103
    v_mfma_f32_32x32x16_bf16 v[112:127], v[172:175], v[32:35], v[112:127]
    v_cvt_pk_bf16_f32 v130, v100, v101
    v_exp_f32 v104, v104
    v_cvt_pk_bf16_f32 v131, v102, v103
    v_exp_f32 v105, v105
    s_mov_b64 exec, s[30:31]
    buffer_load_dwordx4 v[160:163], v3, s[4:7], s23 offen
    buffer_load_dwordx4 v[164:167], v2, s[4:7], s23 offen
    s_mov_b64 exec, -1
    s_add_u32 s23, s23, 36864
    v_exp_f32 v106, v106
    v_cvt_pk_bf16_f32 v132, v104, v105
    v_exp_f32 v107, v107
    v_exp_f32 v108, v108
    v_cvt_pk_bf16_f32 v133, v106, v107
    v_exp_f32 v109, v109
    v_exp_f32 v110, v110
    v_exp_f32 v111, v111
    s_waitcnt vmcnt(12)
    v_cvt_pk_bf16_f32 v134, v108, v109
    v_cvt_pk_bf16_f32 v135, v110, v111
    v_mfma_f32_32x32x16_bf16 v[44:59], v[176:179], v[128:131], v[44:59]
    v_exp_f32 v112, v112
    v_exp_f32 v113, v113
    v_exp_f32 v114, v114
    v_mfma_f32_32x32x16_bf16 v[44:59], v[180:183], v[132:135], v[44:59]
    v_exp_f32 v115, v115
    v_cvt_pk_bf16_f32 v128, v112, v113
    v_exp_f32 v116, v116
    v_cvt_pk_bf16_f32 v129, v114, v115
    v_mfma_f32_32x32x16_bf16 v[96:111], v[168:171], v[20:23], 0
    v_exp_f32 v117, v117
    v_exp_f32 v118, v118
    v_exp_f32 v119, v119
    v_mfma_f32_32x32x16_bf16 v[96:111], v[172:175], v[36:39], v[96:111]
    v_cvt_pk_bf16_f32 v130, v116, v117
    v_exp_f32 v120, v120
    v_cvt_pk_bf16_f32 v131, v118, v119
    v_exp_f32 v121, v121
    v_exp_f32 v122, v122
    v_cvt_pk_bf16_f32 v132, v120, v121
    v_exp_f32 v123, v123
    v_exp_f32 v124, v124
    v_cvt_pk_bf16_f32 v133, v122, v123
    v_exp_f32 v125, v125
    v_exp_f32 v126, v126
    v_exp_f32 v127, v127
    v_cvt_pk_bf16_f32 v134, v124, v125
    v_cvt_pk_bf16_f32 v135, v126, v127
    v_mfma_f32_32x32x16_bf16 v[56:71], v[176:179], v[128:131], v[56:71]
    v_exp_f32 v96, v96
    v_exp_f32 v97, v97
    v_exp_f32 v98, v98
    v_mfma_f32_32x32x16_bf16 v[56:71], v[180:183], v[132:135], v[56:71]
    v_exp_f32 v99, v99
    v_cvt_pk_bf16_f32 v128, v96, v97
    v_exp_f32 v100, v100
    v_cvt_pk_bf16_f32 v129, v98, v99
    v_mfma_f32_32x32x16_bf16 v[112:127], v[168:171], v[24:27], 0
    v_exp_f32 v101, v101
    v_exp_f32 v102, v102
    v_exp_f32 v103, v103
    v_mfma_f32_32x32x16_bf16 v[112:127], v[172:175], v[40:43], v[112:127]
    v_cvt_pk_bf16_f32 v130, v100, v101
    v_exp_f32 v104, v104
    v_cvt_pk_bf16_f32 v131, v102, v103
    v_exp_f32 v105, v105
    buffer_load_dwordx4 v[168:171], v1, s[4:7], s21 offen
    s_mov_b32 exec_hi, 0
    buffer_load_dwordx4 v[172:175], v1, s[4:7], s21 offen offset:1024
    s_mov_b32 exec_hi, -1
    s_add_u32 s21, s21, 36864
    v_exp_f32 v106, v106
    v_cvt_pk_bf16_f32 v132, v104, v105
    v_exp_f32 v107, v107
    v_exp_f32 v108, v108
    v_cvt_pk_bf16_f32 v133, v106, v107
    v_exp_f32 v109, v109
    v_exp_f32 v110, v110
    v_exp_f32 v111, v111
    s_waitcnt vmcnt(12)
    v_cvt_pk_bf16_f32 v134, v108, v109
    v_cvt_pk_bf16_f32 v135, v110, v111
    v_mfma_f32_32x32x16_bf16 v[68:83], v[176:179], v[128:131], v[68:83]
    v_exp_f32 v112, v112
    v_exp_f32 v113, v113
    v_exp_f32 v114, v114
    v_mfma_f32_32x32x16_bf16 v[68:83], v[180:183], v[132:135], v[68:83]
    v_exp_f32 v115, v115
    v_cvt_pk_bf16_f32 v128, v112, v113
    v_exp_f32 v116, v116
    v_cvt_pk_bf16_f32 v129, v114, v115
    v_mfma_f32_32x32x16_bf16 v[96:111], v[184:187], v[12:15], 0
    v_exp_f32 v117, v117
    v_exp_f32 v118, v118
    v_exp_f32 v119, v119
    v_mfma_f32_32x32x16_bf16 v[96:111], v[188:191], v[28:31], v[96:111]
    v_cvt_pk_bf16_f32 v130, v116, v117
    v_exp_f32 v120, v120
    v_cvt_pk_bf16_f32 v131, v118, v119
    v_exp_f32 v121, v121
    v_exp_f32 v122, v122
    v_cvt_pk_bf16_f32 v132, v120, v121
    v_exp_f32 v123, v123
    v_exp_f32 v124, v124
    v_cvt_pk_bf16_f32 v133, v122, v123
    v_exp_f32 v125, v125
    v_exp_f32 v126, v126
    v_exp_f32 v127, v127
    v_cvt_pk_bf16_f32 v134, v124, v125
    v_cvt_pk_bf16_f32 v135, v126, v127
    v_mfma_f32_32x32x16_bf16 v[80:95], v[176:179], v[128:131], v[80:95]
    v_exp_f32 v96, v96
    v_exp_f32 v97, v97
    v_exp_f32 v98, v98
    v_mfma_f32_32x32x16_bf16 v[80:95], v[180:183], v[132:135], v[80:95]
    v_exp_f32 v99, v99
    v_cvt_pk_bf16_f32 v128, v96, v97
    v_exp_f32 v100, v100
    v_cvt_pk_bf16_f32 v129, v98, v99
    v_mfma_f32_32x32x16_bf16 v[112:127], v[184:187], v[16:19], 0
    v_exp_f32 v101, v101
    v_exp_f32 v102, v102
    v_exp_f32 v103, v103
    v_mfma_f32_32x32x16_bf16 v[112:127], v[188:191], v[32:35], v[112:127]
    v_cvt_pk_bf16_f32 v130, v100, v101
    v_exp_f32 v104, v104
    v_cvt_pk_bf16_f32 v131, v102, v103
    v_exp_f32 v105, v105
    s_mov_b64 exec, s[30:31]
    buffer_load_dwordx4 v[176:179], v3, s[4:7], s23 offen
    buffer_load_dwordx4 v[180:183], v2, s[4:7], s23 offen
    s_mov_b64 exec, -1
    s_add_u32 s23, s23, 36864
    v_exp_f32 v106, v106
    v_cvt_pk_bf16_f32 v132, v104, v105
    v_exp_f32 v107, v107
    v_exp_f32 v108, v108
    v_cvt_pk_bf16_f32 v133, v106, v107
    v_exp_f32 v109, v109
    v_exp_f32 v110, v110
    v_exp_f32 v111, v111
    s_waitcnt vmcnt(12)
    v_cvt_pk_bf16_f32 v134, v108, v109
    v_cvt_pk_bf16_f32 v135, v110, v111
    v_mfma_f32_32x32x16_bf16 v[44:59], v[192:195], v[128:131], v[44:59]
    v_exp_f32 v112, v112
    v_exp_f32 v113, v113
    v_exp_f32 v114, v114
    v_mfma_f32_32x32x16_bf16 v[44:59], v[196:199], v[132:135], v[44:59]
    v_exp_f32 v115, v115
    v_cvt_pk_bf16_f32 v128, v112, v113
    v_exp_f32 v116, v116
    v_cvt_pk_bf16_f32 v129, v114, v115
    v_mfma_f32_32x32x16_bf16 v[96:111], v[184:187], v[20:23], 0
    v_exp_f32 v117, v117
    v_exp_f32 v118, v118
    v_exp_f32 v119, v119
    v_mfma_f32_32x32x16_bf16 v[96:111], v[188:191], v[36:39], v[96:111]
    v_cvt_pk_bf16_f32 v130, v116, v117
    v_exp_f32 v120, v120
    v_cvt_pk_bf16_f32 v131, v118, v119
    v_exp_f32 v121, v121
    v_exp_f32 v122, v122
    v_cvt_pk_bf16_f32 v132, v120, v121
    v_exp_f32 v123, v123
    v_exp_f32 v124, v124
    v_cvt_pk_bf16_f32 v133, v122, v123
    v_exp_f32 v125, v125
    v_exp_f32 v126, v126
    v_exp_f32 v127, v127
    v_cvt_pk_bf16_f32 v134, v124, v125
    v_cvt_pk_bf16_f32 v135, v126, v127
    v_mfma_f32_32x32x16_bf16 v[56:71], v[192:195], v[128:131], v[56:71]
    v_exp_f32 v96, v96
    v_exp_f32 v97, v97
    v_exp_f32 v98, v98
    v_mfma_f32_32x32x16_bf16 v[56:71], v[196:199], v[132:135], v[56:71]
    v_exp_f32 v99, v99
    v_cvt_pk_bf16_f32 v128, v96, v97
    v_exp_f32 v100, v100
    v_cvt_pk_bf16_f32 v129, v98, v99
    v_mfma_f32_32x32x16_bf16 v[112:127], v[184:187], v[24:27], 0
    v_exp_f32 v101, v101
    v_exp_f32 v102, v102
    v_exp_f32 v103, v103
    v_mfma_f32_32x32x16_bf16 v[112:127], v[188:191], v[40:43], v[112:127]
    v_cvt_pk_bf16_f32 v130, v100, v101
    v_exp_f32 v104, v104
    v_cvt_pk_bf16_f32 v131, v102, v103
    v_exp_f32 v105, v105
    buffer_load_dwordx4 v[184:187], v1, s[4:7], s21 offen
    s_mov_b32 exec_hi, 0
    buffer_load_dwordx4 v[188:191], v1, s[4:7], s21 offen offset:1024
    s_mov_b32 exec_hi, -1
    s_add_u32 s21, s21, 36864
    v_exp_f32 v106, v106
    v_cvt_pk_bf16_f32 v132, v104, v105
    v_exp_f32 v107, v107
    v_exp_f32 v108, v108
    v_cvt_pk_bf16_f32 v133, v106, v107
    v_exp_f32 v109, v109
    v_exp_f32 v110, v110
    v_exp_f32 v111, v111
    s_waitcnt vmcnt(12)
    v_cvt_pk_bf16_f32 v134, v108, v109
    v_cvt_pk_bf16_f32 v135, v110, v111
    v_mfma_f32_32x32x16_bf16 v[68:83], v[192:195], v[128:131], v[68:83]
    v_exp_f32 v112, v112
    v_exp_f32 v113, v113
    v_exp_f32 v114, v114
    v_mfma_f32_32x32x16_bf16 v[68:83], v[196:199], v[132:135], v[68:83]
    v_exp_f32 v115, v115
    v_cvt_pk_bf16_f32 v128, v112, v113
    v_exp_f32 v116, v116
    v_cvt_pk_bf16_f32 v129, v114, v115
    v_mfma_f32_32x32x16_bf16 v[96:111], v[136:139], v[12:15], 0
    v_exp_f32 v117, v117
    v_exp_f32 v118, v118
    v_exp_f32 v119, v119
    v_mfma_f32_32x32x16_bf16 v[96:111], v[140:143], v[28:31], v[96:111]
    v_cvt_pk_bf16_f32 v130, v116, v117
    v_exp_f32 v120, v120
    v_cvt_pk_bf16_f32 v131, v118, v119
    v_exp_f32 v121, v121
    v_exp_f32 v122, v122
    v_cvt_pk_bf16_f32 v132, v120, v121
    v_exp_f32 v123, v123
    v_exp_f32 v124, v124
    v_cvt_pk_bf16_f32 v133, v122, v123
    v_exp_f32 v125, v125
    v_exp_f32 v126, v126
    v_exp_f32 v127, v127
    v_cvt_pk_bf16_f32 v134, v124, v125
    v_cvt_pk_bf16_f32 v135, v126, v127
    s_sub_u32 s27, s27, 1
    s_cmp_lg_u32 s27, 0
    s_cbranch_scc1 L2_AL
    s_setprio 3
    v_mfma_f32_32x32x16_bf16 v[80:95], v[192:195], v[128:131], v[80:95]
    v_exp_f32 v96, v96
    v_exp_f32 v97, v97
    v_exp_f32 v98, v98
    v_mfma_f32_32x32x16_bf16 v[80:95], v[196:199], v[132:135], v[80:95]
    v_exp_f32 v99, v99
    v_cvt_pk_bf16_f32 v128, v96, v97
    v_exp_f32 v100, v100
    v_cvt_pk_bf16_f32 v129, v98, v99
    v_mfma_f32_32x32x16_bf16 v[112:127], v[136:139], v[16:19], 0
    v_exp_f32 v101, v101
    v_exp_f32 v102, v102
    v_exp_f32 v103, v103
    v_mfma_f32_32x32x16_bf16 v[112:127], v[140:143], v[32:35], v[112:127]
    v_cvt_pk_bf16_f32 v130, v100, v101
    v_exp_f32 v104, v104
    v_cvt_pk_bf16_f32 v131, v102, v103
    v_exp_f32 v105, v105
    s_mov_b64 exec, s[30:31]
    buffer_load_dwordx4 v[192:195], v3, s[4:7], s23 offen
    buffer_load_dwordx4 v[196:199], v2, s[4:7], s23 offen
    s_mov_b64 exec, -1
    s_add_u32 s23, s23, 36864
    v_exp_f32 v106, v106
    v_cvt_pk_bf16_f32 v132, v104, v105
    v_exp_f32 v107, v107
    v_exp_f32 v108, v108
    v_cvt_pk_bf16_f32 v133, v106, v107
    v_exp_f32 v109, v109
    v_exp_f32 v110, v110
    v_exp_f32 v111, v111
    s_waitcnt vmcnt(12)
    v_cvt_pk_bf16_f32 v134, v108, v109
    v_cvt_pk_bf16_f32 v135, v110, v111
    v_mfma_f32_32x32x16_bf16 v[44:59], v[144:147], v[128:131], v[44:59]
    v_exp_f32 v112, v112
    v_exp_f32 v113, v113
    v_exp_f32 v114, v114
    v_mfma_f32_32x32x16_bf16 v[44:59], v[148:151], v[132:135], v[44:59]
    v_exp_f32 v115, v115
    v_cvt_pk_bf16_f32 v128, v112, v113
    v_exp_f32 v116, v116
    v_cvt_pk_bf16_f32 v129, v114, v115
    v_mfma_f32_32x32x16_bf16 v[96:111], v[136:139], v[20:23], 0
    v_exp_f32 v117, v117
    v_exp_f32 v118, v118
    v_exp_f32 v119, v119
    v_mfma_f32_32x32x16_bf16 v[96:111], v[140:143], v[36:39], v[96:111]
    v_cvt_pk_bf16_f32 v130, v116, v117
    v_exp_f32 v120, v120
    v_cvt_pk_bf16_f32 v131, v118, v119
    v_exp_f32 v121, v121
    v_exp_f32 v122, v122
    v_cvt_pk_bf16_f32 v132, v120, v121
    v_exp_f32 v123, v123
    v_exp_f32 v124, v124
    v_cvt_pk_bf16_f32 v133, v122, v123
    v_exp_f32 v125, v125
    v_exp_f32 v126, v126
    v_exp_f32 v127, v127
    v_cvt_pk_bf16_f32 v134, v124, v125
    v_cvt_pk_bf16_f32 v135, v126, v127
    v_mfma_f32_32x32x16_bf16 v[56:71], v[144:147], v[128:131], v[56:71]
    v_exp_f32 v96, v96
    v_exp_f32 v97, v97
    v_exp_f32 v98, v98
    v_mfma_f32_32x32x16_bf16 v[56:71], v[148:151], v[132:135], v[56:71]
    v_exp_f32 v99, v99
    v_cvt_pk_bf16_f32 v128, v96, v97
    v_exp_f32 v100, v100
    v_cvt_pk_bf16_f32 v129, v98, v99
    v_mfma_f32_32x32x16_bf16 v[112:127], v[136:139], v[24:27], 0
    v_exp_f32 v101, v101
    v_exp_f32 v102, v102
    v_exp_f32 v103, v103
    v_mfma_f32_32x32x16_bf16 v[112:127], v[140:143], v[40:43], v[112:127]
    v_cvt_pk_bf16_f32 v130, v100, v101
    v_exp_f32 v104, v104
    v_cvt_pk_bf16_f32 v131, v102, v103
    v_exp_f32 v105, v105
    v_exp_f32 v106, v106
    v_cvt_pk_bf16_f32 v132, v104, v105
    v_exp_f32 v107, v107
    v_exp_f32 v108, v108
    v_cvt_pk_bf16_f32 v133, v106, v107
    v_exp_f32 v109, v109
    v_exp_f32 v110, v110
    v_exp_f32 v111, v111
    s_waitcnt vmcnt(10)
    v_cvt_pk_bf16_f32 v134, v108, v109
    v_cvt_pk_bf16_f32 v135, v110, v111
    v_mfma_f32_32x32x16_bf16 v[68:83], v[144:147], v[128:131], v[68:83]
    v_exp_f32 v112, v112
    v_exp_f32 v113, v113
    v_exp_f32 v114, v114
    v_mfma_f32_32x32x16_bf16 v[68:83], v[148:151], v[132:135], v[68:83]
    v_exp_f32 v115, v115
    v_cvt_pk_bf16_f32 v128, v112, v113
    v_exp_f32 v116, v116
    v_cvt_pk_bf16_f32 v129, v114, v115
    v_mfma_f32_32x32x16_bf16 v[96:111], v[152:155], v[12:15], 0
    v_exp_f32 v117, v117
    v_exp_f32 v118, v118
    v_exp_f32 v119, v119
    v_mfma_f32_32x32x16_bf16 v[96:111], v[156:159], v[28:31], v[96:111]
    v_cvt_pk_bf16_f32 v130, v116, v117
    v_exp_f32 v120, v120
    v_cvt_pk_bf16_f32 v131, v118, v119
    v_exp_f32 v121, v121
    v_exp_f32 v122, v122
    v_cvt_pk_bf16_f32 v132, v120, v121
    v_exp_f32 v123, v123
    v_exp_f32 v124, v124
    v_cvt_pk_bf16_f32 v133, v122, v123
    v_exp_f32 v125, v125
    v_exp_f32 v126, v126
    v_exp_f32 v127, v127
    v_cvt_pk_bf16_f32 v134, v124, v125
    v_cvt_pk_bf16_f32 v135, v126, v127
    v_mfma_f32_32x32x16_bf16 v[80:95], v[144:147], v[128:131], v[80:95]
    v_exp_f32 v96, v96
    v_exp_f32 v97, v97
    v_exp_f32 v98, v98
    v_mfma_f32_32x32x16_bf16 v[80:95], v[148:151], v[132:135], v[80:95]
    v_exp_f32 v99, v99
    v_cvt_pk_bf16_f32 v128, v96, v97
    v_exp_f32 v100, v100
    v_cvt_pk_bf16_f32 v129, v98, v99
    v_mfma_f32_32x32x16_bf16 v[112:127], v[152:155], v[16:19], 0
    v_exp_f32 v101, v101
    v_exp_f32 v102, v102
    v_exp_f32 v103, v103
    v_mfma_f32_32x32x16_bf16 v[112:127], v[156:159], v[32:35], v[112:127]
    v_cvt_pk_bf16_f32 v130, v100, v101
    v_exp_f32 v104, v104
    v_cvt_pk_bf16_f32 v131, v102, v103
    v_exp_f32 v105, v105
    v_exp_f32 v106, v106
    v_cvt_pk_bf16_f32 v132, v104, v105
    v_exp_f32 v107, v107
    v_exp_f32 v108, v108
    v_cvt_pk_bf16_f32 v133, v106, v107
    v_exp_f32 v109, v109
    v_exp_f32 v110, v110
    v_exp_f32 v111, v111
    s_waitcnt vmcnt(8)
    v_cvt_pk_bf16_f32 v134, v108, v109
    v_cvt_pk_bf16_f32 v135, v110, v111
    v_mfma_f32_32x32x16_bf16 v[44:59], v[160:163], v[128:131], v[44:59]
    v_exp_f32 v112, v112
    v_exp_f32 v113, v113
    v_exp_f32 v114, v114
    v_mfma_f32_32x32x16_bf16 v[44:59], v[164:167], v[132:135], v[44:59]
    v_exp_f32 v115, v115
    v_cvt_pk_bf16_f32 v128, v112, v113
    v_exp_f32 v116, v116
    v_cvt_pk_bf16_f32 v129, v114, v115
    v_mfma_f32_32x32x16_bf16 v[96:111], v[152:155], v[20:23], 0
    v_exp_f32 v117, v117
    v_exp_f32 v118, v118
    v_exp_f32 v119, v119
    v_mfma_f32_32x32x16_bf16 v[96:111], v[156:159], v[36:39], v[96:111]
    v_cvt_pk_bf16_f32 v130, v116, v117
    v_exp_f32 v120, v120
    v_cvt_pk_bf16_f32 v131, v118, v119
    v_exp_f32 v121, v121
    v_exp_f32 v122, v122
    v_cvt_pk_bf16_f32 v132, v120, v121
    v_exp_f32 v123, v123
    v_exp_f32 v124, v124
    v_cvt_pk_bf16_f32 v133, v122, v123
    v_exp_f32 v125, v125
    v_exp_f32 v126, v126
    v_exp_f32 v127, v127
    v_cvt_pk_bf16_f32 v134, v124, v125
    v_cvt_pk_bf16_f32 v135, v126, v127
    v_mfma_f32_32x32x16_bf16 v[56:71], v[160:163], v[128:131], v[56:71]
    v_exp_f32 v96, v96
    v_exp_f32 v97, v97
    v_exp_f32 v98, v98
    v_mfma_f32_32x32x16_bf16 v[56:71], v[164:167], v[132:135], v[56:71]
    v_exp_f32 v99, v99
    v_cvt_pk_bf16_f32 v128, v96, v97
    v_exp_f32 v100, v100
    v_cvt_pk_bf16_f32 v129, v98, v99
    v_mfma_f32_32x32x16_bf16 v[112:127], v[152:155], v[24:27], 0
    v_exp_f32 v101, v101
    v_exp_f32 v102, v102
    v_exp_f32 v103, v103
    v_mfma_f32_32x32x16_bf16 v[112:127], v[156:159], v[40:43], v[112:127]
    v_cvt_pk_bf16_f32 v130, v100, v101
    v_exp_f32 v104, v104
    v_cvt_pk_bf16_f32 v131, v102, v103
    v_exp_f32 v105, v105
    v_exp_f32 v106, v106
    v_cvt_pk_bf16_f32 v132, v104, v105
    v_exp_f32 v107, v107
    v_exp_f32 v108, v108
    v_cvt_pk_bf16_f32 v133, v106, v107
    v_exp_f32 v109, v109
    v_exp_f32 v110, v110
    v_exp_f32 v111, v111
    s_waitcnt vmcnt(6)
    v_cvt_pk_bf16_f32 v134, v108, v109
    v_cvt_pk_bf16_f32 v135, v110, v111
    v_mfma_f32_32x32x16_bf16 v[68:83], v[160:163], v[128:131], v[68:83]
    v_exp_f32 v112, v112
    v_exp_f32 v113, v113
    v_exp_f32 v114, v114
    v_mfma_f32_32x32x16_bf16 v[68:83], v[164:167], v[132:135], v[68:83]
    v_exp_f32 v115, v115
    v_cvt_pk_bf16_f32 v128, v112, v113
    v_exp_f32 v116, v116
    v_cvt_pk_bf16_f32 v129, v114, v115
    v_mfma_f32_32x32x16_bf16 v[96:111], v[168:171], v[12:15], 0
    v_exp_f32 v117, v117
    v_exp_f32 v118, v118
    v_exp_f32 v119, v119
    v_mfma_f32_32x32x16_bf16 v[96:111], v[172:175], v[28:31], v[96:111]
    v_cvt_pk_bf16_f32 v130, v116, v117
    v_exp_f32 v120, v120
    v_cvt_pk_bf16_f32 v131, v118, v119
    v_exp_f32 v121, v121
    v_exp_f32 v122, v122
    v_cvt_pk_bf16_f32 v132, v120, v121
    v_exp_f32 v123, v123
    v_exp_f32 v124, v124
    v_cvt_pk_bf16_f32 v133, v122, v123
    v_exp_f32 v125, v125
    v_exp_f32 v126, v126
    v_exp_f32 v127, v127
    v_cvt_pk_bf16_f32 v134, v124, v125
    v_cvt_pk_bf16_f32 v135, v126, v127
    v_mfma_f32_32x32x16_bf16 v[80:95], v[160:163], v[128:131], v[80:95]
    v_exp_f32 v96, v96
    v_exp_f32 v97, v97
    v_exp_f32 v98, v98
    v_mfma_f32_32x32x16_bf16 v[80:95], v[164:167], v[132:135], v[80:95]
    v_exp_f32 v99, v99
    v_cvt_pk_bf16_f32 v128, v96, v97
    v_exp_f32 v100, v100
    v_cvt_pk_bf16_f32 v129, v98, v99
    v_mfma_f32_32x32x16_bf16 v[112:127], v[168:171], v[16:19], 0
    v_exp_f32 v101, v101
    v_exp_f32 v102, v102
    v_exp_f32 v103, v103
    v_mfma_f32_32x32x16_bf16 v[112:127], v[172:175], v[32:35], v[112:127]
    v_cvt_pk_bf16_f32 v130, v100, v101
    v_exp_f32 v104, v104
    v_cvt_pk_bf16_f32 v131, v102, v103
    v_exp_f32 v105, v105
    v_exp_f32 v106, v106
    v_cvt_pk_bf16_f32 v132, v104, v105
    v_exp_f32 v107, v107
    v_exp_f32 v108, v108
    v_cvt_pk_bf16_f32 v133, v106, v107
    v_exp_f32 v109, v109
    v_exp_f32 v110, v110
    v_exp_f32 v111, v111
    s_waitcnt vmcnt(4)
    v_cvt_pk_bf16_f32 v134, v108, v109
    v_cvt_pk_bf16_f32 v135, v110, v111
    v_mfma_f32_32x32x16_bf16 v[44:59], v[176:179], v[128:131], v[44:59]
    v_exp_f32 v112, v112
    v_exp_f32 v113, v113
    v_exp_f32 v114, v114
    v_mfma_f32_32x32x16_bf16 v[44:59], v[180:183], v[132:135], v[44:59]
    v_exp_f32 v115, v115
    v_cvt_pk_bf16_f32 v128, v112, v113
    v_exp_f32 v116, v116
    v_cvt_pk_bf16_f32 v129, v114, v115
    v_mfma_f32_32x32x16_bf16 v[96:111], v[168:171], v[20:23], 0
    v_exp_f32 v117, v117
    v_exp_f32 v118, v118
    v_exp_f32 v119, v119
    v_mfma_f32_32x32x16_bf16 v[96:111], v[172:175], v[36:39], v[96:111]
    v_cvt_pk_bf16_f32 v130, v116, v117
    v_exp_f32 v120, v120
    v_cvt_pk_bf16_f32 v131, v118, v119
    v_exp_f32 v121, v121
    v_exp_f32 v122, v122
    v_cvt_pk_bf16_f32 v132, v120, v121
    v_exp_f32 v123, v123
    v_exp_f32 v124, v124
    v_cvt_pk_bf16_f32 v133, v122, v123
    v_exp_f32 v125, v125
    v_exp_f32 v126, v126
    v_exp_f32 v127, v127
    v_cvt_pk_bf16_f32 v134, v124, v125
    v_cvt_pk_bf16_f32 v135, v126, v127
    v_mfma_f32_32x32x16_bf16 v[56:71], v[176:179], v[128:131], v[56:71]
    v_exp_f32 v96, v96
    v_exp_f32 v97, v97
    v_exp_f32 v98, v98
    v_mfma_f32_32x32x16_bf16 v[56:71], v[180:183], v[132:135], v[56:71]
    v_exp_f32 v99, v99
    v_cvt_pk_bf16_f32 v128, v96, v97
    v_exp_f32 v100, v100
    v_cvt_pk_bf16_f32 v129, v98, v99
    v_mfma_f32_32x32x16_bf16 v[112:127], v[168:171], v[24:27], 0
    v_exp_f32 v101, v101
    v_exp_f32 v102, v102
    v_exp_f32 v103, v103
    v_mfma_f32_32x32x16_bf16 v[112:127], v[172:175], v[40:43], v[112:127]
    v_cvt_pk_bf16_f32 v130, v100, v101
    v_exp_f32 v104, v104
    v_cvt_pk_bf16_f32 v131, v102, v103
    v_exp_f32 v105, v105
    v_exp_f32 v106, v106
    v_cvt_pk_bf16_f32 v132, v104, v105
    v_exp_f32 v107, v107
    v_exp_f32 v108, v108
    v_cvt_pk_bf16_f32 v133, v106, v107
    v_exp_f32 v109, v109
    v_exp_f32 v110, v110
    v_exp_f32 v111, v111
    s_waitcnt vmcnt(2)
    v_cvt_pk_bf16_f32 v134, v108, v109
    v_cvt_pk_bf16_f32 v135, v110, v111
    v_mfma_f32_32x32x16_bf16 v[68:83], v[176:179], v[128:131], v[68:83]
    v_exp_f32 v112, v112
    v_exp_f32 v113, v113
    v_exp_f32 v114, v114
    v_mfma_f32_32x32x16_bf16 v[68:83], v[180:183], v[132:135], v[68:83]
    v_exp_f32 v115, v115
    v_cvt_pk_bf16_f32 v128, v112, v113
    v_exp_f32 v116, v116
    v_cvt_pk_bf16_f32 v129, v114, v115
    v_mfma_f32_32x32x16_bf16 v[96:111], v[184:187], v[12:15], 0
    v_exp_f32 v117, v117
    v_exp_f32 v118, v118
    v_exp_f32 v119, v119
    v_mfma_f32_32x32x16_bf16 v[96:111], v[188:191], v[28:31], v[96:111]
    v_cvt_pk_bf16_f32 v130, v116, v117
    v_exp_f32 v120, v120
    v_cvt_pk_bf16_f32 v131, v118, v119
    v_exp_f32 v121, v121
    v_exp_f32 v122, v122
    v_cvt_pk_bf16_f32 v132, v120, v121
    v_exp_f32 v123, v123
    v_exp_f32 v124, v124
    v_cvt_pk_bf16_f32 v133, v122, v123
    v_exp_f32 v125, v125
    v_exp_f32 v126, v126
    v_exp_f32 v127, v127
    v_cvt_pk_bf16_f32 v134, v124, v125
    v_cvt_pk_bf16_f32 v135, v126, v127
    v_mfma_f32_32x32x16_bf16 v[80:95], v[176:179], v[128:131], v[80:95]
    v_exp_f32 v96, v96
    v_exp_f32 v97, v97
    v_exp_f32 v98, v98
    v_mfma_f32_32x32x16_bf16 v[80:95], v[180:183], v[132:135], v[80:95]
    v_exp_f32 v99, v99
    v_cvt_pk_bf16_f32 v128, v96, v97
    v_exp_f32 v100, v100
    v_cvt_pk_bf16_f32 v129, v98, v99
    v_mfma_f32_32x32x16_bf16 v[112:127], v[184:187], v[16:19], 0
    v_exp_f32 v101, v101
    v_exp_f32 v102, v102
    v_exp_f32 v103, v103
    v_mfma_f32_32x32x16_bf16 v[112:127], v[188:191], v[32:35], v[112:127]
    v_cvt_pk_bf16_f32 v130, v100, v101
    v_exp_f32 v104, v104
    v_cvt_pk_bf16_f32 v131, v102, v103
    v_exp_f32 v105, v105
    v_exp_f32 v106, v106
    v_cvt_pk_bf16_f32 v132, v104, v105
    v_exp_f32 v107, v107
    v_exp_f32 v108, v108
    v_cvt_pk_bf16_f32 v133, v106, v107
    v_exp_f32 v109, v109
    v_exp_f32 v110, v110
    v_exp_f32 v111, v111
    s_waitcnt vmcnt(0)
    v_cvt_pk_bf16_f32 v134, v108, v109
    v_cvt_pk_bf16_f32 v135, v110, v111
    v_mfma_f32_32x32x16_bf16 v[44:59], v[192:195], v[128:131], v[44:59]
    v_exp_f32 v112, v112
    v_exp_f32 v113, v113
    v_exp_f32 v114, v114
    v_mfma_f32_32x32x16_bf16 v[44:59], v[196:199], v[132:135], v[44:59]
    v_exp_f32 v115, v115
    v_cvt_pk_bf16_f32 v128, v112, v113
    v_exp_f32 v116, v116
    v_cvt_pk_bf16_f32 v129, v114, v115
    v_mfma_f32_32x32x16_bf16 v[96:111], v[184:187], v[20:23], 0
    v_exp_f32 v117, v117
    v_exp_f32 v118, v118
    v_exp_f32 v119, v119
    v_mfma_f32_32x32x16_bf16 v[96:111], v[188:191], v[36:39], v[96:111]
    v_cvt_pk_bf16_f32 v130, v116, v117
    v_exp_f32 v120, v120
    v_cvt_pk_bf16_f32 v131, v118, v119
    v_exp_f32 v121, v121
    v_exp_f32 v122, v122
    v_cvt_pk_bf16_f32 v132, v120, v121
    v_exp_f32 v123, v123
    v_exp_f32 v124, v124
    v_cvt_pk_bf16_f32 v133, v122, v123
    v_exp_f32 v125, v125
    v_exp_f32 v126, v126
    v_exp_f32 v127, v127
    v_cvt_pk_bf16_f32 v134, v124, v125
    v_cvt_pk_bf16_f32 v135, v126, v127
    v_mfma_f32_32x32x16_bf16 v[56:71], v[192:195], v[128:131], v[56:71]
    v_exp_f32 v96, v96
    v_exp_f32 v97, v97
    v_exp_f32 v98, v98
    v_mfma_f32_32x32x16_bf16 v[56:71], v[196:199], v[132:135], v[56:71]
    v_exp_f32 v99, v99
    v_cvt_pk_bf16_f32 v128, v96, v97
    v_exp_f32 v100, v100
    v_cvt_pk_bf16_f32 v129, v98, v99
    v_mfma_f32_32x32x16_bf16 v[112:127], v[184:187], v[24:27], 0
    v_exp_f32 v101, v101
    v_exp_f32 v102, v102
    v_exp_f32 v103, v103
    v_mfma_f32_32x32x16_bf16 v[112:127], v[188:191], v[40:43], v[112:127]
    v_cvt_pk_bf16_f32 v130, v100, v101
    v_exp_f32 v104, v104
    v_cvt_pk_bf16_f32 v131, v102, v103
    v_exp_f32 v105, v105
    v_exp_f32 v106, v106
    v_cvt_pk_bf16_f32 v132, v104, v105
    v_exp_f32 v107, v107
    v_exp_f32 v108, v108
    v_cvt_pk_bf16_f32 v133, v106, v107
    v_exp_f32 v109, v109
    v_exp_f32 v110, v110
    v_exp_f32 v111, v111
    v_cvt_pk_bf16_f32 v134, v108, v109
    v_cvt_pk_bf16_f32 v135, v110, v111
    v_mfma_f32_32x32x16_bf16 v[68:83], v[192:195], v[128:131], v[68:83]
    v_exp_f32 v112, v112
    v_exp_f32 v113, v113
    v_exp_f32 v114, v114
    v_mfma_f32_32x32x16_bf16 v[68:83], v[196:199], v[132:135], v[68:83]
    v_exp_f32 v115, v115
    v_cvt_pk_bf16_f32 v128, v112, v113
    v_exp_f32 v116, v116
    v_cvt_pk_bf16_f32 v129, v114, v115
    v_exp_f32 v117, v117
    v_exp_f32 v118, v118
    v_exp_f32 v119, v119
    v_cvt_pk_bf16_f32 v130, v116, v117
    v_exp_f32 v120, v120
    v_cvt_pk_bf16_f32 v131, v118, v119
    v_exp_f32 v121, v121
    v_exp_f32 v122, v122
    v_cvt_pk_bf16_f32 v132, v120, v121
    v_exp_f32 v123, v123
    v_exp_f32 v124, v124
    v_cvt_pk_bf16_f32 v133, v122, v123
    v_exp_f32 v125, v125
    v_exp_f32 v126, v126
    v_exp_f32 v127, v127
    v_cvt_pk_bf16_f32 v134, v124, v125
    v_cvt_pk_bf16_f32 v135, v126, v127
    v_mfma_f32_32x32x16_bf16 v[80:95], v[192:195], v[128:131], v[80:95]
    s_nop 0
    v_mfma_f32_32x32x16_bf16 v[80:95], v[196:199], v[132:135], v[80:95]
    v_mov_b32 v8, 0
    v_mov_b32 v9, 0
    s_mul_i32 s38, s20, 13312
    v_add_u32 v96, s38, v1
    v_lshlrev_b32 v97, 2, v0
    v_add_u32 v97, s38, v97
    ds_write_b32 v97, v4 offset:3072
    ds_write_b32 v97, v5 offset:6400
    ds_write_b32 v97, v6 offset:9728
    ds_write_b32 v97, v7 offset:13056
    ds_write_b128 v96, v[44:47] offset:0
    v_pk_fma_f32 v[8:9], v[44:45], 0, v[8:9]
    v_pk_fma_f32 v[8:9], v[46:47], 0, v[8:9]
    ds_write_b128 v96, v[48:51] offset:1024
    v_pk_fma_f32 v[8:9], v[48:49], 0, v[8:9]
    v_pk_fma_f32 v[8:9], v[50:51], 0, v[8:9]
    ds_write_b128 v96, v[52:55] offset:2048
    v_pk_fma_f32 v[8:9], v[52:53], 0, v[8:9]
    v_pk_fma_f32 v[8:9], v[54:55], 0, v[8:9]
    ds_write_b128 v96, v[56:59] offset:3328
    v_pk_fma_f32 v[8:9], v[56:57], 0, v[8:9]
    v_pk_fma_f32 v[8:9], v[58:59], 0, v[8:9]
    ds_write_b128 v96, v[60:63] offset:4352
    v_pk_fma_f32 v[8:9], v[60:61], 0, v[8:9]
    v_pk_fma_f32 v[8:9], v[62:63], 0, v[8:9]
    ds_write_b128 v96, v[64:67] offset:5376
    v_pk_fma_f32 v[8:9], v[64:65], 0, v[8:9]
    v_pk_fma_f32 v[8:9], v[66:67], 0, v[8:9]
    ds_write_b128 v96, v[68:71] offset:6656
    v_pk_fma_f32 v[8:9], v[68:69], 0, v[8:9]
    v_pk_fma_f32 v[8:9], v[70:71], 0, v[8:9]
    ds_write_b128 v96, v[72:75] offset:7680
    v_pk_fma_f32 v[8:9], v[72:73], 0, v[8:9]
    v_pk_fma_f32 v[8:9], v[74:75], 0, v[8:9]
    ds_write_b128 v96, v[76:79] offset:8704
    v_pk_fma_f32 v[8:9], v[76:77], 0, v[8:9]
    v_pk_fma_f32 v[8:9], v[78:79], 0, v[8:9]
    ds_write_b128 v96, v[80:83] offset:9984
    v_pk_fma_f32 v[8:9], v[80:81], 0, v[8:9]
    v_pk_fma_f32 v[8:9], v[82:83], 0, v[8:9]
    ds_write_b128 v96, v[84:87] offset:11008
    v_pk_fma_f32 v[8:9], v[84:85], 0, v[8:9]
    v_pk_fma_f32 v[8:9], v[86:87], 0, v[8:9]
    ds_write_b128 v96, v[88:91] offset:12032
    v_pk_fma_f32 v[8:9], v[88:89], 0, v[8:9]
    v_pk_fma_f32 v[8:9], v[90:91], 0, v[8:9]
    v_add_f32 v8, v8, v9
    v_min_f32 v9, v54, v66
    v_min3_f32 v9, v78, v90, v9
    v_max_f32 v10, v54, v66
    v_max3_f32 v10, v78, v90, v10
    v_cmp_eq_f32 s[34:35], 0, v8
    v_cmp_lt_f32 vcc, 0x30800000, v9
    s_nop 0
    s_or_b32 vcc_hi, vcc_hi, -1
    s_and_b64 s[34:35], s[34:35], vcc
    v_cmp_gt_f32 vcc, 0x4e800000, v10
    s_nop 0
    s_and_b64 s[34:35], s[34:35], vcc
    s_cmp_eq_u64 s[34:35], -1
    s_cbranch_scc1 L2_AOK
    s_cmp_eq_u32 s28, 16
    s_cbranch_scc1 L2_AOK
    s_mov_b32 s28, 16
    s_mov_b32 s21, s24
    s_mov_b32 s27, 32
    s_waitcnt vmcnt(0)
    v_mov_b32 v4, 0xff800000
    v_mov_b32 v5, 0xff800000
    v_mov_b32 v6, 0xff800000
    v_mov_b32 v7, 0xff800000
    s_mov_b32 exec_lo, 0
    v_mov_b32 v28, 0
    v_mov_b32 v32, 0
    v_mov_b32 v36, 0
    v_mov_b32 v40, 0
    s_mov_b32 exec_lo, -1
L2_MAXL:
    buffer_load_dwordx4 v[136:139], v1, s[4:7], s21 offen
    s_mov_b32 exec_hi, 0
    buffer_load_dwordx4 v[140:143], v1, s[4:7], s21 offen offset:1024
    s_mov_b32 exec_hi, -1
    s_add_u32 s21, s21, 36864
    s_waitcnt vmcnt(0)
    v_mfma_f32_32x32x16_bf16 v[96:111], v[136:139], v[12:15], 0
    v_mfma_f32_32x32x16_bf16 v[96:111], v[140:143], v[28:31], v[96:111]
    v_mfma_f32_32x32x16_bf16 v[112:127], v[136:139], v[16:19], 0
    v_mfma_f32_32x32x16_bf16 v[112:127], v[140:143], v[32:35], v[112:127]
    s_nop 9
    v_max3_f32 v4, v96, v97, v4
    v_max3_f32 v4, v98, v99, v4
    v_max3_f32 v4, v100, v101, v4
    v_max3_f32 v4, v102, v103, v4
    v_max3_f32 v4, v104, v105, v4
    v_max3_f32 v4, v106, v107, v4
    v_max3_f32 v4, v108, v109, v4
    v_max3_f32 v4, v110, v111, v4
    v_mfma_f32_32x32x16_bf16 v[96:111], v[136:139], v[20:23], 0
    v_mfma_f32_32x32x16_bf16 v[96:111], v[140:143], v[36:39], v[96:111]
    v_max3_f32 v5, v112, v113, v5
    v_max3_f32 v5, v114, v115, v5
    v_max3_f32 v5, v116, v117, v5
    v_max3_f32 v5, v118, v119, v5
    v_max3_f32 v5, v120, v121, v5
    v_max3_f32 v5, v122, v123, v5
    v_max3_f32 v5, v124, v125, v5
    v_max3_f32 v5, v126, v127, v5
    v_mfma_f32_32x32x16_bf16 v[112:127], v[136:139], v[24:27], 0
    v_mfma_f32_32x32x16_bf16 v[112:127], v[140:143], v[40:43], v[112:127]
    s_nop 1
    v_max3_f32 v6, v96, v97, v6
    v_max3_f32 v6, v98, v99, v6
    v_max3_f32 v6, v100, v101, v6
    v_max3_f32 v6, v102, v103, v6
    v_max3_f32 v6, v104, v105, v6
    v_max3_f32 v6, v106, v107, v6
    v_max3_f32 v6, v108, v109, v6
    v_max3_f32 v6, v110, v111, v6
    s_nop 1
    v_max3_f32 v7, v112, v113, v7
    v_max3_f32 v7, v114, v115, v7
    v_max3_f32 v7, v116, v117, v7
    v_max3_f32 v7, v118, v119, v7
    v_max3_f32 v7, v120, v121, v7
    v_max3_f32 v7, v122, v123, v7
    v_max3_f32 v7, v124, v125, v7
    v_max3_f32 v7, v126, v127, v7
    s_sub_u32 s27, s27, 1
    s_cmp_lg_u32 s27, 0
    s_cbranch_scc1 L2_MAXL
    s_mov_b32 s21, s24
    s_mov_b32 s23, s26
    buffer_load_dwordx4 v[136:139], v1, s[4:7], s21 offen
    s_mov_b32 exec_hi, 0
    buffer_load_dwordx4 v[140:143], v1, s[4:7], s21 offen offset:1024
    s_mov_b32 exec_hi, -1
    s_add_u32 s21, s21, 36864
    s_mov_b64 exec, s[30:31]
    buffer_load_dwordx4 v[144:147], v3, s[4:7], s23 offen
    buffer_load_dwordx4 v[148:151], v2, s[4:7], s23 offen
    s_mov_b64 exec, -1
    s_add_u32 s23, s23, 36864
    buffer_load_dwordx4 v[152:155], v1, s[4:7], s21 offen
    s_mov_b32 exec_hi, 0
    buffer_load_dwordx4 v[156:159], v1, s[4:7], s21 offen offset:1024
    s_mov_b32 exec_hi, -1
    s_add_u32 s21, s21, 36864
    s_mov_b64 exec, s[30:31]
    buffer_load_dwordx4 v[160:163], v3, s[4:7], s23 offen
    buffer_load_dwordx4 v[164:167], v2, s[4:7], s23 offen
    s_mov_b64 exec, -1
    s_add_u32 s23, s23, 36864
    buffer_load_dwordx4 v[168:171], v1, s[4:7], s21 offen
    s_mov_b32 exec_hi, 0
    buffer_load_dwordx4 v[172:175], v1, s[4:7], s21 offen offset:1024
    s_mov_b32 exec_hi, -1
    s_add_u32 s21, s21, 36864
    s_mov_b64 exec, s[30:31]
    buffer_load_dwordx4 v[176:179], v3, s[4:7], s23 offen
    buffer_load_dwordx4 v[180:183], v2, s[4:7], s23 offen
    s_mov_b64 exec, -1
    s_add_u32 s23, s23, 36864
    buffer_load_dwordx4 v[184:187], v1, s[4:7], s21 offen
    s_mov_b32 exec_hi, 0
    buffer_load_dwordx4 v[188:191], v1, s[4:7], s21 offen offset:1024
    s_mov_b32 exec_hi, -1
    s_add_u32 s21, s21, 36864
    v_mov_b32 v128, 0
    v_mov_b32 v129, 0
    v_mov_b32 v130, 0
    v_mov_b32 v131, 0
    v_mov_b32 v132, 0
    v_mov_b32 v133, 0
    v_mov_b32 v134, 0
    v_mov_b32 v135, 0
    v_mov_b32 v8, v4
    v_mov_b32 v9, v4
    v_mfma_f32_32x32x16_bf16 v[44:59], v[132:135], v[132:135], 0
    s_nop 0
    v_permlane32_swap_b32 v8, v9
    v_max_f32 v4, v8, v9
    v_sub_f32 v8, 0, v4
    v_and_b32 v9, 0xffff0000, v8
    v_sub_f32 v8, v8, v9
    v_and_b32 v10, 0xffff0000, v8
    v_sub_f32 v8, v8, v10
    v_lshrrev_b32 v9, 16, v9
    s_mov_b32 exec_lo, 0
    v_or_b32 v28, v9, v10
    v_lshrrev_b32 v29, 16, v8
    s_mov_b32 exec_lo, -1
    v_mov_b32 v8, v5
    v_mov_b32 v9, v5
    v_mfma_f32_32x32x16_bf16 v[56:71], v[132:135], v[132:135], 0
    s_nop 0
    v_permlane32_swap_b32 v8, v9
    v_max_f32 v5, v8, v9
    v_sub_f32 v8, 0, v5
    v_and_b32 v9, 0xffff0000, v8
    v_sub_f32 v8, v8, v9
    v_and_b32 v10, 0xffff0000, v8
    v_sub_f32 v8, v8, v10
    v_lshrrev_b32 v9, 16, v9
    s_mov_b32 exec_lo, 0
    v_or_b32 v32, v9, v10
    v_lshrrev_b32 v33, 16, v8
    s_mov_b32 exec_lo, -1
    v_mov_b32 v8, v6
    v_mov_b32 v9, v6
    v_mfma_f32_32x32x16_bf16 v[68:83], v[132:135], v[132:135], 0
    s_nop 0
    v_permlane32_swap_b32 v8, v9
    v_max_f32 v6, v8, v9
    v_sub_f32 v8, 0, v6
    v_and_b32 v9, 0xffff0000, v8
    v_sub_f32 v8, v8, v9
    v_and_b32 v10, 0xffff0000, v8
    v_sub_f32 v8, v8, v10
    v_lshrrev_b32 v9, 16, v9
    s_mov_b32 exec_lo, 0
    v_or_b32 v36, v9, v10
    v_lshrrev_b32 v37, 16, v8
    s_mov_b32 exec_lo, -1
    v_mov_b32 v8, v7
    v_mov_b32 v9, v7
    v_mfma_f32_32x32x16_bf16 v[80:95], v[132:135], v[132:135], 0
    s_nop 0
    v_permlane32_swap_b32 v8, v9
    v_max_f32 v7, v8, v9
    v_sub_f32 v8, 0, v7
    v_and_b32 v9, 0xffff0000, v8
    v_sub_f32 v8, v8, v9
    v_and_b32 v10, 0xffff0000, v8
    v_sub_f32 v8, v8, v10
    v_lshrrev_b32 v9, 16, v9
    s_mov_b32 exec_lo, 0
    v_or_b32 v40, v9, v10
    v_lshrrev_b32 v41, 16, v8
    s_mov_b32 exec_lo, -1
    s_waitcnt vmcnt(0)
    v_mfma_f32_32x32x16_bf16 v[96:111], v[136:139], v[12:15], 0
    v_mfma_f32_32x32x16_bf16 v[96:111], v[140:143], v[28:31], v[96:111]
    s_nop 8
    s_branch L2_GO
L2_AOK:
    s_sub_u32 s34, s20, s29
    s_mul_i32 s34, s34, 13312
    s_mul_i32 s35, s29, 6656
    s_add_u32 s34, s34, s35
    v_add_u32 v8, s34, v1
    v_and_b32 v10, 31, v0
    v_lshl_add_u32 v9, v10, 2, s34
    v_lshl_add_u32 v10, v10, 4, s34
    s_lshl_b32 s34, s33, 2
    s_mul_i32 s35, s29, 2
    s_add_u32 s34, s34, s35
    s_mul_i32 s34, s34, 36864
    s_add_u32 s34, s34, 26173440
    s_lshl_b32 s35, s32, 10
    s_add_u32 s35, s35, s34
    s_lshr_b32 s36, s32, 2
    s_lshl_b32 s36, s36, 9
    s_add_u32 s34, s34, s36
    s_and_b32 s36, s32, 3
    s_lshl_b32 s36, s36, 2
    s_add_u32 s34, s34, s36
    s_add_u32 s34, s34, 32768
    s_waitcnt lgkmcnt(0)
    s_barrier
    ds_read_b32 v24, v9 offset:3200
    ds_read_b32 v25, v10 offset:2056
    ds_read_b32 v40, v9 offset:16512
    ds_read_b32 v41, v10 offset:15368
    ds_read_b32 v56, v9 offset:6528
    ds_read_b32 v57, v10 offset:5384
    ds_read_b32 v72, v9 offset:19840
    ds_read_b32 v73, v10 offset:18696
    ds_read_b128 v[12:15], v8 offset:0
    ds_read_b128 v[16:19], v8 offset:1024
    ds_read_b64 v[20:21], v8 offset:2048
    ds_read_b128 v[28:31], v8 offset:13312
    ds_read_b128 v[32:35], v8 offset:14336
    ds_read_b64 v[36:37], v8 offset:15360
    ds_read_b128 v[44:47], v8 offset:3328
    ds_read_b128 v[48:51], v8 offset:4352
    ds_read_b64 v[52:53], v8 offset:5376
    ds_read_b128 v[60:63], v8 offset:16640
    ds_read_b128 v[64:67], v8 offset:17664
    ds_read_b64 v[68:69], v8 offset:18688
    s_waitcnt lgkmcnt(12)
    v_max_f32 v26, v24, v40
    v_sub_f32 v24, v24, v26
    v_sub_f32 v40, v40, v26
    v_exp_f32 v24, v24
    v_exp_f32 v40, v40
    v_mul_f32 v27, v25, v24
    v_fma_f32 v27, v41, v40, v27
    v_rcp_f32 v27, v27
    s_nop 0
    v_mul_f32 v24, v24, v27
    v_mul_f32 v40, v40, v27
    v_max_f32 v58, v56, v72
    v_sub_f32 v56, v56, v58
    v_sub_f32 v72, v72, v58
    v_exp_f32 v56, v56
    v_exp_f32 v72, v72
    v_mul_f32 v59, v57, v56
    v_fma_f32 v59, v73, v72, v59
    v_rcp_f32 v59, v59
    s_nop 0
    v_mul_f32 v56, v56, v59
    v_mul_f32 v72, v72, v59
    s_waitcnt lgkmcnt(0)
    v_mul_f32 v12, v12, v24
    v_mul_f32 v13, v13, v24
    v_mul_f32 v14, v14, v24
    v_mul_f32 v15, v15, v24
    v_mul_f32 v16, v16, v24
    v_mul_f32 v17, v17, v24
    v_mul_f32 v18, v18, v24
    v_mul_f32 v19, v19, v24
    v_mul_f32 v20, v20, v24
    v_mul_f32 v21, v21, v24
    v_fma_f32 v12, v28, v40, v12
    v_fma_f32 v13, v29, v40, v13
    v_fma_f32 v14, v30, v40, v14
    v_fma_f32 v15, v31, v40, v15
    v_fma_f32 v16, v32, v40, v16
    v_fma_f32 v17, v33, v40, v17
    v_fma_f32 v18, v34, v40, v18
    v_fma_f32 v19, v35, v40, v19
    v_fma_f32 v20, v36, v40, v20
    v_fma_f32 v21, v37, v40, v21
    v_cvt_pk_bf16_f32 v28, v12, v13
    v_cvt_pk_bf16_f32 v29, v14, v15
    v_cvt_pk_bf16_f32 v30, v16, v17
    v_cvt_pk_bf16_f32 v31, v18, v19
    v_cvt_pk_bf16_f32 v32, v20, v21
    buffer_store_dwordx4 v[28:31], v1, s[4:7], s35 offen sc1
    s_add_u32 s35, s35, 36864
    v_mul_f32 v44, v44, v56
    v_mul_f32 v45, v45, v56
    v_mul_f32 v46, v46, v56
    v_mul_f32 v47, v47, v56
    v_mul_f32 v48, v48, v56
    v_mul_f32 v49, v49, v56
    v_mul_f32 v50, v50, v56
    v_mul_f32 v51, v51, v56
    v_mul_f32 v52, v52, v56
    v_mul_f32 v53, v53, v56
    v_fma_f32 v44, v60, v72, v44
    v_fma_f32 v45, v61, v72, v45
    v_fma_f32 v46, v62, v72, v46
    v_fma_f32 v47, v63, v72, v47
    v_fma_f32 v48, v64, v72, v48
    v_fma_f32 v49, v65, v72, v49
    v_fma_f32 v50, v66, v72, v50
    v_fma_f32 v51, v67, v72, v51
    v_fma_f32 v52, v68, v72, v52
    v_fma_f32 v53, v69, v72, v53
    v_cvt_pk_bf16_f32 v60, v44, v45
    v_cvt_pk_bf16_f32 v61, v46, v47
    v_cvt_pk_bf16_f32 v62, v48, v49
    v_cvt_pk_bf16_f32 v63, v50, v51
    v_cvt_pk_bf16_f32 v64, v52, v53
    buffer_store_dwordx4 v[60:63], v1, s[4:7], s35 offen sc1
    s_add_u32 s35, s35, 36864
    s_mov_b32 exec_hi, 0
    buffer_store_dword v32, v1, s[4:7], s34 offen sc1
    s_add_u32 s34, s34, 36864
    buffer_store_dword v64, v1, s[4:7], s34 offen sc1
    s_add_u32 s34, s34, 36864
    s_endpgm
L2_END:
    s_endpgm
.globl l3_kernel
.p2align 8
.type l3_kernel,@function
l3_kernel:
    s_cmp_ge_u32 s2, 192
    s_cbranch_scc1 L3_END
    s_load_dwordx2 s[48:49], s[0:1], 80
    s_load_dwordx2 s[50:51], s[0:1], 64
    v_lshrrev_b32 v8, 6, v0
    v_and_b32 v0, 63, v0
    v_readfirstlane_b32 s20, v8
    v_lshlrev_b32 v1, 4, v0
    s_and_b32 s21, s2, 7
    s_lshr_b32 s22, s2, 3
    s_mul_i32 s23, s22, 43
    s_lshr_b32 s23, s23, 8
    s_mul_i32 s24, s23, 6
    s_sub_u32 s24, s22, s24
    s_lshl_b32 s21, s21, 2
    s_add_u32 s21, s21, s23
    s_cmp_ge_u32 s20, 3
    s_cselect_b32 s25, 1, 0
    s_mul_i32 s26, s25, 3
    s_sub_u32 s26, s20, s26
    s_mul_i32 s27, s24, 3
    s_add_u32 s27, s27, s26
    s_lshl_b32 s28, s21, 1
    s_add_u32 s28, s28, s25
    s_mul_i32 s29, s21, 73728
    s_add_u32 s30, s20, s24
    s_cmp_ge_u32 s30, 6
    s_cselect_b32 s36, 6, 0
    s_sub_u32 s30, s30, s36
    s_mul_i32 s30, s30, 12288
    s_add_u32 s29, s29, s30
    s_add_u32 s29, s29, 26173440
    s_mul_i32 s31, s27, 36
    s_mul_i32 s32, s25, 18
    s_add_u32 s31, s31, s32
    s_lshl_b32 s31, s31, 10
    s_add_u32 s31, s31, 28532736
    s_mul_i32 s33, s28, 18
    s_add_u32 s33, s33, s27
    s_lshl_b32 s33, s33, 11
    s_add_u32 s33, s33, 29237248
    s_lshl_b32 s34, s28, 7
    s_add_u32 s34, s34, 29196288
    v_and_b32 v2, 31, v0
    v_lshlrev_b32 v3, 2, v2
    s_waitcnt lgkmcnt(0)
    s_mov_b32 s4, s48
    s_mov_b32 s5, s49
    s_mov_b32 s6, 268435456
    s_mov_b32 s7, 0x00020000
    s_mov_b32 s8, s50
    s_mov_b32 s9, s51
    s_mov_b32 s10, 2359296
    s_mov_b32 s11, 0x00020000
    s_add_u32 m0, s30, 0
    s_nop 0
    buffer_load_dwordx4 v1, s[4:7], s29 offen offset:0 lds
    buffer_load_dwordx4 v1, s[4:7], s29 offen offset:1024 lds
    buffer_load_dwordx4 v1, s[4:7], s29 offen offset:2048 lds
    buffer_load_dwordx4 v1, s[4:7], s29 offen offset:3072 lds
    s_add_u32 s29, s29, 4096
    s_add_u32 m0, s30, 4096
    s_nop 0
    buffer_load_dwordx4 v1, s[4:7], s29 offen offset:0 lds
    buffer_load_dwordx4 v1, s[4:7], s29 offen offset:1024 lds
    buffer_load_dwordx4 v1, s[4:7], s29 offen offset:2048 lds
    buffer_load_dwordx4 v1, s[4:7], s29 offen offset:3072 lds
    s_add_u32 s29, s29, 4096
    s_add_u32 m0, s30, 8192
    s_nop 0
    buffer_load_dwordx4 v1, s[4:7], s29 offen offset:0 lds
    buffer_load_dwordx4 v1, s[4:7], s29 offen offset:1024 lds
    buffer_load_dwordx4 v1, s[4:7], s29 offen offset:2048 lds
    buffer_load_dwordx4 v1, s[4:7], s29 offen offset:3072 lds
    s_add_u32 s29, s29, 4096
    s_barrier
    buffer_load_dwordx4 v[16:19], v1, s[4:7], s31 offen offset:0
    buffer_load_dwordx4 v[20:23], v1, s[4:7], s31 offen offset:1024
    buffer_load_dwordx4 v[24:27], v1, s[4:7], s31 offen offset:2048
    buffer_load_dwordx4 v[28:31], v1, s[4:7], s31 offen offset:3072
    s_add_u32 s31, s31, 4096
    buffer_load_dwordx4 v[32:35], v1, s[4:7], s31 offen offset:0
    buffer_load_dwordx4 v[36:39], v1, s[4:7], s31 offen offset:1024
    buffer_load_dwordx4 v[40:43], v1, s[4:7], s31 offen offset:2048
    buffer_load_dwordx4 v[44:47], v1, s[4:7], s31 offen offset:3072
    s_add_u32 s31, s31, 4096
    buffer_load_dwordx4 v[48:51], v1, s[4:7], s31 offen offset:0
    s_mul_i32 s35, s25, 18432
    v_add_u32 v5, s35, v1
    v_lshrrev_b32 v10, 5, v0
    v_lshlrev_b32 v10, 2, v10
    v_sub_u32 v10, v2, v10
    v_mov_b32 v11, 0x3f80
    v_mov_b32 v12, 0x3f800000
    v_cmp_eq_u32 vcc, 0, v10
    v_cmp_eq_u32 s[38:39], 1, v10
    s_nop 0
    v_cndmask_b32 v208, 0, v11, vcc
    v_cndmask_b32 v208, v208, v12, s[38:39]
    v_cmp_eq_u32 vcc, 2, v10
    v_cmp_eq_u32 s[38:39], 3, v10
    s_nop 0
    v_cndmask_b32 v209, 0, v11, vcc
    v_cndmask_b32 v209, v209, v12, s[38:39]
    v_cmp_eq_u32 vcc, 8, v10
    v_cmp_eq_u32 s[38:39], 9, v10
    s_nop 0
    v_cndmask_b32 v210, 0, v11, vcc
    v_cndmask_b32 v210, v210, v12, s[38:39]
    v_cmp_eq_u32 vcc, 10, v10
    v_cmp_eq_u32 s[38:39], 11, v10
    s_nop 0
    v_cndmask_b32 v211, 0, v11, vcc
    v_cndmask_b32 v211, v211, v12, s[38:39]
    v_cmp_eq_u32 vcc, 16, v10
    v_cmp_eq_u32 s[38:39], 17, v10
    s_nop 0
    v_cndmask_b32 v212, 0, v11, vcc
    v_cndmask_b32 v212, v212, v12, s[38:39]
    v_cmp_eq_u32 vcc, 18, v10
    v_cmp_eq_u32 s[38:39], 19, v10
    s_nop 0
    v_cndmask_b32 v213, 0, v11, vcc
    v_cndmask_b32 v213, v213, v12, s[38:39]
    v_cmp_eq_u32 vcc, 24, v10
    v_cmp_eq_u32 s[38:39], 25, v10
    s_nop 0
    v_cndmask_b32 v214, 0, v11, vcc
    v_cndmask_b32 v214, v214, v12, s[38:39]
    v_cmp_eq_u32 vcc, 26, v10
    v_cmp_eq_u32 s[38:39], 27, v10
    s_nop 0
    v_cndmask_b32 v215, 0, v11, vcc
    v_cndmask_b32 v215, v215, v12, s[38:39]
    v_mul_u32_u24 v9, 1152, v2
    v_lshrrev_b32 v10, 5, v0
    v_lshl_add_u32 v9, v10, 4, v9
    s_lshl_b32 s35, s20, 12
    s_add_u32 s35, s35, 73728
    v_add_u32 v6, s35, v1
    s_mov_b32 s37, 4294955008
    s_cmp_eq_u32 s25, 0
    s_cselect_b32 s36, 12288, s37
    v_add_u32 v7, s36, v6
    s_mul_i32 s35, s28, 36864
    s_lshl_b32 s36, s27, 6
    s_add_u32 s35, s35, s36
    s_mul_i32 s36, s25, 36864
    v_add_u32 v13, s36, v5
    s_sub_u32 s36, 36864, s36
    v_add_u32 v14, s36, v5
    s_waitcnt vmcnt(9)
    s_barrier
    ds_read_b128 v[176:179], v14 offset:0
    ds_read_b128 v[180:183], v13 offset:0
    ds_read_b128 v[184:187], v14 offset:1024
    ds_read_b128 v[188:191], v13 offset:1024
    ds_read_b128 v[192:195], v14 offset:2048
    ds_read_b128 v[196:199], v13 offset:2048
    ds_read_b128 v[200:203], v14 offset:3072
    s_waitcnt lgkmcnt(6)
    s_waitcnt vmcnt(8)
    v_mfma_f32_32x32x16_bf16 v[160:175], v[16:19], v[176:179], 0
    ds_read_b128 v[204:207], v13 offset:3072
    buffer_load_dwordx4 v[52:55], v1, s[4:7], s31 offen offset:1024
    s_waitcnt lgkmcnt(6)
    v_mfma_f32_32x32x16_bf16 v[144:159], v[16:19], v[180:183], 0
    ds_read_b128 v[176:179], v14 offset:4096
    buffer_load_dwordx4 v[56:59], v1, s[4:7], s31 offen offset:2048
    s_waitcnt lgkmcnt(6)
    s_waitcnt vmcnt(9)
    v_mfma_f32_32x32x16_bf16 v[160:175], v[20:23], v[184:187], v[160:175]
    ds_read_b128 v[180:183], v13 offset:4096
    buffer_load_dwordx4 v[60:63], v1, s[4:7], s31 offen offset:3072
    s_add_u32 s31, s31, 4096
    s_waitcnt lgkmcnt(6)
    v_mfma_f32_32x32x16_bf16 v[144:159], v[20:23], v[188:191], v[144:159]
    ds_read_b128 v[184:187], v14 offset:5120
    buffer_load_dwordx4 v[64:67], v1, s[4:7], s31 offen offset:0
    s_waitcnt lgkmcnt(6)
    s_waitcnt vmcnt(10)
    v_mfma_f32_32x32x16_bf16 v[160:175], v[24:27], v[192:195], v[160:175]
    ds_read_b128 v[188:191], v13 offset:5120
    buffer_load_dwordx4 v[68:71], v1, s[4:7], s31 offen offset:1024
    s_waitcnt lgkmcnt(6)
    v_mfma_f32_32x32x16_bf16 v[144:159], v[24:27], v[196:199], v[144:159]
    ds_read_b128 v[192:195], v14 offset:6144
    buffer_load_dwordx4 v[72:75], v1, s[4:7], s31 offen offset:2048
    s_waitcnt lgkmcnt(6)
    s_waitcnt vmcnt(11)
    v_mfma_f32_32x32x16_bf16 v[160:175], v[28:31], v[200:203], v[160:175]
    ds_read_b128 v[196:199], v13 offset:6144
    buffer_load_dwordx4 v[76:79], v1, s[4:7], s31 offen offset:3072
    s_add_u32 s31, s31, 4096
    s_waitcnt lgkmcnt(6)
    v_mfma_f32_32x32x16_bf16 v[144:159], v[28:31], v[204:207], v[144:159]
    ds_read_b128 v[200:203], v14 offset:7168
    buffer_load_dwordx4 v[80:83], v1, s[4:7], s31 offen offset:0
    s_waitcnt lgkmcnt(6)
    s_waitcnt vmcnt(12)
    v_mfma_f32_32x32x16_bf16 v[160:175], v[32:35], v[176:179], v[160:175]
    ds_read_b128 v[204:207], v13 offset:7168
    buffer_load_dwordx4 v[84:87], v1, s[4:7], s31 offen offset:1024
    s_waitcnt lgkmcnt(6)
    v_mfma_f32_32x32x16_bf16 v[144:159], v[32:35], v[180:183], v[144:159]
    ds_read_b128 v[176:179], v14 offset:8192
    buffer_load_dword v4, v3, s[4:7], s34 offen
    s_waitcnt lgkmcnt(6)
    s_waitcnt vmcnt(13)
    v_mfma_f32_32x32x16_bf16 v[160:175], v[36:39], v[184:187], v[160:175]
    ds_read_b128 v[180:183], v13 offset:8192
    buffer_load_dwordx4 v[104:107], v1, s[4:7], s33 offen offset:0
    s_waitcnt lgkmcnt(6)
    v_mfma_f32_32x32x16_bf16 v[144:159], v[36:39], v[188:191], v[144:159]
    ds_read_b128 v[184:187], v14 offset:9216
    buffer_load_dwordx4 v[108:111], v1, s[4:7], s33 offen offset:1024
    s_add_u32 s33, s33, 2359296
    s_waitcnt lgkmcnt(6)
    s_waitcnt vmcnt(14)
    v_mfma_f32_32x32x16_bf16 v[160:175], v[40:43], v[192:195], v[160:175]
    ds_read_b128 v[188:191], v13 offset:9216
    buffer_load_dwordx4 v[112:115], v1, s[4:7], s33 offen offset:0
    s_waitcnt lgkmcnt(6)
    v_mfma_f32_32x32x16_bf16 v[144:159], v[40:43], v[196:199], v[144:159]
    ds_read_b128 v[192:195], v14 offset:10240
    buffer_load_dwordx4 v[116:119], v1, s[4:7], s33 offen offset:1024
    s_add_u32 s33, s33, 2359296
    s_waitcnt lgkmcnt(6)
    s_waitcnt vmcnt(15)
    v_mfma_f32_32x32x16_bf16 v[160:175], v[44:47], v[200:203], v[160:175]
    ds_read_b128 v[196:199], v13 offset:10240
    buffer_load_dwordx4 v[120:123], v1, s[4:7], s33 offen offset:0
    s_waitcnt lgkmcnt(6)
    v_mfma_f32_32x32x16_bf16 v[144:159], v[44:47], v[204:207], v[144:159]
    ds_read_b128 v[200:203], v14 offset:11264
    buffer_load_dwordx4 v[124:127], v1, s[4:7], s33 offen offset:1024
    s_add_u32 s33, s33, 2359296
    s_waitcnt lgkmcnt(6)
    s_waitcnt vmcnt(16)
    v_mfma_f32_32x32x16_bf16 v[160:175], v[48:51], v[176:179], v[160:175]
    ds_read_b128 v[204:207], v13 offset:11264
    buffer_load_dwordx4 v[128:131], v1, s[4:7], s33 offen offset:0
    s_waitcnt lgkmcnt(6)
    v_mfma_f32_32x32x16_bf16 v[144:159], v[48:51], v[180:183], v[144:159]
    ds_read_b128 v[176:179], v14 offset:12288
    buffer_load_dwordx4 v[132:135], v1, s[4:7], s33 offen offset:1024
    s_add_u32 s33, s33, 2359296
    s_waitcnt lgkmcnt(6)
    s_waitcnt vmcnt(17)
    v_mfma_f32_32x32x16_bf16 v[160:175], v[52:55], v[184:187], v[160:175]
    ds_read_b128 v[180:183], v13 offset:12288
    buffer_load_dwordx4 v[136:139], v1, s[4:7], s33 offen offset:0
    s_waitcnt lgkmcnt(6)
    v_mfma_f32_32x32x16_bf16 v[144:159], v[52:55], v[188:191], v[144:159]
    ds_read_b128 v[184:187], v14 offset:13312
    buffer_load_dwordx4 v[140:143], v1, s[4:7], s33 offen offset:1024
    s_add_u32 s33, s33, 2359296
    s_waitcnt lgkmcnt(6)
    s_waitcnt vmcnt(18)
    v_mfma_f32_32x32x16_bf16 v[160:175], v[56:59], v[192:195], v[160:175]
    ds_read_b128 v[188:191], v13 offset:13312
    s_waitcnt lgkmcnt(6)
    v_mfma_f32_32x32x16_bf16 v[144:159], v[56:59], v[196:199], v[144:159]
    ds_read_b128 v[192:195], v14 offset:14336
    s_waitcnt lgkmcnt(6)
    s_waitcnt vmcnt(17)
    v_mfma_f32_32x32x16_bf16 v[160:175], v[60:63], v[200:203], v[160:175]
    ds_read_b128 v[196:199], v13 offset:14336
    s_waitcnt lgkmcnt(6)
    v_mfma_f32_32x32x16_bf16 v[144:159], v[60:63], v[204:207], v[144:159]
    ds_read_b128 v[200:203], v14 offset:15360
    s_waitcnt lgkmcnt(6)
    s_waitcnt vmcnt(16)
    v_mfma_f32_32x32x16_bf16 v[160:175], v[64:67], v[176:179], v[160:175]
    ds_read_b128 v[204:207], v13 offset:15360
    s_waitcnt lgkmcnt(6)
    v_mfma_f32_32x32x16_bf16 v[144:159], v[64:67], v[180:183], v[144:159]
    ds_read_b128 v[176:179], v14 offset:16384
    s_waitcnt lgkmcnt(6)
    s_waitcnt vmcnt(15)
    v_mfma_f32_32x32x16_bf16 v[160:175], v[68:71], v[184:187], v[160:175]
    ds_read_b128 v[180:183], v13 offset:16384
    s_waitcnt lgkmcnt(6)
    v_mfma_f32_32x32x16_bf16 v[144:159], v[68:71], v[188:191], v[144:159]
    ds_read_b128 v[184:187], v14 offset:17408
    s_waitcnt lgkmcnt(6)
    s_waitcnt vmcnt(14)
    v_mfma_f32_32x32x16_bf16 v[160:175], v[72:75], v[192:195], v[160:175]
    ds_read_b128 v[188:191], v13 offset:17408
    s_waitcnt lgkmcnt(6)
    v_mfma_f32_32x32x16_bf16 v[144:159], v[72:75], v[196:199], v[144:159]
    s_waitcnt lgkmcnt(5)
    s_waitcnt vmcnt(13)
    v_mfma_f32_32x32x16_bf16 v[160:175], v[76:79], v[200:203], v[160:175]
    s_waitcnt lgkmcnt(4)
    v_mfma_f32_32x32x16_bf16 v[144:159], v[76:79], v[204:207], v[144:159]
    s_waitcnt lgkmcnt(3)
    s_waitcnt vmcnt(12)
    v_mfma_f32_32x32x16_bf16 v[160:175], v[80:83], v[176:179], v[160:175]
    s_waitcnt lgkmcnt(2)
    v_mfma_f32_32x32x16_bf16 v[144:159], v[80:83], v[180:183], v[144:159]
    s_waitcnt lgkmcnt(1)
    s_waitcnt vmcnt(11)
    v_mfma_f32_32x32x16_bf16 v[160:175], v[84:87], v[184:187], v[160:175]
    s_waitcnt lgkmcnt(0)
    v_mfma_f32_32x32x16_bf16 v[144:159], v[84:87], v[188:191], v[144:159]
    s_nop 9
    ds_write_b128 v6, v[160:163] offset:0
    ds_write_b128 v6, v[164:167] offset:1024
    ds_write_b128 v6, v[168:171] offset:2048
    ds_write_b128 v6, v[172:175] offset:3072
    s_waitcnt lgkmcnt(0)
    s_barrier
    ds_read_b128 v[176:179], v7 offset:0
    ds_read_b128 v[180:183], v7 offset:1024
    ds_read_b128 v[184:187], v7 offset:2048
    ds_read_b128 v[188:191], v7 offset:3072
    s_waitcnt vmcnt(8)
    v_mfma_f32_32x32x16_bf16 v[88:103], v[208:211], v[104:107], 0
    v_mfma_f32_32x32x16_bf16 v[88:103], v[212:215], v[108:111], v[88:103]
    s_waitcnt vmcnt(6)
    v_mfma_f32_32x32x16_bf16 v[88:103], v[208:211], v[112:115], v[88:103]
    v_mfma_f32_32x32x16_bf16 v[88:103], v[212:215], v[116:119], v[88:103]
    s_waitcnt vmcnt(4)
    v_mfma_f32_32x32x16_bf16 v[88:103], v[208:211], v[120:123], v[88:103]
    v_mfma_f32_32x32x16_bf16 v[88:103], v[212:215], v[124:127], v[88:103]
    s_waitcnt vmcnt(2)
    v_mfma_f32_32x32x16_bf16 v[88:103], v[208:211], v[128:131], v[88:103]
    v_mfma_f32_32x32x16_bf16 v[88:103], v[212:215], v[132:135], v[88:103]
    s_waitcnt vmcnt(0)
    v_mfma_f32_32x32x16_bf16 v[88:103], v[208:211], v[136:139], v[88:103]
    v_mfma_f32_32x32x16_bf16 v[88:103], v[212:215], v[140:143], v[88:103]
    v_sub_f32 v11, 1.0, v4
    s_waitcnt lgkmcnt(0)
    v_add_f32 v144, v144, v176
    v_add_f32 v145, v145, v177
    v_add_f32 v146, v146, v178
    v_add_f32 v147, v147, v179
    v_add_f32 v148, v148, v180
    v_add_f32 v149, v149, v181
    v_add_f32 v150, v150, v182
    v_add_f32 v151, v151, v183
    v_add_f32 v152, v152, v184
    v_add_f32 v153, v153, v185
    v_add_f32 v154, v154, v186
    v_add_f32 v155, v155, v187
    v_add_f32 v156, v156, v188
    v_add_f32 v157, v157, v189
    v_add_f32 v158, v158, v190
    v_add_f32 v159, v159, v191
    v_mul_f32 v144, v144, v4
    v_mul_f32 v145, v145, v4
    v_mul_f32 v146, v146, v4
    v_mul_f32 v147, v147, v4
    v_mul_f32 v148, v148, v4
    v_mul_f32 v149, v149, v4
    v_mul_f32 v150, v150, v4
    v_mul_f32 v151, v151, v4
    v_mul_f32 v152, v152, v4
    v_mul_f32 v153, v153, v4
    v_mul_f32 v154, v154, v4
    v_mul_f32 v155, v155, v4
    v_mul_f32 v156, v156, v4
    v_mul_f32 v157, v157, v4
    v_mul_f32 v158, v158, v4
    v_mul_f32 v159, v159, v4
    v_fmac_f32 v144, v88, v11
    v_fmac_f32 v145, v89, v11
    v_fmac_f32 v146, v90, v11
    v_fmac_f32 v147, v91, v11
    v_fmac_f32 v148, v92, v11
    v_fmac_f32 v149, v93, v11
    v_fmac_f32 v150, v94, v11
    v_fmac_f32 v151, v95, v11
    v_fmac_f32 v152, v96, v11
    v_fmac_f32 v153, v97, v11
    v_fmac_f32 v154, v98, v11
    v_fmac_f32 v155, v99, v11
    v_fmac_f32 v156, v100, v11
    v_fmac_f32 v157, v101, v11
    v_fmac_f32 v158, v102, v11
    v_fmac_f32 v159, v103, v11
    v_cvt_pk_bf16_f32 v16, v144, v145
    v_cvt_pk_bf16_f32 v17, v146, v147
    v_cvt_pk_bf16_f32 v18, v148, v149
    v_cvt_pk_bf16_f32 v19, v150, v151
    v_cvt_pk_bf16_f32 v20, v152, v153
    v_cvt_pk_bf16_f32 v21, v154, v155
    v_cvt_pk_bf16_f32 v22, v156, v157
    v_cvt_pk_bf16_f32 v23, v158, v159
    v_permlane32_swap_b32 v16, v18
    v_permlane32_swap_b32 v17, v19
    v_permlane32_swap_b32 v20, v22
    v_permlane32_swap_b32 v21, v23
    buffer_store_dwordx4 v[16:19], v9, s[8:11], s35 offen offset:0
    buffer_store_dwordx4 v[20:23], v9, s[8:11], s35 offen offset:32
L3_END:
    s_endpgm
.section .rodata,"a"
.p2align 6
.amdhsa_kernel l1_kernel
  .amdhsa_next_free_vgpr 256
  .amdhsa_next_free_sgpr 102
  .amdhsa_accum_offset 256
  .amdhsa_group_segment_fixed_size 0
  .amdhsa_kernarg_size 88
  .amdhsa_user_sgpr_count 2
  .amdhsa_user_sgpr_kernarg_segment_ptr 1
  .amdhsa_system_sgpr_workgroup_id_x 1
.end_amdhsa_kernel
.amdhsa_kernel l2_kernel
  .amdhsa_next_free_vgpr 256
  .amdhsa_next_free_sgpr 102
  .amdhsa_accum_offset 256
  .amdhsa_group_segment_fixed_size 0
  .amdhsa_kernarg_size 88
  .amdhsa_user_sgpr_count 2
  .amdhsa_user_sgpr_kernarg_segment_ptr 1
  .amdhsa_system_sgpr_workgroup_id_x 1
.end_amdhsa_kernel
.amdhsa_kernel l3_kernel
  .amdhsa_next_free_vgpr 216
  .amdhsa_next_free_sgpr 102
  .amdhsa_accum_offset 216
  .amdhsa_group_segment_fixed_size 0
  .amdhsa_kernarg_size 88
  .amdhsa_user_sgpr_count 2
  .amdhsa_user_sgpr_kernarg_segment_ptr 1
  .amdhsa_system_sgpr_workgroup_id_x 1
.end_amdhsa_kernel
```
